```python
import torch

def _softmax(x, axis=-1):
    return torch.softmax(x, dim=axis)
def _gelu(x):
    return torch.nn.functional.gelu(x, approximate="tanh")
def _silu(x):
    return torch.nn.functional.silu(x)
def _sigmoid(x):
    return torch.sigmoid(x)
def _layernorm(x, axis=-1, eps=1e-5):
    m = x.mean(dim=axis, keepdim=True)
    v = x.var(dim=axis, keepdim=True, unbiased=False)
    return (x - m) / torch.sqrt(v + eps)
def _scatter_add(tgt, idx, src, axis=0):
    return tgt.clone().index_add_(axis, idx, src)
def _segment_sum(src, seg, n):
    out = torch.zeros((n,) + src.shape[1:], dtype=src.dtype)
    return out.index_add_(0, seg, src)
def _pad(x, pw):
    flat = tuple(v for pair in reversed(pw) for v in pair)
    return torch.nn.functional.pad(x, flat)

kernel_name = 'recurrent_scan__sliding_block_cached__dense_activation_squared_relu__prompt'

def setup_inputs():

    _w = (lambda a: (lambda t: t.to(torch.bfloat16) if t.is_floating_point() else t)(torch.as_tensor(a)))
    def _A_setup():
        B, Sq, D = 1, 2048, 640
        Hq, Hkv, Sk, Dh = 32, 32, 2048, 192
        assert Hq % Hkv == 0, (Hq, Hkv)
        return {
            "x": _w((lambda *s: torch.randn(*s, dtype=torch.bfloat16) * 0.05)(B, Sq, D)),
            "k_cache": _w((lambda *s: torch.randn(*s, dtype=torch.bfloat16) * 0.8)(B, Hkv, Sk, Dh)),
            "v_cache": _w((lambda *s: torch.randn(*s, dtype=torch.bfloat16) * 0.2)(B, Hkv, Sk, Dh)),
            "wq": _w((lambda *s: torch.randn(*s, dtype=torch.bfloat16) * 0.8)(D, Hq * Dh) * (D ** -0.5)),
            "wo": _w((lambda *s: torch.randn(*s, dtype=torch.bfloat16) * 0.2)(Hq * Dh, D) * ((Hq * Dh) ** -0.5)),
        }
    _A_in = _A_setup()

    def _B_setup():
        B, S, D, F = 1, 2048, 640, 1536
        return {
            "x": _w((lambda *s: torch.randn(*s, dtype=torch.bfloat16) * 0.05)(B, S, D)),
            "w1": _w((lambda *s: torch.randn(*s, dtype=torch.bfloat16) * 0.1)(D, F)),
            "b1": _w((lambda *s: torch.randn(*s, dtype=torch.bfloat16) * 0.8)(F)),
            "w2": _w((lambda *s: torch.randn(*s, dtype=torch.bfloat16) * 0.1)(F, D)),
            "b2": _w((lambda *s: torch.randn(*s, dtype=torch.bfloat16) * 12.8)(D)),
        }
    _B_in = _B_setup()

    return {
        "A_x": _A_in["x"],
        "A_k_cache": _A_in["k_cache"],
        "A_v_cache": _A_in["v_cache"],
        "A_wq": _A_in["wq"],
        "A_wo": _A_in["wo"],
        "B_x": _B_in["x"],
        "B_w1": _B_in["w1"],
        "B_b1": _B_in["b1"],
        "B_w2": _B_in["w2"],
        "B_b2": _B_in["b2"],
    }

def reference(A_x, A_k_cache, A_v_cache, A_wq, A_wo, B_x, B_w1, B_b1, B_w2, B_b2):
    def _A_ref(x, k_cache, v_cache, wq, wo):
        B, Sq, D = x.shape
        Hq, Dh = 32, 192
        Hkv, Sk = k_cache.shape[1], k_cache.shape[2]
        W = min(4096, max(256, Sk // 4))
        rep = Hq // Hkv
        q = (lambda x, *d: x.permute(*d))((x @ wq).reshape(B, Sq, Hq, Dh), 0, 2, 1, 3)
        k = (lambda x, n, axis: torch.repeat_interleave(x, n, dim=axis))(k_cache[:, :, Sk - W:, :], rep, axis=1)
        v = (lambda x, n, axis: torch.repeat_interleave(x, n, dim=axis))(v_cache[:, :, Sk - W:, :], rep, axis=1)
        scores = torch.einsum("bhqd,bhkd->bhqk", q, k) * (Dh ** -0.5)
        p = _softmax(scores, axis=-1)
        o = torch.einsum("bhqk,bhkd->bhqd", p, v)
        return (lambda x, *d: x.permute(*d))(o, 0, 2, 1, 3).reshape(B, Sq, Hq * Dh) @ wo

    def _B_ref(x, w1, b1, w2, b2):
        h = torch.einsum("bsd,df->bsf", x, w1) + b1
        zero = torch.zeros_like(h)
        r = torch.where(h > zero, h, zero)
        h = r * r
        out = torch.einsum("bsf,fd->bsd", h, w2) + b2
        return out

    x = A_x
    xn = _layernorm(x, axis=-1)
    s = _A_ref(xn, A_k_cache, A_v_cache, A_wq, A_wo)
    g = _silu(_B_ref(xn, B_w1, B_b1, B_w2, B_b2))
    return x + s * g
```

```asm
; @launch grid=(256,1,1) block=(256,1,1) lds=163840
.amdgcn_target "amdgcn-amd-amdhsa--gfx950"
.text
.globl recurrent_scan__sliding_block_cached__dense_activation_squared_relu__prompt_kernel
.p2align 8
.type recurrent_scan__sliding_block_cached__dense_activation_squared_relu__prompt_kernel,@function
recurrent_scan__sliding_block_cached__dense_activation_squared_relu__prompt_kernel:
s_cmp_ge_u32 s2, 256
s_cbranch_scc1 K1END
s_load_dwordx16 s[64:79], s[0:1], 0
s_load_dwordx8 s[80:87], s[0:1], 64
s_load_dwordx2 s[88:89], s[0:1], 96
v_lshrrev_b32 v1, 6, v0
s_nop 0
v_readfirstlane_b32 s3, v1
v_mov_b32 v64, v0
v_and_b32 v0, 63, v0
s_and_b32 s4, s2, 7
s_bfe_u32 s5, s2, 0x20003
s_lshr_b32 s6, s2, 5
v_and_b32 v66, 7, v64
v_lshrrev_b32 v67, 3, v64
s_lshl_b32 s63, s2, 3
v_add_u32 v68, s63, v66
v_mul_u32_u24 v69, 1280, v68
v_lshl_add_u32 v70, v67, 4, v69
s_mov_b32 s55, 1073741824
s_cmp_lt_u32 s3, 2
s_cselect_b32 s55, 0, s55
v_add_u32 v71, s55, v70
s_and_b32 s63, s2, 31
s_cselect_b32 s93, 1073741824, 0
s_lshl_b32 s63, s2, 7
s_add_u32 s63, s63, s93
s_add_u32 s63, s63, 67108864
v_lshl_add_u32 v130, v64, 4, s63
v_mov_b32 v132, 0
v_mov_b32 v133, 0
v_mov_b32 v134, 0
v_mov_b32 v135, 0
s_waitcnt lgkmcnt(0)
s_mov_b32 s36, s64
s_mov_b32 s37, s65
s_mov_b32 s38, 2621440
s_mov_b32 s39, 0x20000
s_mov_b32 s12, s88
s_mov_b32 s13, s89
s_mov_b32 s14, 117440512
s_mov_b32 s15, 0x20000
buffer_load_dwordx4 v[76:79], v70, s[36:39], 0 offen
buffer_load_dwordx4 v[80:83], v70, s[36:39], 0 offen offset:512
buffer_load_dwordx4 v[84:87], v71, s[36:39], 0 offen offset:1024
buffer_load_ushort v72, v69, s[36:39], 0 offen
buffer_store_dwordx4 v[132:135], v130, s[12:15], 0 offen sc1
v_lshrrev_b32 v73, 5, v68
v_mul_u32_u24 v73, 40960, v73
v_and_b32 v74, 31, v68
v_lshl_add_u32 v73, v74, 4, v73
v_lshl_add_u32 v73, v67, 9, v73
v_add_u32 v75, s55, v73
v_lshl_add_u32 v120, v66, 3, 16
v_add_u32 v120, 65520, v120
s_lshl_b32 s63, s3, 6
v_add_u32 v121, s63, v120
s_lshl_b32 s63, s6, 4
s_add_u32 s63, s63, 128
v_mov_b32 v136, s63
s_add_u32 s63, s63, s93
s_lshl_b32 s93, s3, 2
s_add_u32 s63, s63, s93
v_mov_b32 v131, 1073741824
v_mov_b32 v137, s63
v_and_b32 v138, 63, v64
v_cmp_eq_u32 vcc, 0, v138
v_cndmask_b32 v137, v131, v137, vcc
s_add_u32 s95, s93, 67108864
s_lshl_b32 s63, s2, 7
s_add_u32 s63, s63, s95
v_mov_b32 v138, s63
v_cndmask_b32 v138, v131, v138, vcc
v_mov_b32 v139, 1
s_lshl_b32 s7, s4, 2
s_add_u32 s7, s7, s5
s_and_b32 s58, s5, 1
s_mul_i32 s59, s7, 384
s_lshl_b32 s60, s3, 7
s_add_u32 s59, s59, s60
s_lshr_b32 s60, s7, 1
s_mul_i32 s60, s60, 192
s_lshl_b32 s61, s58, 6
s_add_u32 s61, s60, s61
s_and_b32 s62, s5, 0
s_mul_i32 s62, s62, 5
s_and_b32 s63, s6, 6
s_mul_i32 s63, s63, 5
s_lshr_b32 s63, s63, 1
s_add_u32 s62, s62, s63
s_sub_u32 s63, s62, 20
s_cmp_ge_u32 s62, 20
s_cselect_b32 s62, s63, s62
s_lshl_b32 s48, s62, 11
s_lshl_b32 s47, s3, 12
s_lshl_b32 s51, s3, 10
s_waitcnt lgkmcnt(0)
s_cmp_eq_u32 s3, 3
s_cselect_b32 s8, s76, s70
s_cselect_b32 s9, s77, s71
s_cselect_b32 s59, s61, s59
s_mov_b32 s10, 7864320
s_cselect_b32 s10, 1966080, s10
s_mov_b32 s44, 12288
s_cselect_b32 s44, 3072, s44
s_cselect_b32 s63, s58, 0
s_mov_b32 s11, 0x20000
s_mov_b32 s46, s10
s_mov_b32 s12, s88
s_mov_b32 s13, s89
s_mov_b32 s14, 117440512
s_mov_b32 s15, 0x20000
v_lshrrev_b32 v18, 3, v0
v_and_b32 v19, 7, v0
v_lshlrev_b32 v20, 1, v18
v_and_b32 v20, 4, v20
v_xor_b32 v20, v19, v20
s_lshl_b32 s63, s63, 2
v_xor_b32 v21, s63, v20
v_mul_lo_u32 v1, v18, s44
v_lshlrev_b32 v21, 4, v21
v_add3_u32 v1, v1, v21, s59
s_lshl_b32 s44, s44, 3
s_mul_i32 s45, s44, s62
s_lshl_b32 s45, s45, 2
s_lshl_b32 s90, s6, 3
s_lshl_b32 s91, s3, 1
s_add_u32 s90, s90, s91
s_add_u32 s91, s90, s58
s_xor_b32 s92, s91, 1
v_lshlrev_b32 v30, 4, v0
s_mul_i32 s63, s91, 40960
v_add_u32 v4, s63, v30
s_mul_i32 s63, s92, 40960
v_add_u32 v5, s63, v30
s_lshr_b32 s62, s2, 3
s_lshl_b32 s62, s62, 2
s_add_u32 s62, s62, s3
s_and_b32 s62, s62, 63
s_lshl_b32 s62, s62, 11
s_add_u32 s62, s62, 0
v_lshl_add_u32 v14, v0, 5, s62
v_min_u32 v14, RARE0-CP0, v14
v_mov_b32 v15, 0
s_getpc_b64 s[62:63]
CP0:
v_lshl_add_u64 v[14:15], v[14:15], 0, s[62:63]
global_load_dword a248, v[14:15], off
s_mov_b32 s32, s78
s_mov_b32 s33, s79
s_mov_b32 s34, 3072
s_mov_b32 s35, 0x20000
v_lshrrev_b32 v22, 5, v0
v_lshlrev_b32 v23, 4, v22
s_lshl_b32 s63, s58, 7
s_add_u32 s63, s63, s60
s_add_u32 s93, s60, 64
buffer_load_dwordx4 v[32:35], v23, s[32:35], s63 offen
buffer_load_dwordx4 v[36:39], v23, s[32:35], s63 offen offset:32
buffer_load_dwordx4 v[40:43], v23, s[32:35], s93 offen
buffer_load_dwordx4 v[44:47], v23, s[32:35], s93 offen offset:32
s_mul_i32 s63, s7, 786432
s_add_u32 s63, s63, 589824
s_add_u32 s16, s66, s63
s_addc_u32 s17, s67, 0
s_mov_b32 s18, 196608
s_mov_b32 s19, 0x20000
s_add_u32 s20, s68, s63
s_addc_u32 s21, s69, 0
s_mov_b32 s22, 196608
s_mov_b32 s23, 0x20000
s_mul_i32 s63, s5, 320
s_add_u32 s24, s72, s63
s_addc_u32 s25, s73, 0
s_mov_b32 s26, 7863360
s_mov_b32 s27, 0x20000
s_add_u32 s28, s80, s63
s_addc_u32 s29, s81, 0
s_mov_b32 s30, 1965120
s_mov_b32 s31, 0x20000
s_mov_b32 s36, s64
s_mov_b32 s37, s65
s_mov_b32 s38, 2621440
s_mov_b32 s39, 0x20000
s_mov_b32 s40, s84
s_mov_b32 s41, s85
s_mov_b32 s42, 2621440
s_mov_b32 s43, 0x20000
s_mov_b32 s96, s82
s_mov_b32 s97, s83
s_mov_b32 s98, 1280
s_mov_b32 s99, 0x20000
s_mul_i32 s49, s6, 24576
s_mov_b32 s50, s49
s_mov_b32 s52, 0x3dd53b95
s_mov_b32 s53, s52
s_mov_b32 s54, 0x4b800000
s_mov_b32 s56, 4096
s_mov_b32 s57, 8192
v_bfe_u32 v24, v0, 2, 2
v_bfe_u32 v25, v0, 4, 1
v_and_b32 v26, 1, v0
v_bfe_u32 v27, v0, 1, 1
v_lshl_add_u32 v26, v25, 1, v26
v_lshlrev_b32 v26, 4, v26
v_lshl_add_u32 v26, v27, 3, v26
v_lshl_add_u32 v28, v22, 3, v24
v_mul_u32_u24 v31, 320, v28
v_add_u32 v31, v31, v26
v_bfe_u32 v27, v0, 3, 1
v_lshl_add_u32 v26, v27, 6, v26
v_lshl_add_u32 v2, v28, 7, v26
v_xor_b32 v3, 64, v2
v_lshl_add_u32 v28, v22, 2, v24
v_lshl_add_u32 v12, v28, 7, v26
v_add_u32 v12, 0, v12
v_xor_b32 v13, 64, v12
v_and_b32 v24, 31, v0
v_bfe_u32 v25, v0, 1, 3
v_xor_b32 v25, v25, v22
v_lshlrev_b32 v25, 4, v25
v_lshl_add_u32 v8, v24, 7, v25
v_add_u32 v8, 65536, v8
v_xor_b32 v9, 32, v8
v_xor_b32 v10, 64, v8
v_xor_b32 v11, 0x60, v8
s_lshl_b32 s63, s3, 3
v_add_u32 v24, s63, v18
v_mul_u32_u24 v25, 384, v24
v_lshl_add_u32 v7, v20, 4, v25
v_bfe_u32 v24, v24, 1, 3
v_xor_b32 v24, v24, v19
v_lshl_add_u32 v6, v24, 4, v25
s_mul_i32 s63, s91, 397568
s_add_u32 s63, s63, 83886080
v_add_u32 v26, s63, v30
s_mul_i32 s63, s91, 98304
s_lshl_b32 s93, s60, 5
s_add_u32 s63, s63, s93
s_add_u32 s63, s63, 29360128
v_add_u32 v28, s63, v30
s_mul_i32 s63, s92, 397568
s_add_u32 s63, s63, 83886080
v_add_u32 v27, s63, v30
s_mul_i32 s63, s92, 98304
s_lshl_b32 s93, s60, 5
s_add_u32 s63, s63, s93
s_add_u32 s63, s63, 29360128
v_add_u32 v29, s63, v30
s_lshl_b32 s94, s58, 12
s_mov_b32 s32, s86
s_mov_b32 s33, s87
s_mov_b32 s34, 256
s_mov_b32 s35, 0x20000
s_waitcnt vmcnt(5)
buffer_store_dword v139, v137, s[32:35], 0 offen sc1
v_lshlrev_b32 v72, 16, v72
v_mov_b32 v114, 0
v_mov_b32 v115, 0
v_mov_b32 v118, 0
v_mov_b32 v119, 0
v_lshlrev_b32 v88, 16, v76
v_and_b32 v89, 0xffff0000, v76
v_lshlrev_b32 v90, 16, v77
v_and_b32 v91, 0xffff0000, v77
v_lshlrev_b32 v92, 16, v78
v_and_b32 v93, 0xffff0000, v78
v_lshlrev_b32 v94, 16, v79
v_and_b32 v95, 0xffff0000, v79
v_sub_f32 v116, v88, v72
v_sub_f32 v117, v89, v72
v_add_f32 v114, v114, v116
v_fmac_f32 v115, v116, v116
v_add_f32 v118, v118, v117
v_fmac_f32 v119, v117, v117
v_sub_f32 v116, v90, v72
v_sub_f32 v117, v91, v72
v_add_f32 v114, v114, v116
v_fmac_f32 v115, v116, v116
v_add_f32 v118, v118, v117
v_fmac_f32 v119, v117, v117
v_sub_f32 v116, v92, v72
v_sub_f32 v117, v93, v72
v_add_f32 v114, v114, v116
v_fmac_f32 v115, v116, v116
v_add_f32 v118, v118, v117
v_fmac_f32 v119, v117, v117
v_sub_f32 v116, v94, v72
v_sub_f32 v117, v95, v72
v_add_f32 v114, v114, v116
v_fmac_f32 v115, v116, v116
v_add_f32 v118, v118, v117
v_fmac_f32 v119, v117, v117
v_lshlrev_b32 v96, 16, v80
v_and_b32 v97, 0xffff0000, v80
v_lshlrev_b32 v98, 16, v81
v_and_b32 v99, 0xffff0000, v81
v_lshlrev_b32 v100, 16, v82
v_and_b32 v101, 0xffff0000, v82
v_lshlrev_b32 v102, 16, v83
v_and_b32 v103, 0xffff0000, v83
v_sub_f32 v116, v96, v72
v_sub_f32 v117, v97, v72
v_add_f32 v114, v114, v116
v_fmac_f32 v115, v116, v116
v_add_f32 v118, v118, v117
v_fmac_f32 v119, v117, v117
v_sub_f32 v116, v98, v72
v_sub_f32 v117, v99, v72
v_add_f32 v114, v114, v116
v_fmac_f32 v115, v116, v116
v_add_f32 v118, v118, v117
v_fmac_f32 v119, v117, v117
v_sub_f32 v116, v100, v72
v_sub_f32 v117, v101, v72
v_add_f32 v114, v114, v116
v_fmac_f32 v115, v116, v116
v_add_f32 v118, v118, v117
v_fmac_f32 v119, v117, v117
v_sub_f32 v116, v102, v72
v_sub_f32 v117, v103, v72
v_add_f32 v114, v114, v116
v_fmac_f32 v115, v116, v116
v_add_f32 v118, v118, v117
v_fmac_f32 v119, v117, v117
v_lshlrev_b32 v104, 16, v84
v_and_b32 v105, 0xffff0000, v84
v_lshlrev_b32 v106, 16, v85
v_and_b32 v107, 0xffff0000, v85
v_lshlrev_b32 v108, 16, v86
v_and_b32 v109, 0xffff0000, v86
v_lshlrev_b32 v110, 16, v87
v_and_b32 v111, 0xffff0000, v87
s_cmp_ge_u32 s3, 2
s_cbranch_scc1 LNSK
v_sub_f32 v116, v104, v72
v_sub_f32 v117, v105, v72
v_add_f32 v114, v114, v116
v_fmac_f32 v115, v116, v116
v_add_f32 v118, v118, v117
v_fmac_f32 v119, v117, v117
v_sub_f32 v116, v106, v72
v_sub_f32 v117, v107, v72
v_add_f32 v114, v114, v116
v_fmac_f32 v115, v116, v116
v_add_f32 v118, v118, v117
v_fmac_f32 v119, v117, v117
v_sub_f32 v116, v108, v72
v_sub_f32 v117, v109, v72
v_add_f32 v114, v114, v116
v_fmac_f32 v115, v116, v116
v_add_f32 v118, v118, v117
v_fmac_f32 v119, v117, v117
v_sub_f32 v116, v110, v72
v_sub_f32 v117, v111, v72
v_add_f32 v114, v114, v116
v_fmac_f32 v115, v116, v116
v_add_f32 v118, v118, v117
v_fmac_f32 v119, v117, v117
LNSK:
v_add_f32 v114, v114, v118
v_add_f32 v115, v115, v119
s_nop 0
v_add_f32_dpp v114, v114, v114 row_ror:8 row_mask:0xf bank_mask:0xf
v_add_f32_dpp v115, v115, v115 row_ror:8 row_mask:0xf bank_mask:0xf
v_mov_b32 v116, v114
v_mov_b32 v117, v115
s_nop 0
v_permlane16_swap_b32 v114, v116
v_permlane16_swap_b32 v115, v117
v_add_f32 v114, v114, v116
v_add_f32 v115, v115, v117
v_mov_b32 v116, v114
v_mov_b32 v117, v115
s_nop 0
v_permlane32_swap_b32 v114, v116
v_permlane32_swap_b32 v115, v117
v_add_f32 v114, v114, v116
v_add_f32 v115, v115, v117
ds_write_b64 v121, v[114:115]
s_waitcnt lgkmcnt(0)
s_barrier
ds_read_b64 v[122:123], v120 offset:0
ds_read_b64 v[124:125], v120 offset:64
ds_read_b64 v[126:127], v120 offset:128
ds_read_b64 v[128:129], v120 offset:192
s_waitcnt lgkmcnt(2)
v_add_f32 v114, v122, v124
v_add_f32 v115, v123, v125
s_waitcnt lgkmcnt(0)
v_add_f32 v116, v126, v128
v_add_f32 v117, v127, v129
v_add_f32 v114, v114, v116
v_add_f32 v115, v115, v117
v_mul_f32 v114, 0x3acccccd, v114
v_mul_f32 v115, 0x3acccccd, v115
v_fma_f32 v115, -v114, v114, v115
v_max_f32 v115, 0, v115
v_add_f32 v114, v114, v72
v_cvt_pk_bf16_f32 v114, v114, v114
v_lshlrev_b32 v114, 16, v114
v_cvt_pk_bf16_f32 v115, v115, v115
v_lshlrev_b32 v115, 16, v115
v_add_f32 v115, 0x3727c5ac, v115
v_cvt_pk_bf16_f32 v115, v115, v115
v_lshlrev_b32 v115, 16, v115
v_sqrt_f32 v115, v115
s_nop 0
v_cvt_pk_bf16_f32 v115, v115, v115
v_lshlrev_b32 v115, 16, v115
v_rcp_f32 v115, v115
v_sub_f32 v88, v88, v114
v_sub_f32 v89, v89, v114
v_cvt_pk_bf16_f32 v116, v88, v89
v_lshlrev_b32 v88, 16, v116
v_and_b32 v89, 0xffff0000, v116
v_mul_f32 v88, v88, v115
v_mul_f32 v89, v89, v115
v_cvt_pk_bf16_f32 v76, v88, v89
v_sub_f32 v90, v90, v114
v_sub_f32 v91, v91, v114
v_cvt_pk_bf16_f32 v116, v90, v91
v_lshlrev_b32 v90, 16, v116
v_and_b32 v91, 0xffff0000, v116
v_mul_f32 v90, v90, v115
v_mul_f32 v91, v91, v115
v_cvt_pk_bf16_f32 v77, v90, v91
v_sub_f32 v92, v92, v114
v_sub_f32 v93, v93, v114
v_cvt_pk_bf16_f32 v116, v92, v93
v_lshlrev_b32 v92, 16, v116
v_and_b32 v93, 0xffff0000, v116
v_mul_f32 v92, v92, v115
v_mul_f32 v93, v93, v115
v_cvt_pk_bf16_f32 v78, v92, v93
v_sub_f32 v94, v94, v114
v_sub_f32 v95, v95, v114
v_cvt_pk_bf16_f32 v116, v94, v95
v_lshlrev_b32 v94, 16, v116
v_and_b32 v95, 0xffff0000, v116
v_mul_f32 v94, v94, v115
v_mul_f32 v95, v95, v115
v_cvt_pk_bf16_f32 v79, v94, v95
s_mov_b32 s63, 0
buffer_store_dwordx4 v[76:79], v73, s[12:15], s63 offen sc1
v_sub_f32 v96, v96, v114
v_sub_f32 v97, v97, v114
v_cvt_pk_bf16_f32 v116, v96, v97
v_lshlrev_b32 v96, 16, v116
v_and_b32 v97, 0xffff0000, v116
v_mul_f32 v96, v96, v115
v_mul_f32 v97, v97, v115
v_cvt_pk_bf16_f32 v80, v96, v97
v_sub_f32 v98, v98, v114
v_sub_f32 v99, v99, v114
v_cvt_pk_bf16_f32 v116, v98, v99
v_lshlrev_b32 v98, 16, v116
v_and_b32 v99, 0xffff0000, v116
v_mul_f32 v98, v98, v115
v_mul_f32 v99, v99, v115
v_cvt_pk_bf16_f32 v81, v98, v99
v_sub_f32 v100, v100, v114
v_sub_f32 v101, v101, v114
v_cvt_pk_bf16_f32 v116, v100, v101
v_lshlrev_b32 v100, 16, v116
v_and_b32 v101, 0xffff0000, v116
v_mul_f32 v100, v100, v115
v_mul_f32 v101, v101, v115
v_cvt_pk_bf16_f32 v82, v100, v101
v_sub_f32 v102, v102, v114
v_sub_f32 v103, v103, v114
v_cvt_pk_bf16_f32 v116, v102, v103
v_lshlrev_b32 v102, 16, v116
v_and_b32 v103, 0xffff0000, v116
v_mul_f32 v102, v102, v115
v_mul_f32 v103, v103, v115
v_cvt_pk_bf16_f32 v83, v102, v103
s_mov_b32 s63, 16384
buffer_store_dwordx4 v[80:83], v73, s[12:15], s63 offen sc1
v_sub_f32 v104, v104, v114
v_sub_f32 v105, v105, v114
v_cvt_pk_bf16_f32 v116, v104, v105
v_lshlrev_b32 v104, 16, v116
v_and_b32 v105, 0xffff0000, v116
v_mul_f32 v104, v104, v115
v_mul_f32 v105, v105, v115
v_cvt_pk_bf16_f32 v84, v104, v105
v_sub_f32 v106, v106, v114
v_sub_f32 v107, v107, v114
v_cvt_pk_bf16_f32 v116, v106, v107
v_lshlrev_b32 v106, 16, v116
v_and_b32 v107, 0xffff0000, v116
v_mul_f32 v106, v106, v115
v_mul_f32 v107, v107, v115
v_cvt_pk_bf16_f32 v85, v106, v107
v_sub_f32 v108, v108, v114
v_sub_f32 v109, v109, v114
v_cvt_pk_bf16_f32 v116, v108, v109
v_lshlrev_b32 v108, 16, v116
v_and_b32 v109, 0xffff0000, v116
v_mul_f32 v108, v108, v115
v_mul_f32 v109, v109, v115
v_cvt_pk_bf16_f32 v86, v108, v109
v_sub_f32 v110, v110, v114
v_sub_f32 v111, v111, v114
v_cvt_pk_bf16_f32 v116, v110, v111
v_lshlrev_b32 v110, 16, v116
v_and_b32 v111, 0xffff0000, v116
v_mul_f32 v110, v110, v115
v_mul_f32 v111, v111, v115
v_cvt_pk_bf16_f32 v87, v110, v111
s_mov_b32 s63, 32768
buffer_store_dwordx4 v[84:87], v75, s[12:15], s63 offen sc1
buffer_load_dwordx4 v[132:135], v136, s[32:35], 0 offen sc1
s_waitcnt vmcnt(8)
v_lshlrev_b32 v24, 16, v32
v_and_b32 v25, 0xffff0000, v32
v_accvgpr_write_b32 a192, v24
v_accvgpr_write_b32 a193, v25
v_lshlrev_b32 v24, 16, v33
v_and_b32 v25, 0xffff0000, v33
v_accvgpr_write_b32 a194, v24
v_accvgpr_write_b32 a195, v25
v_lshlrev_b32 v24, 16, v34
v_and_b32 v25, 0xffff0000, v34
v_accvgpr_write_b32 a196, v24
v_accvgpr_write_b32 a197, v25
v_lshlrev_b32 v24, 16, v35
v_and_b32 v25, 0xffff0000, v35
v_accvgpr_write_b32 a198, v24
v_accvgpr_write_b32 a199, v25
s_waitcnt vmcnt(7)
v_lshlrev_b32 v24, 16, v36
v_and_b32 v25, 0xffff0000, v36
v_accvgpr_write_b32 a200, v24
v_accvgpr_write_b32 a201, v25
v_lshlrev_b32 v24, 16, v37
v_and_b32 v25, 0xffff0000, v37
v_accvgpr_write_b32 a202, v24
v_accvgpr_write_b32 a203, v25
v_lshlrev_b32 v24, 16, v38
v_and_b32 v25, 0xffff0000, v38
v_accvgpr_write_b32 a204, v24
v_accvgpr_write_b32 a205, v25
v_lshlrev_b32 v24, 16, v39
v_and_b32 v25, 0xffff0000, v39
v_accvgpr_write_b32 a206, v24
v_accvgpr_write_b32 a207, v25
v_lshlrev_b32 v24, 16, v32
v_and_b32 v25, 0xffff0000, v32
v_accvgpr_write_b32 a208, v24
v_accvgpr_write_b32 a209, v25
v_lshlrev_b32 v24, 16, v33
v_and_b32 v25, 0xffff0000, v33
v_accvgpr_write_b32 a210, v24
v_accvgpr_write_b32 a211, v25
v_lshlrev_b32 v24, 16, v34
v_and_b32 v25, 0xffff0000, v34
v_accvgpr_write_b32 a212, v24
v_accvgpr_write_b32 a213, v25
v_lshlrev_b32 v24, 16, v35
v_and_b32 v25, 0xffff0000, v35
v_accvgpr_write_b32 a214, v24
v_accvgpr_write_b32 a215, v25
v_lshlrev_b32 v24, 16, v36
v_and_b32 v25, 0xffff0000, v36
v_accvgpr_write_b32 a216, v24
v_accvgpr_write_b32 a217, v25
v_lshlrev_b32 v24, 16, v37
v_and_b32 v25, 0xffff0000, v37
v_accvgpr_write_b32 a218, v24
v_accvgpr_write_b32 a219, v25
v_lshlrev_b32 v24, 16, v38
v_and_b32 v25, 0xffff0000, v38
v_accvgpr_write_b32 a220, v24
v_accvgpr_write_b32 a221, v25
v_lshlrev_b32 v24, 16, v39
v_and_b32 v25, 0xffff0000, v39
v_accvgpr_write_b32 a222, v24
v_accvgpr_write_b32 a223, v25
s_waitcnt vmcnt(6)
v_lshlrev_b32 v24, 16, v40
v_and_b32 v25, 0xffff0000, v40
v_accvgpr_write_b32 a224, v24
v_accvgpr_write_b32 a225, v25
v_lshlrev_b32 v24, 16, v41
v_and_b32 v25, 0xffff0000, v41
v_accvgpr_write_b32 a226, v24
v_accvgpr_write_b32 a227, v25
v_lshlrev_b32 v24, 16, v42
v_and_b32 v25, 0xffff0000, v42
v_accvgpr_write_b32 a228, v24
v_accvgpr_write_b32 a229, v25
v_lshlrev_b32 v24, 16, v43
v_and_b32 v25, 0xffff0000, v43
v_accvgpr_write_b32 a230, v24
v_accvgpr_write_b32 a231, v25
s_waitcnt vmcnt(5)
v_lshlrev_b32 v24, 16, v44
v_and_b32 v25, 0xffff0000, v44
v_accvgpr_write_b32 a232, v24
v_accvgpr_write_b32 a233, v25
v_lshlrev_b32 v24, 16, v45
v_and_b32 v25, 0xffff0000, v45
v_accvgpr_write_b32 a234, v24
v_accvgpr_write_b32 a235, v25
v_lshlrev_b32 v24, 16, v46
v_and_b32 v25, 0xffff0000, v46
v_accvgpr_write_b32 a236, v24
v_accvgpr_write_b32 a237, v25
v_lshlrev_b32 v24, 16, v47
v_and_b32 v25, 0xffff0000, v47
v_accvgpr_write_b32 a238, v24
v_accvgpr_write_b32 a239, v25
s_waitcnt vmcnt(0)
v_and_b32 v132, v132, v133
v_and_b32 v134, v134, v135
v_and_b32 v132, v132, v134
v_cmp_ne_u32 vcc, 1, v132
s_cbranch_vccnz SLOWG
GOG:
s_cmp_eq_u32 s3, 0
s_cselect_b32 s62, 0, 1073741824
v_or_b32 v138, s62, v138
s_barrier
buffer_store_dword v139, v138, s[12:15], 0 offen sc1
s_add_u32 m0, s47, 0
s_nop 0
buffer_load_dwordx4 v1, s[8:11], s45 offen lds
s_add_u32 s45, s45, s44
s_add_u32 m0, s47, 1024
s_nop 0
buffer_load_dwordx4 v1, s[8:11], s45 offen lds
s_add_u32 s45, s45, s44
s_add_u32 m0, s47, 2048
s_nop 0
buffer_load_dwordx4 v1, s[8:11], s45 offen lds
s_add_u32 s45, s45, s44
s_add_u32 m0, s47, 3072
s_nop 0
buffer_load_dwordx4 v1, s[8:11], s45 offen lds
s_add_u32 s45, s45, s44
s_cmp_ge_u32 s45, s46
s_cselect_b32 s45, 0, s45
s_add_u32 m0, s47, 16384
s_nop 0
buffer_load_dwordx4 v1, s[8:11], s45 offen lds
s_add_u32 s45, s45, s44
s_add_u32 m0, s47, 17408
s_nop 0
buffer_load_dwordx4 v1, s[8:11], s45 offen lds
s_add_u32 s45, s45, s44
s_add_u32 m0, s47, 18432
s_nop 0
buffer_load_dwordx4 v1, s[8:11], s45 offen lds
s_add_u32 s45, s45, s44
s_add_u32 m0, s47, 19456
s_nop 0
buffer_load_dwordx4 v1, s[8:11], s45 offen lds
s_add_u32 s45, s45, s44
s_cmp_ge_u32 s45, s46
s_cselect_b32 s45, 0, s45
s_add_u32 m0, s47, 32768
s_nop 0
buffer_load_dwordx4 v1, s[8:11], s45 offen lds
s_add_u32 s45, s45, s44
s_add_u32 m0, s47, 33792
s_nop 0
buffer_load_dwordx4 v1, s[8:11], s45 offen lds
s_add_u32 s45, s45, s44
s_add_u32 m0, s47, 34816
s_nop 0
buffer_load_dwordx4 v1, s[8:11], s45 offen lds
s_add_u32 s45, s45, s44
s_add_u32 m0, s47, 35840
s_nop 0
buffer_load_dwordx4 v1, s[8:11], s45 offen lds
s_add_u32 s45, s45, s44
s_cmp_ge_u32 s45, s46
s_cselect_b32 s45, 0, s45
s_cmp_eq_u32 s3, 0
s_cselect_b32 s93, 1, 0
s_cselect_b32 s62, 0, 1073741824
s_and_b32 s63, s2, 0xe0
v_and_b32 v24, 31, v0
v_add_u32 v24, s63, v24
v_lshlrev_b32 v24, 7, v24
v_add_u32 v24, s62, v24
buffer_load_dword v25, v24, s[12:15], s95 offen sc1
s_waitcnt vmcnt(0)
v_cmp_gt_u32 vcc, s93, v25
s_cbranch_vccnz SLOWH1
GOH1:
s_barrier
s_nop 2
buffer_load_dwordx4 a[64:67], v4, s[12:15], s48 offen offset:0 sc1
buffer_load_dwordx4 a[68:71], v5, s[12:15], s48 offen offset:0 sc1
buffer_load_dwordx4 a[72:75], v4, s[12:15], s48 offen offset:1024 sc1
buffer_load_dwordx4 a[76:79], v5, s[12:15], s48 offen offset:1024 sc1
s_add_u32 s48, s48, 2048
s_cmp_ge_u32 s48, 40960
s_cselect_b32 s48, 0, s48
buffer_load_dwordx4 a[80:83], v4, s[12:15], s48 offen offset:0 sc1
buffer_load_dwordx4 a[84:87], v5, s[12:15], s48 offen offset:0 sc1
buffer_load_dwordx4 a[88:91], v4, s[12:15], s48 offen offset:1024 sc1
buffer_load_dwordx4 a[92:95], v5, s[12:15], s48 offen offset:1024 sc1
s_add_u32 s48, s48, 2048
s_cmp_ge_u32 s48, 40960
s_cselect_b32 s48, 0, s48
buffer_load_dwordx4 a[96:99], v4, s[12:15], s48 offen offset:0 sc1
buffer_load_dwordx4 a[100:103], v5, s[12:15], s48 offen offset:0 sc1
buffer_load_dwordx4 a[104:107], v4, s[12:15], s48 offen offset:1024 sc1
buffer_load_dwordx4 a[108:111], v5, s[12:15], s48 offen offset:1024 sc1
s_add_u32 s48, s48, 2048
s_cmp_ge_u32 s48, 40960
s_cselect_b32 s48, 0, s48
buffer_load_dwordx4 a[112:115], v4, s[12:15], s48 offen offset:0 sc1
buffer_load_dwordx4 a[116:119], v5, s[12:15], s48 offen offset:0 sc1
s_barrier
ds_read_b64_tr_b16 a[0:1], v2 offset:0
ds_read_b64_tr_b16 a[2:3], v2 offset:512
ds_read_b64_tr_b16 a[4:5], v3 offset:0
ds_read_b64_tr_b16 a[6:7], v3 offset:512
ds_read_b64_tr_b16 a[8:9], v2 offset:4096
ds_read_b64_tr_b16 a[10:11], v2 offset:4608
ds_read_b64_tr_b16 a[12:13], v3 offset:4096
ds_read_b64_tr_b16 a[14:15], v3 offset:4608
ds_read_b64_tr_b16 a[16:17], v2 offset:8192
ds_read_b64_tr_b16 a[18:19], v2 offset:8704
ds_read_b64_tr_b16 a[20:21], v3 offset:8192
ds_read_b64_tr_b16 a[22:23], v3 offset:8704
ds_read_b64_tr_b16 a[24:25], v2 offset:12288
ds_read_b64_tr_b16 a[26:27], v2 offset:12800
ds_read_b64_tr_b16 a[28:29], v3 offset:12288
ds_read_b64_tr_b16 a[30:31], v3 offset:12800
s_waitcnt vmcnt(13) lgkmcnt(6)
v_mfma_f32_32x32x16_bf16 v[64:79], a[0:3], a[64:67], 0
ds_read_b64_tr_b16 a[32:33], v2 offset:2048
ds_read_b64_tr_b16 a[34:35], v2 offset:2560
s_waitcnt vmcnt(12)
v_mfma_f32_32x32x16_bf16 v[160:175], a[0:3], a[68:71], 0
ds_read_b64_tr_b16 a[36:37], v3 offset:2048
v_mfma_f32_32x32x16_bf16 v[80:95], a[4:7], a[64:67], 0
ds_read_b64_tr_b16 a[38:39], v3 offset:2560
v_mfma_f32_32x32x16_bf16 v[176:191], a[4:7], a[68:71], 0
ds_read_b64_tr_b16 a[40:41], v2 offset:6144
buffer_load_dwordx4 a[120:123], v4, s[12:15], s48 offen offset:1024 sc1
v_mfma_f32_32x32x16_bf16 v[96:111], a[8:11], a[64:67], 0
ds_read_b64_tr_b16 a[42:43], v2 offset:6656
v_mfma_f32_32x32x16_bf16 v[192:207], a[8:11], a[68:71], 0
ds_read_b64_tr_b16 a[44:45], v3 offset:6144
v_mfma_f32_32x32x16_bf16 v[112:127], a[12:15], a[64:67], 0
ds_read_b64_tr_b16 a[46:47], v3 offset:6656
v_mfma_f32_32x32x16_bf16 v[208:223], a[12:15], a[68:71], 0
ds_read_b64_tr_b16 a[48:49], v2 offset:10240
ds_read_b64_tr_b16 a[50:51], v2 offset:10752
buffer_load_dwordx4 a[124:127], v5, s[12:15], s48 offen offset:1024 sc1
s_add_u32 s48, s48, 2048
s_cmp_ge_u32 s48, 40960
s_cselect_b32 s48, 0, s48
v_mfma_f32_32x32x16_bf16 v[128:143], a[16:19], a[64:67], 0
ds_read_b64_tr_b16 a[52:53], v3 offset:10240
v_mfma_f32_32x32x16_bf16 v[224:239], a[16:19], a[68:71], 0
ds_read_b64_tr_b16 a[54:55], v3 offset:10752
s_waitcnt lgkmcnt(6)
v_mfma_f32_32x32x16_bf16 v[144:159], a[20:23], a[64:67], 0
ds_read_b64_tr_b16 a[56:57], v2 offset:14336
v_mfma_f32_32x32x16_bf16 v[240:255], a[20:23], a[68:71], 0
ds_read_b64_tr_b16 a[58:59], v2 offset:14848
v_mfma_f32_32x32x16_bf16 a[192:207], a[24:27], a[64:67], a[192:207]
ds_read_b64_tr_b16 a[60:61], v3 offset:14336
v_mfma_f32_32x32x16_bf16 a[208:223], a[24:27], a[68:71], a[208:223]
ds_read_b64_tr_b16 a[62:63], v3 offset:14848
v_mfma_f32_32x32x16_bf16 a[224:239], a[28:31], a[64:67], a[224:239]
s_waitcnt vmcnt(13)
v_mfma_f32_32x32x16_bf16 v[64:79], a[32:35], a[72:75], v[64:79]
s_barrier
ds_read_b64_tr_b16 a[0:1], v2 offset:16384
ds_read_b64_tr_b16 a[2:3], v2 offset:16896
s_waitcnt vmcnt(12)
v_mfma_f32_32x32x16_bf16 v[160:175], a[32:35], a[76:79], v[160:175]
ds_read_b64_tr_b16 a[4:5], v3 offset:16384
s_add_u32 m0, s47, 49152
v_mfma_f32_32x32x16_bf16 v[80:95], a[36:39], a[72:75], v[80:95]
ds_read_b64_tr_b16 a[6:7], v3 offset:16896
buffer_load_dwordx4 v1, s[8:11], s45 offen lds
s_add_u32 s45, s45, s44
v_mfma_f32_32x32x16_bf16 v[176:191], a[36:39], a[76:79], v[176:191]
ds_read_b64_tr_b16 a[8:9], v2 offset:20480
buffer_load_dwordx4 a[64:67], v4, s[12:15], s48 offen offset:0 sc1
v_mfma_f32_32x32x16_bf16 v[96:111], a[40:43], a[72:75], v[96:111]
ds_read_b64_tr_b16 a[10:11], v2 offset:20992
s_add_u32 m0, s47, 50176
v_mfma_f32_32x32x16_bf16 v[192:207], a[40:43], a[76:79], v[192:207]
ds_read_b64_tr_b16 a[12:13], v3 offset:20480
s_waitcnt lgkmcnt(6)
v_mfma_f32_32x32x16_bf16 v[112:127], a[44:47], a[72:75], v[112:127]
ds_read_b64_tr_b16 a[14:15], v3 offset:20992
buffer_load_dwordx4 v1, s[8:11], s45 offen lds
s_add_u32 s45, s45, s44
v_mfma_f32_32x32x16_bf16 v[208:223], a[44:47], a[76:79], v[208:223]
ds_read_b64_tr_b16 a[16:17], v2 offset:24576
ds_read_b64_tr_b16 a[18:19], v2 offset:25088
buffer_load_dwordx4 a[68:71], v5, s[12:15], s48 offen offset:0 sc1
v_mfma_f32_32x32x16_bf16 v[128:143], a[48:51], a[72:75], v[128:143]
ds_read_b64_tr_b16 a[20:21], v3 offset:24576
s_add_u32 m0, s47, 51200
v_mfma_f32_32x32x16_bf16 v[224:239], a[48:51], a[76:79], v[224:239]
ds_read_b64_tr_b16 a[22:23], v3 offset:25088
buffer_load_dwordx4 v1, s[8:11], s45 offen lds
s_add_u32 s45, s45, s44
v_mfma_f32_32x32x16_bf16 v[144:159], a[52:55], a[72:75], v[144:159]
ds_read_b64_tr_b16 a[24:25], v2 offset:28672
v_mfma_f32_32x32x16_bf16 v[240:255], a[52:55], a[76:79], v[240:255]
ds_read_b64_tr_b16 a[26:27], v2 offset:29184
s_add_u32 m0, s47, 52224
v_mfma_f32_32x32x16_bf16 a[192:207], a[56:59], a[72:75], a[192:207]
ds_read_b64_tr_b16 a[28:29], v3 offset:28672
v_mfma_f32_32x32x16_bf16 a[208:223], a[56:59], a[76:79], a[208:223]
ds_read_b64_tr_b16 a[30:31], v3 offset:29184
buffer_load_dwordx4 v1, s[8:11], s45 offen lds
s_add_u32 s45, s45, s44
s_cmp_ge_u32 s45, s46
s_cselect_b32 s45, 0, s45
v_mfma_f32_32x32x16_bf16 a[224:239], a[60:63], a[72:75], a[224:239]
s_waitcnt vmcnt(17) lgkmcnt(6)
v_mfma_f32_32x32x16_bf16 v[64:79], a[0:3], a[80:83], v[64:79]
ds_read_b64_tr_b16 a[32:33], v2 offset:18432
ds_read_b64_tr_b16 a[34:35], v2 offset:18944
s_waitcnt vmcnt(16)
v_mfma_f32_32x32x16_bf16 v[160:175], a[0:3], a[84:87], v[160:175]
ds_read_b64_tr_b16 a[36:37], v3 offset:18432
v_mfma_f32_32x32x16_bf16 v[80:95], a[4:7], a[80:83], v[80:95]
ds_read_b64_tr_b16 a[38:39], v3 offset:18944
v_mfma_f32_32x32x16_bf16 v[176:191], a[4:7], a[84:87], v[176:191]
ds_read_b64_tr_b16 a[40:41], v2 offset:22528
buffer_load_dwordx4 a[72:75], v4, s[12:15], s48 offen offset:1024 sc1
v_mfma_f32_32x32x16_bf16 v[96:111], a[8:11], a[80:83], v[96:111]
ds_read_b64_tr_b16 a[42:43], v2 offset:23040
v_mfma_f32_32x32x16_bf16 v[192:207], a[8:11], a[84:87], v[192:207]
ds_read_b64_tr_b16 a[44:45], v3 offset:22528
v_mfma_f32_32x32x16_bf16 v[112:127], a[12:15], a[80:83], v[112:127]
ds_read_b64_tr_b16 a[46:47], v3 offset:23040
v_mfma_f32_32x32x16_bf16 v[208:223], a[12:15], a[84:87], v[208:223]
ds_read_b64_tr_b16 a[48:49], v2 offset:26624
ds_read_b64_tr_b16 a[50:51], v2 offset:27136
buffer_load_dwordx4 a[76:79], v5, s[12:15], s48 offen offset:1024 sc1
s_add_u32 s48, s48, 2048
s_cmp_ge_u32 s48, 40960
s_cselect_b32 s48, 0, s48
v_mfma_f32_32x32x16_bf16 v[128:143], a[16:19], a[80:83], v[128:143]
ds_read_b64_tr_b16 a[52:53], v3 offset:26624
v_mfma_f32_32x32x16_bf16 v[224:239], a[16:19], a[84:87], v[224:239]
ds_read_b64_tr_b16 a[54:55], v3 offset:27136
s_waitcnt lgkmcnt(6)
v_mfma_f32_32x32x16_bf16 v[144:159], a[20:23], a[80:83], v[144:159]
ds_read_b64_tr_b16 a[56:57], v2 offset:30720
v_mfma_f32_32x32x16_bf16 v[240:255], a[20:23], a[84:87], v[240:255]
ds_read_b64_tr_b16 a[58:59], v2 offset:31232
v_mfma_f32_32x32x16_bf16 a[192:207], a[24:27], a[80:83], a[192:207]
ds_read_b64_tr_b16 a[60:61], v3 offset:30720
v_mfma_f32_32x32x16_bf16 a[208:223], a[24:27], a[84:87], a[208:223]
ds_read_b64_tr_b16 a[62:63], v3 offset:31232
v_mfma_f32_32x32x16_bf16 a[224:239], a[28:31], a[80:83], a[224:239]
s_waitcnt vmcnt(17)
v_mfma_f32_32x32x16_bf16 v[64:79], a[32:35], a[88:91], v[64:79]
s_barrier
ds_read_b64_tr_b16 a[0:1], v2 offset:32768
ds_read_b64_tr_b16 a[2:3], v2 offset:33280
s_waitcnt vmcnt(16)
v_mfma_f32_32x32x16_bf16 v[160:175], a[32:35], a[92:95], v[160:175]
ds_read_b64_tr_b16 a[4:5], v3 offset:32768
s_add_u32 m0, s47, 0
v_mfma_f32_32x32x16_bf16 v[80:95], a[36:39], a[88:91], v[80:95]
ds_read_b64_tr_b16 a[6:7], v3 offset:33280
buffer_load_dwordx4 v1, s[8:11], s45 offen lds
s_add_u32 s45, s45, s44
v_mfma_f32_32x32x16_bf16 v[176:191], a[36:39], a[92:95], v[176:191]
ds_read_b64_tr_b16 a[8:9], v2 offset:36864
buffer_load_dwordx4 a[80:83], v4, s[12:15], s48 offen offset:0 sc1
v_mfma_f32_32x32x16_bf16 v[96:111], a[40:43], a[88:91], v[96:111]
ds_read_b64_tr_b16 a[10:11], v2 offset:37376
s_add_u32 m0, s47, 1024
v_mfma_f32_32x32x16_bf16 v[192:207], a[40:43], a[92:95], v[192:207]
ds_read_b64_tr_b16 a[12:13], v3 offset:36864
s_waitcnt lgkmcnt(6)
v_mfma_f32_32x32x16_bf16 v[112:127], a[44:47], a[88:91], v[112:127]
ds_read_b64_tr_b16 a[14:15], v3 offset:37376
buffer_load_dwordx4 v1, s[8:11], s45 offen lds
s_add_u32 s45, s45, s44
v_mfma_f32_32x32x16_bf16 v[208:223], a[44:47], a[92:95], v[208:223]
ds_read_b64_tr_b16 a[16:17], v2 offset:40960
ds_read_b64_tr_b16 a[18:19], v2 offset:41472
buffer_load_dwordx4 a[84:87], v5, s[12:15], s48 offen offset:0 sc1
v_mfma_f32_32x32x16_bf16 v[128:143], a[48:51], a[88:91], v[128:143]
ds_read_b64_tr_b16 a[20:21], v3 offset:40960
s_add_u32 m0, s47, 2048
v_mfma_f32_32x32x16_bf16 v[224:239], a[48:51], a[92:95], v[224:239]
ds_read_b64_tr_b16 a[22:23], v3 offset:41472
buffer_load_dwordx4 v1, s[8:11], s45 offen lds
s_add_u32 s45, s45, s44
v_mfma_f32_32x32x16_bf16 v[144:159], a[52:55], a[88:91], v[144:159]
ds_read_b64_tr_b16 a[24:25], v2 offset:45056
v_mfma_f32_32x32x16_bf16 v[240:255], a[52:55], a[92:95], v[240:255]
ds_read_b64_tr_b16 a[26:27], v2 offset:45568
s_add_u32 m0, s47, 3072
v_mfma_f32_32x32x16_bf16 a[192:207], a[56:59], a[88:91], a[192:207]
ds_read_b64_tr_b16 a[28:29], v3 offset:45056
v_mfma_f32_32x32x16_bf16 a[208:223], a[56:59], a[92:95], a[208:223]
ds_read_b64_tr_b16 a[30:31], v3 offset:45568
buffer_load_dwordx4 v1, s[8:11], s45 offen lds
s_add_u32 s45, s45, s44
s_cmp_ge_u32 s45, s46
s_cselect_b32 s45, 0, s45
v_mfma_f32_32x32x16_bf16 a[224:239], a[60:63], a[88:91], a[224:239]
s_waitcnt vmcnt(21) lgkmcnt(6)
v_mfma_f32_32x32x16_bf16 v[64:79], a[0:3], a[96:99], v[64:79]
ds_read_b64_tr_b16 a[32:33], v2 offset:34816
ds_read_b64_tr_b16 a[34:35], v2 offset:35328
s_waitcnt vmcnt(20)
v_mfma_f32_32x32x16_bf16 v[160:175], a[0:3], a[100:103], v[160:175]
ds_read_b64_tr_b16 a[36:37], v3 offset:34816
v_mfma_f32_32x32x16_bf16 v[80:95], a[4:7], a[96:99], v[80:95]
ds_read_b64_tr_b16 a[38:39], v3 offset:35328
v_mfma_f32_32x32x16_bf16 v[176:191], a[4:7], a[100:103], v[176:191]
ds_read_b64_tr_b16 a[40:41], v2 offset:38912
buffer_load_dwordx4 a[88:91], v4, s[12:15], s48 offen offset:1024 sc1
v_mfma_f32_32x32x16_bf16 v[96:111], a[8:11], a[96:99], v[96:111]
ds_read_b64_tr_b16 a[42:43], v2 offset:39424
v_mfma_f32_32x32x16_bf16 v[192:207], a[8:11], a[100:103], v[192:207]
ds_read_b64_tr_b16 a[44:45], v3 offset:38912
v_mfma_f32_32x32x16_bf16 v[112:127], a[12:15], a[96:99], v[112:127]
ds_read_b64_tr_b16 a[46:47], v3 offset:39424
v_mfma_f32_32x32x16_bf16 v[208:223], a[12:15], a[100:103], v[208:223]
ds_read_b64_tr_b16 a[48:49], v2 offset:43008
ds_read_b64_tr_b16 a[50:51], v2 offset:43520
buffer_load_dwordx4 a[92:95], v5, s[12:15], s48 offen offset:1024 sc1
s_add_u32 s48, s48, 2048
s_cmp_ge_u32 s48, 40960
s_cselect_b32 s48, 0, s48
v_mfma_f32_32x32x16_bf16 v[128:143], a[16:19], a[96:99], v[128:143]
ds_read_b64_tr_b16 a[52:53], v3 offset:43008
v_mfma_f32_32x32x16_bf16 v[224:239], a[16:19], a[100:103], v[224:239]
ds_read_b64_tr_b16 a[54:55], v3 offset:43520
s_waitcnt lgkmcnt(6)
v_mfma_f32_32x32x16_bf16 v[144:159], a[20:23], a[96:99], v[144:159]
ds_read_b64_tr_b16 a[56:57], v2 offset:47104
v_mfma_f32_32x32x16_bf16 v[240:255], a[20:23], a[100:103], v[240:255]
ds_read_b64_tr_b16 a[58:59], v2 offset:47616
v_mfma_f32_32x32x16_bf16 a[192:207], a[24:27], a[96:99], a[192:207]
ds_read_b64_tr_b16 a[60:61], v3 offset:47104
v_mfma_f32_32x32x16_bf16 a[208:223], a[24:27], a[100:103], a[208:223]
ds_read_b64_tr_b16 a[62:63], v3 offset:47616
v_mfma_f32_32x32x16_bf16 a[224:239], a[28:31], a[96:99], a[224:239]
s_waitcnt vmcnt(21)
v_mfma_f32_32x32x16_bf16 v[64:79], a[32:35], a[104:107], v[64:79]
s_waitcnt vmcnt(10)
s_barrier
ds_read_b64_tr_b16 a[0:1], v2 offset:49152
ds_read_b64_tr_b16 a[2:3], v2 offset:49664
v_mfma_f32_32x32x16_bf16 v[160:175], a[32:35], a[108:111], v[160:175]
ds_read_b64_tr_b16 a[4:5], v3 offset:49152
s_add_u32 m0, s47, 16384
v_mfma_f32_32x32x16_bf16 v[80:95], a[36:39], a[104:107], v[80:95]
ds_read_b64_tr_b16 a[6:7], v3 offset:49664
buffer_load_dwordx4 v1, s[8:11], s45 offen lds
s_add_u32 s45, s45, s44
v_mfma_f32_32x32x16_bf16 v[176:191], a[36:39], a[108:111], v[176:191]
ds_read_b64_tr_b16 a[8:9], v2 offset:53248
buffer_load_dwordx4 a[96:99], v4, s[12:15], s48 offen offset:0 sc1
v_mfma_f32_32x32x16_bf16 v[96:111], a[40:43], a[104:107], v[96:111]
ds_read_b64_tr_b16 a[10:11], v2 offset:53760
s_add_u32 m0, s47, 17408
v_mfma_f32_32x32x16_bf16 v[192:207], a[40:43], a[108:111], v[192:207]
ds_read_b64_tr_b16 a[12:13], v3 offset:53248
s_waitcnt lgkmcnt(6)
v_mfma_f32_32x32x16_bf16 v[112:127], a[44:47], a[104:107], v[112:127]
ds_read_b64_tr_b16 a[14:15], v3 offset:53760
buffer_load_dwordx4 v1, s[8:11], s45 offen lds
s_add_u32 s45, s45, s44
v_mfma_f32_32x32x16_bf16 v[208:223], a[44:47], a[108:111], v[208:223]
ds_read_b64_tr_b16 a[16:17], v2 offset:57344
ds_read_b64_tr_b16 a[18:19], v2 offset:57856
buffer_load_dwordx4 a[100:103], v5, s[12:15], s48 offen offset:0 sc1
v_mfma_f32_32x32x16_bf16 v[128:143], a[48:51], a[104:107], v[128:143]
ds_read_b64_tr_b16 a[20:21], v3 offset:57344
s_add_u32 m0, s47, 18432
v_mfma_f32_32x32x16_bf16 v[224:239], a[48:51], a[108:111], v[224:239]
ds_read_b64_tr_b16 a[22:23], v3 offset:57856
buffer_load_dwordx4 v1, s[8:11], s45 offen lds
s_add_u32 s45, s45, s44
v_mfma_f32_32x32x16_bf16 v[144:159], a[52:55], a[104:107], v[144:159]
ds_read_b64_tr_b16 a[24:25], v2 offset:61440
v_mfma_f32_32x32x16_bf16 v[240:255], a[52:55], a[108:111], v[240:255]
ds_read_b64_tr_b16 a[26:27], v2 offset:61952
s_add_u32 m0, s47, 19456
v_mfma_f32_32x32x16_bf16 a[192:207], a[56:59], a[104:107], a[192:207]
ds_read_b64_tr_b16 a[28:29], v3 offset:61440
v_mfma_f32_32x32x16_bf16 a[208:223], a[56:59], a[108:111], a[208:223]
ds_read_b64_tr_b16 a[30:31], v3 offset:61952
buffer_load_dwordx4 v1, s[8:11], s45 offen lds
s_add_u32 s45, s45, s44
s_cmp_ge_u32 s45, s46
s_cselect_b32 s45, 0, s45
v_mfma_f32_32x32x16_bf16 a[224:239], a[60:63], a[104:107], a[224:239]
s_waitcnt lgkmcnt(6)
v_mfma_f32_32x32x16_bf16 v[64:79], a[0:3], a[112:115], v[64:79]
ds_read_b64_tr_b16 a[32:33], v2 offset:51200
ds_read_b64_tr_b16 a[34:35], v2 offset:51712
v_mfma_f32_32x32x16_bf16 v[160:175], a[0:3], a[116:119], v[160:175]
ds_read_b64_tr_b16 a[36:37], v3 offset:51200
v_mfma_f32_32x32x16_bf16 v[80:95], a[4:7], a[112:115], v[80:95]
ds_read_b64_tr_b16 a[38:39], v3 offset:51712
v_mfma_f32_32x32x16_bf16 v[176:191], a[4:7], a[116:119], v[176:191]
ds_read_b64_tr_b16 a[40:41], v2 offset:55296
buffer_load_dwordx4 a[104:107], v4, s[12:15], s48 offen offset:1024 sc1
v_mfma_f32_32x32x16_bf16 v[96:111], a[8:11], a[112:115], v[96:111]
ds_read_b64_tr_b16 a[42:43], v2 offset:55808
v_mfma_f32_32x32x16_bf16 v[192:207], a[8:11], a[116:119], v[192:207]
ds_read_b64_tr_b16 a[44:45], v3 offset:55296
v_mfma_f32_32x32x16_bf16 v[112:127], a[12:15], a[112:115], v[112:127]
ds_read_b64_tr_b16 a[46:47], v3 offset:55808
v_mfma_f32_32x32x16_bf16 v[208:223], a[12:15], a[116:119], v[208:223]
ds_read_b64_tr_b16 a[48:49], v2 offset:59392
ds_read_b64_tr_b16 a[50:51], v2 offset:59904
buffer_load_dwordx4 a[108:111], v5, s[12:15], s48 offen offset:1024 sc1
s_add_u32 s48, s48, 2048
s_cmp_ge_u32 s48, 40960
s_cselect_b32 s48, 0, s48
v_mfma_f32_32x32x16_bf16 v[128:143], a[16:19], a[112:115], v[128:143]
ds_read_b64_tr_b16 a[52:53], v3 offset:59392
v_mfma_f32_32x32x16_bf16 v[224:239], a[16:19], a[116:119], v[224:239]
ds_read_b64_tr_b16 a[54:55], v3 offset:59904
s_waitcnt lgkmcnt(6)
v_mfma_f32_32x32x16_bf16 v[144:159], a[20:23], a[112:115], v[144:159]
ds_read_b64_tr_b16 a[56:57], v2 offset:63488
v_mfma_f32_32x32x16_bf16 v[240:255], a[20:23], a[116:119], v[240:255]
ds_read_b64_tr_b16 a[58:59], v2 offset:64000
v_mfma_f32_32x32x16_bf16 a[192:207], a[24:27], a[112:115], a[192:207]
ds_read_b64_tr_b16 a[60:61], v3 offset:63488
v_mfma_f32_32x32x16_bf16 a[208:223], a[24:27], a[116:119], a[208:223]
ds_read_b64_tr_b16 a[62:63], v3 offset:64000
v_mfma_f32_32x32x16_bf16 a[224:239], a[28:31], a[112:115], a[224:239]
v_mfma_f32_32x32x16_bf16 v[64:79], a[32:35], a[120:123], v[64:79]
s_waitcnt vmcnt(10)
s_barrier
ds_read_b64_tr_b16 a[0:1], v2 offset:0
ds_read_b64_tr_b16 a[2:3], v2 offset:512
v_mfma_f32_32x32x16_bf16 v[160:175], a[32:35], a[124:127], v[160:175]
ds_read_b64_tr_b16 a[4:5], v3 offset:0
s_add_u32 m0, s47, 32768
v_mfma_f32_32x32x16_bf16 v[80:95], a[36:39], a[120:123], v[80:95]
ds_read_b64_tr_b16 a[6:7], v3 offset:512
buffer_load_dwordx4 v1, s[8:11], s45 offen lds
s_add_u32 s45, s45, s44
v_mfma_f32_32x32x16_bf16 v[176:191], a[36:39], a[124:127], v[176:191]
ds_read_b64_tr_b16 a[8:9], v2 offset:4096
buffer_load_dwordx4 a[112:115], v4, s[12:15], s48 offen offset:0 sc1
v_mfma_f32_32x32x16_bf16 v[96:111], a[40:43], a[120:123], v[96:111]
ds_read_b64_tr_b16 a[10:11], v2 offset:4608
s_add_u32 m0, s47, 33792
v_mfma_f32_32x32x16_bf16 v[192:207], a[40:43], a[124:127], v[192:207]
ds_read_b64_tr_b16 a[12:13], v3 offset:4096
s_waitcnt lgkmcnt(6)
v_mfma_f32_32x32x16_bf16 v[112:127], a[44:47], a[120:123], v[112:127]
ds_read_b64_tr_b16 a[14:15], v3 offset:4608
buffer_load_dwordx4 v1, s[8:11], s45 offen lds
s_add_u32 s45, s45, s44
v_mfma_f32_32x32x16_bf16 v[208:223], a[44:47], a[124:127], v[208:223]
ds_read_b64_tr_b16 a[16:17], v2 offset:8192
ds_read_b64_tr_b16 a[18:19], v2 offset:8704
buffer_load_dwordx4 a[116:119], v5, s[12:15], s48 offen offset:0 sc1
v_mfma_f32_32x32x16_bf16 v[128:143], a[48:51], a[120:123], v[128:143]
ds_read_b64_tr_b16 a[20:21], v3 offset:8192
s_add_u32 m0, s47, 34816
v_mfma_f32_32x32x16_bf16 v[224:239], a[48:51], a[124:127], v[224:239]
ds_read_b64_tr_b16 a[22:23], v3 offset:8704
buffer_load_dwordx4 v1, s[8:11], s45 offen lds
s_add_u32 s45, s45, s44
v_mfma_f32_32x32x16_bf16 v[144:159], a[52:55], a[120:123], v[144:159]
ds_read_b64_tr_b16 a[24:25], v2 offset:12288
v_mfma_f32_32x32x16_bf16 v[240:255], a[52:55], a[124:127], v[240:255]
ds_read_b64_tr_b16 a[26:27], v2 offset:12800
s_add_u32 m0, s47, 35840
v_mfma_f32_32x32x16_bf16 a[192:207], a[56:59], a[120:123], a[192:207]
ds_read_b64_tr_b16 a[28:29], v3 offset:12288
v_mfma_f32_32x32x16_bf16 a[208:223], a[56:59], a[124:127], a[208:223]
ds_read_b64_tr_b16 a[30:31], v3 offset:12800
buffer_load_dwordx4 v1, s[8:11], s45 offen lds
s_add_u32 s45, s45, s44
s_cmp_ge_u32 s45, s46
s_cselect_b32 s45, 0, s45
v_mfma_f32_32x32x16_bf16 a[224:239], a[60:63], a[120:123], a[224:239]
s_waitcnt lgkmcnt(6)
v_mfma_f32_32x32x16_bf16 v[64:79], a[0:3], a[64:67], v[64:79]
ds_read_b64_tr_b16 a[32:33], v2 offset:2048
ds_read_b64_tr_b16 a[34:35], v2 offset:2560
v_mfma_f32_32x32x16_bf16 v[160:175], a[0:3], a[68:71], v[160:175]
ds_read_b64_tr_b16 a[36:37], v3 offset:2048
v_mfma_f32_32x32x16_bf16 v[80:95], a[4:7], a[64:67], v[80:95]
ds_read_b64_tr_b16 a[38:39], v3 offset:2560
v_mfma_f32_32x32x16_bf16 v[176:191], a[4:7], a[68:71], v[176:191]
ds_read_b64_tr_b16 a[40:41], v2 offset:6144
buffer_load_dwordx4 a[120:123], v4, s[12:15], s48 offen offset:1024 sc1
v_mfma_f32_32x32x16_bf16 v[96:111], a[8:11], a[64:67], v[96:111]
ds_read_b64_tr_b16 a[42:43], v2 offset:6656
v_mfma_f32_32x32x16_bf16 v[192:207], a[8:11], a[68:71], v[192:207]
ds_read_b64_tr_b16 a[44:45], v3 offset:6144
v_mfma_f32_32x32x16_bf16 v[112:127], a[12:15], a[64:67], v[112:127]
ds_read_b64_tr_b16 a[46:47], v3 offset:6656
v_mfma_f32_32x32x16_bf16 v[208:223], a[12:15], a[68:71], v[208:223]
ds_read_b64_tr_b16 a[48:49], v2 offset:10240
ds_read_b64_tr_b16 a[50:51], v2 offset:10752
buffer_load_dwordx4 a[124:127], v5, s[12:15], s48 offen offset:1024 sc1
s_add_u32 s48, s48, 2048
s_cmp_ge_u32 s48, 40960
s_cselect_b32 s48, 0, s48
v_mfma_f32_32x32x16_bf16 v[128:143], a[16:19], a[64:67], v[128:143]
ds_read_b64_tr_b16 a[52:53], v3 offset:10240
v_mfma_f32_32x32x16_bf16 v[224:239], a[16:19], a[68:71], v[224:239]
ds_read_b64_tr_b16 a[54:55], v3 offset:10752
s_waitcnt lgkmcnt(6)
v_mfma_f32_32x32x16_bf16 v[144:159], a[20:23], a[64:67], v[144:159]
ds_read_b64_tr_b16 a[56:57], v2 offset:14336
v_mfma_f32_32x32x16_bf16 v[240:255], a[20:23], a[68:71], v[240:255]
ds_read_b64_tr_b16 a[58:59], v2 offset:14848
v_mfma_f32_32x32x16_bf16 a[192:207], a[24:27], a[64:67], a[192:207]
ds_read_b64_tr_b16 a[60:61], v3 offset:14336
v_mfma_f32_32x32x16_bf16 a[208:223], a[24:27], a[68:71], a[208:223]
ds_read_b64_tr_b16 a[62:63], v3 offset:14848
v_mfma_f32_32x32x16_bf16 a[224:239], a[28:31], a[64:67], a[224:239]
v_mfma_f32_32x32x16_bf16 v[64:79], a[32:35], a[72:75], v[64:79]
s_waitcnt vmcnt(10)
s_barrier
ds_read_b64_tr_b16 a[0:1], v2 offset:16384
ds_read_b64_tr_b16 a[2:3], v2 offset:16896
v_mfma_f32_32x32x16_bf16 v[160:175], a[32:35], a[76:79], v[160:175]
ds_read_b64_tr_b16 a[4:5], v3 offset:16384
s_add_u32 m0, s47, 49152
v_mfma_f32_32x32x16_bf16 v[80:95], a[36:39], a[72:75], v[80:95]
ds_read_b64_tr_b16 a[6:7], v3 offset:16896
buffer_load_dwordx4 v1, s[8:11], s45 offen lds
s_add_u32 s45, s45, s44
v_mfma_f32_32x32x16_bf16 v[176:191], a[36:39], a[76:79], v[176:191]
ds_read_b64_tr_b16 a[8:9], v2 offset:20480
buffer_load_dwordx4 a[64:67], v4, s[12:15], s48 offen offset:0 sc1
v_mfma_f32_32x32x16_bf16 v[96:111], a[40:43], a[72:75], v[96:111]
ds_read_b64_tr_b16 a[10:11], v2 offset:20992
s_add_u32 m0, s47, 50176
v_mfma_f32_32x32x16_bf16 v[192:207], a[40:43], a[76:79], v[192:207]
ds_read_b64_tr_b16 a[12:13], v3 offset:20480
s_waitcnt lgkmcnt(6)
v_mfma_f32_32x32x16_bf16 v[112:127], a[44:47], a[72:75], v[112:127]
ds_read_b64_tr_b16 a[14:15], v3 offset:20992
buffer_load_dwordx4 v1, s[8:11], s45 offen lds
s_add_u32 s45, s45, s44
v_mfma_f32_32x32x16_bf16 v[208:223], a[44:47], a[76:79], v[208:223]
ds_read_b64_tr_b16 a[16:17], v2 offset:24576
ds_read_b64_tr_b16 a[18:19], v2 offset:25088
buffer_load_dwordx4 a[68:71], v5, s[12:15], s48 offen offset:0 sc1
v_mfma_f32_32x32x16_bf16 v[128:143], a[48:51], a[72:75], v[128:143]
ds_read_b64_tr_b16 a[20:21], v3 offset:24576
s_add_u32 m0, s47, 51200
v_mfma_f32_32x32x16_bf16 v[224:239], a[48:51], a[76:79], v[224:239]
ds_read_b64_tr_b16 a[22:23], v3 offset:25088
buffer_load_dwordx4 v1, s[8:11], s45 offen lds
s_add_u32 s45, s45, s44
v_mfma_f32_32x32x16_bf16 v[144:159], a[52:55], a[72:75], v[144:159]
ds_read_b64_tr_b16 a[24:25], v2 offset:28672
v_mfma_f32_32x32x16_bf16 v[240:255], a[52:55], a[76:79], v[240:255]
ds_read_b64_tr_b16 a[26:27], v2 offset:29184
s_add_u32 m0, s47, 52224
v_mfma_f32_32x32x16_bf16 a[192:207], a[56:59], a[72:75], a[192:207]
ds_read_b64_tr_b16 a[28:29], v3 offset:28672
v_mfma_f32_32x32x16_bf16 a[208:223], a[56:59], a[76:79], a[208:223]
ds_read_b64_tr_b16 a[30:31], v3 offset:29184
buffer_load_dwordx4 v1, s[8:11], s45 offen lds
s_add_u32 s45, s45, s44
s_cmp_ge_u32 s45, s46
s_cselect_b32 s45, 0, s45
v_mfma_f32_32x32x16_bf16 a[224:239], a[60:63], a[72:75], a[224:239]
s_waitcnt lgkmcnt(6)
v_mfma_f32_32x32x16_bf16 v[64:79], a[0:3], a[80:83], v[64:79]
ds_read_b64_tr_b16 a[32:33], v2 offset:18432
ds_read_b64_tr_b16 a[34:35], v2 offset:18944
v_mfma_f32_32x32x16_bf16 v[160:175], a[0:3], a[84:87], v[160:175]
ds_read_b64_tr_b16 a[36:37], v3 offset:18432
v_mfma_f32_32x32x16_bf16 v[80:95], a[4:7], a[80:83], v[80:95]
ds_read_b64_tr_b16 a[38:39], v3 offset:18944
v_mfma_f32_32x32x16_bf16 v[176:191], a[4:7], a[84:87], v[176:191]
ds_read_b64_tr_b16 a[40:41], v2 offset:22528
buffer_load_dwordx4 a[72:75], v4, s[12:15], s48 offen offset:1024 sc1
v_mfma_f32_32x32x16_bf16 v[96:111], a[8:11], a[80:83], v[96:111]
ds_read_b64_tr_b16 a[42:43], v2 offset:23040
v_mfma_f32_32x32x16_bf16 v[192:207], a[8:11], a[84:87], v[192:207]
ds_read_b64_tr_b16 a[44:45], v3 offset:22528
v_mfma_f32_32x32x16_bf16 v[112:127], a[12:15], a[80:83], v[112:127]
ds_read_b64_tr_b16 a[46:47], v3 offset:23040
v_mfma_f32_32x32x16_bf16 v[208:223], a[12:15], a[84:87], v[208:223]
ds_read_b64_tr_b16 a[48:49], v2 offset:26624
ds_read_b64_tr_b16 a[50:51], v2 offset:27136
buffer_load_dwordx4 a[76:79], v5, s[12:15], s48 offen offset:1024 sc1
s_add_u32 s48, s48, 2048
s_cmp_ge_u32 s48, 40960
s_cselect_b32 s48, 0, s48
v_mfma_f32_32x32x16_bf16 v[128:143], a[16:19], a[80:83], v[128:143]
ds_read_b64_tr_b16 a[52:53], v3 offset:26624
v_mfma_f32_32x32x16_bf16 v[224:239], a[16:19], a[84:87], v[224:239]
ds_read_b64_tr_b16 a[54:55], v3 offset:27136
s_waitcnt lgkmcnt(6)
v_mfma_f32_32x32x16_bf16 v[144:159], a[20:23], a[80:83], v[144:159]
ds_read_b64_tr_b16 a[56:57], v2 offset:30720
v_mfma_f32_32x32x16_bf16 v[240:255], a[20:23], a[84:87], v[240:255]
ds_read_b64_tr_b16 a[58:59], v2 offset:31232
v_mfma_f32_32x32x16_bf16 a[192:207], a[24:27], a[80:83], a[192:207]
ds_read_b64_tr_b16 a[60:61], v3 offset:30720
s_lshr_b32 s90, s2, 3
s_lshl_b32 s90, s90, 3
s_add_u32 s90, s90, s4
s_mul_i32 s90, s90, 122880
s_mul_i32 s93, s3, 20480
s_add_u32 s90, s90, s93
s_add_u32 s90, s90, 35651584
v_accvgpr_write_b32 a244, -1
v_accvgpr_write_b32 a245, -1
v_accvgpr_write_b32 a246, -1
v_accvgpr_write_b32 a247, -1
v_mfma_f32_32x32x16_bf16 a[208:223], a[24:27], a[84:87], a[208:223]
ds_read_b64_tr_b16 a[62:63], v3 offset:31232
v_mfma_f32_32x32x16_bf16 a[224:239], a[28:31], a[80:83], a[224:239]
v_mfma_f32_32x32x16_bf16 v[64:79], a[32:35], a[88:91], v[64:79]
s_waitcnt vmcnt(10)
s_barrier
ds_read_b64_tr_b16 a[0:1], v2 offset:32768
ds_read_b64_tr_b16 a[2:3], v2 offset:33280
v_mfma_f32_32x32x16_bf16 v[160:175], a[32:35], a[92:95], v[160:175]
ds_read_b64_tr_b16 a[4:5], v3 offset:32768
s_add_u32 m0, s47, 0
v_mfma_f32_32x32x16_bf16 v[80:95], a[36:39], a[88:91], v[80:95]
ds_read_b64_tr_b16 a[6:7], v3 offset:33280
buffer_load_dwordx4 v1, s[8:11], s45 offen lds
s_add_u32 s45, s45, s44
v_mfma_f32_32x32x16_bf16 v[176:191], a[36:39], a[92:95], v[176:191]
ds_read_b64_tr_b16 a[8:9], v2 offset:36864
buffer_load_dwordx4 a[80:83], v4, s[12:15], s48 offen offset:0 sc1
v_mfma_f32_32x32x16_bf16 v[96:111], a[40:43], a[88:91], v[96:111]
ds_read_b64_tr_b16 a[10:11], v2 offset:37376
s_add_u32 m0, s47, 1024
v_mfma_f32_32x32x16_bf16 v[192:207], a[40:43], a[92:95], v[192:207]
ds_read_b64_tr_b16 a[12:13], v3 offset:36864
s_waitcnt lgkmcnt(6)
v_mfma_f32_32x32x16_bf16 v[112:127], a[44:47], a[88:91], v[112:127]
ds_read_b64_tr_b16 a[14:15], v3 offset:37376
buffer_load_dwordx4 v1, s[8:11], s45 offen lds
s_add_u32 s45, s45, s44
v_mfma_f32_32x32x16_bf16 v[208:223], a[44:47], a[92:95], v[208:223]
ds_read_b64_tr_b16 a[16:17], v2 offset:40960
ds_read_b64_tr_b16 a[18:19], v2 offset:41472
buffer_load_dwordx4 a[84:87], v5, s[12:15], s48 offen offset:0 sc1
v_mfma_f32_32x32x16_bf16 v[128:143], a[48:51], a[88:91], v[128:143]
ds_read_b64_tr_b16 a[20:21], v3 offset:40960
s_add_u32 m0, s47, 2048
v_mfma_f32_32x32x16_bf16 v[224:239], a[48:51], a[92:95], v[224:239]
ds_read_b64_tr_b16 a[22:23], v3 offset:41472
buffer_load_dwordx4 v1, s[8:11], s45 offen lds
s_add_u32 s45, s45, s44
v_mfma_f32_32x32x16_bf16 v[144:159], a[52:55], a[88:91], v[144:159]
ds_read_b64_tr_b16 a[24:25], v2 offset:45056
v_mfma_f32_32x32x16_bf16 v[240:255], a[52:55], a[92:95], v[240:255]
ds_read_b64_tr_b16 a[26:27], v2 offset:45568
s_add_u32 m0, s47, 3072
v_mfma_f32_32x32x16_bf16 a[192:207], a[56:59], a[88:91], a[192:207]
ds_read_b64_tr_b16 a[28:29], v3 offset:45056
v_mfma_f32_32x32x16_bf16 a[208:223], a[56:59], a[92:95], a[208:223]
ds_read_b64_tr_b16 a[30:31], v3 offset:45568
buffer_load_dwordx4 v1, s[8:11], s45 offen lds
s_add_u32 s45, s45, s44
s_cmp_ge_u32 s45, s46
s_cselect_b32 s45, 0, s45
v_mfma_f32_32x32x16_bf16 a[224:239], a[60:63], a[88:91], a[224:239]
s_waitcnt lgkmcnt(6)
v_mfma_f32_32x32x16_bf16 v[64:79], a[0:3], a[96:99], v[64:79]
ds_read_b64_tr_b16 a[32:33], v2 offset:34816
ds_read_b64_tr_b16 a[34:35], v2 offset:35328
v_mfma_f32_32x32x16_bf16 v[160:175], a[0:3], a[100:103], v[160:175]
ds_read_b64_tr_b16 a[36:37], v3 offset:34816
v_mfma_f32_32x32x16_bf16 v[80:95], a[4:7], a[96:99], v[80:95]
ds_read_b64_tr_b16 a[38:39], v3 offset:35328
v_mfma_f32_32x32x16_bf16 v[176:191], a[4:7], a[100:103], v[176:191]
ds_read_b64_tr_b16 a[40:41], v2 offset:38912
buffer_load_dwordx4 a[88:91], v4, s[12:15], s48 offen offset:1024 sc1
v_mfma_f32_32x32x16_bf16 v[96:111], a[8:11], a[96:99], v[96:111]
ds_read_b64_tr_b16 a[42:43], v2 offset:39424
v_mfma_f32_32x32x16_bf16 v[192:207], a[8:11], a[100:103], v[192:207]
ds_read_b64_tr_b16 a[44:45], v3 offset:38912
v_mfma_f32_32x32x16_bf16 v[112:127], a[12:15], a[96:99], v[112:127]
ds_read_b64_tr_b16 a[46:47], v3 offset:39424
v_mfma_f32_32x32x16_bf16 v[208:223], a[12:15], a[100:103], v[208:223]
ds_read_b64_tr_b16 a[48:49], v2 offset:43008
ds_read_b64_tr_b16 a[50:51], v2 offset:43520
buffer_load_dwordx4 a[92:95], v5, s[12:15], s48 offen offset:1024 sc1
s_add_u32 s48, s48, 2048
s_cmp_ge_u32 s48, 40960
s_cselect_b32 s48, 0, s48
v_mfma_f32_32x32x16_bf16 v[128:143], a[16:19], a[96:99], v[128:143]
ds_read_b64_tr_b16 a[52:53], v3 offset:43008
v_mfma_f32_32x32x16_bf16 v[224:239], a[16:19], a[100:103], v[224:239]
ds_read_b64_tr_b16 a[54:55], v3 offset:43520
s_waitcnt lgkmcnt(6)
v_mfma_f32_32x32x16_bf16 v[144:159], a[20:23], a[96:99], v[144:159]
ds_read_b64_tr_b16 a[56:57], v2 offset:47104
v_mfma_f32_32x32x16_bf16 v[240:255], a[20:23], a[100:103], v[240:255]
ds_read_b64_tr_b16 a[58:59], v2 offset:47616
v_mfma_f32_32x32x16_bf16 a[192:207], a[24:27], a[96:99], a[192:207]
ds_read_b64_tr_b16 a[60:61], v3 offset:47104
buffer_store_dwordx4 a[244:247], v30, s[12:15], s90 offen offset:0 sc1
v_mfma_f32_32x32x16_bf16 a[208:223], a[24:27], a[100:103], a[208:223]
ds_read_b64_tr_b16 a[62:63], v3 offset:47616
v_mfma_f32_32x32x16_bf16 a[224:239], a[28:31], a[96:99], a[224:239]
v_mfma_f32_32x32x16_bf16 v[64:79], a[32:35], a[104:107], v[64:79]
s_waitcnt vmcnt(11)
s_barrier
ds_read_b64_tr_b16 a[0:1], v2 offset:49152
ds_read_b64_tr_b16 a[2:3], v2 offset:49664
v_mfma_f32_32x32x16_bf16 v[160:175], a[32:35], a[108:111], v[160:175]
ds_read_b64_tr_b16 a[4:5], v3 offset:49152
s_add_u32 m0, s47, 16384
v_mfma_f32_32x32x16_bf16 v[80:95], a[36:39], a[104:107], v[80:95]
ds_read_b64_tr_b16 a[6:7], v3 offset:49664
buffer_load_dwordx4 v1, s[8:11], s45 offen lds
s_add_u32 s45, s45, s44
v_mfma_f32_32x32x16_bf16 v[176:191], a[36:39], a[108:111], v[176:191]
ds_read_b64_tr_b16 a[8:9], v2 offset:53248
buffer_load_dwordx4 a[96:99], v4, s[12:15], s48 offen offset:0 sc1
v_mfma_f32_32x32x16_bf16 v[96:111], a[40:43], a[104:107], v[96:111]
ds_read_b64_tr_b16 a[10:11], v2 offset:53760
s_add_u32 m0, s47, 17408
v_mfma_f32_32x32x16_bf16 v[192:207], a[40:43], a[108:111], v[192:207]
ds_read_b64_tr_b16 a[12:13], v3 offset:53248
s_waitcnt lgkmcnt(6)
v_mfma_f32_32x32x16_bf16 v[112:127], a[44:47], a[104:107], v[112:127]
ds_read_b64_tr_b16 a[14:15], v3 offset:53760
buffer_load_dwordx4 v1, s[8:11], s45 offen lds
s_add_u32 s45, s45, s44
v_mfma_f32_32x32x16_bf16 v[208:223], a[44:47], a[108:111], v[208:223]
ds_read_b64_tr_b16 a[16:17], v2 offset:57344
ds_read_b64_tr_b16 a[18:19], v2 offset:57856
buffer_load_dwordx4 a[100:103], v5, s[12:15], s48 offen offset:0 sc1
v_mfma_f32_32x32x16_bf16 v[128:143], a[48:51], a[104:107], v[128:143]
ds_read_b64_tr_b16 a[20:21], v3 offset:57344
s_add_u32 m0, s47, 18432
v_mfma_f32_32x32x16_bf16 v[224:239], a[48:51], a[108:111], v[224:239]
ds_read_b64_tr_b16 a[22:23], v3 offset:57856
buffer_load_dwordx4 v1, s[8:11], s45 offen lds
s_add_u32 s45, s45, s44
v_mfma_f32_32x32x16_bf16 v[144:159], a[52:55], a[104:107], v[144:159]
ds_read_b64_tr_b16 a[24:25], v2 offset:61440
v_mfma_f32_32x32x16_bf16 v[240:255], a[52:55], a[108:111], v[240:255]
ds_read_b64_tr_b16 a[26:27], v2 offset:61952
s_add_u32 m0, s47, 19456
v_mfma_f32_32x32x16_bf16 a[192:207], a[56:59], a[104:107], a[192:207]
ds_read_b64_tr_b16 a[28:29], v3 offset:61440
v_mfma_f32_32x32x16_bf16 a[208:223], a[56:59], a[108:111], a[208:223]
ds_read_b64_tr_b16 a[30:31], v3 offset:61952
buffer_load_dwordx4 v1, s[8:11], s45 offen lds
s_add_u32 s45, s45, s44
s_cmp_ge_u32 s45, s46
s_cselect_b32 s45, 0, s45
v_mfma_f32_32x32x16_bf16 a[224:239], a[60:63], a[104:107], a[224:239]
s_waitcnt lgkmcnt(6)
v_mfma_f32_32x32x16_bf16 v[64:79], a[0:3], a[112:115], v[64:79]
ds_read_b64_tr_b16 a[32:33], v2 offset:51200
ds_read_b64_tr_b16 a[34:35], v2 offset:51712
v_mfma_f32_32x32x16_bf16 v[160:175], a[0:3], a[116:119], v[160:175]
ds_read_b64_tr_b16 a[36:37], v3 offset:51200
v_mfma_f32_32x32x16_bf16 v[80:95], a[4:7], a[112:115], v[80:95]
ds_read_b64_tr_b16 a[38:39], v3 offset:51712
v_mfma_f32_32x32x16_bf16 v[176:191], a[4:7], a[116:119], v[176:191]
ds_read_b64_tr_b16 a[40:41], v2 offset:55296
buffer_load_dwordx4 a[104:107], v4, s[12:15], s48 offen offset:1024 sc1
v_mfma_f32_32x32x16_bf16 v[96:111], a[8:11], a[112:115], v[96:111]
ds_read_b64_tr_b16 a[42:43], v2 offset:55808
v_mfma_f32_32x32x16_bf16 v[192:207], a[8:11], a[116:119], v[192:207]
ds_read_b64_tr_b16 a[44:45], v3 offset:55296
v_mfma_f32_32x32x16_bf16 v[112:127], a[12:15], a[112:115], v[112:127]
ds_read_b64_tr_b16 a[46:47], v3 offset:55808
v_mfma_f32_32x32x16_bf16 v[208:223], a[12:15], a[116:119], v[208:223]
ds_read_b64_tr_b16 a[48:49], v2 offset:59392
ds_read_b64_tr_b16 a[50:51], v2 offset:59904
buffer_load_dwordx4 a[108:111], v5, s[12:15], s48 offen offset:1024 sc1
s_add_u32 s48, s48, 2048
s_cmp_ge_u32 s48, 40960
s_cselect_b32 s48, 0, s48
v_mfma_f32_32x32x16_bf16 v[128:143], a[16:19], a[112:115], v[128:143]
ds_read_b64_tr_b16 a[52:53], v3 offset:59392
v_mfma_f32_32x32x16_bf16 v[224:239], a[16:19], a[116:119], v[224:239]
ds_read_b64_tr_b16 a[54:55], v3 offset:59904
s_waitcnt lgkmcnt(6)
v_mfma_f32_32x32x16_bf16 v[144:159], a[20:23], a[112:115], v[144:159]
ds_read_b64_tr_b16 a[56:57], v2 offset:63488
v_mfma_f32_32x32x16_bf16 v[240:255], a[20:23], a[116:119], v[240:255]
ds_read_b64_tr_b16 a[58:59], v2 offset:64000
v_mfma_f32_32x32x16_bf16 a[192:207], a[24:27], a[112:115], a[192:207]
ds_read_b64_tr_b16 a[60:61], v3 offset:63488
v_mfma_f32_32x32x16_bf16 a[208:223], a[24:27], a[116:119], a[208:223]
ds_read_b64_tr_b16 a[62:63], v3 offset:64000
v_mfma_f32_32x32x16_bf16 a[224:239], a[28:31], a[112:115], a[224:239]
v_mfma_f32_32x32x16_bf16 v[64:79], a[32:35], a[120:123], v[64:79]
s_waitcnt vmcnt(11)
s_barrier
ds_read_b64_tr_b16 a[0:1], v2 offset:0
ds_read_b64_tr_b16 a[2:3], v2 offset:512
v_mfma_f32_32x32x16_bf16 v[160:175], a[32:35], a[124:127], v[160:175]
ds_read_b64_tr_b16 a[4:5], v3 offset:0
s_add_u32 m0, s47, 32768
v_mfma_f32_32x32x16_bf16 v[80:95], a[36:39], a[120:123], v[80:95]
ds_read_b64_tr_b16 a[6:7], v3 offset:512
buffer_load_dwordx4 v1, s[8:11], s45 offen lds
s_add_u32 s45, s45, s44
v_mfma_f32_32x32x16_bf16 v[176:191], a[36:39], a[124:127], v[176:191]
ds_read_b64_tr_b16 a[8:9], v2 offset:4096
buffer_load_dwordx4 a[112:115], v4, s[12:15], s48 offen offset:0 sc1
v_mfma_f32_32x32x16_bf16 v[96:111], a[40:43], a[120:123], v[96:111]
ds_read_b64_tr_b16 a[10:11], v2 offset:4608
s_add_u32 m0, s47, 33792
v_mfma_f32_32x32x16_bf16 v[192:207], a[40:43], a[124:127], v[192:207]
ds_read_b64_tr_b16 a[12:13], v3 offset:4096
s_waitcnt lgkmcnt(6)
v_mfma_f32_32x32x16_bf16 v[112:127], a[44:47], a[120:123], v[112:127]
ds_read_b64_tr_b16 a[14:15], v3 offset:4608
buffer_load_dwordx4 v1, s[8:11], s45 offen lds
s_add_u32 s45, s45, s44
v_mfma_f32_32x32x16_bf16 v[208:223], a[44:47], a[124:127], v[208:223]
ds_read_b64_tr_b16 a[16:17], v2 offset:8192
ds_read_b64_tr_b16 a[18:19], v2 offset:8704
buffer_load_dwordx4 a[116:119], v5, s[12:15], s48 offen offset:0 sc1
v_mfma_f32_32x32x16_bf16 v[128:143], a[48:51], a[120:123], v[128:143]
ds_read_b64_tr_b16 a[20:21], v3 offset:8192
s_add_u32 m0, s47, 34816
v_mfma_f32_32x32x16_bf16 v[224:239], a[48:51], a[124:127], v[224:239]
ds_read_b64_tr_b16 a[22:23], v3 offset:8704
buffer_load_dwordx4 v1, s[8:11], s45 offen lds
s_add_u32 s45, s45, s44
v_mfma_f32_32x32x16_bf16 v[144:159], a[52:55], a[120:123], v[144:159]
ds_read_b64_tr_b16 a[24:25], v2 offset:12288
v_mfma_f32_32x32x16_bf16 v[240:255], a[52:55], a[124:127], v[240:255]
ds_read_b64_tr_b16 a[26:27], v2 offset:12800
s_add_u32 m0, s47, 35840
v_mfma_f32_32x32x16_bf16 a[192:207], a[56:59], a[120:123], a[192:207]
ds_read_b64_tr_b16 a[28:29], v3 offset:12288
buffer_store_dwordx4 a[244:247], v30, s[12:15], s90 offen offset:1024 sc1
v_mfma_f32_32x32x16_bf16 a[208:223], a[56:59], a[124:127], a[208:223]
ds_read_b64_tr_b16 a[30:31], v3 offset:12800
buffer_load_dwordx4 v1, s[8:11], s45 offen lds
s_add_u32 s45, s45, s44
s_cmp_ge_u32 s45, s46
s_cselect_b32 s45, 0, s45
v_mfma_f32_32x32x16_bf16 a[224:239], a[60:63], a[120:123], a[224:239]
s_waitcnt lgkmcnt(6)
v_mfma_f32_32x32x16_bf16 v[64:79], a[0:3], a[64:67], v[64:79]
ds_read_b64_tr_b16 a[32:33], v2 offset:2048
ds_read_b64_tr_b16 a[34:35], v2 offset:2560
v_mfma_f32_32x32x16_bf16 v[160:175], a[0:3], a[68:71], v[160:175]
ds_read_b64_tr_b16 a[36:37], v3 offset:2048
v_mfma_f32_32x32x16_bf16 v[80:95], a[4:7], a[64:67], v[80:95]
ds_read_b64_tr_b16 a[38:39], v3 offset:2560
v_mfma_f32_32x32x16_bf16 v[176:191], a[4:7], a[68:71], v[176:191]
ds_read_b64_tr_b16 a[40:41], v2 offset:6144
buffer_load_dwordx4 a[120:123], v4, s[12:15], s48 offen offset:1024 sc1
v_mfma_f32_32x32x16_bf16 v[96:111], a[8:11], a[64:67], v[96:111]
ds_read_b64_tr_b16 a[42:43], v2 offset:6656
v_mfma_f32_32x32x16_bf16 v[192:207], a[8:11], a[68:71], v[192:207]
ds_read_b64_tr_b16 a[44:45], v3 offset:6144
v_mfma_f32_32x32x16_bf16 v[112:127], a[12:15], a[64:67], v[112:127]
ds_read_b64_tr_b16 a[46:47], v3 offset:6656
v_mfma_f32_32x32x16_bf16 v[208:223], a[12:15], a[68:71], v[208:223]
ds_read_b64_tr_b16 a[48:49], v2 offset:10240
ds_read_b64_tr_b16 a[50:51], v2 offset:10752
buffer_load_dwordx4 a[124:127], v5, s[12:15], s48 offen offset:1024 sc1
s_add_u32 s48, s48, 2048
s_cmp_ge_u32 s48, 40960
s_cselect_b32 s48, 0, s48
v_mfma_f32_32x32x16_bf16 v[128:143], a[16:19], a[64:67], v[128:143]
ds_read_b64_tr_b16 a[52:53], v3 offset:10240
v_mfma_f32_32x32x16_bf16 v[224:239], a[16:19], a[68:71], v[224:239]
ds_read_b64_tr_b16 a[54:55], v3 offset:10752
s_waitcnt lgkmcnt(6)
v_mfma_f32_32x32x16_bf16 v[144:159], a[20:23], a[64:67], v[144:159]
ds_read_b64_tr_b16 a[56:57], v2 offset:14336
v_mfma_f32_32x32x16_bf16 v[240:255], a[20:23], a[68:71], v[240:255]
ds_read_b64_tr_b16 a[58:59], v2 offset:14848
v_mfma_f32_32x32x16_bf16 a[192:207], a[24:27], a[64:67], a[192:207]
ds_read_b64_tr_b16 a[60:61], v3 offset:14336
v_mfma_f32_32x32x16_bf16 a[208:223], a[24:27], a[68:71], a[208:223]
ds_read_b64_tr_b16 a[62:63], v3 offset:14848
v_mfma_f32_32x32x16_bf16 a[224:239], a[28:31], a[64:67], a[224:239]
v_mfma_f32_32x32x16_bf16 v[64:79], a[32:35], a[72:75], v[64:79]
s_waitcnt vmcnt(11)
s_barrier
ds_read_b64_tr_b16 a[0:1], v2 offset:16384
ds_read_b64_tr_b16 a[2:3], v2 offset:16896
v_mfma_f32_32x32x16_bf16 v[160:175], a[32:35], a[76:79], v[160:175]
ds_read_b64_tr_b16 a[4:5], v3 offset:16384
s_add_u32 m0, s47, 49152
v_mfma_f32_32x32x16_bf16 v[80:95], a[36:39], a[72:75], v[80:95]
ds_read_b64_tr_b16 a[6:7], v3 offset:16896
buffer_load_dwordx4 v1, s[8:11], s45 offen lds
s_add_u32 s45, s45, s44
v_mfma_f32_32x32x16_bf16 v[176:191], a[36:39], a[76:79], v[176:191]
ds_read_b64_tr_b16 a[8:9], v2 offset:20480
buffer_load_dwordx4 a[64:67], v4, s[12:15], s48 offen offset:0 sc1
v_mfma_f32_32x32x16_bf16 v[96:111], a[40:43], a[72:75], v[96:111]
ds_read_b64_tr_b16 a[10:11], v2 offset:20992
s_add_u32 m0, s47, 50176
v_mfma_f32_32x32x16_bf16 v[192:207], a[40:43], a[76:79], v[192:207]
ds_read_b64_tr_b16 a[12:13], v3 offset:20480
s_waitcnt lgkmcnt(6)
v_mfma_f32_32x32x16_bf16 v[112:127], a[44:47], a[72:75], v[112:127]
ds_read_b64_tr_b16 a[14:15], v3 offset:20992
buffer_load_dwordx4 v1, s[8:11], s45 offen lds
s_add_u32 s45, s45, s44
v_mfma_f32_32x32x16_bf16 v[208:223], a[44:47], a[76:79], v[208:223]
ds_read_b64_tr_b16 a[16:17], v2 offset:24576
ds_read_b64_tr_b16 a[18:19], v2 offset:25088
buffer_load_dwordx4 a[68:71], v5, s[12:15], s48 offen offset:0 sc1
v_mfma_f32_32x32x16_bf16 v[128:143], a[48:51], a[72:75], v[128:143]
ds_read_b64_tr_b16 a[20:21], v3 offset:24576
s_add_u32 m0, s47, 51200
v_mfma_f32_32x32x16_bf16 v[224:239], a[48:51], a[76:79], v[224:239]
ds_read_b64_tr_b16 a[22:23], v3 offset:25088
buffer_load_dwordx4 v1, s[8:11], s45 offen lds
s_add_u32 s45, s45, s44
v_mfma_f32_32x32x16_bf16 v[144:159], a[52:55], a[72:75], v[144:159]
ds_read_b64_tr_b16 a[24:25], v2 offset:28672
v_mfma_f32_32x32x16_bf16 v[240:255], a[52:55], a[76:79], v[240:255]
ds_read_b64_tr_b16 a[26:27], v2 offset:29184
s_add_u32 m0, s47, 52224
v_mfma_f32_32x32x16_bf16 a[192:207], a[56:59], a[72:75], a[192:207]
ds_read_b64_tr_b16 a[28:29], v3 offset:28672
buffer_store_dwordx4 a[244:247], v30, s[12:15], s90 offen offset:2048 sc1
v_mfma_f32_32x32x16_bf16 a[208:223], a[56:59], a[76:79], a[208:223]
ds_read_b64_tr_b16 a[30:31], v3 offset:29184
buffer_load_dwordx4 v1, s[8:11], s45 offen lds
s_add_u32 s45, s45, s44
s_cmp_ge_u32 s45, s46
s_cselect_b32 s45, 0, s45
v_mfma_f32_32x32x16_bf16 a[224:239], a[60:63], a[72:75], a[224:239]
s_waitcnt lgkmcnt(6)
v_mfma_f32_32x32x16_bf16 v[64:79], a[0:3], a[80:83], v[64:79]
ds_read_b64_tr_b16 a[32:33], v2 offset:18432
ds_read_b64_tr_b16 a[34:35], v2 offset:18944
v_mfma_f32_32x32x16_bf16 v[160:175], a[0:3], a[84:87], v[160:175]
ds_read_b64_tr_b16 a[36:37], v3 offset:18432
v_mfma_f32_32x32x16_bf16 v[80:95], a[4:7], a[80:83], v[80:95]
ds_read_b64_tr_b16 a[38:39], v3 offset:18944
v_mfma_f32_32x32x16_bf16 v[176:191], a[4:7], a[84:87], v[176:191]
ds_read_b64_tr_b16 a[40:41], v2 offset:22528
buffer_load_dwordx4 a[72:75], v4, s[12:15], s48 offen offset:1024 sc1
v_mfma_f32_32x32x16_bf16 v[96:111], a[8:11], a[80:83], v[96:111]
ds_read_b64_tr_b16 a[42:43], v2 offset:23040
v_mfma_f32_32x32x16_bf16 v[192:207], a[8:11], a[84:87], v[192:207]
ds_read_b64_tr_b16 a[44:45], v3 offset:22528
v_mfma_f32_32x32x16_bf16 v[112:127], a[12:15], a[80:83], v[112:127]
ds_read_b64_tr_b16 a[46:47], v3 offset:23040
v_mfma_f32_32x32x16_bf16 v[208:223], a[12:15], a[84:87], v[208:223]
ds_read_b64_tr_b16 a[48:49], v2 offset:26624
ds_read_b64_tr_b16 a[50:51], v2 offset:27136
buffer_load_dwordx4 a[76:79], v5, s[12:15], s48 offen offset:1024 sc1
s_add_u32 s48, s48, 2048
s_cmp_ge_u32 s48, 40960
s_cselect_b32 s48, 0, s48
v_mfma_f32_32x32x16_bf16 v[128:143], a[16:19], a[80:83], v[128:143]
ds_read_b64_tr_b16 a[52:53], v3 offset:26624
v_mfma_f32_32x32x16_bf16 v[224:239], a[16:19], a[84:87], v[224:239]
ds_read_b64_tr_b16 a[54:55], v3 offset:27136
s_waitcnt lgkmcnt(6)
v_mfma_f32_32x32x16_bf16 v[144:159], a[20:23], a[80:83], v[144:159]
ds_read_b64_tr_b16 a[56:57], v2 offset:30720
v_mfma_f32_32x32x16_bf16 v[240:255], a[20:23], a[84:87], v[240:255]
ds_read_b64_tr_b16 a[58:59], v2 offset:31232
v_mfma_f32_32x32x16_bf16 a[192:207], a[24:27], a[80:83], a[192:207]
ds_read_b64_tr_b16 a[60:61], v3 offset:30720
v_mfma_f32_32x32x16_bf16 a[208:223], a[24:27], a[84:87], a[208:223]
ds_read_b64_tr_b16 a[62:63], v3 offset:31232
v_mfma_f32_32x32x16_bf16 a[224:239], a[28:31], a[80:83], a[224:239]
v_mfma_f32_32x32x16_bf16 v[64:79], a[32:35], a[88:91], v[64:79]
s_waitcnt vmcnt(11)
s_barrier
ds_read_b64_tr_b16 a[0:1], v2 offset:32768
ds_read_b64_tr_b16 a[2:3], v2 offset:33280
v_mfma_f32_32x32x16_bf16 v[160:175], a[32:35], a[92:95], v[160:175]
ds_read_b64_tr_b16 a[4:5], v3 offset:32768
s_add_u32 m0, s47, 0
v_mfma_f32_32x32x16_bf16 v[80:95], a[36:39], a[88:91], v[80:95]
ds_read_b64_tr_b16 a[6:7], v3 offset:33280
buffer_load_dwordx4 v1, s[8:11], s45 offen lds
s_add_u32 s45, s45, s44
v_mfma_f32_32x32x16_bf16 v[176:191], a[36:39], a[92:95], v[176:191]
ds_read_b64_tr_b16 a[8:9], v2 offset:36864
buffer_load_dwordx4 a[80:83], v4, s[12:15], s48 offen offset:0 sc1
v_mfma_f32_32x32x16_bf16 v[96:111], a[40:43], a[88:91], v[96:111]
ds_read_b64_tr_b16 a[10:11], v2 offset:37376
s_add_u32 m0, s47, 1024
v_mfma_f32_32x32x16_bf16 v[192:207], a[40:43], a[92:95], v[192:207]
ds_read_b64_tr_b16 a[12:13], v3 offset:36864
s_waitcnt lgkmcnt(6)
v_mfma_f32_32x32x16_bf16 v[112:127], a[44:47], a[88:91], v[112:127]
ds_read_b64_tr_b16 a[14:15], v3 offset:37376
buffer_load_dwordx4 v1, s[8:11], s45 offen lds
s_add_u32 s45, s45, s44
v_mfma_f32_32x32x16_bf16 v[208:223], a[44:47], a[92:95], v[208:223]
ds_read_b64_tr_b16 a[16:17], v2 offset:40960
ds_read_b64_tr_b16 a[18:19], v2 offset:41472
buffer_load_dwordx4 a[84:87], v5, s[12:15], s48 offen offset:0 sc1
v_mfma_f32_32x32x16_bf16 v[128:143], a[48:51], a[88:91], v[128:143]
ds_read_b64_tr_b16 a[20:21], v3 offset:40960
s_add_u32 m0, s47, 2048
v_mfma_f32_32x32x16_bf16 v[224:239], a[48:51], a[92:95], v[224:239]
ds_read_b64_tr_b16 a[22:23], v3 offset:41472
buffer_load_dwordx4 v1, s[8:11], s45 offen lds
s_add_u32 s45, s45, s44
v_mfma_f32_32x32x16_bf16 v[144:159], a[52:55], a[88:91], v[144:159]
ds_read_b64_tr_b16 a[24:25], v2 offset:45056
v_mfma_f32_32x32x16_bf16 v[240:255], a[52:55], a[92:95], v[240:255]
ds_read_b64_tr_b16 a[26:27], v2 offset:45568
s_add_u32 m0, s47, 3072
v_mfma_f32_32x32x16_bf16 a[192:207], a[56:59], a[88:91], a[192:207]
ds_read_b64_tr_b16 a[28:29], v3 offset:45056
buffer_store_dwordx4 a[244:247], v30, s[12:15], s90 offen offset:3072 sc1
s_add_u32 s90, s90, 4096
v_mfma_f32_32x32x16_bf16 a[208:223], a[56:59], a[92:95], a[208:223]
ds_read_b64_tr_b16 a[30:31], v3 offset:45568
buffer_load_dwordx4 v1, s[8:11], s45 offen lds
s_add_u32 s45, s45, s44
s_cmp_ge_u32 s45, s46
s_cselect_b32 s45, 0, s45
v_mfma_f32_32x32x16_bf16 a[224:239], a[60:63], a[88:91], a[224:239]
s_waitcnt lgkmcnt(6)
v_mfma_f32_32x32x16_bf16 v[64:79], a[0:3], a[96:99], v[64:79]
ds_read_b64_tr_b16 a[32:33], v2 offset:34816
ds_read_b64_tr_b16 a[34:35], v2 offset:35328
v_mfma_f32_32x32x16_bf16 v[160:175], a[0:3], a[100:103], v[160:175]
ds_read_b64_tr_b16 a[36:37], v3 offset:34816
v_mfma_f32_32x32x16_bf16 v[80:95], a[4:7], a[96:99], v[80:95]
ds_read_b64_tr_b16 a[38:39], v3 offset:35328
v_mfma_f32_32x32x16_bf16 v[176:191], a[4:7], a[100:103], v[176:191]
ds_read_b64_tr_b16 a[40:41], v2 offset:38912
buffer_load_dwordx4 a[88:91], v4, s[12:15], s48 offen offset:1024 sc1
v_mfma_f32_32x32x16_bf16 v[96:111], a[8:11], a[96:99], v[96:111]
ds_read_b64_tr_b16 a[42:43], v2 offset:39424
v_mfma_f32_32x32x16_bf16 v[192:207], a[8:11], a[100:103], v[192:207]
ds_read_b64_tr_b16 a[44:45], v3 offset:38912
v_mfma_f32_32x32x16_bf16 v[112:127], a[12:15], a[96:99], v[112:127]
ds_read_b64_tr_b16 a[46:47], v3 offset:39424
v_mfma_f32_32x32x16_bf16 v[208:223], a[12:15], a[100:103], v[208:223]
ds_read_b64_tr_b16 a[48:49], v2 offset:43008
ds_read_b64_tr_b16 a[50:51], v2 offset:43520
buffer_load_dwordx4 a[92:95], v5, s[12:15], s48 offen offset:1024 sc1
s_add_u32 s48, s48, 2048
s_cmp_ge_u32 s48, 40960
s_cselect_b32 s48, 0, s48
v_mfma_f32_32x32x16_bf16 v[128:143], a[16:19], a[96:99], v[128:143]
ds_read_b64_tr_b16 a[52:53], v3 offset:43008
v_mfma_f32_32x32x16_bf16 v[224:239], a[16:19], a[100:103], v[224:239]
ds_read_b64_tr_b16 a[54:55], v3 offset:43520
s_waitcnt lgkmcnt(6)
v_mfma_f32_32x32x16_bf16 v[144:159], a[20:23], a[96:99], v[144:159]
ds_read_b64_tr_b16 a[56:57], v2 offset:47104
v_mfma_f32_32x32x16_bf16 v[240:255], a[20:23], a[100:103], v[240:255]
ds_read_b64_tr_b16 a[58:59], v2 offset:47616
v_mfma_f32_32x32x16_bf16 a[192:207], a[24:27], a[96:99], a[192:207]
ds_read_b64_tr_b16 a[60:61], v3 offset:47104
v_mfma_f32_32x32x16_bf16 a[208:223], a[24:27], a[100:103], a[208:223]
ds_read_b64_tr_b16 a[62:63], v3 offset:47616
v_mfma_f32_32x32x16_bf16 a[224:239], a[28:31], a[96:99], a[224:239]
v_mfma_f32_32x32x16_bf16 v[64:79], a[32:35], a[104:107], v[64:79]
s_waitcnt vmcnt(11)
s_barrier
ds_read_b64_tr_b16 a[0:1], v2 offset:49152
ds_read_b64_tr_b16 a[2:3], v2 offset:49664
v_mfma_f32_32x32x16_bf16 v[160:175], a[32:35], a[108:111], v[160:175]
ds_read_b64_tr_b16 a[4:5], v3 offset:49152
s_add_u32 m0, s47, 16384
v_mfma_f32_32x32x16_bf16 v[80:95], a[36:39], a[104:107], v[80:95]
ds_read_b64_tr_b16 a[6:7], v3 offset:49664
buffer_load_dwordx4 v1, s[8:11], s45 offen lds
s_add_u32 s45, s45, s44
v_mfma_f32_32x32x16_bf16 v[176:191], a[36:39], a[108:111], v[176:191]
ds_read_b64_tr_b16 a[8:9], v2 offset:53248
buffer_load_dwordx4 a[96:99], v4, s[12:15], s48 offen offset:0 sc1
v_mfma_f32_32x32x16_bf16 v[96:111], a[40:43], a[104:107], v[96:111]
ds_read_b64_tr_b16 a[10:11], v2 offset:53760
s_add_u32 m0, s47, 17408
v_mfma_f32_32x32x16_bf16 v[192:207], a[40:43], a[108:111], v[192:207]
ds_read_b64_tr_b16 a[12:13], v3 offset:53248
s_waitcnt lgkmcnt(6)
v_mfma_f32_32x32x16_bf16 v[112:127], a[44:47], a[104:107], v[112:127]
ds_read_b64_tr_b16 a[14:15], v3 offset:53760
buffer_load_dwordx4 v1, s[8:11], s45 offen lds
s_add_u32 s45, s45, s44
v_mfma_f32_32x32x16_bf16 v[208:223], a[44:47], a[108:111], v[208:223]
ds_read_b64_tr_b16 a[16:17], v2 offset:57344
ds_read_b64_tr_b16 a[18:19], v2 offset:57856
buffer_load_dwordx4 a[100:103], v5, s[12:15], s48 offen offset:0 sc1
v_mfma_f32_32x32x16_bf16 v[128:143], a[48:51], a[104:107], v[128:143]
ds_read_b64_tr_b16 a[20:21], v3 offset:57344
s_add_u32 m0, s47, 18432
v_mfma_f32_32x32x16_bf16 v[224:239], a[48:51], a[108:111], v[224:239]
ds_read_b64_tr_b16 a[22:23], v3 offset:57856
buffer_load_dwordx4 v1, s[8:11], s45 offen lds
s_add_u32 s45, s45, s44
v_mfma_f32_32x32x16_bf16 v[144:159], a[52:55], a[104:107], v[144:159]
ds_read_b64_tr_b16 a[24:25], v2 offset:61440
v_mfma_f32_32x32x16_bf16 v[240:255], a[52:55], a[108:111], v[240:255]
ds_read_b64_tr_b16 a[26:27], v2 offset:61952
s_add_u32 m0, s47, 19456
v_mfma_f32_32x32x16_bf16 a[192:207], a[56:59], a[104:107], a[192:207]
ds_read_b64_tr_b16 a[28:29], v3 offset:61440
v_mfma_f32_32x32x16_bf16 a[208:223], a[56:59], a[108:111], a[208:223]
ds_read_b64_tr_b16 a[30:31], v3 offset:61952
buffer_load_dwordx4 v1, s[8:11], s45 offen lds
s_add_u32 s45, s45, s44
s_cmp_ge_u32 s45, s46
s_cselect_b32 s45, 0, s45
v_mfma_f32_32x32x16_bf16 a[224:239], a[60:63], a[104:107], a[224:239]
s_waitcnt lgkmcnt(6)
v_mfma_f32_32x32x16_bf16 v[64:79], a[0:3], a[112:115], v[64:79]
ds_read_b64_tr_b16 a[32:33], v2 offset:51200
ds_read_b64_tr_b16 a[34:35], v2 offset:51712
v_mfma_f32_32x32x16_bf16 v[160:175], a[0:3], a[116:119], v[160:175]
ds_read_b64_tr_b16 a[36:37], v3 offset:51200
v_mfma_f32_32x32x16_bf16 v[80:95], a[4:7], a[112:115], v[80:95]
ds_read_b64_tr_b16 a[38:39], v3 offset:51712
v_mfma_f32_32x32x16_bf16 v[176:191], a[4:7], a[116:119], v[176:191]
ds_read_b64_tr_b16 a[40:41], v2 offset:55296
buffer_load_dwordx4 a[104:107], v4, s[12:15], s48 offen offset:1024 sc1
v_mfma_f32_32x32x16_bf16 v[96:111], a[8:11], a[112:115], v[96:111]
ds_read_b64_tr_b16 a[42:43], v2 offset:55808
v_mfma_f32_32x32x16_bf16 v[192:207], a[8:11], a[116:119], v[192:207]
ds_read_b64_tr_b16 a[44:45], v3 offset:55296
v_mfma_f32_32x32x16_bf16 v[112:127], a[12:15], a[112:115], v[112:127]
ds_read_b64_tr_b16 a[46:47], v3 offset:55808
v_mfma_f32_32x32x16_bf16 v[208:223], a[12:15], a[116:119], v[208:223]
ds_read_b64_tr_b16 a[48:49], v2 offset:59392
ds_read_b64_tr_b16 a[50:51], v2 offset:59904
buffer_load_dwordx4 a[108:111], v5, s[12:15], s48 offen offset:1024 sc1
s_add_u32 s48, s48, 2048
s_cmp_ge_u32 s48, 40960
s_cselect_b32 s48, 0, s48
v_mfma_f32_32x32x16_bf16 v[128:143], a[16:19], a[112:115], v[128:143]
ds_read_b64_tr_b16 a[52:53], v3 offset:59392
v_mfma_f32_32x32x16_bf16 v[224:239], a[16:19], a[116:119], v[224:239]
ds_read_b64_tr_b16 a[54:55], v3 offset:59904
s_waitcnt lgkmcnt(6)
v_mfma_f32_32x32x16_bf16 v[144:159], a[20:23], a[112:115], v[144:159]
ds_read_b64_tr_b16 a[56:57], v2 offset:63488
v_mfma_f32_32x32x16_bf16 v[240:255], a[20:23], a[116:119], v[240:255]
ds_read_b64_tr_b16 a[58:59], v2 offset:64000
v_mfma_f32_32x32x16_bf16 a[192:207], a[24:27], a[112:115], a[192:207]
ds_read_b64_tr_b16 a[60:61], v3 offset:63488
buffer_store_dwordx4 a[244:247], v30, s[12:15], s90 offen offset:0 sc1
v_mfma_f32_32x32x16_bf16 a[208:223], a[24:27], a[116:119], a[208:223]
ds_read_b64_tr_b16 a[62:63], v3 offset:64000
v_mfma_f32_32x32x16_bf16 a[224:239], a[28:31], a[112:115], a[224:239]
v_mfma_f32_32x32x16_bf16 v[64:79], a[32:35], a[120:123], v[64:79]
s_waitcnt vmcnt(11)
s_barrier
ds_read_b64_tr_b16 a[0:1], v2 offset:0
ds_read_b64_tr_b16 a[2:3], v2 offset:512
v_mfma_f32_32x32x16_bf16 v[160:175], a[32:35], a[124:127], v[160:175]
ds_read_b64_tr_b16 a[4:5], v3 offset:0
s_add_u32 m0, s47, 32768
v_mfma_f32_32x32x16_bf16 v[80:95], a[36:39], a[120:123], v[80:95]
ds_read_b64_tr_b16 a[6:7], v3 offset:512
buffer_load_dwordx4 v1, s[8:11], s45 offen lds
s_add_u32 s45, s45, s44
v_mfma_f32_32x32x16_bf16 v[176:191], a[36:39], a[124:127], v[176:191]
ds_read_b64_tr_b16 a[8:9], v2 offset:4096
buffer_load_dwordx4 a[112:115], v4, s[12:15], s48 offen offset:0 sc1
v_mfma_f32_32x32x16_bf16 v[96:111], a[40:43], a[120:123], v[96:111]
ds_read_b64_tr_b16 a[10:11], v2 offset:4608
s_add_u32 m0, s47, 33792
v_mfma_f32_32x32x16_bf16 v[192:207], a[40:43], a[124:127], v[192:207]
ds_read_b64_tr_b16 a[12:13], v3 offset:4096
s_waitcnt lgkmcnt(6)
v_mfma_f32_32x32x16_bf16 v[112:127], a[44:47], a[120:123], v[112:127]
ds_read_b64_tr_b16 a[14:15], v3 offset:4608
buffer_load_dwordx4 v1, s[8:11], s45 offen lds
s_add_u32 s45, s45, s44
v_mfma_f32_32x32x16_bf16 v[208:223], a[44:47], a[124:127], v[208:223]
ds_read_b64_tr_b16 a[16:17], v2 offset:8192
ds_read_b64_tr_b16 a[18:19], v2 offset:8704
buffer_load_dwordx4 a[116:119], v5, s[12:15], s48 offen offset:0 sc1
v_mfma_f32_32x32x16_bf16 v[128:143], a[48:51], a[120:123], v[128:143]
ds_read_b64_tr_b16 a[20:21], v3 offset:8192
s_add_u32 m0, s47, 34816
v_mfma_f32_32x32x16_bf16 v[224:239], a[48:51], a[124:127], v[224:239]
ds_read_b64_tr_b16 a[22:23], v3 offset:8704
buffer_load_dwordx4 v1, s[8:11], s45 offen lds
s_add_u32 s45, s45, s44
v_mfma_f32_32x32x16_bf16 v[144:159], a[52:55], a[120:123], v[144:159]
ds_read_b64_tr_b16 a[24:25], v2 offset:12288
v_mfma_f32_32x32x16_bf16 v[240:255], a[52:55], a[124:127], v[240:255]
ds_read_b64_tr_b16 a[26:27], v2 offset:12800
s_add_u32 m0, s47, 35840
v_mfma_f32_32x32x16_bf16 a[192:207], a[56:59], a[120:123], a[192:207]
ds_read_b64_tr_b16 a[28:29], v3 offset:12288
v_mfma_f32_32x32x16_bf16 a[208:223], a[56:59], a[124:127], a[208:223]
ds_read_b64_tr_b16 a[30:31], v3 offset:12800
buffer_load_dwordx4 v1, s[8:11], s45 offen lds
s_add_u32 s45, s45, s44
s_cmp_ge_u32 s45, s46
s_cselect_b32 s45, 0, s45
v_mfma_f32_32x32x16_bf16 a[224:239], a[60:63], a[120:123], a[224:239]
s_waitcnt lgkmcnt(6)
v_mfma_f32_32x32x16_bf16 v[64:79], a[0:3], a[64:67], v[64:79]
ds_read_b64_tr_b16 a[32:33], v2 offset:2048
ds_read_b64_tr_b16 a[34:35], v2 offset:2560
v_mfma_f32_32x32x16_bf16 v[160:175], a[0:3], a[68:71], v[160:175]
ds_read_b64_tr_b16 a[36:37], v3 offset:2048
s_lshr_b32 s62, s2, 3
s_lshl_b32 s62, s62, 2
s_add_u32 s62, s62, s3
s_and_b32 s62, s62, 31
s_lshl_b32 s62, s62, 11
s_add_u32 s62, s62, 8192
v_lshl_add_u32 v14, v0, 5, s62
v_mfma_f32_32x32x16_bf16 v[80:95], a[4:7], a[64:67], v[80:95]
ds_read_b64_tr_b16 a[38:39], v3 offset:2560
v_mfma_f32_32x32x16_bf16 v[176:191], a[4:7], a[68:71], v[176:191]
ds_read_b64_tr_b16 a[40:41], v2 offset:6144
buffer_load_dwordx4 a[120:123], v4, s[12:15], s48 offen offset:1024 sc1
v_mfma_f32_32x32x16_bf16 v[96:111], a[8:11], a[64:67], v[96:111]
ds_read_b64_tr_b16 a[42:43], v2 offset:6656
v_min_u32 v14, RARE0-CP1, v14
v_mov_b32 v15, 0
v_mfma_f32_32x32x16_bf16 v[192:207], a[8:11], a[68:71], v[192:207]
ds_read_b64_tr_b16 a[44:45], v3 offset:6144
v_mfma_f32_32x32x16_bf16 v[112:127], a[12:15], a[64:67], v[112:127]
ds_read_b64_tr_b16 a[46:47], v3 offset:6656
v_mfma_f32_32x32x16_bf16 v[208:223], a[12:15], a[68:71], v[208:223]
ds_read_b64_tr_b16 a[48:49], v2 offset:10240
ds_read_b64_tr_b16 a[50:51], v2 offset:10752
buffer_load_dwordx4 a[124:127], v5, s[12:15], s48 offen offset:1024 sc1
s_add_u32 s48, s48, 2048
s_cmp_ge_u32 s48, 40960
s_cselect_b32 s48, 0, s48
s_getpc_b64 s[62:63]
CP1:
v_lshl_add_u64 v[14:15], v[14:15], 0, s[62:63]
v_mfma_f32_32x32x16_bf16 v[128:143], a[16:19], a[64:67], v[128:143]
ds_read_b64_tr_b16 a[52:53], v3 offset:10240
v_mfma_f32_32x32x16_bf16 v[224:239], a[16:19], a[68:71], v[224:239]
ds_read_b64_tr_b16 a[54:55], v3 offset:10752
s_waitcnt lgkmcnt(6)
v_mfma_f32_32x32x16_bf16 v[144:159], a[20:23], a[64:67], v[144:159]
ds_read_b64_tr_b16 a[56:57], v2 offset:14336
global_load_dword a249, v[14:15], off
v_mfma_f32_32x32x16_bf16 v[240:255], a[20:23], a[68:71], v[240:255]
ds_read_b64_tr_b16 a[58:59], v2 offset:14848
v_mfma_f32_32x32x16_bf16 a[192:207], a[24:27], a[64:67], a[192:207]
ds_read_b64_tr_b16 a[60:61], v3 offset:14336
buffer_store_dwordx4 a[244:247], v30, s[12:15], s90 offen offset:1024 sc1
v_mfma_f32_32x32x16_bf16 a[208:223], a[24:27], a[68:71], a[208:223]
ds_read_b64_tr_b16 a[62:63], v3 offset:14848
v_mfma_f32_32x32x16_bf16 a[224:239], a[28:31], a[64:67], a[224:239]
v_mfma_f32_32x32x16_bf16 v[64:79], a[32:35], a[72:75], v[64:79]
s_waitcnt vmcnt(13)
s_barrier
ds_read_b64_tr_b16 a[0:1], v2 offset:16384
ds_read_b64_tr_b16 a[2:3], v2 offset:16896
v_mfma_f32_32x32x16_bf16 v[160:175], a[32:35], a[76:79], v[160:175]
ds_read_b64_tr_b16 a[4:5], v3 offset:16384
s_add_u32 m0, s47, 49152
v_mfma_f32_32x32x16_bf16 v[80:95], a[36:39], a[72:75], v[80:95]
ds_read_b64_tr_b16 a[6:7], v3 offset:16896
buffer_load_dwordx4 v1, s[8:11], s45 offen lds
s_add_u32 s45, s45, s44
v_mfma_f32_32x32x16_bf16 v[176:191], a[36:39], a[76:79], v[176:191]
ds_read_b64_tr_b16 a[8:9], v2 offset:20480
buffer_load_dwordx4 a[64:67], v4, s[12:15], s48 offen offset:0 sc1
v_mfma_f32_32x32x16_bf16 v[96:111], a[40:43], a[72:75], v[96:111]
ds_read_b64_tr_b16 a[10:11], v2 offset:20992
s_add_u32 m0, s47, 50176
v_mfma_f32_32x32x16_bf16 v[192:207], a[40:43], a[76:79], v[192:207]
ds_read_b64_tr_b16 a[12:13], v3 offset:20480
s_waitcnt lgkmcnt(6)
v_mfma_f32_32x32x16_bf16 v[112:127], a[44:47], a[72:75], v[112:127]
ds_read_b64_tr_b16 a[14:15], v3 offset:20992
buffer_load_dwordx4 v1, s[8:11], s45 offen lds
s_add_u32 s45, s45, s44
v_mfma_f32_32x32x16_bf16 v[208:223], a[44:47], a[76:79], v[208:223]
ds_read_b64_tr_b16 a[16:17], v2 offset:24576
ds_read_b64_tr_b16 a[18:19], v2 offset:25088
buffer_load_dwordx4 a[68:71], v5, s[12:15], s48 offen offset:0 sc1
v_mfma_f32_32x32x16_bf16 v[128:143], a[48:51], a[72:75], v[128:143]
ds_read_b64_tr_b16 a[20:21], v3 offset:24576
s_add_u32 m0, s47, 51200
v_mfma_f32_32x32x16_bf16 v[224:239], a[48:51], a[76:79], v[224:239]
ds_read_b64_tr_b16 a[22:23], v3 offset:25088
buffer_load_dwordx4 v1, s[8:11], s45 offen lds
s_add_u32 s45, s45, s44
v_mfma_f32_32x32x16_bf16 v[144:159], a[52:55], a[72:75], v[144:159]
ds_read_b64_tr_b16 a[24:25], v2 offset:28672
v_mfma_f32_32x32x16_bf16 v[240:255], a[52:55], a[76:79], v[240:255]
ds_read_b64_tr_b16 a[26:27], v2 offset:29184
s_add_u32 m0, s47, 52224
v_mfma_f32_32x32x16_bf16 a[192:207], a[56:59], a[72:75], a[192:207]
ds_read_b64_tr_b16 a[28:29], v3 offset:28672
v_mfma_f32_32x32x16_bf16 a[208:223], a[56:59], a[76:79], a[208:223]
ds_read_b64_tr_b16 a[30:31], v3 offset:29184
buffer_load_dwordx4 v1, s[8:11], s45 offen lds
s_add_u32 s45, s45, s44
s_cmp_ge_u32 s45, s46
s_cselect_b32 s45, 0, s45
v_mfma_f32_32x32x16_bf16 a[224:239], a[60:63], a[72:75], a[224:239]
s_waitcnt lgkmcnt(6)
v_mfma_f32_32x32x16_bf16 v[64:79], a[0:3], a[80:83], v[64:79]
ds_read_b64_tr_b16 a[32:33], v2 offset:18432
ds_read_b64_tr_b16 a[34:35], v2 offset:18944
v_mfma_f32_32x32x16_bf16 v[160:175], a[0:3], a[84:87], v[160:175]
ds_read_b64_tr_b16 a[36:37], v3 offset:18432
v_mfma_f32_32x32x16_bf16 v[80:95], a[4:7], a[80:83], v[80:95]
ds_read_b64_tr_b16 a[38:39], v3 offset:18944
v_mfma_f32_32x32x16_bf16 v[176:191], a[4:7], a[84:87], v[176:191]
ds_read_b64_tr_b16 a[40:41], v2 offset:22528
buffer_load_dwordx4 a[72:75], v4, s[12:15], s48 offen offset:1024 sc1
v_mfma_f32_32x32x16_bf16 v[96:111], a[8:11], a[80:83], v[96:111]
ds_read_b64_tr_b16 a[42:43], v2 offset:23040
v_mfma_f32_32x32x16_bf16 v[192:207], a[8:11], a[84:87], v[192:207]
ds_read_b64_tr_b16 a[44:45], v3 offset:22528
v_mfma_f32_32x32x16_bf16 v[112:127], a[12:15], a[80:83], v[112:127]
ds_read_b64_tr_b16 a[46:47], v3 offset:23040
v_mfma_f32_32x32x16_bf16 v[208:223], a[12:15], a[84:87], v[208:223]
ds_read_b64_tr_b16 a[48:49], v2 offset:26624
ds_read_b64_tr_b16 a[50:51], v2 offset:27136
buffer_load_dwordx4 a[76:79], v5, s[12:15], s48 offen offset:1024 sc1
s_add_u32 s48, s48, 2048
s_cmp_ge_u32 s48, 40960
s_cselect_b32 s48, 0, s48
v_mfma_f32_32x32x16_bf16 v[128:143], a[16:19], a[80:83], v[128:143]
ds_read_b64_tr_b16 a[52:53], v3 offset:26624
v_mfma_f32_32x32x16_bf16 v[224:239], a[16:19], a[84:87], v[224:239]
ds_read_b64_tr_b16 a[54:55], v3 offset:27136
s_waitcnt lgkmcnt(6)
v_mfma_f32_32x32x16_bf16 v[144:159], a[20:23], a[80:83], v[144:159]
ds_read_b64_tr_b16 a[56:57], v2 offset:30720
v_mfma_f32_32x32x16_bf16 v[240:255], a[20:23], a[84:87], v[240:255]
ds_read_b64_tr_b16 a[58:59], v2 offset:31232
v_mfma_f32_32x32x16_bf16 a[192:207], a[24:27], a[80:83], a[192:207]
ds_read_b64_tr_b16 a[60:61], v3 offset:30720
buffer_store_dwordx4 a[244:247], v30, s[12:15], s90 offen offset:2048 sc1
v_mfma_f32_32x32x16_bf16 a[208:223], a[24:27], a[84:87], a[208:223]
ds_read_b64_tr_b16 a[62:63], v3 offset:31232
v_mfma_f32_32x32x16_bf16 a[224:239], a[28:31], a[80:83], a[224:239]
v_mfma_f32_32x32x16_bf16 v[64:79], a[32:35], a[88:91], v[64:79]
s_waitcnt vmcnt(13)
s_barrier
ds_read_b64_tr_b16 a[0:1], v2 offset:32768
ds_read_b64_tr_b16 a[2:3], v2 offset:33280
v_mfma_f32_32x32x16_bf16 v[160:175], a[32:35], a[92:95], v[160:175]
ds_read_b64_tr_b16 a[4:5], v3 offset:32768
s_add_u32 m0, s47, 0
v_mfma_f32_32x32x16_bf16 v[80:95], a[36:39], a[88:91], v[80:95]
ds_read_b64_tr_b16 a[6:7], v3 offset:33280
buffer_load_dwordx4 v1, s[8:11], s45 offen lds
s_add_u32 s45, s45, s44
v_mfma_f32_32x32x16_bf16 v[176:191], a[36:39], a[92:95], v[176:191]
ds_read_b64_tr_b16 a[8:9], v2 offset:36864
buffer_load_dwordx4 a[80:83], v4, s[12:15], s48 offen offset:0 sc1
v_mfma_f32_32x32x16_bf16 v[96:111], a[40:43], a[88:91], v[96:111]
ds_read_b64_tr_b16 a[10:11], v2 offset:37376
s_add_u32 m0, s47, 1024
v_mfma_f32_32x32x16_bf16 v[192:207], a[40:43], a[92:95], v[192:207]
ds_read_b64_tr_b16 a[12:13], v3 offset:36864
s_waitcnt lgkmcnt(6)
v_mfma_f32_32x32x16_bf16 v[112:127], a[44:47], a[88:91], v[112:127]
ds_read_b64_tr_b16 a[14:15], v3 offset:37376
buffer_load_dwordx4 v1, s[8:11], s45 offen lds
s_add_u32 s45, s45, s44
v_mfma_f32_32x32x16_bf16 v[208:223], a[44:47], a[92:95], v[208:223]
ds_read_b64_tr_b16 a[16:17], v2 offset:40960
ds_read_b64_tr_b16 a[18:19], v2 offset:41472
buffer_load_dwordx4 a[84:87], v5, s[12:15], s48 offen offset:0 sc1
v_mfma_f32_32x32x16_bf16 v[128:143], a[48:51], a[88:91], v[128:143]
ds_read_b64_tr_b16 a[20:21], v3 offset:40960
s_add_u32 m0, s47, 2048
v_mfma_f32_32x32x16_bf16 v[224:239], a[48:51], a[92:95], v[224:239]
ds_read_b64_tr_b16 a[22:23], v3 offset:41472
buffer_load_dwordx4 v1, s[8:11], s45 offen lds
s_add_u32 s45, s45, s44
v_mfma_f32_32x32x16_bf16 v[144:159], a[52:55], a[88:91], v[144:159]
ds_read_b64_tr_b16 a[24:25], v2 offset:45056
v_mfma_f32_32x32x16_bf16 v[240:255], a[52:55], a[92:95], v[240:255]
ds_read_b64_tr_b16 a[26:27], v2 offset:45568
s_add_u32 m0, s47, 3072
v_mfma_f32_32x32x16_bf16 a[192:207], a[56:59], a[88:91], a[192:207]
ds_read_b64_tr_b16 a[28:29], v3 offset:45056
v_mfma_f32_32x32x16_bf16 a[208:223], a[56:59], a[92:95], a[208:223]
ds_read_b64_tr_b16 a[30:31], v3 offset:45568
buffer_load_dwordx4 v1, s[8:11], s45 offen lds
s_add_u32 s45, s45, s44
s_cmp_ge_u32 s45, s46
s_cselect_b32 s45, 0, s45
v_mfma_f32_32x32x16_bf16 a[224:239], a[60:63], a[88:91], a[224:239]
s_waitcnt lgkmcnt(6)
v_mfma_f32_32x32x16_bf16 v[64:79], a[0:3], a[96:99], v[64:79]
ds_read_b64_tr_b16 a[32:33], v2 offset:34816
ds_read_b64_tr_b16 a[34:35], v2 offset:35328
v_mfma_f32_32x32x16_bf16 v[160:175], a[0:3], a[100:103], v[160:175]
ds_read_b64_tr_b16 a[36:37], v3 offset:34816
v_mfma_f32_32x32x16_bf16 v[80:95], a[4:7], a[96:99], v[80:95]
ds_read_b64_tr_b16 a[38:39], v3 offset:35328
v_mfma_f32_32x32x16_bf16 v[176:191], a[4:7], a[100:103], v[176:191]
ds_read_b64_tr_b16 a[40:41], v2 offset:38912
buffer_load_dwordx4 a[88:91], v4, s[12:15], s48 offen offset:1024 sc1
v_mfma_f32_32x32x16_bf16 v[96:111], a[8:11], a[96:99], v[96:111]
ds_read_b64_tr_b16 a[42:43], v2 offset:39424
v_mfma_f32_32x32x16_bf16 v[192:207], a[8:11], a[100:103], v[192:207]
ds_read_b64_tr_b16 a[44:45], v3 offset:38912
v_mfma_f32_32x32x16_bf16 v[112:127], a[12:15], a[96:99], v[112:127]
ds_read_b64_tr_b16 a[46:47], v3 offset:39424
v_mfma_f32_32x32x16_bf16 v[208:223], a[12:15], a[100:103], v[208:223]
ds_read_b64_tr_b16 a[48:49], v2 offset:43008
ds_read_b64_tr_b16 a[50:51], v2 offset:43520
buffer_load_dwordx4 a[92:95], v5, s[12:15], s48 offen offset:1024 sc1
s_add_u32 s48, s48, 2048
s_cmp_ge_u32 s48, 40960
s_cselect_b32 s48, 0, s48
v_mfma_f32_32x32x16_bf16 v[128:143], a[16:19], a[96:99], v[128:143]
ds_read_b64_tr_b16 a[52:53], v3 offset:43008
v_mfma_f32_32x32x16_bf16 v[224:239], a[16:19], a[100:103], v[224:239]
ds_read_b64_tr_b16 a[54:55], v3 offset:43520
s_waitcnt lgkmcnt(6)
v_mfma_f32_32x32x16_bf16 v[144:159], a[20:23], a[96:99], v[144:159]
ds_read_b64_tr_b16 a[56:57], v2 offset:47104
v_mfma_f32_32x32x16_bf16 v[240:255], a[20:23], a[100:103], v[240:255]
ds_read_b64_tr_b16 a[58:59], v2 offset:47616
v_mfma_f32_32x32x16_bf16 a[192:207], a[24:27], a[96:99], a[192:207]
ds_read_b64_tr_b16 a[60:61], v3 offset:47104
v_mfma_f32_32x32x16_bf16 a[208:223], a[24:27], a[100:103], a[208:223]
ds_read_b64_tr_b16 a[62:63], v3 offset:47616
v_mfma_f32_32x32x16_bf16 a[224:239], a[28:31], a[96:99], a[224:239]
v_mfma_f32_32x32x16_bf16 v[64:79], a[32:35], a[104:107], v[64:79]
s_waitcnt vmcnt(11)
s_barrier
ds_read_b64_tr_b16 a[0:1], v2 offset:49152
ds_read_b64_tr_b16 a[2:3], v2 offset:49664
v_mfma_f32_32x32x16_bf16 v[160:175], a[32:35], a[108:111], v[160:175]
ds_read_b64_tr_b16 a[4:5], v3 offset:49152
s_add_u32 m0, s47, 16384
v_mfma_f32_32x32x16_bf16 v[80:95], a[36:39], a[104:107], v[80:95]
ds_read_b64_tr_b16 a[6:7], v3 offset:49664
buffer_load_dwordx4 v1, s[8:11], s45 offen lds
s_add_u32 s45, s45, s44
v_mfma_f32_32x32x16_bf16 v[176:191], a[36:39], a[108:111], v[176:191]
ds_read_b64_tr_b16 a[8:9], v2 offset:53248
buffer_load_dwordx4 a[96:99], v4, s[12:15], s48 offen offset:0 sc1
v_mfma_f32_32x32x16_bf16 v[96:111], a[40:43], a[104:107], v[96:111]
ds_read_b64_tr_b16 a[10:11], v2 offset:53760
s_add_u32 m0, s47, 17408
v_mfma_f32_32x32x16_bf16 v[192:207], a[40:43], a[108:111], v[192:207]
ds_read_b64_tr_b16 a[12:13], v3 offset:53248
s_waitcnt lgkmcnt(6)
v_mfma_f32_32x32x16_bf16 v[112:127], a[44:47], a[104:107], v[112:127]
ds_read_b64_tr_b16 a[14:15], v3 offset:53760
buffer_load_dwordx4 v1, s[8:11], s45 offen lds
s_add_u32 s45, s45, s44
v_mfma_f32_32x32x16_bf16 v[208:223], a[44:47], a[108:111], v[208:223]
ds_read_b64_tr_b16 a[16:17], v2 offset:57344
ds_read_b64_tr_b16 a[18:19], v2 offset:57856
buffer_load_dwordx4 a[100:103], v5, s[12:15], s48 offen offset:0 sc1
v_mfma_f32_32x32x16_bf16 v[128:143], a[48:51], a[104:107], v[128:143]
ds_read_b64_tr_b16 a[20:21], v3 offset:57344
s_add_u32 m0, s47, 18432
v_mfma_f32_32x32x16_bf16 v[224:239], a[48:51], a[108:111], v[224:239]
ds_read_b64_tr_b16 a[22:23], v3 offset:57856
buffer_load_dwordx4 v1, s[8:11], s45 offen lds
s_add_u32 s45, s45, s44
v_mfma_f32_32x32x16_bf16 v[144:159], a[52:55], a[104:107], v[144:159]
ds_read_b64_tr_b16 a[24:25], v2 offset:61440
v_mfma_f32_32x32x16_bf16 v[240:255], a[52:55], a[108:111], v[240:255]
ds_read_b64_tr_b16 a[26:27], v2 offset:61952
s_add_u32 m0, s47, 19456
v_mfma_f32_32x32x16_bf16 a[192:207], a[56:59], a[104:107], a[192:207]
ds_read_b64_tr_b16 a[28:29], v3 offset:61440
buffer_store_dwordx4 a[244:247], v30, s[12:15], s90 offen offset:3072 sc1
s_add_u32 s90, s90, 4096
v_mfma_f32_32x32x16_bf16 a[208:223], a[56:59], a[108:111], a[208:223]
ds_read_b64_tr_b16 a[30:31], v3 offset:61952
buffer_load_dwordx4 v1, s[8:11], s45 offen lds
s_add_u32 s45, s45, s44
s_cmp_ge_u32 s45, s46
s_cselect_b32 s45, 0, s45
v_mfma_f32_32x32x16_bf16 a[224:239], a[60:63], a[104:107], a[224:239]
s_waitcnt lgkmcnt(6)
v_mfma_f32_32x32x16_bf16 v[64:79], a[0:3], a[112:115], v[64:79]
ds_read_b64_tr_b16 a[32:33], v2 offset:51200
ds_read_b64_tr_b16 a[34:35], v2 offset:51712
v_mfma_f32_32x32x16_bf16 v[160:175], a[0:3], a[116:119], v[160:175]
ds_read_b64_tr_b16 a[36:37], v3 offset:51200
v_mfma_f32_32x32x16_bf16 v[80:95], a[4:7], a[112:115], v[80:95]
ds_read_b64_tr_b16 a[38:39], v3 offset:51712
v_mfma_f32_32x32x16_bf16 v[176:191], a[4:7], a[116:119], v[176:191]
ds_read_b64_tr_b16 a[40:41], v2 offset:55296
buffer_load_dwordx4 a[104:107], v4, s[12:15], s48 offen offset:1024 sc1
v_mfma_f32_32x32x16_bf16 v[96:111], a[8:11], a[112:115], v[96:111]
ds_read_b64_tr_b16 a[42:43], v2 offset:55808
v_mfma_f32_32x32x16_bf16 v[192:207], a[8:11], a[116:119], v[192:207]
ds_read_b64_tr_b16 a[44:45], v3 offset:55296
v_mfma_f32_32x32x16_bf16 v[112:127], a[12:15], a[112:115], v[112:127]
ds_read_b64_tr_b16 a[46:47], v3 offset:55808
v_mfma_f32_32x32x16_bf16 v[208:223], a[12:15], a[116:119], v[208:223]
ds_read_b64_tr_b16 a[48:49], v2 offset:59392
ds_read_b64_tr_b16 a[50:51], v2 offset:59904
buffer_load_dwordx4 a[108:111], v5, s[12:15], s48 offen offset:1024 sc1
s_add_u32 s48, s48, 2048
s_cmp_ge_u32 s48, 40960
s_cselect_b32 s48, 0, s48
v_mfma_f32_32x32x16_bf16 v[128:143], a[16:19], a[112:115], v[128:143]
ds_read_b64_tr_b16 a[52:53], v3 offset:59392
v_mfma_f32_32x32x16_bf16 v[224:239], a[16:19], a[116:119], v[224:239]
ds_read_b64_tr_b16 a[54:55], v3 offset:59904
s_waitcnt lgkmcnt(6)
v_mfma_f32_32x32x16_bf16 v[144:159], a[20:23], a[112:115], v[144:159]
ds_read_b64_tr_b16 a[56:57], v2 offset:63488
v_mfma_f32_32x32x16_bf16 v[240:255], a[20:23], a[116:119], v[240:255]
ds_read_b64_tr_b16 a[58:59], v2 offset:64000
v_mfma_f32_32x32x16_bf16 a[192:207], a[24:27], a[112:115], a[192:207]
ds_read_b64_tr_b16 a[60:61], v3 offset:63488
v_mfma_f32_32x32x16_bf16 a[208:223], a[24:27], a[116:119], a[208:223]
ds_read_b64_tr_b16 a[62:63], v3 offset:64000
v_mfma_f32_32x32x16_bf16 a[224:239], a[28:31], a[112:115], a[224:239]
v_mfma_f32_32x32x16_bf16 v[64:79], a[32:35], a[120:123], v[64:79]
s_waitcnt vmcnt(11)
s_barrier
ds_read_b64_tr_b16 a[0:1], v2 offset:0
ds_read_b64_tr_b16 a[2:3], v2 offset:512
v_mfma_f32_32x32x16_bf16 v[160:175], a[32:35], a[124:127], v[160:175]
ds_read_b64_tr_b16 a[4:5], v3 offset:0
s_add_u32 m0, s47, 32768
v_mfma_f32_32x32x16_bf16 v[80:95], a[36:39], a[120:123], v[80:95]
ds_read_b64_tr_b16 a[6:7], v3 offset:512
buffer_load_dwordx4 v1, s[8:11], s45 offen lds
s_add_u32 s45, s45, s44
v_mfma_f32_32x32x16_bf16 v[176:191], a[36:39], a[124:127], v[176:191]
ds_read_b64_tr_b16 a[8:9], v2 offset:4096
buffer_load_dwordx4 a[112:115], v4, s[12:15], s48 offen offset:0 sc1
v_mfma_f32_32x32x16_bf16 v[96:111], a[40:43], a[120:123], v[96:111]
ds_read_b64_tr_b16 a[10:11], v2 offset:4608
s_add_u32 m0, s47, 33792
v_mfma_f32_32x32x16_bf16 v[192:207], a[40:43], a[124:127], v[192:207]
ds_read_b64_tr_b16 a[12:13], v3 offset:4096
s_waitcnt lgkmcnt(6)
v_mfma_f32_32x32x16_bf16 v[112:127], a[44:47], a[120:123], v[112:127]
ds_read_b64_tr_b16 a[14:15], v3 offset:4608
buffer_load_dwordx4 v1, s[8:11], s45 offen lds
s_add_u32 s45, s45, s44
v_mfma_f32_32x32x16_bf16 v[208:223], a[44:47], a[124:127], v[208:223]
ds_read_b64_tr_b16 a[16:17], v2 offset:8192
ds_read_b64_tr_b16 a[18:19], v2 offset:8704
buffer_load_dwordx4 a[116:119], v5, s[12:15], s48 offen offset:0 sc1
v_mfma_f32_32x32x16_bf16 v[128:143], a[48:51], a[120:123], v[128:143]
ds_read_b64_tr_b16 a[20:21], v3 offset:8192
s_add_u32 m0, s47, 34816
v_mfma_f32_32x32x16_bf16 v[224:239], a[48:51], a[124:127], v[224:239]
ds_read_b64_tr_b16 a[22:23], v3 offset:8704
buffer_load_dwordx4 v1, s[8:11], s45 offen lds
s_add_u32 s45, s45, s44
v_mfma_f32_32x32x16_bf16 v[144:159], a[52:55], a[120:123], v[144:159]
ds_read_b64_tr_b16 a[24:25], v2 offset:12288
v_mfma_f32_32x32x16_bf16 v[240:255], a[52:55], a[124:127], v[240:255]
ds_read_b64_tr_b16 a[26:27], v2 offset:12800
s_add_u32 m0, s47, 35840
v_mfma_f32_32x32x16_bf16 a[192:207], a[56:59], a[120:123], a[192:207]
ds_read_b64_tr_b16 a[28:29], v3 offset:12288
buffer_store_dwordx4 a[244:247], v30, s[12:15], s90 offen offset:0 sc1
v_mfma_f32_32x32x16_bf16 a[208:223], a[56:59], a[124:127], a[208:223]
ds_read_b64_tr_b16 a[30:31], v3 offset:12800
buffer_load_dwordx4 v1, s[8:11], s45 offen lds
s_add_u32 s45, s45, s44
s_cmp_ge_u32 s45, s46
s_cselect_b32 s45, 0, s45
v_mfma_f32_32x32x16_bf16 a[224:239], a[60:63], a[120:123], a[224:239]
s_waitcnt lgkmcnt(6)
v_mfma_f32_32x32x16_bf16 v[64:79], a[0:3], a[64:67], v[64:79]
ds_read_b64_tr_b16 a[32:33], v2 offset:2048
ds_read_b64_tr_b16 a[34:35], v2 offset:2560
v_mfma_f32_32x32x16_bf16 v[160:175], a[0:3], a[68:71], v[160:175]
ds_read_b64_tr_b16 a[36:37], v3 offset:2048
v_mfma_f32_32x32x16_bf16 v[80:95], a[4:7], a[64:67], v[80:95]
ds_read_b64_tr_b16 a[38:39], v3 offset:2560
v_mfma_f32_32x32x16_bf16 v[176:191], a[4:7], a[68:71], v[176:191]
ds_read_b64_tr_b16 a[40:41], v2 offset:6144
buffer_load_dwordx4 a[120:123], v4, s[12:15], s48 offen offset:1024 sc1
v_mfma_f32_32x32x16_bf16 v[96:111], a[8:11], a[64:67], v[96:111]
ds_read_b64_tr_b16 a[42:43], v2 offset:6656
v_mfma_f32_32x32x16_bf16 v[192:207], a[8:11], a[68:71], v[192:207]
ds_read_b64_tr_b16 a[44:45], v3 offset:6144
v_mfma_f32_32x32x16_bf16 v[112:127], a[12:15], a[64:67], v[112:127]
ds_read_b64_tr_b16 a[46:47], v3 offset:6656
v_mfma_f32_32x32x16_bf16 v[208:223], a[12:15], a[68:71], v[208:223]
ds_read_b64_tr_b16 a[48:49], v2 offset:10240
ds_read_b64_tr_b16 a[50:51], v2 offset:10752
buffer_load_dwordx4 a[124:127], v5, s[12:15], s48 offen offset:1024 sc1
s_add_u32 s48, s48, 2048
s_cmp_ge_u32 s48, 40960
s_cselect_b32 s48, 0, s48
v_mfma_f32_32x32x16_bf16 v[128:143], a[16:19], a[64:67], v[128:143]
ds_read_b64_tr_b16 a[52:53], v3 offset:10240
v_mfma_f32_32x32x16_bf16 v[224:239], a[16:19], a[68:71], v[224:239]
ds_read_b64_tr_b16 a[54:55], v3 offset:10752
s_waitcnt lgkmcnt(6)
v_mfma_f32_32x32x16_bf16 v[144:159], a[20:23], a[64:67], v[144:159]
ds_read_b64_tr_b16 a[56:57], v2 offset:14336
v_mfma_f32_32x32x16_bf16 v[240:255], a[20:23], a[68:71], v[240:255]
ds_read_b64_tr_b16 a[58:59], v2 offset:14848
v_mfma_f32_32x32x16_bf16 a[192:207], a[24:27], a[64:67], a[192:207]
ds_read_b64_tr_b16 a[60:61], v3 offset:14336
v_mfma_f32_32x32x16_bf16 a[208:223], a[24:27], a[68:71], a[208:223]
ds_read_b64_tr_b16 a[62:63], v3 offset:14848
v_mfma_f32_32x32x16_bf16 a[224:239], a[28:31], a[64:67], a[224:239]
v_mfma_f32_32x32x16_bf16 v[64:79], a[32:35], a[72:75], v[64:79]
s_waitcnt vmcnt(11)
s_barrier
ds_read_b64_tr_b16 a[0:1], v2 offset:16384
ds_read_b64_tr_b16 a[2:3], v2 offset:16896
v_mfma_f32_32x32x16_bf16 v[160:175], a[32:35], a[76:79], v[160:175]
ds_read_b64_tr_b16 a[4:5], v3 offset:16384
s_add_u32 m0, s47, 49152
v_mfma_f32_32x32x16_bf16 v[80:95], a[36:39], a[72:75], v[80:95]
ds_read_b64_tr_b16 a[6:7], v3 offset:16896
buffer_load_dwordx4 v1, s[8:11], s45 offen lds
s_add_u32 s45, s45, s44
v_mfma_f32_32x32x16_bf16 v[176:191], a[36:39], a[76:79], v[176:191]
ds_read_b64_tr_b16 a[8:9], v2 offset:20480
v_mfma_f32_32x32x16_bf16 v[96:111], a[40:43], a[72:75], v[96:111]
ds_read_b64_tr_b16 a[10:11], v2 offset:20992
s_add_u32 m0, s47, 50176
v_mfma_f32_32x32x16_bf16 v[192:207], a[40:43], a[76:79], v[192:207]
ds_read_b64_tr_b16 a[12:13], v3 offset:20480
s_waitcnt lgkmcnt(6)
v_mfma_f32_32x32x16_bf16 v[112:127], a[44:47], a[72:75], v[112:127]
ds_read_b64_tr_b16 a[14:15], v3 offset:20992
buffer_load_dwordx4 v1, s[8:11], s45 offen lds
s_add_u32 s45, s45, s44
v_mfma_f32_32x32x16_bf16 v[208:223], a[44:47], a[76:79], v[208:223]
ds_read_b64_tr_b16 a[16:17], v2 offset:24576
ds_read_b64_tr_b16 a[18:19], v2 offset:25088
v_mfma_f32_32x32x16_bf16 v[128:143], a[48:51], a[72:75], v[128:143]
ds_read_b64_tr_b16 a[20:21], v3 offset:24576
s_add_u32 m0, s47, 51200
v_mfma_f32_32x32x16_bf16 v[224:239], a[48:51], a[76:79], v[224:239]
ds_read_b64_tr_b16 a[22:23], v3 offset:25088
buffer_load_dwordx4 v1, s[8:11], s45 offen lds
s_add_u32 s45, s45, s44
v_mfma_f32_32x32x16_bf16 v[144:159], a[52:55], a[72:75], v[144:159]
ds_read_b64_tr_b16 a[24:25], v2 offset:28672
v_mfma_f32_32x32x16_bf16 v[240:255], a[52:55], a[76:79], v[240:255]
ds_read_b64_tr_b16 a[26:27], v2 offset:29184
s_add_u32 m0, s47, 52224
v_mfma_f32_32x32x16_bf16 a[192:207], a[56:59], a[72:75], a[192:207]
ds_read_b64_tr_b16 a[28:29], v3 offset:28672
buffer_store_dwordx4 a[244:247], v30, s[12:15], s90 offen offset:1024 sc1
v_mfma_f32_32x32x16_bf16 a[208:223], a[56:59], a[76:79], a[208:223]
ds_read_b64_tr_b16 a[30:31], v3 offset:29184
buffer_load_dwordx4 v1, s[8:11], s45 offen lds
s_add_u32 s45, s45, s44
s_cmp_ge_u32 s45, s46
s_cselect_b32 s45, 0, s45
v_mfma_f32_32x32x16_bf16 a[224:239], a[60:63], a[72:75], a[224:239]
s_waitcnt lgkmcnt(6)
v_mfma_f32_32x32x16_bf16 v[64:79], a[0:3], a[80:83], v[64:79]
ds_read_b64_tr_b16 a[32:33], v2 offset:18432
ds_read_b64_tr_b16 a[34:35], v2 offset:18944
v_mfma_f32_32x32x16_bf16 v[160:175], a[0:3], a[84:87], v[160:175]
ds_read_b64_tr_b16 a[36:37], v3 offset:18432
s_add_u32 m0, s51, 65536
v_mfma_f32_32x32x16_bf16 v[80:95], a[4:7], a[80:83], v[80:95]
ds_read_b64_tr_b16 a[38:39], v3 offset:18944
buffer_load_dwordx4 v6, s[16:19], s49 offen offset:0 lds
v_mfma_f32_32x32x16_bf16 v[176:191], a[4:7], a[84:87], v[176:191]
ds_read_b64_tr_b16 a[40:41], v2 offset:22528
v_mfma_f32_32x32x16_bf16 v[96:111], a[8:11], a[80:83], v[96:111]
ds_read_b64_tr_b16 a[42:43], v2 offset:23040
s_add_u32 m0, s51, 69504
v_mfma_f32_32x32x16_bf16 v[192:207], a[8:11], a[84:87], v[192:207]
ds_read_b64_tr_b16 a[44:45], v3 offset:22528
v_mfma_f32_32x32x16_bf16 v[112:127], a[12:15], a[80:83], v[112:127]
ds_read_b64_tr_b16 a[46:47], v3 offset:23040
buffer_load_dwordx4 v6, s[16:19], s49 offen offset:128 lds
v_mfma_f32_32x32x16_bf16 v[208:223], a[12:15], a[84:87], v[208:223]
ds_read_b64_tr_b16 a[48:49], v2 offset:26624
ds_read_b64_tr_b16 a[50:51], v2 offset:27136
v_mfma_f32_32x32x16_bf16 v[128:143], a[16:19], a[80:83], v[128:143]
ds_read_b64_tr_b16 a[52:53], v3 offset:26624
s_add_u32 m0, s51, 73472
v_mfma_f32_32x32x16_bf16 v[224:239], a[16:19], a[84:87], v[224:239]
ds_read_b64_tr_b16 a[54:55], v3 offset:27136
buffer_load_dwordx4 v6, s[16:19], s49 offen offset:256 lds
s_add_u32 s49, s49, 12288
s_waitcnt lgkmcnt(6)
v_mfma_f32_32x32x16_bf16 v[144:159], a[20:23], a[80:83], v[144:159]
ds_read_b64_tr_b16 a[56:57], v2 offset:30720
v_mfma_f32_32x32x16_bf16 v[240:255], a[20:23], a[84:87], v[240:255]
ds_read_b64_tr_b16 a[58:59], v2 offset:31232
s_add_u32 m0, s51, 77824
v_mfma_f32_32x32x16_bf16 a[192:207], a[24:27], a[80:83], a[192:207]
ds_read_b64_tr_b16 a[60:61], v3 offset:30720
v_mfma_f32_32x32x16_bf16 a[208:223], a[24:27], a[84:87], a[208:223]
ds_read_b64_tr_b16 a[62:63], v3 offset:31232
buffer_load_dwordx4 v6, s[16:19], s49 offen offset:0 lds
v_mfma_f32_32x32x16_bf16 a[224:239], a[28:31], a[80:83], a[224:239]
v_mfma_f32_32x32x16_bf16 v[64:79], a[32:35], a[88:91], v[64:79]
s_waitcnt vmcnt(11)
s_barrier
ds_read_b64_tr_b16 a[0:1], v2 offset:32768
ds_read_b64_tr_b16 a[2:3], v2 offset:33280
v_mfma_f32_32x32x16_bf16 v[160:175], a[32:35], a[92:95], v[160:175]
ds_read_b64_tr_b16 a[4:5], v3 offset:32768
s_add_u32 m0, s51, 81792
v_mfma_f32_32x32x16_bf16 v[80:95], a[36:39], a[88:91], v[80:95]
ds_read_b64_tr_b16 a[6:7], v3 offset:33280
buffer_load_dwordx4 v6, s[16:19], s49 offen offset:128 lds
v_mfma_f32_32x32x16_bf16 v[176:191], a[36:39], a[92:95], v[176:191]
ds_read_b64_tr_b16 a[8:9], v2 offset:36864
v_mfma_f32_32x32x16_bf16 v[96:111], a[40:43], a[88:91], v[96:111]
ds_read_b64_tr_b16 a[10:11], v2 offset:37376
s_add_u32 m0, s51, 85760
v_mfma_f32_32x32x16_bf16 v[192:207], a[40:43], a[92:95], v[192:207]
ds_read_b64_tr_b16 a[12:13], v3 offset:36864
s_waitcnt lgkmcnt(6)
v_mfma_f32_32x32x16_bf16 v[112:127], a[44:47], a[88:91], v[112:127]
ds_read_b64_tr_b16 a[14:15], v3 offset:37376
buffer_load_dwordx4 v6, s[16:19], s49 offen offset:256 lds
s_add_u32 s49, s49, 12288
s_cmp_ge_u32 s49, 196608
s_cselect_b32 s49, 0, s49
v_mfma_f32_32x32x16_bf16 v[208:223], a[44:47], a[92:95], v[208:223]
ds_read_b64_tr_b16 a[16:17], v2 offset:40960
ds_read_b64_tr_b16 a[18:19], v2 offset:41472
v_mfma_f32_32x32x16_bf16 v[128:143], a[48:51], a[88:91], v[128:143]
ds_read_b64_tr_b16 a[20:21], v3 offset:40960
s_add_u32 m0, s51, 90112
v_mfma_f32_32x32x16_bf16 v[224:239], a[48:51], a[92:95], v[224:239]
ds_read_b64_tr_b16 a[22:23], v3 offset:41472
buffer_load_dwordx4 v6, s[16:19], s49 offen offset:0 lds
v_mfma_f32_32x32x16_bf16 v[144:159], a[52:55], a[88:91], v[144:159]
ds_read_b64_tr_b16 a[24:25], v2 offset:45056
v_mfma_f32_32x32x16_bf16 v[240:255], a[52:55], a[92:95], v[240:255]
ds_read_b64_tr_b16 a[26:27], v2 offset:45568
s_add_u32 m0, s51, 94080
v_mfma_f32_32x32x16_bf16 a[192:207], a[56:59], a[88:91], a[192:207]
ds_read_b64_tr_b16 a[28:29], v3 offset:45056
v_mfma_f32_32x32x16_bf16 a[208:223], a[56:59], a[92:95], a[208:223]
ds_read_b64_tr_b16 a[30:31], v3 offset:45568
buffer_load_dwordx4 v6, s[16:19], s49 offen offset:128 lds
v_mfma_f32_32x32x16_bf16 a[224:239], a[60:63], a[88:91], a[224:239]
s_waitcnt lgkmcnt(6)
v_mfma_f32_32x32x16_bf16 v[64:79], a[0:3], a[96:99], v[64:79]
ds_read_b64_tr_b16 a[32:33], v2 offset:34816
ds_read_b64_tr_b16 a[34:35], v2 offset:35328
v_mfma_f32_32x32x16_bf16 v[160:175], a[0:3], a[100:103], v[160:175]
ds_read_b64_tr_b16 a[36:37], v3 offset:34816
s_add_u32 m0, s51, 98048
v_mfma_f32_32x32x16_bf16 v[80:95], a[4:7], a[96:99], v[80:95]
ds_read_b64_tr_b16 a[38:39], v3 offset:35328
buffer_load_dwordx4 v6, s[16:19], s49 offen offset:256 lds
s_add_u32 s49, s49, 12288
v_mfma_f32_32x32x16_bf16 v[176:191], a[4:7], a[100:103], v[176:191]
ds_read_b64_tr_b16 a[40:41], v2 offset:38912
v_mfma_f32_32x32x16_bf16 v[96:111], a[8:11], a[96:99], v[96:111]
ds_read_b64_tr_b16 a[42:43], v2 offset:39424
s_add_u32 m0, s51, 102400
v_mfma_f32_32x32x16_bf16 v[192:207], a[8:11], a[100:103], v[192:207]
ds_read_b64_tr_b16 a[44:45], v3 offset:38912
v_mfma_f32_32x32x16_bf16 v[112:127], a[12:15], a[96:99], v[112:127]
ds_read_b64_tr_b16 a[46:47], v3 offset:39424
buffer_load_dwordx4 v6, s[16:19], s49 offen offset:0 lds
v_mfma_f32_32x32x16_bf16 v[208:223], a[12:15], a[100:103], v[208:223]
ds_read_b64_tr_b16 a[48:49], v2 offset:43008
ds_read_b64_tr_b16 a[50:51], v2 offset:43520
v_mfma_f32_32x32x16_bf16 v[128:143], a[16:19], a[96:99], v[128:143]
ds_read_b64_tr_b16 a[52:53], v3 offset:43008
s_add_u32 m0, s51, 106368
v_mfma_f32_32x32x16_bf16 v[224:239], a[16:19], a[100:103], v[224:239]
ds_read_b64_tr_b16 a[54:55], v3 offset:43520
buffer_load_dwordx4 v6, s[16:19], s49 offen offset:128 lds
s_waitcnt lgkmcnt(6)
v_mfma_f32_32x32x16_bf16 v[144:159], a[20:23], a[96:99], v[144:159]
ds_read_b64_tr_b16 a[56:57], v2 offset:47104
v_mfma_f32_32x32x16_bf16 v[240:255], a[20:23], a[100:103], v[240:255]
ds_read_b64_tr_b16 a[58:59], v2 offset:47616
s_add_u32 m0, s51, 110336
v_mfma_f32_32x32x16_bf16 a[192:207], a[24:27], a[96:99], a[192:207]
ds_read_b64_tr_b16 a[60:61], v3 offset:47104
v_mfma_f32_32x32x16_bf16 a[208:223], a[24:27], a[100:103], a[208:223]
ds_read_b64_tr_b16 a[62:63], v3 offset:47616
buffer_load_dwordx4 v6, s[16:19], s49 offen offset:256 lds
s_add_u32 s49, s49, 12288
s_cmp_ge_u32 s49, 196608
s_cselect_b32 s49, 0, s49
v_mfma_f32_32x32x16_bf16 a[224:239], a[28:31], a[96:99], a[224:239]
v_mfma_f32_32x32x16_bf16 v[64:79], a[32:35], a[104:107], v[64:79]
s_waitcnt vmcnt(12)
s_barrier
ds_read_b64_tr_b16 a[0:1], v2 offset:49152
ds_read_b64_tr_b16 a[2:3], v2 offset:49664
v_mfma_f32_32x32x16_bf16 v[160:175], a[32:35], a[108:111], v[160:175]
ds_read_b64_tr_b16 a[4:5], v3 offset:49152
s_add_u32 m0, s51, 114688
v_mfma_f32_32x32x16_bf16 v[80:95], a[36:39], a[104:107], v[80:95]
ds_read_b64_tr_b16 a[6:7], v3 offset:49664
buffer_load_dwordx4 v6, s[16:19], s49 offen offset:0 lds
v_mfma_f32_32x32x16_bf16 v[176:191], a[36:39], a[108:111], v[176:191]
ds_read_b64_tr_b16 a[8:9], v2 offset:53248
v_mfma_f32_32x32x16_bf16 v[96:111], a[40:43], a[104:107], v[96:111]
ds_read_b64_tr_b16 a[10:11], v2 offset:53760
s_add_u32 m0, s51, 118656
v_mfma_f32_32x32x16_bf16 v[192:207], a[40:43], a[108:111], v[192:207]
ds_read_b64_tr_b16 a[12:13], v3 offset:53248
s_waitcnt lgkmcnt(6)
v_mfma_f32_32x32x16_bf16 v[112:127], a[44:47], a[104:107], v[112:127]
ds_read_b64_tr_b16 a[14:15], v3 offset:53760
buffer_load_dwordx4 v6, s[16:19], s49 offen offset:128 lds
v_mfma_f32_32x32x16_bf16 v[208:223], a[44:47], a[108:111], v[208:223]
ds_read_b64_tr_b16 a[16:17], v2 offset:57344
ds_read_b64_tr_b16 a[18:19], v2 offset:57856
v_mfma_f32_32x32x16_bf16 v[128:143], a[48:51], a[104:107], v[128:143]
ds_read_b64_tr_b16 a[20:21], v3 offset:57344
s_add_u32 m0, s51, 122624
v_mfma_f32_32x32x16_bf16 v[224:239], a[48:51], a[108:111], v[224:239]
ds_read_b64_tr_b16 a[22:23], v3 offset:57856
buffer_load_dwordx4 v6, s[16:19], s49 offen offset:256 lds
s_add_u32 s49, s49, 12288
v_mfma_f32_32x32x16_bf16 v[144:159], a[52:55], a[104:107], v[144:159]
ds_read_b64_tr_b16 a[24:25], v2 offset:61440
v_mfma_f32_32x32x16_bf16 v[240:255], a[52:55], a[108:111], v[240:255]
ds_read_b64_tr_b16 a[26:27], v2 offset:61952
s_add_u32 m0, s51, 126976
v_mfma_f32_32x32x16_bf16 a[192:207], a[56:59], a[104:107], a[192:207]
ds_read_b64_tr_b16 a[28:29], v3 offset:61440
v_mfma_f32_32x32x16_bf16 a[208:223], a[56:59], a[108:111], a[208:223]
ds_read_b64_tr_b16 a[30:31], v3 offset:61952
buffer_load_dwordx4 v6, s[16:19], s49 offen offset:0 lds
v_mfma_f32_32x32x16_bf16 a[224:239], a[60:63], a[104:107], a[224:239]
s_waitcnt lgkmcnt(6)
v_mfma_f32_32x32x16_bf16 v[64:79], a[0:3], a[112:115], v[64:79]
ds_read_b64_tr_b16 a[32:33], v2 offset:51200
ds_read_b64_tr_b16 a[34:35], v2 offset:51712
v_mfma_f32_32x32x16_bf16 v[160:175], a[0:3], a[116:119], v[160:175]
ds_read_b64_tr_b16 a[36:37], v3 offset:51200
s_add_u32 m0, s51, 130944
v_mfma_f32_32x32x16_bf16 v[80:95], a[4:7], a[112:115], v[80:95]
ds_read_b64_tr_b16 a[38:39], v3 offset:51712
buffer_load_dwordx4 v6, s[16:19], s49 offen offset:128 lds
v_mfma_f32_32x32x16_bf16 v[176:191], a[4:7], a[116:119], v[176:191]
ds_read_b64_tr_b16 a[40:41], v2 offset:55296
v_mfma_f32_32x32x16_bf16 v[96:111], a[8:11], a[112:115], v[96:111]
ds_read_b64_tr_b16 a[42:43], v2 offset:55808
s_add_u32 m0, s51, 134912
v_mfma_f32_32x32x16_bf16 v[192:207], a[8:11], a[116:119], v[192:207]
ds_read_b64_tr_b16 a[44:45], v3 offset:55296
v_mfma_f32_32x32x16_bf16 v[112:127], a[12:15], a[112:115], v[112:127]
ds_read_b64_tr_b16 a[46:47], v3 offset:55808
buffer_load_dwordx4 v6, s[16:19], s49 offen offset:256 lds
s_add_u32 s49, s49, 12288
s_cmp_ge_u32 s49, 196608
s_cselect_b32 s49, 0, s49
v_mfma_f32_32x32x16_bf16 v[208:223], a[12:15], a[116:119], v[208:223]
ds_read_b64_tr_b16 a[48:49], v2 offset:59392
ds_read_b64_tr_b16 a[50:51], v2 offset:59904
v_mfma_f32_32x32x16_bf16 v[128:143], a[16:19], a[112:115], v[128:143]
ds_read_b64_tr_b16 a[52:53], v3 offset:59392
s_add_u32 m0, s51, 139264
v_mfma_f32_32x32x16_bf16 v[224:239], a[16:19], a[116:119], v[224:239]
ds_read_b64_tr_b16 a[54:55], v3 offset:59904
buffer_load_dwordx4 v6, s[16:19], s49 offen offset:0 lds
s_waitcnt lgkmcnt(6)
v_mfma_f32_32x32x16_bf16 v[144:159], a[20:23], a[112:115], v[144:159]
ds_read_b64_tr_b16 a[56:57], v2 offset:63488
v_mfma_f32_32x32x16_bf16 v[240:255], a[20:23], a[116:119], v[240:255]
ds_read_b64_tr_b16 a[58:59], v2 offset:64000
s_add_u32 m0, s51, 143232
v_mfma_f32_32x32x16_bf16 a[192:207], a[24:27], a[112:115], a[192:207]
ds_read_b64_tr_b16 a[60:61], v3 offset:63488
v_mfma_f32_32x32x16_bf16 a[208:223], a[24:27], a[116:119], a[208:223]
ds_read_b64_tr_b16 a[62:63], v3 offset:64000
buffer_load_dwordx4 v6, s[16:19], s49 offen offset:128 lds
v_mfma_f32_32x32x16_bf16 a[224:239], a[28:31], a[112:115], a[224:239]
v_mfma_f32_32x32x16_bf16 v[64:79], a[32:35], a[120:123], v[64:79]
v_mfma_f32_32x32x16_bf16 v[160:175], a[32:35], a[124:127], v[160:175]
s_add_u32 m0, s51, 147200
v_mfma_f32_32x32x16_bf16 v[80:95], a[36:39], a[120:123], v[80:95]
buffer_load_dwordx4 v6, s[16:19], s49 offen offset:256 lds
s_add_u32 s49, s49, 12288
v_mfma_f32_32x32x16_bf16 v[176:191], a[36:39], a[124:127], v[176:191]
v_mfma_f32_32x32x16_bf16 v[96:111], a[40:43], a[120:123], v[96:111]
s_add_u32 m0, s51, 151552
v_mfma_f32_32x32x16_bf16 v[192:207], a[40:43], a[124:127], v[192:207]
s_waitcnt lgkmcnt(6)
v_mfma_f32_32x32x16_bf16 v[112:127], a[44:47], a[120:123], v[112:127]
buffer_load_dwordx4 v6, s[16:19], s49 offen offset:0 lds
v_mfma_f32_32x32x16_bf16 v[208:223], a[44:47], a[124:127], v[208:223]
v_mfma_f32_32x32x16_bf16 v[128:143], a[48:51], a[120:123], v[128:143]
s_add_u32 m0, s51, 155520
v_mfma_f32_32x32x16_bf16 v[224:239], a[48:51], a[124:127], v[224:239]
buffer_load_dwordx4 v6, s[16:19], s49 offen offset:128 lds
s_waitcnt lgkmcnt(4)
v_mfma_f32_32x32x16_bf16 v[144:159], a[52:55], a[120:123], v[144:159]
v_mfma_f32_32x32x16_bf16 v[240:255], a[52:55], a[124:127], v[240:255]
s_add_u32 m0, s51, 159488
s_waitcnt lgkmcnt(2)
v_mfma_f32_32x32x16_bf16 a[192:207], a[56:59], a[120:123], a[192:207]
v_mfma_f32_32x32x16_bf16 a[208:223], a[56:59], a[124:127], a[208:223]
buffer_load_dwordx4 v6, s[16:19], s49 offen offset:256 lds
s_add_u32 s49, s49, 12288
s_cmp_ge_u32 s49, 196608
s_cselect_b32 s49, 0, s49
s_waitcnt lgkmcnt(0)
v_mfma_f32_32x32x16_bf16 a[224:239], a[60:63], a[120:123], a[224:239]
s_waitcnt vmcnt(18)
s_barrier
.p2align 3
v_pk_mul_f32 v[64:65], v[64:65], s[52:53]
v_cvt_pk_bf16_f32 v64, v64, v65
v_pk_mul_f32 v[66:67], v[66:67], s[52:53]
v_cvt_pk_bf16_f32 v65, v66, v67
v_pk_mul_f32 v[68:69], v[68:69], s[52:53]
v_cvt_pk_bf16_f32 v66, v68, v69
v_pk_mul_f32 v[70:71], v[70:71], s[52:53]
v_cvt_pk_bf16_f32 v67, v70, v71
v_pk_mul_f32 v[72:73], v[72:73], s[52:53]
v_cvt_pk_bf16_f32 v68, v72, v73
v_pk_mul_f32 v[74:75], v[74:75], s[52:53]
v_cvt_pk_bf16_f32 v69, v74, v75
v_pk_mul_f32 v[76:77], v[76:77], s[52:53]
v_cvt_pk_bf16_f32 v70, v76, v77
v_pk_mul_f32 v[78:79], v[78:79], s[52:53]
v_cvt_pk_bf16_f32 v71, v78, v79
v_pk_mul_f32 v[80:81], v[80:81], s[52:53]
v_cvt_pk_bf16_f32 v72, v80, v81
v_pk_mul_f32 v[82:83], v[82:83], s[52:53]
v_cvt_pk_bf16_f32 v73, v82, v83
v_pk_mul_f32 v[84:85], v[84:85], s[52:53]
v_cvt_pk_bf16_f32 v74, v84, v85
v_pk_mul_f32 v[86:87], v[86:87], s[52:53]
v_cvt_pk_bf16_f32 v75, v86, v87
v_pk_mul_f32 v[88:89], v[88:89], s[52:53]
v_cvt_pk_bf16_f32 v76, v88, v89
v_pk_mul_f32 v[90:91], v[90:91], s[52:53]
v_cvt_pk_bf16_f32 v77, v90, v91
v_pk_mul_f32 v[92:93], v[92:93], s[52:53]
v_cvt_pk_bf16_f32 v78, v92, v93
v_pk_mul_f32 v[94:95], v[94:95], s[52:53]
v_cvt_pk_bf16_f32 v79, v94, v95
v_pk_mul_f32 v[96:97], v[96:97], s[52:53]
v_cvt_pk_bf16_f32 v80, v96, v97
v_pk_mul_f32 v[98:99], v[98:99], s[52:53]
v_cvt_pk_bf16_f32 v81, v98, v99
v_pk_mul_f32 v[100:101], v[100:101], s[52:53]
v_cvt_pk_bf16_f32 v82, v100, v101
v_pk_mul_f32 v[102:103], v[102:103], s[52:53]
v_cvt_pk_bf16_f32 v83, v102, v103
v_pk_mul_f32 v[104:105], v[104:105], s[52:53]
v_cvt_pk_bf16_f32 v84, v104, v105
v_pk_mul_f32 v[106:107], v[106:107], s[52:53]
v_cvt_pk_bf16_f32 v85, v106, v107
v_pk_mul_f32 v[108:109], v[108:109], s[52:53]
v_cvt_pk_bf16_f32 v86, v108, v109
v_pk_mul_f32 v[110:111], v[110:111], s[52:53]
v_cvt_pk_bf16_f32 v87, v110, v111
v_pk_mul_f32 v[112:113], v[112:113], s[52:53]
v_cvt_pk_bf16_f32 v88, v112, v113
v_pk_mul_f32 v[114:115], v[114:115], s[52:53]
v_cvt_pk_bf16_f32 v89, v114, v115
v_pk_mul_f32 v[116:117], v[116:117], s[52:53]
v_cvt_pk_bf16_f32 v90, v116, v117
v_pk_mul_f32 v[118:119], v[118:119], s[52:53]
v_cvt_pk_bf16_f32 v91, v118, v119
v_pk_mul_f32 v[120:121], v[120:121], s[52:53]
v_cvt_pk_bf16_f32 v92, v120, v121
v_pk_mul_f32 v[122:123], v[122:123], s[52:53]
v_cvt_pk_bf16_f32 v93, v122, v123
v_pk_mul_f32 v[124:125], v[124:125], s[52:53]
v_cvt_pk_bf16_f32 v94, v124, v125
v_pk_mul_f32 v[126:127], v[126:127], s[52:53]
v_cvt_pk_bf16_f32 v95, v126, v127
v_pk_mul_f32 v[128:129], v[128:129], s[52:53]
v_cvt_pk_bf16_f32 v96, v128, v129
v_pk_mul_f32 v[130:131], v[130:131], s[52:53]
v_cvt_pk_bf16_f32 v97, v130, v131
v_pk_mul_f32 v[132:133], v[132:133], s[52:53]
v_cvt_pk_bf16_f32 v98, v132, v133
v_pk_mul_f32 v[134:135], v[134:135], s[52:53]
v_cvt_pk_bf16_f32 v99, v134, v135
v_pk_mul_f32 v[136:137], v[136:137], s[52:53]
v_cvt_pk_bf16_f32 v100, v136, v137
v_pk_mul_f32 v[138:139], v[138:139], s[52:53]
v_cvt_pk_bf16_f32 v101, v138, v139
v_pk_mul_f32 v[140:141], v[140:141], s[52:53]
v_cvt_pk_bf16_f32 v102, v140, v141
v_pk_mul_f32 v[142:143], v[142:143], s[52:53]
v_cvt_pk_bf16_f32 v103, v142, v143
v_pk_mul_f32 v[144:145], v[144:145], s[52:53]
v_cvt_pk_bf16_f32 v104, v144, v145
v_pk_mul_f32 v[146:147], v[146:147], s[52:53]
v_cvt_pk_bf16_f32 v105, v146, v147
v_pk_mul_f32 v[148:149], v[148:149], s[52:53]
v_cvt_pk_bf16_f32 v106, v148, v149
v_pk_mul_f32 v[150:151], v[150:151], s[52:53]
v_cvt_pk_bf16_f32 v107, v150, v151
v_pk_mul_f32 v[152:153], v[152:153], s[52:53]
v_cvt_pk_bf16_f32 v108, v152, v153
v_pk_mul_f32 v[154:155], v[154:155], s[52:53]
v_cvt_pk_bf16_f32 v109, v154, v155
v_pk_mul_f32 v[156:157], v[156:157], s[52:53]
v_cvt_pk_bf16_f32 v110, v156, v157
v_pk_mul_f32 v[158:159], v[158:159], s[52:53]
v_cvt_pk_bf16_f32 v111, v158, v159
v_pk_mul_f32 v[160:161], v[160:161], s[52:53]
v_cvt_pk_bf16_f32 v112, v160, v161
v_pk_mul_f32 v[162:163], v[162:163], s[52:53]
v_cvt_pk_bf16_f32 v113, v162, v163
v_pk_mul_f32 v[164:165], v[164:165], s[52:53]
v_cvt_pk_bf16_f32 v114, v164, v165
v_pk_mul_f32 v[166:167], v[166:167], s[52:53]
v_cvt_pk_bf16_f32 v115, v166, v167
v_pk_mul_f32 v[168:169], v[168:169], s[52:53]
v_cvt_pk_bf16_f32 v116, v168, v169
v_pk_mul_f32 v[170:171], v[170:171], s[52:53]
v_cvt_pk_bf16_f32 v117, v170, v171
v_pk_mul_f32 v[172:173], v[172:173], s[52:53]
v_cvt_pk_bf16_f32 v118, v172, v173
v_pk_mul_f32 v[174:175], v[174:175], s[52:53]
v_cvt_pk_bf16_f32 v119, v174, v175
v_pk_mul_f32 v[176:177], v[176:177], s[52:53]
v_cvt_pk_bf16_f32 v120, v176, v177
v_pk_mul_f32 v[178:179], v[178:179], s[52:53]
v_cvt_pk_bf16_f32 v121, v178, v179
v_pk_mul_f32 v[180:181], v[180:181], s[52:53]
v_cvt_pk_bf16_f32 v122, v180, v181
v_pk_mul_f32 v[182:183], v[182:183], s[52:53]
v_cvt_pk_bf16_f32 v123, v182, v183
v_pk_mul_f32 v[184:185], v[184:185], s[52:53]
v_cvt_pk_bf16_f32 v124, v184, v185
v_pk_mul_f32 v[186:187], v[186:187], s[52:53]
v_cvt_pk_bf16_f32 v125, v186, v187
v_pk_mul_f32 v[188:189], v[188:189], s[52:53]
v_cvt_pk_bf16_f32 v126, v188, v189
v_pk_mul_f32 v[190:191], v[190:191], s[52:53]
v_cvt_pk_bf16_f32 v127, v190, v191
v_pk_mul_f32 v[192:193], v[192:193], s[52:53]
v_cvt_pk_bf16_f32 v128, v192, v193
v_pk_mul_f32 v[194:195], v[194:195], s[52:53]
v_cvt_pk_bf16_f32 v129, v194, v195
v_pk_mul_f32 v[196:197], v[196:197], s[52:53]
v_cvt_pk_bf16_f32 v130, v196, v197
v_pk_mul_f32 v[198:199], v[198:199], s[52:53]
v_cvt_pk_bf16_f32 v131, v198, v199
v_pk_mul_f32 v[200:201], v[200:201], s[52:53]
v_cvt_pk_bf16_f32 v132, v200, v201
v_pk_mul_f32 v[202:203], v[202:203], s[52:53]
v_cvt_pk_bf16_f32 v133, v202, v203
v_pk_mul_f32 v[204:205], v[204:205], s[52:53]
v_cvt_pk_bf16_f32 v134, v204, v205
v_pk_mul_f32 v[206:207], v[206:207], s[52:53]
v_cvt_pk_bf16_f32 v135, v206, v207
v_pk_mul_f32 v[208:209], v[208:209], s[52:53]
v_cvt_pk_bf16_f32 v136, v208, v209
v_pk_mul_f32 v[210:211], v[210:211], s[52:53]
v_cvt_pk_bf16_f32 v137, v210, v211
v_pk_mul_f32 v[212:213], v[212:213], s[52:53]
v_cvt_pk_bf16_f32 v138, v212, v213
v_pk_mul_f32 v[214:215], v[214:215], s[52:53]
v_cvt_pk_bf16_f32 v139, v214, v215
v_pk_mul_f32 v[216:217], v[216:217], s[52:53]
v_cvt_pk_bf16_f32 v140, v216, v217
v_pk_mul_f32 v[218:219], v[218:219], s[52:53]
v_cvt_pk_bf16_f32 v141, v218, v219
v_pk_mul_f32 v[220:221], v[220:221], s[52:53]
v_cvt_pk_bf16_f32 v142, v220, v221
v_pk_mul_f32 v[222:223], v[222:223], s[52:53]
v_cvt_pk_bf16_f32 v143, v222, v223
v_pk_mul_f32 v[224:225], v[224:225], s[52:53]
v_cvt_pk_bf16_f32 v144, v224, v225
v_pk_mul_f32 v[226:227], v[226:227], s[52:53]
v_cvt_pk_bf16_f32 v145, v226, v227
v_pk_mul_f32 v[228:229], v[228:229], s[52:53]
v_cvt_pk_bf16_f32 v146, v228, v229
v_pk_mul_f32 v[230:231], v[230:231], s[52:53]
v_cvt_pk_bf16_f32 v147, v230, v231
v_pk_mul_f32 v[232:233], v[232:233], s[52:53]
v_cvt_pk_bf16_f32 v148, v232, v233
v_pk_mul_f32 v[234:235], v[234:235], s[52:53]
v_cvt_pk_bf16_f32 v149, v234, v235
v_pk_mul_f32 v[236:237], v[236:237], s[52:53]
v_cvt_pk_bf16_f32 v150, v236, v237
v_pk_mul_f32 v[238:239], v[238:239], s[52:53]
v_cvt_pk_bf16_f32 v151, v238, v239
v_pk_mul_f32 v[240:241], v[240:241], s[52:53]
v_cvt_pk_bf16_f32 v152, v240, v241
v_pk_mul_f32 v[242:243], v[242:243], s[52:53]
v_cvt_pk_bf16_f32 v153, v242, v243
v_pk_mul_f32 v[244:245], v[244:245], s[52:53]
v_cvt_pk_bf16_f32 v154, v244, v245
v_pk_mul_f32 v[246:247], v[246:247], s[52:53]
v_cvt_pk_bf16_f32 v155, v246, v247
v_pk_mul_f32 v[248:249], v[248:249], s[52:53]
v_cvt_pk_bf16_f32 v156, v248, v249
v_pk_mul_f32 v[250:251], v[250:251], s[52:53]
v_cvt_pk_bf16_f32 v157, v250, v251
v_pk_mul_f32 v[252:253], v[252:253], s[52:53]
v_cvt_pk_bf16_f32 v158, v252, v253
v_pk_mul_f32 v[254:255], v[254:255], s[52:53]
v_cvt_pk_bf16_f32 v159, v254, v255
ds_read_b128 v[224:227], v8 offset:0
ds_read_b128 v[228:231], v9 offset:0
ds_read_b128 v[232:235], v10 offset:0
ds_read_b128 v[236:239], v11 offset:0
ds_read_b128 v[240:243], v8 offset:4096
ds_read_b128 v[244:247], v9 offset:4096
v_accvgpr_read_b32 v18, a192
v_accvgpr_read_b32 v19, a193
v_max_f32 v18, 0, v18
v_max_f32 v19, 0, v19
v_mul_f32 v18, v18, v18
v_mul_f32 v19, v19, v19
v_cvt_pk_bf16_f32 v192, v18, v19
v_accvgpr_read_b32 v20, a194
v_accvgpr_read_b32 v21, a195
v_max_f32 v20, 0, v20
v_max_f32 v21, 0, v21
v_mul_f32 v20, v20, v20
v_mul_f32 v21, v21, v21
v_cvt_pk_bf16_f32 v193, v20, v21
v_accvgpr_read_b32 v18, a196
v_accvgpr_read_b32 v19, a197
v_max_f32 v18, 0, v18
v_max_f32 v19, 0, v19
v_mul_f32 v18, v18, v18
v_mul_f32 v19, v19, v19
v_cvt_pk_bf16_f32 v194, v18, v19
v_accvgpr_read_b32 v20, a198
v_accvgpr_read_b32 v21, a199
v_max_f32 v20, 0, v20
v_max_f32 v21, 0, v21
v_mul_f32 v20, v20, v20
v_mul_f32 v21, v21, v21
v_cvt_pk_bf16_f32 v195, v20, v21
buffer_store_dwordx4 v[192:195], v28, s[12:15], s94 offen offset:0 sc1
s_waitcnt lgkmcnt(5)
v_mfma_f32_32x32x16_bf16 v[160:175], v[224:227], v[64:67], 0
s_add_u32 m0, s51, 0
ds_read_b128 v[248:251], v10 offset:4096
buffer_load_dwordx4 v7, s[20:23], s50 offen lds
s_add_u32 s50, s50, 12288
v_accvgpr_read_b32 v18, a200
v_accvgpr_read_b32 v19, a201
v_max_f32 v18, 0, v18
v_mfma_f32_32x32x16_bf16 v[176:191], v[224:227], v[112:115], 0
v_max_f32 v19, 0, v19
v_mul_f32 v18, v18, v18
v_mul_f32 v19, v19, v19
v_cvt_pk_bf16_f32 v196, v18, v19
v_accvgpr_read_b32 v20, a202
v_accvgpr_read_b32 v21, a203
v_max_f32 v20, 0, v20
s_waitcnt lgkmcnt(5)
v_mfma_f32_32x32x16_bf16 v[160:175], v[228:231], v[68:71], v[160:175]
ds_read_b128 v[252:255], v11 offset:4096
v_max_f32 v21, 0, v21
v_mul_f32 v20, v20, v20
v_mul_f32 v21, v21, v21
v_cvt_pk_bf16_f32 v197, v20, v21
v_accvgpr_read_b32 v18, a204
v_mfma_f32_32x32x16_bf16 v[176:191], v[228:231], v[116:119], v[176:191]
v_accvgpr_read_b32 v19, a205
v_max_f32 v18, 0, v18
v_max_f32 v19, 0, v19
v_mul_f32 v18, v18, v18
v_mul_f32 v19, v19, v19
v_cvt_pk_bf16_f32 v198, v18, v19
v_accvgpr_read_b32 v20, a206
s_waitcnt lgkmcnt(5)
v_mfma_f32_32x32x16_bf16 v[160:175], v[232:235], v[72:75], v[160:175]
ds_read_b128 v[224:227], v8 offset:8192
v_accvgpr_read_b32 v21, a207
v_max_f32 v20, 0, v20
v_max_f32 v21, 0, v21
v_mul_f32 v20, v20, v20
v_mul_f32 v21, v21, v21
v_cvt_pk_bf16_f32 v199, v20, v21
v_mfma_f32_32x32x16_bf16 v[176:191], v[232:235], v[120:123], v[176:191]
buffer_store_dwordx4 v[196:199], v28, s[12:15], s94 offen offset:1024 sc1
v_accvgpr_read_b32 v18, a208
v_accvgpr_read_b32 v19, a209
v_max_f32 v18, 0, v18
v_max_f32 v19, 0, v19
v_mul_f32 v18, v18, v18
v_mul_f32 v19, v19, v19
s_waitcnt lgkmcnt(5)
v_mfma_f32_32x32x16_bf16 v[160:175], v[236:239], v[76:79], v[160:175]
ds_read_b128 v[228:231], v9 offset:8192
v_cvt_pk_bf16_f32 v200, v18, v19
v_accvgpr_read_b32 v20, a210
v_accvgpr_read_b32 v21, a211
v_max_f32 v20, 0, v20
v_max_f32 v21, 0, v21
v_mul_f32 v20, v20, v20
v_mfma_f32_32x32x16_bf16 v[176:191], v[236:239], v[124:127], v[176:191]
s_waitcnt lgkmcnt(2)
v_mul_f32 v21, v21, v21
v_cvt_pk_bf16_f32 v201, v20, v21
v_accvgpr_read_b32 v18, a212
v_accvgpr_read_b32 v19, a213
v_max_f32 v18, 0, v18
v_mfma_f32_32x32x16_bf16 v[160:175], v[240:243], v[80:83], v[160:175]
ds_read_b128 v[232:235], v10 offset:8192
v_max_f32 v19, 0, v19
v_mul_f32 v18, v18, v18
v_mul_f32 v19, v19, v19
v_cvt_pk_bf16_f32 v202, v18, v19
v_accvgpr_read_b32 v20, a214
v_accvgpr_read_b32 v21, a215
v_mfma_f32_32x32x16_bf16 v[176:191], v[240:243], v[128:131], v[176:191]
v_max_f32 v20, 0, v20
v_max_f32 v21, 0, v21
v_mul_f32 v20, v20, v20
v_mul_f32 v21, v21, v21
v_cvt_pk_bf16_f32 v203, v20, v21
buffer_store_dwordx4 v[200:203], v29, s[12:15], s94 offen offset:0 sc1
v_accvgpr_read_b32 v18, a216
v_mfma_f32_32x32x16_bf16 v[160:175], v[244:247], v[84:87], v[160:175]
ds_read_b128 v[236:239], v11 offset:8192
v_accvgpr_read_b32 v19, a217
v_max_f32 v18, 0, v18
v_max_f32 v19, 0, v19
v_mul_f32 v18, v18, v18
v_mul_f32 v19, v19, v19
v_cvt_pk_bf16_f32 v204, v18, v19
v_mfma_f32_32x32x16_bf16 v[176:191], v[244:247], v[132:135], v[176:191]
v_accvgpr_read_b32 v20, a218
v_accvgpr_read_b32 v21, a219
v_max_f32 v20, 0, v20
v_max_f32 v21, 0, v21
v_mul_f32 v20, v20, v20
v_mul_f32 v21, v21, v21
v_cvt_pk_bf16_f32 v205, v20, v21
v_mfma_f32_32x32x16_bf16 v[160:175], v[248:251], v[88:91], v[160:175]
ds_read_b128 v[240:243], v8 offset:12288
v_accvgpr_read_b32 v18, a220
v_accvgpr_read_b32 v19, a221
v_max_f32 v18, 0, v18
v_max_f32 v19, 0, v19
v_mul_f32 v18, v18, v18
v_mfma_f32_32x32x16_bf16 v[176:191], v[248:251], v[136:139], v[176:191]
v_mul_f32 v19, v19, v19
v_cvt_pk_bf16_f32 v206, v18, v19
v_accvgpr_read_b32 v20, a222
v_accvgpr_read_b32 v21, a223
v_max_f32 v20, 0, v20
v_max_f32 v21, 0, v21
v_mul_f32 v20, v20, v20
v_mfma_f32_32x32x16_bf16 v[160:175], v[252:255], v[92:95], v[160:175]
ds_read_b128 v[244:247], v9 offset:12288
v_mul_f32 v21, v21, v21
v_cvt_pk_bf16_f32 v207, v20, v21
buffer_store_dwordx4 v[204:207], v29, s[12:15], s94 offen offset:1024 sc1
v_accvgpr_read_b32 v18, a224
v_accvgpr_read_b32 v19, a225
v_max_f32 v18, 0, v18
v_mfma_f32_32x32x16_bf16 v[176:191], v[252:255], v[140:143], v[176:191]
s_waitcnt lgkmcnt(2)
v_max_f32 v19, 0, v19
v_mul_f32 v18, v18, v18
v_mul_f32 v19, v19, v19
v_cvt_pk_bf16_f32 v208, v18, v19
v_accvgpr_read_b32 v20, a226
v_accvgpr_read_b32 v21, a227
v_mfma_f32_32x32x16_bf16 v[160:175], v[224:227], v[96:99], v[160:175]
ds_read_b128 v[248:251], v10 offset:12288
v_max_f32 v20, 0, v20
v_max_f32 v21, 0, v21
v_mul_f32 v20, v20, v20
v_mul_f32 v21, v21, v21
v_cvt_pk_bf16_f32 v209, v20, v21
v_accvgpr_read_b32 v18, a228
v_mfma_f32_32x32x16_bf16 v[176:191], v[224:227], v[144:147], v[176:191]
v_accvgpr_read_b32 v19, a229
v_max_f32 v18, 0, v18
v_max_f32 v19, 0, v19
v_mul_f32 v18, v18, v18
v_mul_f32 v19, v19, v19
v_cvt_pk_bf16_f32 v210, v18, v19
v_mfma_f32_32x32x16_bf16 v[160:175], v[228:231], v[100:103], v[160:175]
ds_read_b128 v[252:255], v11 offset:12288
v_accvgpr_read_b32 v20, a230
v_accvgpr_read_b32 v21, a231
v_max_f32 v20, 0, v20
v_max_f32 v21, 0, v21
v_mul_f32 v20, v20, v20
v_mul_f32 v21, v21, v21
v_mfma_f32_32x32x16_bf16 v[176:191], v[228:231], v[148:151], v[176:191]
v_cvt_pk_bf16_f32 v211, v20, v21
buffer_store_dwordx4 v[208:211], v28, s[12:15], 0 offen offset:2048 sc1
v_accvgpr_read_b32 v18, a232
v_accvgpr_read_b32 v19, a233
v_max_f32 v18, 0, v18
v_max_f32 v19, 0, v19
v_mul_f32 v18, v18, v18
v_mfma_f32_32x32x16_bf16 v[160:175], v[232:235], v[104:107], v[160:175]
ds_read_b128 v[224:227], v8 offset:16384
v_mul_f32 v19, v19, v19
v_cvt_pk_bf16_f32 v212, v18, v19
v_accvgpr_read_b32 v20, a234
v_accvgpr_read_b32 v21, a235
v_max_f32 v20, 0, v20
v_max_f32 v21, 0, v21
v_mfma_f32_32x32x16_bf16 v[176:191], v[232:235], v[152:155], v[176:191]
v_mul_f32 v20, v20, v20
v_mul_f32 v21, v21, v21
v_cvt_pk_bf16_f32 v213, v20, v21
v_accvgpr_read_b32 v18, a236
v_accvgpr_read_b32 v19, a237
v_max_f32 v18, 0, v18
v_max_f32 v19, 0, v19
v_mfma_f32_32x32x16_bf16 v[160:175], v[236:239], v[108:111], v[160:175]
ds_read_b128 v[228:231], v9 offset:16384
v_mul_f32 v18, v18, v18
v_mul_f32 v19, v19, v19
v_cvt_pk_bf16_f32 v214, v18, v19
v_accvgpr_read_b32 v20, a238
v_accvgpr_read_b32 v21, a239
v_mfma_f32_32x32x16_bf16 v[176:191], v[236:239], v[156:159], v[176:191]
s_waitcnt lgkmcnt(2)
v_max_f32 v20, 0, v20
v_max_f32 v21, 0, v21
v_mul_f32 v20, v20, v20
v_mul_f32 v21, v21, v21
v_cvt_pk_bf16_f32 v215, v20, v21
buffer_store_dwordx4 v[212:215], v28, s[12:15], 0 offen offset:3072 sc1
v_max3_f32 v22, v160, v161, v162
v_max3_f32 v22, v22, v163, v164
v_max3_f32 v22, v22, v165, v166
v_max3_f32 v22, v22, v167, v168
v_max3_f32 v22, v22, v169, v170
v_max3_f32 v22, v22, v171, v172
v_max3_f32 v22, v22, v173, v174
v_max_f32 v22, v22, v175
v_mov_b32 v23, v22
s_nop 1
v_permlane32_swap_b32 v22, v23
v_max_f32 v22, v22, v23
v_sub_f32 v32, 0, v22
v_sub_f32 v33, 0, v22
v_sub_f32 v34, 0, v22
v_sub_f32 v35, 0, v22
v_sub_f32 v36, 0, v22
v_sub_f32 v37, 0, v22
v_sub_f32 v38, 0, v22
v_sub_f32 v39, 0, v22
v_sub_f32 v40, 0, v22
v_sub_f32 v41, 0, v22
v_sub_f32 v42, 0, v22
v_sub_f32 v43, 0, v22
v_sub_f32 v44, 0, v22
v_sub_f32 v45, 0, v22
v_sub_f32 v46, 0, v22
v_sub_f32 v47, 0, v22
v_max3_f32 v22, v176, v177, v178
v_max3_f32 v22, v22, v179, v180
v_max3_f32 v22, v22, v181, v182
v_max3_f32 v22, v22, v183, v184
v_max3_f32 v22, v22, v185, v186
v_max3_f32 v22, v22, v187, v188
v_max3_f32 v22, v22, v189, v190
v_max_f32 v22, v22, v191
v_mov_b32 v23, v22
s_nop 1
v_permlane32_swap_b32 v22, v23
v_max_f32 v22, v22, v23
v_sub_f32 v48, 0, v22
v_sub_f32 v49, 0, v22
v_sub_f32 v50, 0, v22
v_sub_f32 v51, 0, v22
v_sub_f32 v52, 0, v22
v_sub_f32 v53, 0, v22
v_sub_f32 v54, 0, v22
v_sub_f32 v55, 0, v22
v_sub_f32 v56, 0, v22
v_sub_f32 v57, 0, v22
v_sub_f32 v58, 0, v22
v_sub_f32 v59, 0, v22
v_sub_f32 v60, 0, v22
v_sub_f32 v61, 0, v22
v_sub_f32 v62, 0, v22
v_sub_f32 v63, 0, v22
v_mfma_f32_32x32x16_bf16 v[192:207], v[240:243], v[64:67], v[32:47]
s_add_u32 m0, s51, 4096
ds_read_b128 v[232:235], v10 offset:16384
buffer_load_dwordx4 v7, s[20:23], s50 offen lds
s_add_u32 s50, s50, 12288
s_cmp_ge_u32 s50, 196608
s_cselect_b32 s50, 0, s50
v_add_f32 v160, v160, v32
v_add_f32 v161, v161, v33
v_mfma_f32_32x32x16_bf16 v[208:223], v[240:243], v[112:115], v[48:63]
v_add_f32 v162, v162, v34
v_add_f32 v163, v163, v35
v_add_f32 v164, v164, v36
v_add_f32 v165, v165, v37
v_add_f32 v166, v166, v38
v_add_f32 v167, v167, v39
v_add_f32 v168, v168, v40
v_add_f32 v169, v169, v41
v_mfma_f32_32x32x16_bf16 v[192:207], v[244:247], v[68:71], v[192:207]
ds_read_b128 v[236:239], v11 offset:16384
s_lshl_b32 s46, s6, 2
v_add_f32 v170, v170, v42
v_add_f32 v171, v171, v43
v_add_f32 v172, v172, v44
v_add_f32 v173, v173, v45
v_add_f32 v174, v174, v46
v_add_f32 v175, v175, v47
v_mfma_f32_32x32x16_bf16 v[208:223], v[244:247], v[116:119], v[208:223]
v_exp_f32 v18, v160
v_exp_f32 v19, v161
v_mov_b32 v14, 0
v_cvt_pk_bf16_f32 v22, v18, v19
v_add_f32 v16, v18, v19
v_exp_f32 v20, v162
v_mfma_f32_32x32x16_bf16 v[192:207], v[248:251], v[72:75], v[192:207]
ds_read_b128 v[240:243], v8 offset:20480
v_exp_f32 v21, v163
v_accvgpr_write_b32 a0, v22
v_add_f32 v16, v16, v20
v_cvt_pk_bf16_f32 v23, v20, v21
v_add_f32 v16, v16, v21
v_mfma_f32_32x32x16_bf16 v[208:223], v[248:251], v[120:123], v[208:223]
s_add_u32 s46, s46, s3
v_exp_f32 v18, v164
v_exp_f32 v19, v165
v_accvgpr_write_b32 a1, v23
v_add_f32 v16, v16, v18
v_cvt_pk_bf16_f32 v22, v18, v19
v_mfma_f32_32x32x16_bf16 v[192:207], v[252:255], v[76:79], v[192:207]
ds_read_b128 v[244:247], v9 offset:20480
v_add_f32 v16, v16, v19
v_exp_f32 v20, v166
v_exp_f32 v21, v167
v_accvgpr_write_b32 a2, v22
v_add_f32 v16, v16, v20
v_mfma_f32_32x32x16_bf16 v[208:223], v[252:255], v[124:127], v[208:223]
s_waitcnt lgkmcnt(2)
v_cvt_pk_bf16_f32 v23, v20, v21
v_add_f32 v16, v16, v21
v_exp_f32 v18, v168
v_exp_f32 v19, v169
v_accvgpr_write_b32 a3, v23
v_mfma_f32_32x32x16_bf16 v[192:207], v[224:227], v[80:83], v[192:207]
ds_read_b128 v[248:251], v10 offset:20480
s_mul_i32 s46, s46, 6144
v_add_f32 v16, v16, v18
v_cvt_pk_bf16_f32 v22, v18, v19
v_add_f32 v16, v16, v19
v_exp_f32 v20, v170
v_exp_f32 v21, v171
v_mfma_f32_32x32x16_bf16 v[208:223], v[224:227], v[128:131], v[208:223]
v_accvgpr_write_b32 a4, v22
v_add_f32 v16, v16, v20
v_cvt_pk_bf16_f32 v23, v20, v21
v_add_f32 v16, v16, v21
v_exp_f32 v18, v172
v_exp_f32 v19, v173
v_mfma_f32_32x32x16_bf16 v[192:207], v[228:231], v[84:87], v[192:207]
ds_read_b128 v[252:255], v11 offset:20480
v_accvgpr_write_b32 a5, v23
v_add_f32 v16, v16, v18
v_cvt_pk_bf16_f32 v22, v18, v19
v_add_f32 v16, v16, v19
v_exp_f32 v20, v174
v_mfma_f32_32x32x16_bf16 v[208:223], v[228:231], v[132:135], v[208:223]
v_exp_f32 v21, v175
v_accvgpr_write_b32 a6, v22
v_add_f32 v16, v16, v20
v_cvt_pk_bf16_f32 v23, v20, v21
v_add_f32 v16, v16, v21
v_accvgpr_write_b32 a7, v23
v_add_f32 v176, v176, v48
v_add_f32 v177, v177, v49
v_mfma_f32_32x32x16_bf16 v[192:207], v[232:235], v[88:91], v[192:207]
s_waitcnt vmcnt(20)
s_barrier
ds_read_b128 v[224:227], v8 offset:24576
buffer_load_dword v1, v30, s[20:23], s46 offen offset:0
v_add_f32 v178, v178, v50
v_add_f32 v179, v179, v51
v_add_f32 v180, v180, v52
v_add_f32 v181, v181, v53
v_mfma_f32_32x32x16_bf16 v[208:223], v[232:235], v[136:139], v[208:223]
s_add_u32 m0, s51, 65536
v_add_f32 v182, v182, v54
v_add_f32 v183, v183, v55
v_add_f32 v184, v184, v56
v_add_f32 v185, v185, v57
v_add_f32 v186, v186, v58
v_add_f32 v187, v187, v59
v_add_f32 v188, v188, v60
v_mfma_f32_32x32x16_bf16 v[192:207], v[236:239], v[92:95], v[192:207]
ds_read_b128 v[228:231], v9 offset:24576
buffer_load_dwordx4 v6, s[16:19], s49 offen offset:0 lds
v_add_f32 v189, v189, v61
v_add_f32 v190, v190, v62
v_add_f32 v191, v191, v63
v_exp_f32 v18, v176
v_mfma_f32_32x32x16_bf16 v[208:223], v[236:239], v[140:143], v[208:223]
s_waitcnt lgkmcnt(2)
v_exp_f32 v19, v177
v_mov_b32 v15, 0
v_cvt_pk_bf16_f32 v22, v18, v19
v_add_f32 v17, v18, v19
v_exp_f32 v20, v178
v_mfma_f32_32x32x16_bf16 v[192:207], v[240:243], v[96:99], v[192:207]
ds_read_b128 v[232:235], v10 offset:24576
s_add_u32 m0, s51, 69504
v_exp_f32 v21, v179
v_accvgpr_write_b32 a8, v22
v_add_f32 v17, v17, v20
v_cvt_pk_bf16_f32 v23, v20, v21
v_add_f32 v17, v17, v21
v_mfma_f32_32x32x16_bf16 v[208:223], v[240:243], v[144:147], v[208:223]
v_exp_f32 v18, v180
v_exp_f32 v19, v181
v_accvgpr_write_b32 a9, v23
v_add_f32 v17, v17, v18
v_cvt_pk_bf16_f32 v22, v18, v19
v_add_f32 v17, v17, v19
v_mfma_f32_32x32x16_bf16 v[192:207], v[244:247], v[100:103], v[192:207]
ds_read_b128 v[236:239], v11 offset:24576
buffer_load_dwordx4 v6, s[16:19], s49 offen offset:128 lds
v_exp_f32 v20, v182
v_exp_f32 v21, v183
v_accvgpr_write_b32 a10, v22
v_add_f32 v17, v17, v20
v_cvt_pk_bf16_f32 v23, v20, v21
v_mfma_f32_32x32x16_bf16 v[208:223], v[244:247], v[148:151], v[208:223]
v_add_f32 v17, v17, v21
v_exp_f32 v18, v184
v_exp_f32 v19, v185
v_accvgpr_write_b32 a11, v23
v_add_f32 v17, v17, v18
v_cvt_pk_bf16_f32 v22, v18, v19
v_mfma_f32_32x32x16_bf16 v[192:207], v[248:251], v[104:107], v[192:207]
ds_read_b128 v[240:243], v8 offset:28672
s_add_u32 m0, s51, 73472
v_add_f32 v17, v17, v19
v_exp_f32 v20, v186
v_exp_f32 v21, v187
v_accvgpr_write_b32 a12, v22
v_mfma_f32_32x32x16_bf16 v[208:223], v[248:251], v[152:155], v[208:223]
v_add_f32 v17, v17, v20
v_cvt_pk_bf16_f32 v23, v20, v21
v_add_f32 v17, v17, v21
v_exp_f32 v18, v188
v_exp_f32 v19, v189
v_accvgpr_write_b32 a13, v23
v_mfma_f32_32x32x16_bf16 v[192:207], v[252:255], v[108:111], v[192:207]
ds_read_b128 v[244:247], v9 offset:28672
buffer_load_dwordx4 v6, s[16:19], s49 offen offset:256 lds
s_add_u32 s49, s49, 12288
v_add_f32 v17, v17, v18
v_cvt_pk_bf16_f32 v22, v18, v19
v_add_f32 v17, v17, v19
v_exp_f32 v20, v190
v_mfma_f32_32x32x16_bf16 v[208:223], v[252:255], v[156:159], v[208:223]
s_waitcnt lgkmcnt(2)
v_exp_f32 v21, v191
v_accvgpr_write_b32 a14, v22
v_add_f32 v17, v17, v20
v_cvt_pk_bf16_f32 v23, v20, v21
v_add_f32 v17, v17, v21
v_accvgpr_write_b32 a15, v23
v_mfma_f32_32x32x16_bf16 v[160:175], v[224:227], v[64:67], v[32:47]
s_add_u32 m0, s51, 8192
ds_read_b128 v[248:251], v10 offset:28672
buffer_load_dwordx4 v7, s[20:23], s50 offen lds
s_add_u32 s50, s50, 12288
v_mfma_f32_32x32x16_bf16 v[176:191], v[224:227], v[112:115], v[48:63]
v_exp_f32 v18, v192
v_exp_f32 v19, v193
v_add_f32 v14, v14, v16
v_cvt_pk_bf16_f32 v22, v18, v19
v_mfma_f32_32x32x16_bf16 v[160:175], v[228:231], v[68:71], v[160:175]
ds_read_b128 v[252:255], v11 offset:28672
buffer_store_dwordx4 a[244:247], v30, s[12:15], s90 offen offset:2048 sc1
v_add_f32 v16, v18, v19
v_exp_f32 v20, v194
v_exp_f32 v21, v195
v_mfma_f32_32x32x16_bf16 v[176:191], v[228:231], v[116:119], v[176:191]
v_accvgpr_write_b32 a16, v22
v_add_f32 v16, v16, v20
v_cvt_pk_bf16_f32 v23, v20, v21
v_add_f32 v16, v16, v21
v_exp_f32 v18, v196
v_mfma_f32_32x32x16_bf16 v[160:175], v[232:235], v[72:75], v[160:175]
ds_read_b128 v[224:227], v8 offset:32768
v_exp_f32 v19, v197
v_accvgpr_write_b32 a17, v23
v_add_f32 v16, v16, v18
v_cvt_pk_bf16_f32 v22, v18, v19
v_mfma_f32_32x32x16_bf16 v[176:191], v[232:235], v[120:123], v[176:191]
v_add_f32 v16, v16, v19
v_exp_f32 v20, v198
v_exp_f32 v21, v199
v_accvgpr_write_b32 a18, v22
v_add_f32 v16, v16, v20
v_mfma_f32_32x32x16_bf16 v[160:175], v[236:239], v[76:79], v[160:175]
ds_read_b128 v[228:231], v9 offset:32768
v_cvt_pk_bf16_f32 v23, v20, v21
v_add_f32 v16, v16, v21
v_exp_f32 v18, v200
v_exp_f32 v19, v201
v_mfma_f32_32x32x16_bf16 v[176:191], v[236:239], v[124:127], v[176:191]
s_waitcnt lgkmcnt(2)
v_accvgpr_write_b32 a19, v23
v_add_f32 v16, v16, v18
v_cvt_pk_bf16_f32 v22, v18, v19
v_add_f32 v16, v16, v19
v_mfma_f32_32x32x16_bf16 v[160:175], v[240:243], v[80:83], v[160:175]
ds_read_b128 v[232:235], v10 offset:32768
v_exp_f32 v20, v202
v_exp_f32 v21, v203
v_accvgpr_write_b32 a20, v22
v_add_f32 v16, v16, v20
v_mfma_f32_32x32x16_bf16 v[176:191], v[240:243], v[128:131], v[176:191]
v_cvt_pk_bf16_f32 v23, v20, v21
v_add_f32 v16, v16, v21
v_exp_f32 v18, v204
v_exp_f32 v19, v205
v_mfma_f32_32x32x16_bf16 v[160:175], v[244:247], v[84:87], v[160:175]
ds_read_b128 v[236:239], v11 offset:32768
v_accvgpr_write_b32 a21, v23
v_add_f32 v16, v16, v18
v_cvt_pk_bf16_f32 v22, v18, v19
v_add_f32 v16, v16, v19
v_exp_f32 v20, v206
v_mfma_f32_32x32x16_bf16 v[176:191], v[244:247], v[132:135], v[176:191]
v_exp_f32 v21, v207
v_accvgpr_write_b32 a22, v22
v_add_f32 v16, v16, v20
v_cvt_pk_bf16_f32 v23, v20, v21
v_add_f32 v16, v16, v21
v_mfma_f32_32x32x16_bf16 v[160:175], v[248:251], v[88:91], v[160:175]
ds_read_b128 v[240:243], v8 offset:36864
buffer_load_dword v2, v30, s[20:23], s46 offen offset:1024
v_accvgpr_write_b32 a23, v23
v_exp_f32 v18, v208
v_exp_f32 v19, v209
v_mfma_f32_32x32x16_bf16 v[176:191], v[248:251], v[136:139], v[176:191]
v_add_f32 v15, v15, v17
v_cvt_pk_bf16_f32 v22, v18, v19
v_add_f32 v17, v18, v19
v_exp_f32 v20, v210
v_mfma_f32_32x32x16_bf16 v[160:175], v[252:255], v[92:95], v[160:175]
ds_read_b128 v[244:247], v9 offset:36864
v_exp_f32 v21, v211
v_accvgpr_write_b32 a24, v22
v_add_f32 v17, v17, v20
v_cvt_pk_bf16_f32 v23, v20, v21
v_add_f32 v17, v17, v21
v_mfma_f32_32x32x16_bf16 v[176:191], v[252:255], v[140:143], v[176:191]
s_waitcnt lgkmcnt(2)
v_exp_f32 v18, v212
v_exp_f32 v19, v213
v_accvgpr_write_b32 a25, v23
v_mfma_f32_32x32x16_bf16 v[160:175], v[224:227], v[96:99], v[160:175]
ds_read_b128 v[248:251], v10 offset:36864
v_add_f32 v17, v17, v18
v_cvt_pk_bf16_f32 v22, v18, v19
v_add_f32 v17, v17, v19
v_exp_f32 v20, v214
v_mfma_f32_32x32x16_bf16 v[176:191], v[224:227], v[144:147], v[176:191]
v_exp_f32 v21, v215
v_accvgpr_write_b32 a26, v22
v_add_f32 v17, v17, v20
v_cvt_pk_bf16_f32 v23, v20, v21
v_add_f32 v17, v17, v21
v_mfma_f32_32x32x16_bf16 v[160:175], v[228:231], v[100:103], v[160:175]
ds_read_b128 v[252:255], v11 offset:36864
v_exp_f32 v18, v216
v_exp_f32 v19, v217
v_accvgpr_write_b32 a27, v23
v_add_f32 v17, v17, v18
v_mfma_f32_32x32x16_bf16 v[176:191], v[228:231], v[148:151], v[176:191]
v_cvt_pk_bf16_f32 v22, v18, v19
v_add_f32 v17, v17, v19
v_exp_f32 v20, v218
v_exp_f32 v21, v219
v_accvgpr_write_b32 a28, v22
v_mfma_f32_32x32x16_bf16 v[160:175], v[232:235], v[104:107], v[160:175]
ds_read_b128 v[224:227], v8 offset:40960
v_add_f32 v17, v17, v20
v_cvt_pk_bf16_f32 v23, v20, v21
v_add_f32 v17, v17, v21
v_exp_f32 v18, v220
v_mfma_f32_32x32x16_bf16 v[176:191], v[232:235], v[152:155], v[176:191]
v_exp_f32 v19, v221
v_accvgpr_write_b32 a29, v23
v_add_f32 v17, v17, v18
v_cvt_pk_bf16_f32 v22, v18, v19
v_add_f32 v17, v17, v19
v_mfma_f32_32x32x16_bf16 v[160:175], v[236:239], v[108:111], v[160:175]
ds_read_b128 v[228:231], v9 offset:40960
v_exp_f32 v20, v222
v_exp_f32 v21, v223
v_accvgpr_write_b32 a30, v22
v_add_f32 v17, v17, v20
v_mfma_f32_32x32x16_bf16 v[176:191], v[236:239], v[156:159], v[176:191]
s_waitcnt lgkmcnt(2)
v_cvt_pk_bf16_f32 v23, v20, v21
v_add_f32 v17, v17, v21
v_accvgpr_write_b32 a31, v23
v_add_f32 v22, v16, v17
v_cmp_nge_f32 vcc, s54, v22
s_cbranch_vccnz STUB1
RET1:
v_mfma_f32_32x32x16_bf16 v[192:207], v[240:243], v[64:67], v[32:47]
s_add_u32 m0, s51, 12288
ds_read_b128 v[232:235], v10 offset:40960
buffer_load_dwordx4 v7, s[20:23], s50 offen lds
s_add_u32 s50, s50, 12288
s_cmp_ge_u32 s50, 196608
s_cselect_b32 s50, 0, s50
v_mfma_f32_32x32x16_bf16 v[208:223], v[240:243], v[112:115], v[48:63]
v_exp_f32 v18, v160
v_exp_f32 v19, v161
v_add_f32 v14, v14, v16
v_cvt_pk_bf16_f32 v22, v18, v19
v_add_f32 v16, v18, v19
v_mfma_f32_32x32x16_bf16 v[192:207], v[244:247], v[68:71], v[192:207]
ds_read_b128 v[236:239], v11 offset:40960
buffer_store_dwordx4 a[244:247], v30, s[12:15], s90 offen offset:3072 sc1
s_add_u32 s90, s90, 4096
v_exp_f32 v20, v162
v_exp_f32 v21, v163
v_mfma_f32_32x32x16_bf16 v[208:223], v[244:247], v[116:119], v[208:223]
v_accvgpr_write_b32 a32, v22
v_add_f32 v16, v16, v20
v_cvt_pk_bf16_f32 v23, v20, v21
v_add_f32 v16, v16, v21
v_exp_f32 v18, v164
v_mfma_f32_32x32x16_bf16 v[192:207], v[248:251], v[72:75], v[192:207]
ds_read_b128 v[240:243], v8 offset:45056
v_exp_f32 v19, v165
v_accvgpr_write_b32 a33, v23
v_add_f32 v16, v16, v18
v_cvt_pk_bf16_f32 v22, v18, v19
v_add_f32 v16, v16, v19
v_mfma_f32_32x32x16_bf16 v[208:223], v[248:251], v[120:123], v[208:223]
v_exp_f32 v20, v166
v_exp_f32 v21, v167
v_accvgpr_write_b32 a34, v22
v_add_f32 v16, v16, v20
v_cvt_pk_bf16_f32 v23, v20, v21
v_mfma_f32_32x32x16_bf16 v[192:207], v[252:255], v[76:79], v[192:207]
ds_read_b128 v[244:247], v9 offset:45056
v_add_f32 v16, v16, v21
v_exp_f32 v18, v168
v_exp_f32 v19, v169
v_accvgpr_write_b32 a35, v23
v_mfma_f32_32x32x16_bf16 v[208:223], v[252:255], v[124:127], v[208:223]
s_waitcnt lgkmcnt(2)
v_add_f32 v16, v16, v18
v_cvt_pk_bf16_f32 v22, v18, v19
v_add_f32 v16, v16, v19
v_exp_f32 v20, v170
v_exp_f32 v21, v171
v_mfma_f32_32x32x16_bf16 v[192:207], v[224:227], v[80:83], v[192:207]
ds_read_b128 v[248:251], v10 offset:45056
v_accvgpr_write_b32 a36, v22
v_add_f32 v16, v16, v20
v_cvt_pk_bf16_f32 v23, v20, v21
v_add_f32 v16, v16, v21
v_exp_f32 v18, v172
v_mfma_f32_32x32x16_bf16 v[208:223], v[224:227], v[128:131], v[208:223]
v_exp_f32 v19, v173
v_accvgpr_write_b32 a37, v23
v_add_f32 v16, v16, v18
v_cvt_pk_bf16_f32 v22, v18, v19
v_add_f32 v16, v16, v19
v_mfma_f32_32x32x16_bf16 v[192:207], v[228:231], v[84:87], v[192:207]
ds_read_b128 v[252:255], v11 offset:45056
v_exp_f32 v20, v174
v_exp_f32 v21, v175
v_accvgpr_write_b32 a38, v22
v_add_f32 v16, v16, v20
v_mfma_f32_32x32x16_bf16 v[208:223], v[228:231], v[132:135], v[208:223]
v_cvt_pk_bf16_f32 v23, v20, v21
v_add_f32 v16, v16, v21
v_accvgpr_write_b32 a39, v23
v_exp_f32 v18, v176
v_exp_f32 v19, v177
v_mfma_f32_32x32x16_bf16 v[192:207], v[232:235], v[88:91], v[192:207]
s_waitcnt vmcnt(23)
s_barrier
ds_read_b128 v[224:227], v8 offset:49152
buffer_load_dword v3, v30, s[20:23], s46 offen offset:2048
v_add_f32 v15, v15, v17
v_cvt_pk_bf16_f32 v22, v18, v19
v_add_f32 v17, v18, v19
v_mfma_f32_32x32x16_bf16 v[208:223], v[232:235], v[136:139], v[208:223]
s_add_u32 m0, s51, 77824
v_exp_f32 v20, v178
v_exp_f32 v21, v179
v_accvgpr_write_b32 a40, v22
v_add_f32 v17, v17, v20
v_mfma_f32_32x32x16_bf16 v[192:207], v[236:239], v[92:95], v[192:207]
ds_read_b128 v[228:231], v9 offset:49152
buffer_load_dwordx4 v6, s[16:19], s49 offen offset:0 lds
v_cvt_pk_bf16_f32 v23, v20, v21
v_add_f32 v17, v17, v21
v_exp_f32 v18, v180
v_mfma_f32_32x32x16_bf16 v[208:223], v[236:239], v[140:143], v[208:223]
s_waitcnt lgkmcnt(2)
v_exp_f32 v19, v181
v_accvgpr_write_b32 a41, v23
v_add_f32 v17, v17, v18
v_cvt_pk_bf16_f32 v22, v18, v19
v_add_f32 v17, v17, v19
v_mfma_f32_32x32x16_bf16 v[192:207], v[240:243], v[96:99], v[192:207]
ds_read_b128 v[232:235], v10 offset:49152
s_add_u32 m0, s51, 81792
v_exp_f32 v20, v182
v_exp_f32 v21, v183
v_accvgpr_write_b32 a42, v22
v_mfma_f32_32x32x16_bf16 v[208:223], v[240:243], v[144:147], v[208:223]
v_add_f32 v17, v17, v20
v_cvt_pk_bf16_f32 v23, v20, v21
v_add_f32 v17, v17, v21
v_exp_f32 v18, v184
v_exp_f32 v19, v185
v_mfma_f32_32x32x16_bf16 v[192:207], v[244:247], v[100:103], v[192:207]
ds_read_b128 v[236:239], v11 offset:49152
buffer_load_dwordx4 v6, s[16:19], s49 offen offset:128 lds
v_accvgpr_write_b32 a43, v23
v_add_f32 v17, v17, v18
v_cvt_pk_bf16_f32 v22, v18, v19
v_add_f32 v17, v17, v19
v_exp_f32 v20, v186
v_mfma_f32_32x32x16_bf16 v[208:223], v[244:247], v[148:151], v[208:223]
v_exp_f32 v21, v187
v_accvgpr_write_b32 a44, v22
v_add_f32 v17, v17, v20
v_cvt_pk_bf16_f32 v23, v20, v21
v_add_f32 v17, v17, v21
v_mfma_f32_32x32x16_bf16 v[192:207], v[248:251], v[104:107], v[192:207]
ds_read_b128 v[240:243], v8 offset:53248
s_add_u32 m0, s51, 85760
v_exp_f32 v18, v188
v_exp_f32 v19, v189
v_accvgpr_write_b32 a45, v23
v_mfma_f32_32x32x16_bf16 v[208:223], v[248:251], v[152:155], v[208:223]
v_add_f32 v17, v17, v18
v_cvt_pk_bf16_f32 v22, v18, v19
v_add_f32 v17, v17, v19
v_exp_f32 v20, v190
v_exp_f32 v21, v191
v_mfma_f32_32x32x16_bf16 v[192:207], v[252:255], v[108:111], v[192:207]
ds_read_b128 v[244:247], v9 offset:53248
buffer_load_dwordx4 v6, s[16:19], s49 offen offset:256 lds
s_add_u32 s49, s49, 12288
s_cmp_ge_u32 s49, 196608
s_cselect_b32 s49, 0, s49
v_accvgpr_write_b32 a46, v22
v_add_f32 v17, v17, v20
v_mfma_f32_32x32x16_bf16 v[208:223], v[252:255], v[156:159], v[208:223]
s_waitcnt lgkmcnt(2)
v_cvt_pk_bf16_f32 v23, v20, v21
v_add_f32 v17, v17, v21
v_accvgpr_write_b32 a47, v23
v_add_f32 v22, v16, v17
v_cmp_nge_f32 vcc, s54, v22
s_cbranch_vccnz STUB2
RET2:
v_mfma_f32_32x32x16_bf16 v[160:175], v[224:227], v[64:67], v[32:47]
s_add_u32 m0, s51, 16384
ds_read_b128 v[248:251], v10 offset:53248
buffer_load_dwordx4 v7, s[20:23], s50 offen lds
s_add_u32 s50, s50, 12288
v_mfma_f32_32x32x16_bf16 v[176:191], v[224:227], v[112:115], v[48:63]
s_add_u32 m0, s51, 90112
v_exp_f32 v18, v192
v_exp_f32 v19, v193
v_add_f32 v14, v14, v16
v_cvt_pk_bf16_f32 v22, v18, v19
v_mfma_f32_32x32x16_bf16 v[160:175], v[228:231], v[68:71], v[160:175]
ds_read_b128 v[252:255], v11 offset:53248
v_add_f32 v16, v18, v19
v_exp_f32 v20, v194
v_exp_f32 v21, v195
v_accvgpr_write_b32 a48, v22
v_mfma_f32_32x32x16_bf16 v[176:191], v[228:231], v[116:119], v[176:191]
v_add_f32 v16, v16, v20
v_cvt_pk_bf16_f32 v23, v20, v21
v_add_f32 v16, v16, v21
v_exp_f32 v18, v196
v_exp_f32 v19, v197
v_mfma_f32_32x32x16_bf16 v[160:175], v[232:235], v[72:75], v[160:175]
ds_read_b128 v[224:227], v8 offset:57344
buffer_load_dwordx4 v6, s[16:19], s49 offen offset:0 lds
v_accvgpr_write_b32 a49, v23
v_add_f32 v16, v16, v18
v_cvt_pk_bf16_f32 v22, v18, v19
v_add_f32 v16, v16, v19
v_mfma_f32_32x32x16_bf16 v[176:191], v[232:235], v[120:123], v[176:191]
v_exp_f32 v20, v198
v_exp_f32 v21, v199
v_accvgpr_write_b32 a50, v22
v_add_f32 v16, v16, v20
v_cvt_pk_bf16_f32 v23, v20, v21
v_mfma_f32_32x32x16_bf16 v[160:175], v[236:239], v[76:79], v[160:175]
ds_read_b128 v[228:231], v9 offset:57344
v_add_f32 v16, v16, v21
v_exp_f32 v18, v200
v_exp_f32 v19, v201
v_accvgpr_write_b32 a51, v23
v_mfma_f32_32x32x16_bf16 v[176:191], v[236:239], v[124:127], v[176:191]
s_waitcnt lgkmcnt(2)
v_add_f32 v16, v16, v18
v_cvt_pk_bf16_f32 v22, v18, v19
v_add_f32 v16, v16, v19
v_exp_f32 v20, v202
v_mfma_f32_32x32x16_bf16 v[160:175], v[240:243], v[80:83], v[160:175]
ds_read_b128 v[232:235], v10 offset:57344
s_add_u32 m0, s51, 94080
v_exp_f32 v21, v203
v_accvgpr_write_b32 a52, v22
v_add_f32 v16, v16, v20
v_cvt_pk_bf16_f32 v23, v20, v21
v_add_f32 v16, v16, v21
v_mfma_f32_32x32x16_bf16 v[176:191], v[240:243], v[128:131], v[176:191]
v_exp_f32 v18, v204
v_exp_f32 v19, v205
v_accvgpr_write_b32 a53, v23
v_add_f32 v16, v16, v18
v_cvt_pk_bf16_f32 v22, v18, v19
v_mfma_f32_32x32x16_bf16 v[160:175], v[244:247], v[84:87], v[160:175]
ds_read_b128 v[236:239], v11 offset:57344
v_add_f32 v16, v16, v19
v_exp_f32 v20, v206
v_exp_f32 v21, v207
v_mfma_f32_32x32x16_bf16 v[176:191], v[244:247], v[132:135], v[176:191]
v_accvgpr_write_b32 a54, v22
v_add_f32 v16, v16, v20
v_cvt_pk_bf16_f32 v23, v20, v21
v_add_f32 v16, v16, v21
v_accvgpr_write_b32 a55, v23
v_exp_f32 v18, v208
v_mfma_f32_32x32x16_bf16 v[160:175], v[248:251], v[88:91], v[160:175]
v_add_u32 v8, 61440, v8
ds_read_b128 v[240:243], v8 offset:0
buffer_load_dword v4, v30, s[20:23], s46 offen offset:3072
s_add_u32 s46, s46, 4096
buffer_load_dwordx4 v6, s[16:19], s49 offen offset:128 lds
v_exp_f32 v19, v209
v_mfma_f32_32x32x16_bf16 v[176:191], v[248:251], v[136:139], v[176:191]
v_add_f32 v15, v15, v17
v_cvt_pk_bf16_f32 v22, v18, v19
v_add_f32 v17, v18, v19
v_exp_f32 v20, v210
v_exp_f32 v21, v211
v_mfma_f32_32x32x16_bf16 v[160:175], v[252:255], v[92:95], v[160:175]
v_add_u32 v9, 61440, v9
ds_read_b128 v[244:247], v9 offset:0
v_accvgpr_write_b32 a56, v22
v_add_f32 v17, v17, v20
v_cvt_pk_bf16_f32 v23, v20, v21
v_add_f32 v17, v17, v21
v_mfma_f32_32x32x16_bf16 v[176:191], v[252:255], v[140:143], v[176:191]
s_waitcnt lgkmcnt(2)
v_exp_f32 v18, v212
v_exp_f32 v19, v213
v_accvgpr_write_b32 a57, v23
v_add_f32 v17, v17, v18
v_cvt_pk_bf16_f32 v22, v18, v19
v_mfma_f32_32x32x16_bf16 v[160:175], v[224:227], v[96:99], v[160:175]
v_add_u32 v10, 61440, v10
ds_read_b128 v[248:251], v10 offset:0
s_add_u32 m0, s51, 98048
v_add_f32 v17, v17, v19
v_exp_f32 v20, v214
v_mfma_f32_32x32x16_bf16 v[176:191], v[224:227], v[144:147], v[176:191]
v_exp_f32 v21, v215
v_accvgpr_write_b32 a58, v22
v_add_f32 v17, v17, v20
v_cvt_pk_bf16_f32 v23, v20, v21
v_add_f32 v17, v17, v21
v_exp_f32 v18, v216
v_mfma_f32_32x32x16_bf16 v[160:175], v[228:231], v[100:103], v[160:175]
v_add_u32 v11, 61440, v11
ds_read_b128 v[252:255], v11 offset:0
v_exp_f32 v19, v217
v_accvgpr_write_b32 a59, v23
v_add_f32 v17, v17, v18
v_mfma_f32_32x32x16_bf16 v[176:191], v[228:231], v[148:151], v[176:191]
v_cvt_pk_bf16_f32 v22, v18, v19
v_add_f32 v17, v17, v19
v_exp_f32 v20, v218
v_exp_f32 v21, v219
v_accvgpr_write_b32 a60, v22
v_mfma_f32_32x32x16_bf16 v[160:175], v[232:235], v[104:107], v[160:175]
ds_read_b128 v[224:227], v8 offset:4096
buffer_load_dwordx4 v6, s[16:19], s49 offen offset:256 lds
s_add_u32 s49, s49, 12288
v_add_f32 v17, v17, v20
v_cvt_pk_bf16_f32 v23, v20, v21
v_add_f32 v17, v17, v21
v_mfma_f32_32x32x16_bf16 v[176:191], v[232:235], v[152:155], v[176:191]
v_exp_f32 v18, v220
v_exp_f32 v19, v221
v_accvgpr_write_b32 a61, v23
v_add_f32 v17, v17, v18
v_cvt_pk_bf16_f32 v22, v18, v19
v_add_f32 v17, v17, v19
v_mfma_f32_32x32x16_bf16 v[160:175], v[236:239], v[108:111], v[160:175]
ds_read_b128 v[228:231], v9 offset:4096
v_exp_f32 v20, v222
v_exp_f32 v21, v223
v_accvgpr_write_b32 a62, v22
v_add_f32 v17, v17, v20
v_mfma_f32_32x32x16_bf16 v[176:191], v[236:239], v[156:159], v[176:191]
s_waitcnt lgkmcnt(2)
v_cvt_pk_bf16_f32 v23, v20, v21
v_add_f32 v17, v17, v21
v_accvgpr_write_b32 a63, v23
v_add_f32 v22, v16, v17
v_cmp_nge_f32 vcc, s54, v22
s_cbranch_vccnz STUB3
RET3:
v_mfma_f32_32x32x16_bf16 v[192:207], v[240:243], v[64:67], v[32:47]
s_add_u32 m0, s51, 20480
ds_read_b128 v[232:235], v10 offset:4096
buffer_load_dwordx4 v7, s[20:23], s50 offen lds
s_add_u32 s50, s50, 12288
s_cmp_ge_u32 s50, 196608
s_cselect_b32 s50, 0, s50
v_mfma_f32_32x32x16_bf16 v[208:223], v[240:243], v[112:115], v[48:63]
v_exp_f32 v18, v160
v_exp_f32 v19, v161
v_add_f32 v14, v14, v16
v_cvt_pk_bf16_f32 v22, v18, v19
v_add_f32 v16, v18, v19
v_mfma_f32_32x32x16_bf16 v[192:207], v[244:247], v[68:71], v[192:207]
ds_read_b128 v[236:239], v11 offset:4096
buffer_store_dwordx4 a[244:247], v30, s[12:15], s90 offen offset:0 sc1
v_exp_f32 v20, v162
v_exp_f32 v21, v163
v_accvgpr_write_b32 a64, v22
v_mfma_f32_32x32x16_bf16 v[208:223], v[244:247], v[116:119], v[208:223]
v_add_f32 v16, v16, v20
v_cvt_pk_bf16_f32 v23, v20, v21
v_add_f32 v16, v16, v21
v_exp_f32 v18, v164
v_exp_f32 v19, v165
v_mfma_f32_32x32x16_bf16 v[192:207], v[248:251], v[72:75], v[192:207]
ds_read_b128 v[240:243], v8 offset:8192
v_accvgpr_write_b32 a65, v23
v_add_f32 v16, v16, v18
v_cvt_pk_bf16_f32 v22, v18, v19
v_add_f32 v16, v16, v19
v_exp_f32 v20, v166
v_mfma_f32_32x32x16_bf16 v[208:223], v[248:251], v[120:123], v[208:223]
v_exp_f32 v21, v167
v_accvgpr_write_b32 a66, v22
v_add_f32 v16, v16, v20
v_cvt_pk_bf16_f32 v23, v20, v21
v_add_f32 v16, v16, v21
v_mfma_f32_32x32x16_bf16 v[192:207], v[252:255], v[76:79], v[192:207]
ds_read_b128 v[244:247], v9 offset:8192
v_exp_f32 v18, v168
v_exp_f32 v19, v169
v_accvgpr_write_b32 a67, v23
v_add_f32 v16, v16, v18
v_mfma_f32_32x32x16_bf16 v[208:223], v[252:255], v[124:127], v[208:223]
s_waitcnt lgkmcnt(2)
v_cvt_pk_bf16_f32 v22, v18, v19
v_add_f32 v16, v16, v19
v_exp_f32 v20, v170
v_exp_f32 v21, v171
v_mfma_f32_32x32x16_bf16 v[192:207], v[224:227], v[80:83], v[192:207]
ds_read_b128 v[248:251], v10 offset:8192
v_accvgpr_write_b32 a68, v22
v_add_f32 v16, v16, v20
v_cvt_pk_bf16_f32 v23, v20, v21
v_add_f32 v16, v16, v21
v_exp_f32 v18, v172
v_mfma_f32_32x32x16_bf16 v[208:223], v[224:227], v[128:131], v[208:223]
v_exp_f32 v19, v173
v_accvgpr_write_b32 a69, v23
v_add_f32 v16, v16, v18
v_cvt_pk_bf16_f32 v22, v18, v19
v_add_f32 v16, v16, v19
v_mfma_f32_32x32x16_bf16 v[192:207], v[228:231], v[84:87], v[192:207]
ds_read_b128 v[252:255], v11 offset:8192
v_exp_f32 v20, v174
v_exp_f32 v21, v175
v_accvgpr_write_b32 a70, v22
v_add_f32 v16, v16, v20
v_mfma_f32_32x32x16_bf16 v[208:223], v[228:231], v[132:135], v[208:223]
v_cvt_pk_bf16_f32 v23, v20, v21
v_add_f32 v16, v16, v21
v_accvgpr_write_b32 a71, v23
v_exp_f32 v18, v176
v_exp_f32 v19, v177
v_mfma_f32_32x32x16_bf16 v[192:207], v[232:235], v[88:91], v[192:207]
s_waitcnt vmcnt(28)
s_barrier
ds_read_b128 v[224:227], v8 offset:12288
buffer_load_dword v5, v30, s[20:23], s46 offen offset:0
v_add_f32 v15, v15, v17
v_cvt_pk_bf16_f32 v22, v18, v19
v_add_f32 v17, v18, v19
v_mfma_f32_32x32x16_bf16 v[208:223], v[232:235], v[136:139], v[208:223]
s_add_u32 m0, s51, 102400
v_exp_f32 v20, v178
v_exp_f32 v21, v179
v_accvgpr_write_b32 a72, v22
v_add_f32 v17, v17, v20
v_mfma_f32_32x32x16_bf16 v[192:207], v[236:239], v[92:95], v[192:207]
ds_read_b128 v[228:231], v9 offset:12288
buffer_load_dwordx4 v6, s[16:19], s49 offen offset:0 lds
v_cvt_pk_bf16_f32 v23, v20, v21
v_add_f32 v17, v17, v21
v_exp_f32 v18, v180
v_mfma_f32_32x32x16_bf16 v[208:223], v[236:239], v[140:143], v[208:223]
s_waitcnt lgkmcnt(2)
v_exp_f32 v19, v181
v_accvgpr_write_b32 a73, v23
v_add_f32 v17, v17, v18
v_cvt_pk_bf16_f32 v22, v18, v19
v_add_f32 v17, v17, v19
v_mfma_f32_32x32x16_bf16 v[192:207], v[240:243], v[96:99], v[192:207]
ds_read_b128 v[232:235], v10 offset:12288
s_add_u32 m0, s51, 106368
v_exp_f32 v20, v182
v_exp_f32 v21, v183
v_accvgpr_write_b32 a74, v22
v_add_f32 v17, v17, v20
v_mfma_f32_32x32x16_bf16 v[208:223], v[240:243], v[144:147], v[208:223]
v_cvt_pk_bf16_f32 v23, v20, v21
v_add_f32 v17, v17, v21
v_exp_f32 v18, v184
v_exp_f32 v19, v185
v_mfma_f32_32x32x16_bf16 v[192:207], v[244:247], v[100:103], v[192:207]
ds_read_b128 v[236:239], v11 offset:12288
buffer_load_dwordx4 v6, s[16:19], s49 offen offset:128 lds
v_accvgpr_write_b32 a75, v23
v_add_f32 v17, v17, v18
v_cvt_pk_bf16_f32 v22, v18, v19
v_add_f32 v17, v17, v19
v_exp_f32 v20, v186
v_mfma_f32_32x32x16_bf16 v[208:223], v[244:247], v[148:151], v[208:223]
v_exp_f32 v21, v187
v_accvgpr_write_b32 a76, v22
v_add_f32 v17, v17, v20
v_cvt_pk_bf16_f32 v23, v20, v21
v_add_f32 v17, v17, v21
v_mfma_f32_32x32x16_bf16 v[192:207], v[248:251], v[104:107], v[192:207]
ds_read_b128 v[240:243], v8 offset:16384
s_add_u32 m0, s51, 110336
v_exp_f32 v18, v188
v_exp_f32 v19, v189
v_accvgpr_write_b32 a77, v23
v_mfma_f32_32x32x16_bf16 v[208:223], v[248:251], v[152:155], v[208:223]
v_add_f32 v17, v17, v18
v_cvt_pk_bf16_f32 v22, v18, v19
v_add_f32 v17, v17, v19
v_exp_f32 v20, v190
v_exp_f32 v21, v191
v_mfma_f32_32x32x16_bf16 v[192:207], v[252:255], v[108:111], v[192:207]
ds_read_b128 v[244:247], v9 offset:16384
buffer_load_dwordx4 v6, s[16:19], s49 offen offset:256 lds
s_add_u32 s49, s49, 12288
s_cmp_ge_u32 s49, 196608
s_cselect_b32 s49, 0, s49
v_accvgpr_write_b32 a78, v22
v_add_f32 v17, v17, v20
v_mfma_f32_32x32x16_bf16 v[208:223], v[252:255], v[156:159], v[208:223]
s_waitcnt lgkmcnt(2)
v_cvt_pk_bf16_f32 v23, v20, v21
v_add_f32 v17, v17, v21
v_accvgpr_write_b32 a79, v23
v_add_f32 v22, v16, v17
v_cmp_nge_f32 vcc, s54, v22
s_cbranch_vccnz STUB4
RET4:
v_mfma_f32_32x32x16_bf16 v[160:175], v[224:227], v[64:67], v[32:47]
s_add_u32 m0, s51, 24576
ds_read_b128 v[248:251], v10 offset:16384
buffer_load_dwordx4 v7, s[20:23], s50 offen lds
s_add_u32 s50, s50, 12288
v_mfma_f32_32x32x16_bf16 v[176:191], v[224:227], v[112:115], v[48:63]
s_add_u32 m0, s51, 114688
v_exp_f32 v18, v192
v_exp_f32 v19, v193
v_add_f32 v14, v14, v16
v_cvt_pk_bf16_f32 v22, v18, v19
v_mfma_f32_32x32x16_bf16 v[160:175], v[228:231], v[68:71], v[160:175]
ds_read_b128 v[252:255], v11 offset:16384
buffer_store_dwordx4 a[244:247], v30, s[12:15], s90 offen offset:1024 sc1
v_add_f32 v16, v18, v19
v_exp_f32 v20, v194
v_exp_f32 v21, v195
v_mfma_f32_32x32x16_bf16 v[176:191], v[228:231], v[116:119], v[176:191]
v_accvgpr_write_b32 a80, v22
v_add_f32 v16, v16, v20
v_cvt_pk_bf16_f32 v23, v20, v21
v_add_f32 v16, v16, v21
v_exp_f32 v18, v196
v_mfma_f32_32x32x16_bf16 v[160:175], v[232:235], v[72:75], v[160:175]
ds_read_b128 v[224:227], v8 offset:20480
buffer_load_dwordx4 v6, s[16:19], s49 offen offset:0 lds
v_exp_f32 v19, v197
v_accvgpr_write_b32 a81, v23
v_add_f32 v16, v16, v18
v_cvt_pk_bf16_f32 v22, v18, v19
v_mfma_f32_32x32x16_bf16 v[176:191], v[232:235], v[120:123], v[176:191]
v_add_f32 v16, v16, v19
v_exp_f32 v20, v198
v_exp_f32 v21, v199
v_accvgpr_write_b32 a82, v22
v_mfma_f32_32x32x16_bf16 v[160:175], v[236:239], v[76:79], v[160:175]
ds_read_b128 v[228:231], v9 offset:20480
v_add_f32 v16, v16, v20
v_cvt_pk_bf16_f32 v23, v20, v21
v_add_f32 v16, v16, v21
v_exp_f32 v18, v200
v_exp_f32 v19, v201
v_mfma_f32_32x32x16_bf16 v[176:191], v[236:239], v[124:127], v[176:191]
s_waitcnt lgkmcnt(2)
v_accvgpr_write_b32 a83, v23
v_add_f32 v16, v16, v18
v_cvt_pk_bf16_f32 v22, v18, v19
v_add_f32 v16, v16, v19
v_mfma_f32_32x32x16_bf16 v[160:175], v[240:243], v[80:83], v[160:175]
ds_read_b128 v[232:235], v10 offset:20480
s_add_u32 m0, s51, 118656
v_exp_f32 v20, v202
v_exp_f32 v21, v203
v_accvgpr_write_b32 a84, v22
v_add_f32 v16, v16, v20
v_mfma_f32_32x32x16_bf16 v[176:191], v[240:243], v[128:131], v[176:191]
v_cvt_pk_bf16_f32 v23, v20, v21
v_add_f32 v16, v16, v21
v_exp_f32 v18, v204
v_exp_f32 v19, v205
v_mfma_f32_32x32x16_bf16 v[160:175], v[244:247], v[84:87], v[160:175]
ds_read_b128 v[236:239], v11 offset:20480
v_accvgpr_write_b32 a85, v23
v_add_f32 v16, v16, v18
v_cvt_pk_bf16_f32 v22, v18, v19
v_add_f32 v16, v16, v19
v_exp_f32 v20, v206
v_mfma_f32_32x32x16_bf16 v[176:191], v[244:247], v[132:135], v[176:191]
v_exp_f32 v21, v207
v_accvgpr_write_b32 a86, v22
v_add_f32 v16, v16, v20
v_cvt_pk_bf16_f32 v23, v20, v21
v_add_f32 v16, v16, v21
v_accvgpr_write_b32 a87, v23
v_mfma_f32_32x32x16_bf16 v[160:175], v[248:251], v[88:91], v[160:175]
ds_read_b128 v[240:243], v8 offset:24576
s_waitcnt vmcnt(26)
buffer_load_dword v1, v30, s[20:23], s46 offen offset:1024
buffer_load_dwordx4 v6, s[16:19], s49 offen offset:128 lds
v_exp_f32 v18, v208
v_exp_f32 v19, v209
v_mfma_f32_32x32x16_bf16 v[176:191], v[248:251], v[136:139], v[176:191]
v_add_f32 v15, v15, v17
v_cvt_pk_bf16_f32 v22, v18, v19
v_add_f32 v17, v18, v19
v_exp_f32 v20, v210
v_exp_f32 v21, v211
v_mfma_f32_32x32x16_bf16 v[160:175], v[252:255], v[92:95], v[160:175]
ds_read_b128 v[244:247], v9 offset:24576
v_accvgpr_write_b32 a88, v22
v_add_f32 v17, v17, v20
v_cvt_pk_bf16_f32 v23, v20, v21
v_add_f32 v17, v17, v21
v_mfma_f32_32x32x16_bf16 v[176:191], v[252:255], v[140:143], v[176:191]
s_waitcnt lgkmcnt(2)
v_exp_f32 v18, v212
v_exp_f32 v19, v213
v_accvgpr_write_b32 a89, v23
v_add_f32 v17, v17, v18
v_mfma_f32_32x32x16_bf16 v[160:175], v[224:227], v[96:99], v[160:175]
ds_read_b128 v[248:251], v10 offset:24576
s_add_u32 m0, s51, 122624
v_cvt_pk_bf16_f32 v22, v18, v19
v_add_f32 v17, v17, v19
v_exp_f32 v20, v214
v_exp_f32 v21, v215
v_mfma_f32_32x32x16_bf16 v[176:191], v[224:227], v[144:147], v[176:191]
v_accvgpr_write_b32 a90, v22
v_add_f32 v17, v17, v20
v_cvt_pk_bf16_f32 v23, v20, v21
v_add_f32 v17, v17, v21
v_exp_f32 v18, v216
v_mfma_f32_32x32x16_bf16 v[160:175], v[228:231], v[100:103], v[160:175]
ds_read_b128 v[252:255], v11 offset:24576
v_exp_f32 v19, v217
v_accvgpr_write_b32 a91, v23
v_add_f32 v17, v17, v18
v_cvt_pk_bf16_f32 v22, v18, v19
v_add_f32 v17, v17, v19
v_mfma_f32_32x32x16_bf16 v[176:191], v[228:231], v[148:151], v[176:191]
v_exp_f32 v20, v218
v_exp_f32 v21, v219
v_accvgpr_write_b32 a92, v22
v_add_f32 v17, v17, v20
v_mfma_f32_32x32x16_bf16 v[160:175], v[232:235], v[104:107], v[160:175]
ds_read_b128 v[224:227], v8 offset:28672
buffer_load_dwordx4 v6, s[16:19], s49 offen offset:256 lds
s_add_u32 s49, s49, 12288
v_cvt_pk_bf16_f32 v23, v20, v21
v_add_f32 v17, v17, v21
v_exp_f32 v18, v220
v_mfma_f32_32x32x16_bf16 v[176:191], v[232:235], v[152:155], v[176:191]
v_exp_f32 v19, v221
v_accvgpr_write_b32 a93, v23
v_add_f32 v17, v17, v18
v_cvt_pk_bf16_f32 v22, v18, v19
v_add_f32 v17, v17, v19
v_mfma_f32_32x32x16_bf16 v[160:175], v[236:239], v[108:111], v[160:175]
ds_read_b128 v[228:231], v9 offset:28672
v_exp_f32 v20, v222
v_exp_f32 v21, v223
v_accvgpr_write_b32 a94, v22
v_add_f32 v17, v17, v20
v_mfma_f32_32x32x16_bf16 v[176:191], v[236:239], v[156:159], v[176:191]
s_waitcnt lgkmcnt(2)
v_cvt_pk_bf16_f32 v23, v20, v21
v_add_f32 v17, v17, v21
v_accvgpr_write_b32 a95, v23
v_add_f32 v22, v16, v17
v_cmp_nge_f32 vcc, s54, v22
s_cbranch_vccnz STUB5
RET5:
v_mfma_f32_32x32x16_bf16 v[192:207], v[240:243], v[64:67], v[32:47]
s_add_u32 m0, s51, 28672
ds_read_b128 v[232:235], v10 offset:28672
buffer_load_dwordx4 v7, s[20:23], s50 offen lds
s_add_u32 s50, s50, 12288
s_cmp_ge_u32 s50, 196608
s_cselect_b32 s50, 0, s50
v_mfma_f32_32x32x16_bf16 v[208:223], v[240:243], v[112:115], v[48:63]
v_exp_f32 v18, v160
v_exp_f32 v19, v161
v_add_f32 v14, v14, v16
v_cvt_pk_bf16_f32 v22, v18, v19
v_add_f32 v16, v18, v19
v_mfma_f32_32x32x16_bf16 v[192:207], v[244:247], v[68:71], v[192:207]
ds_read_b128 v[236:239], v11 offset:28672
s_lshr_b32 s63, s2, 3
buffer_store_dwordx4 a[244:247], v30, s[12:15], s90 offen offset:2048 sc1
v_exp_f32 v20, v162
v_exp_f32 v21, v163
v_accvgpr_write_b32 a96, v22
v_mfma_f32_32x32x16_bf16 v[208:223], v[244:247], v[116:119], v[208:223]
s_lshl_b32 s63, s63, 2
v_add_f32 v16, v16, v20
v_cvt_pk_bf16_f32 v23, v20, v21
v_add_f32 v16, v16, v21
v_exp_f32 v18, v164
v_exp_f32 v19, v165
v_mfma_f32_32x32x16_bf16 v[192:207], v[248:251], v[72:75], v[192:207]
ds_read_b128 v[240:243], v8 offset:32768
s_add_u32 s63, s63, s3
v_accvgpr_write_b32 a97, v23
v_add_f32 v16, v16, v18
v_cvt_pk_bf16_f32 v22, v18, v19
v_add_f32 v16, v16, v19
v_mfma_f32_32x32x16_bf16 v[208:223], v[248:251], v[120:123], v[208:223]
s_mul_i32 s45, s63, 3840
v_exp_f32 v20, v166
v_exp_f32 v21, v167
v_accvgpr_write_b32 a98, v22
v_add_f32 v16, v16, v20
v_cvt_pk_bf16_f32 v23, v20, v21
v_mfma_f32_32x32x16_bf16 v[192:207], v[252:255], v[76:79], v[192:207]
ds_read_b128 v[244:247], v9 offset:32768
v_add_f32 v16, v16, v21
v_exp_f32 v18, v168
v_exp_f32 v19, v169
v_accvgpr_write_b32 a99, v23
v_mfma_f32_32x32x16_bf16 v[208:223], v[252:255], v[124:127], v[208:223]
s_waitcnt lgkmcnt(2)
s_mul_i32 s48, s63, 7680
v_add_f32 v16, v16, v18
v_cvt_pk_bf16_f32 v22, v18, v19
v_add_f32 v16, v16, v19
v_exp_f32 v20, v170
v_mfma_f32_32x32x16_bf16 v[192:207], v[224:227], v[80:83], v[192:207]
ds_read_b128 v[248:251], v10 offset:32768
s_lshr_b32 s93, s4, 1
v_exp_f32 v21, v171
v_accvgpr_write_b32 a100, v22
v_add_f32 v16, v16, v20
v_cvt_pk_bf16_f32 v23, v20, v21
v_add_f32 v16, v16, v21
v_mfma_f32_32x32x16_bf16 v[208:223], v[224:227], v[128:131], v[208:223]
s_mul_i32 s93, s93, 491520
v_exp_f32 v18, v172
v_exp_f32 v19, v173
v_accvgpr_write_b32 a101, v23
v_add_f32 v16, v16, v18
v_mfma_f32_32x32x16_bf16 v[192:207], v[228:231], v[84:87], v[192:207]
ds_read_b128 v[252:255], v11 offset:32768
s_add_u32 s45, s45, s93
v_cvt_pk_bf16_f32 v22, v18, v19
v_add_f32 v16, v16, v19
v_exp_f32 v20, v174
v_exp_f32 v21, v175
v_mfma_f32_32x32x16_bf16 v[208:223], v[228:231], v[132:135], v[208:223]
v_accvgpr_write_b32 a102, v22
v_add_f32 v16, v16, v20
v_cvt_pk_bf16_f32 v23, v20, v21
v_add_f32 v16, v16, v21
v_accvgpr_write_b32 a103, v23
v_exp_f32 v18, v176
v_mfma_f32_32x32x16_bf16 v[192:207], v[232:235], v[88:91], v[192:207]
s_waitcnt vmcnt(19)
s_barrier
v_subrev_u32 v8, 61440, v8
ds_read_b128 v[224:227], v8 offset:0
buffer_load_dword v2, v30, s[28:31], s45 offen offset:0
v_exp_f32 v19, v177
v_mfma_f32_32x32x16_bf16 v[208:223], v[232:235], v[136:139], v[208:223]
s_add_u32 m0, s51, 126976
v_add_f32 v15, v15, v17
v_cvt_pk_bf16_f32 v22, v18, v19
v_add_f32 v17, v18, v19
v_exp_f32 v20, v178
v_exp_f32 v21, v179
v_mfma_f32_32x32x16_bf16 v[192:207], v[236:239], v[92:95], v[192:207]
v_subrev_u32 v9, 61440, v9
ds_read_b128 v[228:231], v9 offset:0
buffer_load_dwordx4 v6, s[16:19], s49 offen offset:0 lds
v_accvgpr_write_b32 a104, v22
v_add_f32 v17, v17, v20
v_cvt_pk_bf16_f32 v23, v20, v21
v_add_f32 v17, v17, v21
v_mfma_f32_32x32x16_bf16 v[208:223], v[236:239], v[140:143], v[208:223]
s_waitcnt lgkmcnt(2)
v_exp_f32 v18, v180
v_exp_f32 v19, v181
v_accvgpr_write_b32 a105, v23
v_add_f32 v17, v17, v18
v_mfma_f32_32x32x16_bf16 v[192:207], v[240:243], v[96:99], v[192:207]
v_subrev_u32 v10, 61440, v10
ds_read_b128 v[232:235], v10 offset:0
s_add_u32 m0, s51, 130944
v_cvt_pk_bf16_f32 v22, v18, v19
v_add_f32 v17, v17, v19
v_exp_f32 v20, v182
v_mfma_f32_32x32x16_bf16 v[208:223], v[240:243], v[144:147], v[208:223]
v_exp_f32 v21, v183
v_accvgpr_write_b32 a106, v22
v_add_f32 v17, v17, v20
v_cvt_pk_bf16_f32 v23, v20, v21
v_add_f32 v17, v17, v21
v_exp_f32 v18, v184
v_mfma_f32_32x32x16_bf16 v[192:207], v[244:247], v[100:103], v[192:207]
v_subrev_u32 v11, 61440, v11
ds_read_b128 v[236:239], v11 offset:0
buffer_load_dwordx4 v6, s[16:19], s49 offen offset:128 lds
v_exp_f32 v19, v185
v_accvgpr_write_b32 a107, v23
v_add_f32 v17, v17, v18
v_mfma_f32_32x32x16_bf16 v[208:223], v[244:247], v[148:151], v[208:223]
v_cvt_pk_bf16_f32 v22, v18, v19
v_add_f32 v17, v17, v19
v_exp_f32 v20, v186
v_exp_f32 v21, v187
v_accvgpr_write_b32 a108, v22
v_add_f32 v17, v17, v20
v_mfma_f32_32x32x16_bf16 v[192:207], v[248:251], v[104:107], v[192:207]
ds_read_b128 v[240:243], v8 offset:4096
s_add_u32 m0, s51, 134912
v_cvt_pk_bf16_f32 v23, v20, v21
v_add_f32 v17, v17, v21
v_exp_f32 v18, v188
v_mfma_f32_32x32x16_bf16 v[208:223], v[248:251], v[152:155], v[208:223]
v_exp_f32 v19, v189
v_accvgpr_write_b32 a109, v23
v_add_f32 v17, v17, v18
v_cvt_pk_bf16_f32 v22, v18, v19
v_add_f32 v17, v17, v19
v_exp_f32 v20, v190
v_mfma_f32_32x32x16_bf16 v[192:207], v[252:255], v[108:111], v[192:207]
ds_read_b128 v[244:247], v9 offset:4096
buffer_load_dwordx4 v6, s[16:19], s49 offen offset:256 lds
s_add_u32 s49, s49, 12288
s_cmp_ge_u32 s49, 196608
s_cselect_b32 s49, 0, s49
v_exp_f32 v21, v191
v_accvgpr_write_b32 a110, v22
v_mfma_f32_32x32x16_bf16 v[208:223], v[252:255], v[156:159], v[208:223]
s_waitcnt lgkmcnt(2)
v_add_f32 v17, v17, v20
v_cvt_pk_bf16_f32 v23, v20, v21
v_add_f32 v17, v17, v21
v_accvgpr_write_b32 a111, v23
v_add_f32 v22, v16, v17
v_cmp_nge_f32 vcc, s54, v22
s_cbranch_vccnz STUB6
RET6:
v_mfma_f32_32x32x16_bf16 v[160:175], v[224:227], v[64:67], v[32:47]
s_add_u32 m0, s51, 32768
ds_read_b128 v[248:251], v10 offset:4096
buffer_load_dwordx4 v7, s[20:23], s50 offen lds
s_add_u32 s50, s50, 12288
v_mfma_f32_32x32x16_bf16 v[176:191], v[224:227], v[112:115], v[48:63]
s_add_u32 m0, s51, 139264
v_exp_f32 v18, v192
v_exp_f32 v19, v193
v_add_f32 v14, v14, v16
v_cvt_pk_bf16_f32 v22, v18, v19
v_mfma_f32_32x32x16_bf16 v[160:175], v[228:231], v[68:71], v[160:175]
ds_read_b128 v[252:255], v11 offset:4096
v_add_f32 v16, v18, v19
v_exp_f32 v20, v194
v_exp_f32 v21, v195
v_mfma_f32_32x32x16_bf16 v[176:191], v[228:231], v[116:119], v[176:191]
v_accvgpr_write_b32 a112, v22
v_add_f32 v16, v16, v20
v_cvt_pk_bf16_f32 v23, v20, v21
v_add_f32 v16, v16, v21
v_exp_f32 v18, v196
v_mfma_f32_32x32x16_bf16 v[160:175], v[232:235], v[72:75], v[160:175]
ds_read_b128 v[224:227], v8 offset:8192
buffer_load_dwordx4 v6, s[16:19], s49 offen offset:0 lds
v_exp_f32 v19, v197
v_accvgpr_write_b32 a113, v23
v_add_f32 v16, v16, v18
v_cvt_pk_bf16_f32 v22, v18, v19
v_add_f32 v16, v16, v19
v_mfma_f32_32x32x16_bf16 v[176:191], v[232:235], v[120:123], v[176:191]
v_exp_f32 v20, v198
v_exp_f32 v21, v199
v_accvgpr_write_b32 a114, v22
v_add_f32 v16, v16, v20
v_mfma_f32_32x32x16_bf16 v[160:175], v[236:239], v[76:79], v[160:175]
ds_read_b128 v[228:231], v9 offset:8192
v_cvt_pk_bf16_f32 v23, v20, v21
v_add_f32 v16, v16, v21
v_exp_f32 v18, v200
v_exp_f32 v19, v201
v_mfma_f32_32x32x16_bf16 v[176:191], v[236:239], v[124:127], v[176:191]
s_waitcnt lgkmcnt(2)
v_accvgpr_write_b32 a115, v23
v_add_f32 v16, v16, v18
v_cvt_pk_bf16_f32 v22, v18, v19
v_add_f32 v16, v16, v19
v_exp_f32 v20, v202
v_mfma_f32_32x32x16_bf16 v[160:175], v[240:243], v[80:83], v[160:175]
ds_read_b128 v[232:235], v10 offset:8192
s_add_u32 m0, s51, 143232
v_exp_f32 v21, v203
v_accvgpr_write_b32 a116, v22
v_add_f32 v16, v16, v20
v_mfma_f32_32x32x16_bf16 v[176:191], v[240:243], v[128:131], v[176:191]
v_cvt_pk_bf16_f32 v23, v20, v21
v_add_f32 v16, v16, v21
v_exp_f32 v18, v204
v_exp_f32 v19, v205
v_accvgpr_write_b32 a117, v23
v_mfma_f32_32x32x16_bf16 v[160:175], v[244:247], v[84:87], v[160:175]
ds_read_b128 v[236:239], v11 offset:8192
v_add_f32 v16, v16, v18
v_cvt_pk_bf16_f32 v22, v18, v19
v_add_f32 v16, v16, v19
v_exp_f32 v20, v206
v_mfma_f32_32x32x16_bf16 v[176:191], v[244:247], v[132:135], v[176:191]
v_exp_f32 v21, v207
v_accvgpr_write_b32 a118, v22
v_add_f32 v16, v16, v20
v_cvt_pk_bf16_f32 v23, v20, v21
v_add_f32 v16, v16, v21
v_accvgpr_write_b32 a119, v23
v_mfma_f32_32x32x16_bf16 v[160:175], v[248:251], v[88:91], v[160:175]
ds_read_b128 v[240:243], v8 offset:12288
buffer_load_dword v3, v30, s[28:31], s45 offen offset:1024
buffer_load_dwordx4 v6, s[16:19], s49 offen offset:128 lds
v_exp_f32 v18, v208
v_exp_f32 v19, v209
v_mfma_f32_32x32x16_bf16 v[176:191], v[248:251], v[136:139], v[176:191]
v_add_f32 v15, v15, v17
v_cvt_pk_bf16_f32 v22, v18, v19
v_add_f32 v17, v18, v19
v_exp_f32 v20, v210
v_exp_f32 v21, v211
v_mfma_f32_32x32x16_bf16 v[160:175], v[252:255], v[92:95], v[160:175]
ds_read_b128 v[244:247], v9 offset:12288
v_accvgpr_write_b32 a120, v22
v_add_f32 v17, v17, v20
v_cvt_pk_bf16_f32 v23, v20, v21
v_add_f32 v17, v17, v21
v_exp_f32 v18, v212
v_mfma_f32_32x32x16_bf16 v[176:191], v[252:255], v[140:143], v[176:191]
s_waitcnt lgkmcnt(2)
v_exp_f32 v19, v213
v_accvgpr_write_b32 a121, v23
v_add_f32 v17, v17, v18
v_cvt_pk_bf16_f32 v22, v18, v19
v_mfma_f32_32x32x16_bf16 v[160:175], v[224:227], v[96:99], v[160:175]
ds_read_b128 v[248:251], v10 offset:12288
s_add_u32 m0, s51, 147200
v_add_f32 v17, v17, v19
v_exp_f32 v20, v214
v_exp_f32 v21, v215
v_mfma_f32_32x32x16_bf16 v[176:191], v[224:227], v[144:147], v[176:191]
v_accvgpr_write_b32 a122, v22
v_add_f32 v17, v17, v20
v_cvt_pk_bf16_f32 v23, v20, v21
v_add_f32 v17, v17, v21
v_exp_f32 v18, v216
v_mfma_f32_32x32x16_bf16 v[160:175], v[228:231], v[100:103], v[160:175]
ds_read_b128 v[252:255], v11 offset:12288
v_exp_f32 v19, v217
v_accvgpr_write_b32 a123, v23
v_add_f32 v17, v17, v18
v_cvt_pk_bf16_f32 v22, v18, v19
v_add_f32 v17, v17, v19
v_mfma_f32_32x32x16_bf16 v[176:191], v[228:231], v[148:151], v[176:191]
v_exp_f32 v20, v218
v_exp_f32 v21, v219
v_accvgpr_write_b32 a124, v22
v_add_f32 v17, v17, v20
v_mfma_f32_32x32x16_bf16 v[160:175], v[232:235], v[104:107], v[160:175]
ds_read_b128 v[224:227], v8 offset:16384
buffer_load_dwordx4 v6, s[16:19], s49 offen offset:256 lds
s_add_u32 s49, s49, 12288
v_cvt_pk_bf16_f32 v23, v20, v21
v_add_f32 v17, v17, v21
v_exp_f32 v18, v220
v_mfma_f32_32x32x16_bf16 v[176:191], v[232:235], v[152:155], v[176:191]
v_exp_f32 v19, v221
v_accvgpr_write_b32 a125, v23
v_add_f32 v17, v17, v18
v_cvt_pk_bf16_f32 v22, v18, v19
v_add_f32 v17, v17, v19
v_mfma_f32_32x32x16_bf16 v[160:175], v[236:239], v[108:111], v[160:175]
ds_read_b128 v[228:231], v9 offset:16384
v_exp_f32 v20, v222
v_exp_f32 v21, v223
v_accvgpr_write_b32 a126, v22
v_add_f32 v17, v17, v20
v_mfma_f32_32x32x16_bf16 v[176:191], v[236:239], v[156:159], v[176:191]
s_waitcnt lgkmcnt(2)
v_cvt_pk_bf16_f32 v23, v20, v21
v_add_f32 v17, v17, v21
v_accvgpr_write_b32 a127, v23
v_add_f32 v22, v16, v17
v_cmp_nge_f32 vcc, s54, v22
s_cbranch_vccnz STUB7
RET7:
v_mfma_f32_32x32x16_bf16 v[192:207], v[240:243], v[64:67], v[32:47]
s_add_u32 m0, s51, 36864
ds_read_b128 v[232:235], v10 offset:16384
buffer_load_dwordx4 v7, s[20:23], s50 offen lds
s_add_u32 s50, s50, 12288
s_cmp_ge_u32 s50, 196608
s_cselect_b32 s50, 0, s50
v_mfma_f32_32x32x16_bf16 v[208:223], v[240:243], v[112:115], v[48:63]
v_exp_f32 v18, v160
v_exp_f32 v19, v161
v_add_f32 v14, v14, v16
v_cvt_pk_bf16_f32 v22, v18, v19
v_add_f32 v16, v18, v19
v_mfma_f32_32x32x16_bf16 v[192:207], v[244:247], v[68:71], v[192:207]
ds_read_b128 v[236:239], v11 offset:16384
buffer_store_dwordx4 a[244:247], v30, s[12:15], s90 offen offset:3072 sc1
s_add_u32 s90, s90, 4096
v_exp_f32 v20, v162
v_exp_f32 v21, v163
v_mfma_f32_32x32x16_bf16 v[208:223], v[244:247], v[116:119], v[208:223]
v_accvgpr_write_b32 a128, v22
v_add_f32 v16, v16, v20
v_cvt_pk_bf16_f32 v23, v20, v21
v_add_f32 v16, v16, v21
v_exp_f32 v18, v164
v_mfma_f32_32x32x16_bf16 v[192:207], v[248:251], v[72:75], v[192:207]
ds_read_b128 v[240:243], v8 offset:20480
v_exp_f32 v19, v165
v_accvgpr_write_b32 a129, v23
v_add_f32 v16, v16, v18
v_cvt_pk_bf16_f32 v22, v18, v19
v_add_f32 v16, v16, v19
v_mfma_f32_32x32x16_bf16 v[208:223], v[248:251], v[120:123], v[208:223]
v_exp_f32 v20, v166
v_exp_f32 v21, v167
v_accvgpr_write_b32 a130, v22
v_add_f32 v16, v16, v20
v_cvt_pk_bf16_f32 v23, v20, v21
v_mfma_f32_32x32x16_bf16 v[192:207], v[252:255], v[76:79], v[192:207]
ds_read_b128 v[244:247], v9 offset:20480
v_add_f32 v16, v16, v21
v_exp_f32 v18, v168
v_exp_f32 v19, v169
v_accvgpr_write_b32 a131, v23
v_mfma_f32_32x32x16_bf16 v[208:223], v[252:255], v[124:127], v[208:223]
s_waitcnt lgkmcnt(2)
v_add_f32 v16, v16, v18
v_cvt_pk_bf16_f32 v22, v18, v19
v_add_f32 v16, v16, v19
v_exp_f32 v20, v170
v_exp_f32 v21, v171
v_mfma_f32_32x32x16_bf16 v[192:207], v[224:227], v[80:83], v[192:207]
ds_read_b128 v[248:251], v10 offset:20480
v_accvgpr_write_b32 a132, v22
v_add_f32 v16, v16, v20
v_cvt_pk_bf16_f32 v23, v20, v21
v_add_f32 v16, v16, v21
v_exp_f32 v18, v172
v_mfma_f32_32x32x16_bf16 v[208:223], v[224:227], v[128:131], v[208:223]
v_exp_f32 v19, v173
v_accvgpr_write_b32 a133, v23
v_add_f32 v16, v16, v18
v_cvt_pk_bf16_f32 v22, v18, v19
v_add_f32 v16, v16, v19
v_mfma_f32_32x32x16_bf16 v[192:207], v[228:231], v[84:87], v[192:207]
ds_read_b128 v[252:255], v11 offset:20480
v_exp_f32 v20, v174
v_exp_f32 v21, v175
v_accvgpr_write_b32 a134, v22
v_add_f32 v16, v16, v20
v_mfma_f32_32x32x16_bf16 v[208:223], v[228:231], v[132:135], v[208:223]
v_cvt_pk_bf16_f32 v23, v20, v21
v_add_f32 v16, v16, v21
v_accvgpr_write_b32 a135, v23
v_exp_f32 v18, v176
v_exp_f32 v19, v177
v_mfma_f32_32x32x16_bf16 v[192:207], v[232:235], v[88:91], v[192:207]
s_waitcnt vmcnt(19)
s_barrier
ds_read_b128 v[224:227], v8 offset:24576
buffer_load_dword v4, v30, s[28:31], s45 offen offset:2048
v_add_f32 v15, v15, v17
v_cvt_pk_bf16_f32 v22, v18, v19
v_add_f32 v17, v18, v19
v_mfma_f32_32x32x16_bf16 v[208:223], v[232:235], v[136:139], v[208:223]
s_add_u32 m0, s51, 151552
v_exp_f32 v20, v178
v_exp_f32 v21, v179
v_accvgpr_write_b32 a136, v22
v_add_f32 v17, v17, v20
v_mfma_f32_32x32x16_bf16 v[192:207], v[236:239], v[92:95], v[192:207]
ds_read_b128 v[228:231], v9 offset:24576
buffer_load_dwordx4 v6, s[16:19], s49 offen offset:0 lds
v_cvt_pk_bf16_f32 v23, v20, v21
v_add_f32 v17, v17, v21
v_exp_f32 v18, v180
v_mfma_f32_32x32x16_bf16 v[208:223], v[236:239], v[140:143], v[208:223]
s_waitcnt lgkmcnt(2)
v_exp_f32 v19, v181
v_accvgpr_write_b32 a137, v23
v_add_f32 v17, v17, v18
v_cvt_pk_bf16_f32 v22, v18, v19
v_add_f32 v17, v17, v19
v_mfma_f32_32x32x16_bf16 v[192:207], v[240:243], v[96:99], v[192:207]
ds_read_b128 v[232:235], v10 offset:24576
s_add_u32 m0, s51, 155520
v_exp_f32 v20, v182
v_exp_f32 v21, v183
v_accvgpr_write_b32 a138, v22
v_mfma_f32_32x32x16_bf16 v[208:223], v[240:243], v[144:147], v[208:223]
v_add_f32 v17, v17, v20
v_cvt_pk_bf16_f32 v23, v20, v21
v_add_f32 v17, v17, v21
v_exp_f32 v18, v184
v_exp_f32 v19, v185
v_mfma_f32_32x32x16_bf16 v[192:207], v[244:247], v[100:103], v[192:207]
ds_read_b128 v[236:239], v11 offset:24576
buffer_load_dwordx4 v6, s[16:19], s49 offen offset:128 lds
v_accvgpr_write_b32 a139, v23
v_add_f32 v17, v17, v18
v_cvt_pk_bf16_f32 v22, v18, v19
v_add_f32 v17, v17, v19
v_exp_f32 v20, v186
v_mfma_f32_32x32x16_bf16 v[208:223], v[244:247], v[148:151], v[208:223]
v_exp_f32 v21, v187
v_accvgpr_write_b32 a140, v22
v_add_f32 v17, v17, v20
v_cvt_pk_bf16_f32 v23, v20, v21
v_add_f32 v17, v17, v21
v_mfma_f32_32x32x16_bf16 v[192:207], v[248:251], v[104:107], v[192:207]
ds_read_b128 v[240:243], v8 offset:28672
s_add_u32 m0, s51, 159488
v_exp_f32 v18, v188
v_exp_f32 v19, v189
v_accvgpr_write_b32 a141, v23
v_mfma_f32_32x32x16_bf16 v[208:223], v[248:251], v[152:155], v[208:223]
v_add_f32 v17, v17, v18
v_cvt_pk_bf16_f32 v22, v18, v19
v_add_f32 v17, v17, v19
v_exp_f32 v20, v190
v_exp_f32 v21, v191
v_mfma_f32_32x32x16_bf16 v[192:207], v[252:255], v[108:111], v[192:207]
ds_read_b128 v[244:247], v9 offset:28672
buffer_load_dwordx4 v6, s[16:19], s49 offen offset:256 lds
s_add_u32 s49, s49, 12288
s_cmp_ge_u32 s49, 196608
s_cselect_b32 s49, 0, s49
v_accvgpr_write_b32 a142, v22
v_add_f32 v17, v17, v20
v_mfma_f32_32x32x16_bf16 v[208:223], v[252:255], v[156:159], v[208:223]
s_waitcnt lgkmcnt(2)
v_cvt_pk_bf16_f32 v23, v20, v21
v_add_f32 v17, v17, v21
v_accvgpr_write_b32 a143, v23
v_add_f32 v22, v16, v17
v_cmp_nge_f32 vcc, s54, v22
s_cbranch_vccnz STUB8
RET8:
v_mfma_f32_32x32x16_bf16 v[160:175], v[224:227], v[64:67], v[32:47]
s_add_u32 m0, s51, 40960
ds_read_b128 v[248:251], v10 offset:28672
buffer_load_dwordx4 v7, s[20:23], s50 offen lds
s_add_u32 s50, s50, 12288
v_mfma_f32_32x32x16_bf16 v[176:191], v[224:227], v[112:115], v[48:63]
v_exp_f32 v18, v192
v_exp_f32 v19, v193
v_add_f32 v14, v14, v16
v_cvt_pk_bf16_f32 v22, v18, v19
v_mfma_f32_32x32x16_bf16 v[160:175], v[228:231], v[68:71], v[160:175]
ds_read_b128 v[252:255], v11 offset:28672
buffer_store_dwordx4 a[244:247], v30, s[12:15], s90 offen offset:0 sc1
v_add_f32 v16, v18, v19
v_exp_f32 v20, v194
v_exp_f32 v21, v195
v_mfma_f32_32x32x16_bf16 v[176:191], v[228:231], v[116:119], v[176:191]
v_accvgpr_write_b32 a144, v22
v_add_f32 v16, v16, v20
v_cvt_pk_bf16_f32 v23, v20, v21
v_add_f32 v16, v16, v21
v_exp_f32 v18, v196
v_mfma_f32_32x32x16_bf16 v[160:175], v[232:235], v[72:75], v[160:175]
ds_read_b128 v[224:227], v8 offset:32768
v_exp_f32 v19, v197
v_accvgpr_write_b32 a145, v23
v_add_f32 v16, v16, v18
v_cvt_pk_bf16_f32 v22, v18, v19
v_add_f32 v16, v16, v19
v_mfma_f32_32x32x16_bf16 v[176:191], v[232:235], v[120:123], v[176:191]
v_exp_f32 v20, v198
v_exp_f32 v21, v199
v_accvgpr_write_b32 a146, v22
v_add_f32 v16, v16, v20
v_mfma_f32_32x32x16_bf16 v[160:175], v[236:239], v[76:79], v[160:175]
ds_read_b128 v[228:231], v9 offset:32768
v_cvt_pk_bf16_f32 v23, v20, v21
v_add_f32 v16, v16, v21
v_exp_f32 v18, v200
v_exp_f32 v19, v201
v_mfma_f32_32x32x16_bf16 v[176:191], v[236:239], v[124:127], v[176:191]
s_waitcnt lgkmcnt(2)
v_accvgpr_write_b32 a147, v23
v_add_f32 v16, v16, v18
v_cvt_pk_bf16_f32 v22, v18, v19
v_add_f32 v16, v16, v19
v_mfma_f32_32x32x16_bf16 v[160:175], v[240:243], v[80:83], v[160:175]
ds_read_b128 v[232:235], v10 offset:32768
v_exp_f32 v20, v202
v_exp_f32 v21, v203
v_accvgpr_write_b32 a148, v22
v_add_f32 v16, v16, v20
v_mfma_f32_32x32x16_bf16 v[176:191], v[240:243], v[128:131], v[176:191]
v_cvt_pk_bf16_f32 v23, v20, v21
v_add_f32 v16, v16, v21
v_exp_f32 v18, v204
v_exp_f32 v19, v205
v_accvgpr_write_b32 a149, v23
v_mfma_f32_32x32x16_bf16 v[160:175], v[244:247], v[84:87], v[160:175]
ds_read_b128 v[236:239], v11 offset:32768
v_add_f32 v16, v16, v18
v_cvt_pk_bf16_f32 v22, v18, v19
v_add_f32 v16, v16, v19
v_exp_f32 v20, v206
v_mfma_f32_32x32x16_bf16 v[176:191], v[244:247], v[132:135], v[176:191]
v_exp_f32 v21, v207
v_accvgpr_write_b32 a150, v22
v_add_f32 v16, v16, v20
v_cvt_pk_bf16_f32 v23, v20, v21
v_add_f32 v16, v16, v21
v_mfma_f32_32x32x16_bf16 v[160:175], v[248:251], v[88:91], v[160:175]
ds_read_b128 v[240:243], v8 offset:36864
buffer_load_dword v5, v30, s[28:31], s45 offen offset:3072
s_add_u32 s45, s45, 4096
v_accvgpr_write_b32 a151, v23
v_exp_f32 v18, v208
v_mfma_f32_32x32x16_bf16 v[176:191], v[248:251], v[136:139], v[176:191]
v_exp_f32 v19, v209
v_add_f32 v15, v15, v17
v_cvt_pk_bf16_f32 v22, v18, v19
v_add_f32 v17, v18, v19
v_exp_f32 v20, v210
v_mfma_f32_32x32x16_bf16 v[160:175], v[252:255], v[92:95], v[160:175]
ds_read_b128 v[244:247], v9 offset:36864
v_exp_f32 v21, v211
v_accvgpr_write_b32 a152, v22
v_add_f32 v17, v17, v20
v_cvt_pk_bf16_f32 v23, v20, v21
v_add_f32 v17, v17, v21
v_mfma_f32_32x32x16_bf16 v[176:191], v[252:255], v[140:143], v[176:191]
s_waitcnt lgkmcnt(2)
v_exp_f32 v18, v212
v_exp_f32 v19, v213
v_accvgpr_write_b32 a153, v23
v_mfma_f32_32x32x16_bf16 v[160:175], v[224:227], v[96:99], v[160:175]
ds_read_b128 v[248:251], v10 offset:36864
v_add_f32 v17, v17, v18
v_cvt_pk_bf16_f32 v22, v18, v19
v_add_f32 v17, v17, v19
v_exp_f32 v20, v214
v_mfma_f32_32x32x16_bf16 v[176:191], v[224:227], v[144:147], v[176:191]
v_exp_f32 v21, v215
v_accvgpr_write_b32 a154, v22
v_add_f32 v17, v17, v20
v_cvt_pk_bf16_f32 v23, v20, v21
v_add_f32 v17, v17, v21
v_mfma_f32_32x32x16_bf16 v[160:175], v[228:231], v[100:103], v[160:175]
ds_read_b128 v[252:255], v11 offset:36864
v_exp_f32 v18, v216
v_exp_f32 v19, v217
v_accvgpr_write_b32 a155, v23
v_add_f32 v17, v17, v18
v_mfma_f32_32x32x16_bf16 v[176:191], v[228:231], v[148:151], v[176:191]
v_cvt_pk_bf16_f32 v22, v18, v19
v_add_f32 v17, v17, v19
v_exp_f32 v20, v218
v_exp_f32 v21, v219
v_accvgpr_write_b32 a156, v22
v_mfma_f32_32x32x16_bf16 v[160:175], v[232:235], v[104:107], v[160:175]
ds_read_b128 v[224:227], v8 offset:40960
v_add_f32 v17, v17, v20
v_cvt_pk_bf16_f32 v23, v20, v21
v_add_f32 v17, v17, v21
v_exp_f32 v18, v220
v_mfma_f32_32x32x16_bf16 v[176:191], v[232:235], v[152:155], v[176:191]
v_exp_f32 v19, v221
v_accvgpr_write_b32 a157, v23
v_add_f32 v17, v17, v18
v_cvt_pk_bf16_f32 v22, v18, v19
v_add_f32 v17, v17, v19
v_mfma_f32_32x32x16_bf16 v[160:175], v[236:239], v[108:111], v[160:175]
ds_read_b128 v[228:231], v9 offset:40960
v_exp_f32 v20, v222
v_exp_f32 v21, v223
v_accvgpr_write_b32 a158, v22
v_add_f32 v17, v17, v20
v_mfma_f32_32x32x16_bf16 v[176:191], v[236:239], v[156:159], v[176:191]
s_waitcnt lgkmcnt(2)
v_cvt_pk_bf16_f32 v23, v20, v21
v_add_f32 v17, v17, v21
v_accvgpr_write_b32 a159, v23
v_add_f32 v22, v16, v17
v_cmp_nge_f32 vcc, s54, v22
s_cbranch_vccnz STUB9
RET9:
v_mfma_f32_32x32x16_bf16 v[192:207], v[240:243], v[64:67], v[32:47]
s_add_u32 m0, s51, 45056
ds_read_b128 v[232:235], v10 offset:40960
buffer_load_dwordx4 v7, s[20:23], s50 offen lds
s_add_u32 s50, s50, 12288
s_cmp_ge_u32 s50, 196608
s_cselect_b32 s50, 0, s50
v_mfma_f32_32x32x16_bf16 v[208:223], v[240:243], v[112:115], v[48:63]
v_exp_f32 v18, v160
v_exp_f32 v19, v161
v_add_f32 v14, v14, v16
v_cvt_pk_bf16_f32 v22, v18, v19
v_mfma_f32_32x32x16_bf16 v[192:207], v[244:247], v[68:71], v[192:207]
ds_read_b128 v[236:239], v11 offset:40960
s_mul_i32 s93, s4, 983040
v_add_f32 v16, v18, v19
v_exp_f32 v20, v162
v_exp_f32 v21, v163
v_mfma_f32_32x32x16_bf16 v[208:223], v[244:247], v[116:119], v[208:223]
v_accvgpr_write_b32 a160, v22
v_add_f32 v16, v16, v20
v_cvt_pk_bf16_f32 v23, v20, v21
v_add_f32 v16, v16, v21
v_exp_f32 v18, v164
v_mfma_f32_32x32x16_bf16 v[192:207], v[248:251], v[72:75], v[192:207]
ds_read_b128 v[240:243], v8 offset:45056
v_exp_f32 v19, v165
v_accvgpr_write_b32 a161, v23
v_add_f32 v16, v16, v18
v_cvt_pk_bf16_f32 v22, v18, v19
v_add_f32 v16, v16, v19
v_mfma_f32_32x32x16_bf16 v[208:223], v[248:251], v[120:123], v[208:223]
v_exp_f32 v20, v166
v_exp_f32 v21, v167
v_accvgpr_write_b32 a162, v22
v_add_f32 v16, v16, v20
v_mfma_f32_32x32x16_bf16 v[192:207], v[252:255], v[76:79], v[192:207]
ds_read_b128 v[244:247], v9 offset:45056
v_cvt_pk_bf16_f32 v23, v20, v21
v_add_f32 v16, v16, v21
v_exp_f32 v18, v168
v_exp_f32 v19, v169
v_mfma_f32_32x32x16_bf16 v[208:223], v[252:255], v[124:127], v[208:223]
s_waitcnt lgkmcnt(2)
s_add_u32 s48, s48, s93
v_accvgpr_write_b32 a163, v23
v_add_f32 v16, v16, v18
v_cvt_pk_bf16_f32 v22, v18, v19
v_add_f32 v16, v16, v19
v_mfma_f32_32x32x16_bf16 v[192:207], v[224:227], v[80:83], v[192:207]
ds_read_b128 v[248:251], v10 offset:45056
v_exp_f32 v20, v170
v_exp_f32 v21, v171
v_accvgpr_write_b32 a164, v22
v_add_f32 v16, v16, v20
v_mfma_f32_32x32x16_bf16 v[208:223], v[224:227], v[128:131], v[208:223]
v_cvt_pk_bf16_f32 v23, v20, v21
v_add_f32 v16, v16, v21
v_exp_f32 v18, v172
v_exp_f32 v19, v173
v_mfma_f32_32x32x16_bf16 v[192:207], v[228:231], v[84:87], v[192:207]
ds_read_b128 v[252:255], v11 offset:45056
v_accvgpr_write_b32 a165, v23
v_add_f32 v16, v16, v18
v_cvt_pk_bf16_f32 v22, v18, v19
v_add_f32 v16, v16, v19
v_exp_f32 v20, v174
v_mfma_f32_32x32x16_bf16 v[208:223], v[228:231], v[132:135], v[208:223]
v_exp_f32 v21, v175
v_accvgpr_write_b32 a166, v22
v_add_f32 v16, v16, v20
v_cvt_pk_bf16_f32 v23, v20, v21
v_add_f32 v16, v16, v21
v_mfma_f32_32x32x16_bf16 v[192:207], v[232:235], v[88:91], v[192:207]
s_waitcnt vmcnt(15)
s_barrier
ds_read_b128 v[224:227], v8 offset:49152
buffer_load_dword v1, v30, s[24:27], s48 offen offset:0
v_accvgpr_write_b32 a167, v23
v_exp_f32 v18, v176
v_mfma_f32_32x32x16_bf16 v[208:223], v[232:235], v[136:139], v[208:223]
v_exp_f32 v19, v177
v_add_f32 v15, v15, v17
v_cvt_pk_bf16_f32 v22, v18, v19
v_add_f32 v17, v18, v19
v_exp_f32 v20, v178
v_mfma_f32_32x32x16_bf16 v[192:207], v[236:239], v[92:95], v[192:207]
ds_read_b128 v[228:231], v9 offset:49152
v_exp_f32 v21, v179
v_accvgpr_write_b32 a168, v22
v_add_f32 v17, v17, v20
v_cvt_pk_bf16_f32 v23, v20, v21
v_mfma_f32_32x32x16_bf16 v[208:223], v[236:239], v[140:143], v[208:223]
s_waitcnt lgkmcnt(2)
v_add_f32 v17, v17, v21
v_exp_f32 v18, v180
v_exp_f32 v19, v181
v_mfma_f32_32x32x16_bf16 v[192:207], v[240:243], v[96:99], v[192:207]
ds_read_b128 v[232:235], v10 offset:49152
v_accvgpr_write_b32 a169, v23
v_add_f32 v17, v17, v18
v_cvt_pk_bf16_f32 v22, v18, v19
v_add_f32 v17, v17, v19
v_exp_f32 v20, v182
v_mfma_f32_32x32x16_bf16 v[208:223], v[240:243], v[144:147], v[208:223]
v_exp_f32 v21, v183
v_accvgpr_write_b32 a170, v22
v_add_f32 v17, v17, v20
v_cvt_pk_bf16_f32 v23, v20, v21
v_add_f32 v17, v17, v21
v_mfma_f32_32x32x16_bf16 v[192:207], v[244:247], v[100:103], v[192:207]
ds_read_b128 v[236:239], v11 offset:49152
v_exp_f32 v18, v184
v_exp_f32 v19, v185
v_accvgpr_write_b32 a171, v23
v_add_f32 v17, v17, v18
v_mfma_f32_32x32x16_bf16 v[208:223], v[244:247], v[148:151], v[208:223]
v_cvt_pk_bf16_f32 v22, v18, v19
v_add_f32 v17, v17, v19
v_exp_f32 v20, v186
v_exp_f32 v21, v187
v_mfma_f32_32x32x16_bf16 v[192:207], v[248:251], v[104:107], v[192:207]
ds_read_b128 v[240:243], v8 offset:53248
v_accvgpr_write_b32 a172, v22
v_add_f32 v17, v17, v20
v_cvt_pk_bf16_f32 v23, v20, v21
v_add_f32 v17, v17, v21
v_exp_f32 v18, v188
v_mfma_f32_32x32x16_bf16 v[208:223], v[248:251], v[152:155], v[208:223]
v_exp_f32 v19, v189
v_accvgpr_write_b32 a173, v23
v_add_f32 v17, v17, v18
v_cvt_pk_bf16_f32 v22, v18, v19
v_add_f32 v17, v17, v19
v_mfma_f32_32x32x16_bf16 v[192:207], v[252:255], v[108:111], v[192:207]
ds_read_b128 v[244:247], v9 offset:53248
v_exp_f32 v20, v190
v_exp_f32 v21, v191
v_accvgpr_write_b32 a174, v22
v_add_f32 v17, v17, v20
v_mfma_f32_32x32x16_bf16 v[208:223], v[252:255], v[156:159], v[208:223]
s_waitcnt lgkmcnt(2)
v_cvt_pk_bf16_f32 v23, v20, v21
v_add_f32 v17, v17, v21
v_accvgpr_write_b32 a175, v23
v_add_f32 v22, v16, v17
v_cmp_nge_f32 vcc, s54, v22
s_cbranch_vccnz STUB10
RET10:
v_mfma_f32_32x32x16_bf16 v[160:175], v[224:227], v[64:67], v[32:47]
s_add_u32 m0, s51, 49152
ds_read_b128 v[248:251], v10 offset:53248
buffer_load_dwordx4 v7, s[20:23], s50 offen lds
s_add_u32 s50, s50, 12288
v_mfma_f32_32x32x16_bf16 v[176:191], v[224:227], v[112:115], v[48:63]
v_exp_f32 v18, v192
v_exp_f32 v19, v193
v_add_f32 v14, v14, v16
v_cvt_pk_bf16_f32 v22, v18, v19
v_add_f32 v16, v18, v19
v_mfma_f32_32x32x16_bf16 v[160:175], v[228:231], v[68:71], v[160:175]
ds_read_b128 v[252:255], v11 offset:53248
buffer_store_dwordx4 a[244:247], v30, s[12:15], s90 offen offset:1024 sc1
v_exp_f32 v20, v194
v_exp_f32 v21, v195
v_mfma_f32_32x32x16_bf16 v[176:191], v[228:231], v[116:119], v[176:191]
v_accvgpr_write_b32 a176, v22
v_add_f32 v16, v16, v20
v_cvt_pk_bf16_f32 v23, v20, v21
v_add_f32 v16, v16, v21
v_exp_f32 v18, v196
v_mfma_f32_32x32x16_bf16 v[160:175], v[232:235], v[72:75], v[160:175]
ds_read_b128 v[224:227], v8 offset:57344
v_exp_f32 v19, v197
v_accvgpr_write_b32 a177, v23
v_add_f32 v16, v16, v18
v_cvt_pk_bf16_f32 v22, v18, v19
v_add_f32 v16, v16, v19
v_mfma_f32_32x32x16_bf16 v[176:191], v[232:235], v[120:123], v[176:191]
v_exp_f32 v20, v198
v_exp_f32 v21, v199
v_accvgpr_write_b32 a178, v22
v_add_f32 v16, v16, v20
v_cvt_pk_bf16_f32 v23, v20, v21
v_mfma_f32_32x32x16_bf16 v[160:175], v[236:239], v[76:79], v[160:175]
ds_read_b128 v[228:231], v9 offset:57344
v_add_f32 v16, v16, v21
v_exp_f32 v18, v200
v_exp_f32 v19, v201
v_mfma_f32_32x32x16_bf16 v[176:191], v[236:239], v[124:127], v[176:191]
s_waitcnt lgkmcnt(2)
v_accvgpr_write_b32 a179, v23
v_add_f32 v16, v16, v18
v_cvt_pk_bf16_f32 v22, v18, v19
v_add_f32 v16, v16, v19
v_exp_f32 v20, v202
v_mfma_f32_32x32x16_bf16 v[160:175], v[240:243], v[80:83], v[160:175]
ds_read_b128 v[232:235], v10 offset:57344
v_exp_f32 v21, v203
v_accvgpr_write_b32 a180, v22
v_add_f32 v16, v16, v20
v_cvt_pk_bf16_f32 v23, v20, v21
v_mfma_f32_32x32x16_bf16 v[176:191], v[240:243], v[128:131], v[176:191]
v_add_f32 v16, v16, v21
v_exp_f32 v18, v204
v_exp_f32 v19, v205
v_accvgpr_write_b32 a181, v23
v_add_f32 v16, v16, v18
v_mfma_f32_32x32x16_bf16 v[160:175], v[244:247], v[84:87], v[160:175]
ds_read_b128 v[236:239], v11 offset:57344
v_cvt_pk_bf16_f32 v22, v18, v19
v_add_f32 v16, v16, v19
v_exp_f32 v20, v206
v_exp_f32 v21, v207
v_mfma_f32_32x32x16_bf16 v[176:191], v[244:247], v[132:135], v[176:191]
v_accvgpr_write_b32 a182, v22
v_add_f32 v16, v16, v20
v_cvt_pk_bf16_f32 v23, v20, v21
v_add_f32 v16, v16, v21
v_accvgpr_write_b32 a183, v23
v_exp_f32 v18, v208
v_mfma_f32_32x32x16_bf16 v[160:175], v[248:251], v[88:91], v[160:175]
v_add_u32 v8, 61440, v8
ds_read_b128 v[240:243], v8 offset:0
buffer_load_dword v2, v30, s[24:27], s48 offen offset:1024
v_exp_f32 v19, v209
v_add_f32 v15, v15, v17
v_mfma_f32_32x32x16_bf16 v[176:191], v[248:251], v[136:139], v[176:191]
v_cvt_pk_bf16_f32 v22, v18, v19
v_add_f32 v17, v18, v19
v_exp_f32 v20, v210
v_exp_f32 v21, v211
v_mfma_f32_32x32x16_bf16 v[160:175], v[252:255], v[92:95], v[160:175]
v_add_u32 v9, 61440, v9
ds_read_b128 v[244:247], v9 offset:0
v_accvgpr_write_b32 a184, v22
v_add_f32 v17, v17, v20
v_cvt_pk_bf16_f32 v23, v20, v21
v_add_f32 v17, v17, v21
v_mfma_f32_32x32x16_bf16 v[176:191], v[252:255], v[140:143], v[176:191]
s_waitcnt lgkmcnt(2)
v_exp_f32 v18, v212
v_exp_f32 v19, v213
v_accvgpr_write_b32 a185, v23
v_add_f32 v17, v17, v18
v_mfma_f32_32x32x16_bf16 v[160:175], v[224:227], v[96:99], v[160:175]
v_add_u32 v10, 61440, v10
ds_read_b128 v[248:251], v10 offset:0
v_cvt_pk_bf16_f32 v22, v18, v19
v_add_f32 v17, v17, v19
v_exp_f32 v20, v214
v_mfma_f32_32x32x16_bf16 v[176:191], v[224:227], v[144:147], v[176:191]
v_exp_f32 v21, v215
v_accvgpr_write_b32 a186, v22
v_add_f32 v17, v17, v20
v_cvt_pk_bf16_f32 v23, v20, v21
v_add_f32 v17, v17, v21
v_exp_f32 v18, v216
v_mfma_f32_32x32x16_bf16 v[160:175], v[228:231], v[100:103], v[160:175]
v_add_u32 v11, 61440, v11
ds_read_b128 v[252:255], v11 offset:0
v_exp_f32 v19, v217
v_accvgpr_write_b32 a187, v23
v_add_f32 v17, v17, v18
v_mfma_f32_32x32x16_bf16 v[176:191], v[228:231], v[148:151], v[176:191]
v_cvt_pk_bf16_f32 v22, v18, v19
v_add_f32 v17, v17, v19
v_exp_f32 v20, v218
v_exp_f32 v21, v219
v_mfma_f32_32x32x16_bf16 v[160:175], v[232:235], v[104:107], v[160:175]
ds_read_b128 v[224:227], v8 offset:4096
v_accvgpr_write_b32 a188, v22
v_add_f32 v17, v17, v20
v_cvt_pk_bf16_f32 v23, v20, v21
v_add_f32 v17, v17, v21
v_exp_f32 v18, v220
v_mfma_f32_32x32x16_bf16 v[176:191], v[232:235], v[152:155], v[176:191]
v_exp_f32 v19, v221
v_accvgpr_write_b32 a189, v23
v_add_f32 v17, v17, v18
v_cvt_pk_bf16_f32 v22, v18, v19
v_add_f32 v17, v17, v19
v_mfma_f32_32x32x16_bf16 v[160:175], v[236:239], v[108:111], v[160:175]
ds_read_b128 v[228:231], v9 offset:4096
v_exp_f32 v20, v222
v_exp_f32 v21, v223
v_accvgpr_write_b32 a190, v22
v_add_f32 v17, v17, v20
v_mfma_f32_32x32x16_bf16 v[176:191], v[236:239], v[156:159], v[176:191]
s_waitcnt lgkmcnt(2)
v_cvt_pk_bf16_f32 v23, v20, v21
v_add_f32 v17, v17, v21
v_accvgpr_write_b32 a191, v23
v_add_f32 v22, v16, v17
v_cmp_nge_f32 vcc, s54, v22
s_cbranch_vccnz STUB11
RET11:
v_mfma_f32_32x32x16_bf16 v[192:207], v[240:243], v[64:67], v[32:47]
s_add_u32 m0, s51, 53248
ds_read_b128 v[232:235], v10 offset:4096
buffer_load_dwordx4 v7, s[20:23], s50 offen lds
s_add_u32 s50, s50, 12288
s_cmp_ge_u32 s50, 196608
s_cselect_b32 s50, 0, s50
v_mfma_f32_32x32x16_bf16 v[208:223], v[240:243], v[112:115], v[48:63]
v_exp_f32 v18, v160
v_exp_f32 v19, v161
v_add_f32 v14, v14, v16
v_cvt_pk_bf16_f32 v22, v18, v19
v_mfma_f32_32x32x16_bf16 v[192:207], v[244:247], v[68:71], v[192:207]
ds_read_b128 v[236:239], v11 offset:4096
buffer_store_dwordx4 a[244:247], v30, s[12:15], s90 offen offset:2048 sc1
v_add_f32 v16, v18, v19
v_exp_f32 v20, v162
v_exp_f32 v21, v163
v_mfma_f32_32x32x16_bf16 v[208:223], v[244:247], v[116:119], v[208:223]
v_accvgpr_write_b32 a192, v22
v_add_f32 v16, v16, v20
v_cvt_pk_bf16_f32 v23, v20, v21
v_add_f32 v16, v16, v21
v_exp_f32 v18, v164
v_mfma_f32_32x32x16_bf16 v[192:207], v[248:251], v[72:75], v[192:207]
ds_read_b128 v[240:243], v8 offset:8192
v_exp_f32 v19, v165
v_accvgpr_write_b32 a193, v23
v_add_f32 v16, v16, v18
v_cvt_pk_bf16_f32 v22, v18, v19
v_add_f32 v16, v16, v19
v_mfma_f32_32x32x16_bf16 v[208:223], v[248:251], v[120:123], v[208:223]
v_exp_f32 v20, v166
v_exp_f32 v21, v167
v_accvgpr_write_b32 a194, v22
v_add_f32 v16, v16, v20
v_mfma_f32_32x32x16_bf16 v[192:207], v[252:255], v[76:79], v[192:207]
ds_read_b128 v[244:247], v9 offset:8192
v_cvt_pk_bf16_f32 v23, v20, v21
v_add_f32 v16, v16, v21
v_exp_f32 v18, v168
v_exp_f32 v19, v169
v_mfma_f32_32x32x16_bf16 v[208:223], v[252:255], v[124:127], v[208:223]
s_waitcnt lgkmcnt(2)
v_accvgpr_write_b32 a195, v23
v_add_f32 v16, v16, v18
v_cvt_pk_bf16_f32 v22, v18, v19
v_add_f32 v16, v16, v19
v_exp_f32 v20, v170
v_mfma_f32_32x32x16_bf16 v[192:207], v[224:227], v[80:83], v[192:207]
ds_read_b128 v[248:251], v10 offset:8192
v_exp_f32 v21, v171
v_accvgpr_write_b32 a196, v22
v_add_f32 v16, v16, v20
v_cvt_pk_bf16_f32 v23, v20, v21
v_mfma_f32_32x32x16_bf16 v[208:223], v[224:227], v[128:131], v[208:223]
v_add_f32 v16, v16, v21
v_exp_f32 v18, v172
v_exp_f32 v19, v173
v_accvgpr_write_b32 a197, v23
v_mfma_f32_32x32x16_bf16 v[192:207], v[228:231], v[84:87], v[192:207]
ds_read_b128 v[252:255], v11 offset:8192
v_add_f32 v16, v16, v18
v_cvt_pk_bf16_f32 v22, v18, v19
v_add_f32 v16, v16, v19
v_exp_f32 v20, v174
v_mfma_f32_32x32x16_bf16 v[208:223], v[228:231], v[132:135], v[208:223]
v_exp_f32 v21, v175
v_accvgpr_write_b32 a198, v22
v_add_f32 v16, v16, v20
v_cvt_pk_bf16_f32 v23, v20, v21
v_add_f32 v16, v16, v21
v_accvgpr_write_b32 a199, v23
v_mfma_f32_32x32x16_bf16 v[192:207], v[232:235], v[88:91], v[192:207]
s_waitcnt vmcnt(10)
s_barrier
ds_read_b128 v[224:227], v8 offset:12288
buffer_load_dword v3, v30, s[24:27], s48 offen offset:2048
v_exp_f32 v18, v176
v_mfma_f32_32x32x16_bf16 v[208:223], v[232:235], v[136:139], v[208:223]
v_exp_f32 v19, v177
v_add_f32 v15, v15, v17
v_cvt_pk_bf16_f32 v22, v18, v19
v_add_f32 v17, v18, v19
v_exp_f32 v20, v178
v_mfma_f32_32x32x16_bf16 v[192:207], v[236:239], v[92:95], v[192:207]
ds_read_b128 v[228:231], v9 offset:12288
v_exp_f32 v21, v179
v_accvgpr_write_b32 a200, v22
v_add_f32 v17, v17, v20
v_cvt_pk_bf16_f32 v23, v20, v21
v_mfma_f32_32x32x16_bf16 v[208:223], v[236:239], v[140:143], v[208:223]
s_waitcnt lgkmcnt(2)
v_add_f32 v17, v17, v21
v_exp_f32 v18, v180
v_exp_f32 v19, v181
v_accvgpr_write_b32 a201, v23
v_mfma_f32_32x32x16_bf16 v[192:207], v[240:243], v[96:99], v[192:207]
ds_read_b128 v[232:235], v10 offset:12288
v_add_f32 v17, v17, v18
v_cvt_pk_bf16_f32 v22, v18, v19
v_add_f32 v17, v17, v19
v_exp_f32 v20, v182
v_mfma_f32_32x32x16_bf16 v[208:223], v[240:243], v[144:147], v[208:223]
v_exp_f32 v21, v183
v_accvgpr_write_b32 a202, v22
v_add_f32 v17, v17, v20
v_cvt_pk_bf16_f32 v23, v20, v21
v_add_f32 v17, v17, v21
v_mfma_f32_32x32x16_bf16 v[192:207], v[244:247], v[100:103], v[192:207]
ds_read_b128 v[236:239], v11 offset:12288
v_exp_f32 v18, v184
v_exp_f32 v19, v185
v_accvgpr_write_b32 a203, v23
v_add_f32 v17, v17, v18
v_mfma_f32_32x32x16_bf16 v[208:223], v[244:247], v[148:151], v[208:223]
v_cvt_pk_bf16_f32 v22, v18, v19
v_add_f32 v17, v17, v19
v_exp_f32 v20, v186
v_exp_f32 v21, v187
v_accvgpr_write_b32 a204, v22
v_mfma_f32_32x32x16_bf16 v[192:207], v[248:251], v[104:107], v[192:207]
ds_read_b128 v[240:243], v8 offset:16384
v_add_f32 v17, v17, v20
v_cvt_pk_bf16_f32 v23, v20, v21
v_add_f32 v17, v17, v21
v_exp_f32 v18, v188
v_mfma_f32_32x32x16_bf16 v[208:223], v[248:251], v[152:155], v[208:223]
v_exp_f32 v19, v189
v_accvgpr_write_b32 a205, v23
v_add_f32 v17, v17, v18
v_cvt_pk_bf16_f32 v22, v18, v19
v_add_f32 v17, v17, v19
v_mfma_f32_32x32x16_bf16 v[192:207], v[252:255], v[108:111], v[192:207]
ds_read_b128 v[244:247], v9 offset:16384
v_exp_f32 v20, v190
v_exp_f32 v21, v191
v_accvgpr_write_b32 a206, v22
v_add_f32 v17, v17, v20
v_mfma_f32_32x32x16_bf16 v[208:223], v[252:255], v[156:159], v[208:223]
s_waitcnt lgkmcnt(2)
v_cvt_pk_bf16_f32 v23, v20, v21
v_add_f32 v17, v17, v21
v_accvgpr_write_b32 a207, v23
v_add_f32 v22, v16, v17
v_cmp_nge_f32 vcc, s54, v22
s_cbranch_vccnz STUB12
RET12:
v_mfma_f32_32x32x16_bf16 v[160:175], v[224:227], v[64:67], v[32:47]
s_add_u32 m0, s51, 57344
ds_read_b128 v[248:251], v10 offset:16384
buffer_load_dwordx4 v7, s[20:23], s50 offen lds
s_add_u32 s50, s50, 12288
v_mfma_f32_32x32x16_bf16 v[176:191], v[224:227], v[112:115], v[48:63]
v_exp_f32 v18, v192
v_exp_f32 v19, v193
v_add_f32 v14, v14, v16
v_cvt_pk_bf16_f32 v22, v18, v19
v_mfma_f32_32x32x16_bf16 v[160:175], v[228:231], v[68:71], v[160:175]
ds_read_b128 v[252:255], v11 offset:16384
buffer_store_dwordx4 a[244:247], v30, s[12:15], s90 offen offset:3072 sc1
s_add_u32 s90, s90, 4096
v_add_f32 v16, v18, v19
v_exp_f32 v20, v194
v_mfma_f32_32x32x16_bf16 v[176:191], v[228:231], v[116:119], v[176:191]
v_exp_f32 v21, v195
v_accvgpr_write_b32 a208, v22
v_add_f32 v16, v16, v20
v_cvt_pk_bf16_f32 v23, v20, v21
v_add_f32 v16, v16, v21
v_exp_f32 v18, v196
v_mfma_f32_32x32x16_bf16 v[160:175], v[232:235], v[72:75], v[160:175]
ds_read_b128 v[224:227], v8 offset:20480
v_exp_f32 v19, v197
v_accvgpr_write_b32 a209, v23
v_add_f32 v16, v16, v18
v_mfma_f32_32x32x16_bf16 v[176:191], v[232:235], v[120:123], v[176:191]
v_cvt_pk_bf16_f32 v22, v18, v19
v_add_f32 v16, v16, v19
v_exp_f32 v20, v198
v_exp_f32 v21, v199
v_accvgpr_write_b32 a210, v22
v_mfma_f32_32x32x16_bf16 v[160:175], v[236:239], v[76:79], v[160:175]
ds_read_b128 v[228:231], v9 offset:20480
v_add_f32 v16, v16, v20
v_cvt_pk_bf16_f32 v23, v20, v21
v_add_f32 v16, v16, v21
v_exp_f32 v18, v200
v_mfma_f32_32x32x16_bf16 v[176:191], v[236:239], v[124:127], v[176:191]
s_waitcnt lgkmcnt(2)
v_exp_f32 v19, v201
v_accvgpr_write_b32 a211, v23
v_add_f32 v16, v16, v18
v_cvt_pk_bf16_f32 v22, v18, v19
v_mfma_f32_32x32x16_bf16 v[160:175], v[240:243], v[80:83], v[160:175]
ds_read_b128 v[232:235], v10 offset:20480
v_add_f32 v16, v16, v19
v_exp_f32 v20, v202
v_exp_f32 v21, v203
v_accvgpr_write_b32 a212, v22
v_mfma_f32_32x32x16_bf16 v[176:191], v[240:243], v[128:131], v[176:191]
v_add_f32 v16, v16, v20
v_cvt_pk_bf16_f32 v23, v20, v21
v_add_f32 v16, v16, v21
v_exp_f32 v18, v204
v_exp_f32 v19, v205
v_mfma_f32_32x32x16_bf16 v[160:175], v[244:247], v[84:87], v[160:175]
ds_read_b128 v[236:239], v11 offset:20480
v_accvgpr_write_b32 a213, v23
v_add_f32 v16, v16, v18
v_cvt_pk_bf16_f32 v22, v18, v19
v_add_f32 v16, v16, v19
v_mfma_f32_32x32x16_bf16 v[176:191], v[244:247], v[132:135], v[176:191]
v_exp_f32 v20, v206
v_exp_f32 v21, v207
v_accvgpr_write_b32 a214, v22
v_add_f32 v16, v16, v20
v_cvt_pk_bf16_f32 v23, v20, v21
v_mfma_f32_32x32x16_bf16 v[160:175], v[248:251], v[88:91], v[160:175]
ds_read_b128 v[240:243], v8 offset:24576
v_add_f32 v16, v16, v21
v_accvgpr_write_b32 a215, v23
v_exp_f32 v18, v208
v_exp_f32 v19, v209
v_mfma_f32_32x32x16_bf16 v[176:191], v[248:251], v[136:139], v[176:191]
v_add_f32 v15, v15, v17
v_cvt_pk_bf16_f32 v22, v18, v19
v_add_f32 v17, v18, v19
v_exp_f32 v20, v210
v_mfma_f32_32x32x16_bf16 v[160:175], v[252:255], v[92:95], v[160:175]
ds_read_b128 v[244:247], v9 offset:24576
v_exp_f32 v21, v211
v_accvgpr_write_b32 a216, v22
v_add_f32 v17, v17, v20
v_cvt_pk_bf16_f32 v23, v20, v21
v_add_f32 v17, v17, v21
v_mfma_f32_32x32x16_bf16 v[176:191], v[252:255], v[140:143], v[176:191]
s_waitcnt lgkmcnt(2)
v_exp_f32 v18, v212
v_exp_f32 v19, v213
v_accvgpr_write_b32 a217, v23
v_mfma_f32_32x32x16_bf16 v[160:175], v[224:227], v[96:99], v[160:175]
ds_read_b128 v[248:251], v10 offset:24576
v_add_f32 v17, v17, v18
v_cvt_pk_bf16_f32 v22, v18, v19
v_add_f32 v17, v17, v19
v_exp_f32 v20, v214
v_mfma_f32_32x32x16_bf16 v[176:191], v[224:227], v[144:147], v[176:191]
v_exp_f32 v21, v215
v_accvgpr_write_b32 a218, v22
v_add_f32 v17, v17, v20
v_cvt_pk_bf16_f32 v23, v20, v21
v_add_f32 v17, v17, v21
v_mfma_f32_32x32x16_bf16 v[160:175], v[228:231], v[100:103], v[160:175]
ds_read_b128 v[252:255], v11 offset:24576
v_exp_f32 v18, v216
v_exp_f32 v19, v217
v_accvgpr_write_b32 a219, v23
v_add_f32 v17, v17, v18
v_mfma_f32_32x32x16_bf16 v[176:191], v[228:231], v[148:151], v[176:191]
v_cvt_pk_bf16_f32 v22, v18, v19
v_add_f32 v17, v17, v19
v_exp_f32 v20, v218
v_exp_f32 v21, v219
v_accvgpr_write_b32 a220, v22
v_mfma_f32_32x32x16_bf16 v[160:175], v[232:235], v[104:107], v[160:175]
ds_read_b128 v[224:227], v8 offset:28672
v_add_f32 v17, v17, v20
v_cvt_pk_bf16_f32 v23, v20, v21
v_add_f32 v17, v17, v21
v_exp_f32 v18, v220
v_mfma_f32_32x32x16_bf16 v[176:191], v[232:235], v[152:155], v[176:191]
v_exp_f32 v19, v221
v_accvgpr_write_b32 a221, v23
v_add_f32 v17, v17, v18
v_cvt_pk_bf16_f32 v22, v18, v19
v_add_f32 v17, v17, v19
v_mfma_f32_32x32x16_bf16 v[160:175], v[236:239], v[108:111], v[160:175]
ds_read_b128 v[228:231], v9 offset:28672
v_exp_f32 v20, v222
v_exp_f32 v21, v223
v_accvgpr_write_b32 a222, v22
v_add_f32 v17, v17, v20
v_mfma_f32_32x32x16_bf16 v[176:191], v[236:239], v[156:159], v[176:191]
s_waitcnt lgkmcnt(2)
v_cvt_pk_bf16_f32 v23, v20, v21
v_add_f32 v17, v17, v21
v_accvgpr_write_b32 a223, v23
v_add_f32 v22, v16, v17
v_cmp_nge_f32 vcc, s54, v22
s_cbranch_vccnz STUB13
RET13:
v_mfma_f32_32x32x16_bf16 v[192:207], v[240:243], v[64:67], v[32:47]
s_add_u32 m0, s51, 61440
ds_read_b128 v[232:235], v10 offset:28672
buffer_load_dwordx4 v7, s[20:23], s50 offen lds
s_add_u32 s50, s50, 12288
s_cmp_ge_u32 s50, 196608
s_cselect_b32 s50, 0, s50
v_mfma_f32_32x32x16_bf16 v[208:223], v[240:243], v[112:115], v[48:63]
v_exp_f32 v18, v160
v_exp_f32 v19, v161
v_add_f32 v14, v14, v16
v_cvt_pk_bf16_f32 v22, v18, v19
v_add_f32 v16, v18, v19
v_mfma_f32_32x32x16_bf16 v[192:207], v[244:247], v[68:71], v[192:207]
ds_read_b128 v[236:239], v11 offset:28672
v_exp_f32 v20, v162
v_exp_f32 v21, v163
v_accvgpr_write_b32 a224, v22
v_mfma_f32_32x32x16_bf16 v[208:223], v[244:247], v[116:119], v[208:223]
v_add_f32 v16, v16, v20
v_cvt_pk_bf16_f32 v23, v20, v21
v_add_f32 v16, v16, v21
v_exp_f32 v18, v164
v_exp_f32 v19, v165
v_mfma_f32_32x32x16_bf16 v[192:207], v[248:251], v[72:75], v[192:207]
ds_read_b128 v[240:243], v8 offset:32768
v_accvgpr_write_b32 a225, v23
v_add_f32 v16, v16, v18
v_cvt_pk_bf16_f32 v22, v18, v19
v_add_f32 v16, v16, v19
v_exp_f32 v20, v166
v_mfma_f32_32x32x16_bf16 v[208:223], v[248:251], v[120:123], v[208:223]
v_exp_f32 v21, v167
v_accvgpr_write_b32 a226, v22
v_add_f32 v16, v16, v20
v_cvt_pk_bf16_f32 v23, v20, v21
v_add_f32 v16, v16, v21
v_mfma_f32_32x32x16_bf16 v[192:207], v[252:255], v[76:79], v[192:207]
ds_read_b128 v[244:247], v9 offset:32768
v_exp_f32 v18, v168
v_exp_f32 v19, v169
v_accvgpr_write_b32 a227, v23
v_add_f32 v16, v16, v18
v_mfma_f32_32x32x16_bf16 v[208:223], v[252:255], v[124:127], v[208:223]
s_waitcnt lgkmcnt(2)
v_cvt_pk_bf16_f32 v22, v18, v19
v_add_f32 v16, v16, v19
v_exp_f32 v20, v170
v_exp_f32 v21, v171
v_mfma_f32_32x32x16_bf16 v[192:207], v[224:227], v[80:83], v[192:207]
ds_read_b128 v[248:251], v10 offset:32768
v_accvgpr_write_b32 a228, v22
v_add_f32 v16, v16, v20
v_cvt_pk_bf16_f32 v23, v20, v21
v_add_f32 v16, v16, v21
v_exp_f32 v18, v172
v_mfma_f32_32x32x16_bf16 v[208:223], v[224:227], v[128:131], v[208:223]
v_exp_f32 v19, v173
v_accvgpr_write_b32 a229, v23
v_add_f32 v16, v16, v18
v_cvt_pk_bf16_f32 v22, v18, v19
v_add_f32 v16, v16, v19
v_mfma_f32_32x32x16_bf16 v[192:207], v[228:231], v[84:87], v[192:207]
ds_read_b128 v[252:255], v11 offset:32768
v_exp_f32 v20, v174
v_exp_f32 v21, v175
v_accvgpr_write_b32 a230, v22
v_add_f32 v16, v16, v20
v_mfma_f32_32x32x16_bf16 v[208:223], v[228:231], v[132:135], v[208:223]
v_cvt_pk_bf16_f32 v23, v20, v21
v_add_f32 v16, v16, v21
v_accvgpr_write_b32 a231, v23
v_exp_f32 v18, v176
v_exp_f32 v19, v177
v_mfma_f32_32x32x16_bf16 v[192:207], v[232:235], v[88:91], v[192:207]
s_barrier
ds_read_b64_tr_b16 v[224:225], v12 offset:0
buffer_load_dword v53, v30, s[24:27], s48 offen offset:3072
s_add_u32 s48, s48, 4096
buffer_load_dword v54, v30, s[24:27], s48 offen offset:0
v_mfma_f32_32x32x16_bf16 v[208:223], v[232:235], v[136:139], v[208:223]
ds_read_b64_tr_b16 v[226:227], v12 offset:1024
v_add_f32 v15, v15, v17
v_cvt_pk_bf16_f32 v22, v18, v19
v_add_f32 v17, v18, v19
v_exp_f32 v20, v178
v_exp_f32 v21, v179
v_mfma_f32_32x32x16_bf16 v[192:207], v[236:239], v[92:95], v[192:207]
ds_read_b64_tr_b16 v[228:229], v12 offset:2048
v_accvgpr_write_b32 a232, v22
v_add_f32 v17, v17, v20
v_cvt_pk_bf16_f32 v23, v20, v21
v_add_f32 v17, v17, v21
v_mfma_f32_32x32x16_bf16 v[208:223], v[236:239], v[140:143], v[208:223]
ds_read_b64_tr_b16 v[230:231], v12 offset:3072
v_exp_f32 v18, v180
v_exp_f32 v19, v181
v_accvgpr_write_b32 a233, v23
v_add_f32 v17, v17, v18
s_waitcnt lgkmcnt(6)
v_mfma_f32_32x32x16_bf16 v[192:207], v[240:243], v[96:99], v[192:207]
ds_read_b64_tr_b16 v[232:233], v13 offset:0
v_cvt_pk_bf16_f32 v22, v18, v19
v_add_f32 v17, v17, v19
v_exp_f32 v20, v182
v_exp_f32 v21, v183
v_mfma_f32_32x32x16_bf16 v[208:223], v[240:243], v[144:147], v[208:223]
ds_read_b64_tr_b16 v[234:235], v13 offset:1024
v_accvgpr_write_b32 a234, v22
v_add_f32 v17, v17, v20
v_cvt_pk_bf16_f32 v23, v20, v21
v_add_f32 v17, v17, v21
v_exp_f32 v18, v184
v_mfma_f32_32x32x16_bf16 v[192:207], v[244:247], v[100:103], v[192:207]
ds_read_b64_tr_b16 v[236:237], v13 offset:2048
v_exp_f32 v19, v185
v_accvgpr_write_b32 a235, v23
v_add_f32 v17, v17, v18
v_cvt_pk_bf16_f32 v22, v18, v19
v_add_f32 v17, v17, v19
v_mfma_f32_32x32x16_bf16 v[208:223], v[244:247], v[148:151], v[208:223]
ds_read_b64_tr_b16 v[238:239], v13 offset:3072
v_exp_f32 v20, v186
v_exp_f32 v21, v187
v_accvgpr_write_b32 a236, v22
s_waitcnt lgkmcnt(6)
v_mfma_f32_32x32x16_bf16 v[192:207], v[248:251], v[104:107], v[192:207]
ds_read_b64_tr_b16 v[240:241], v12 offset:4096
v_add_f32 v17, v17, v20
v_cvt_pk_bf16_f32 v23, v20, v21
v_add_f32 v17, v17, v21
v_exp_f32 v18, v188
v_mfma_f32_32x32x16_bf16 v[208:223], v[248:251], v[152:155], v[208:223]
ds_read_b64_tr_b16 v[242:243], v12 offset:5120
v_exp_f32 v19, v189
v_accvgpr_write_b32 a237, v23
v_add_f32 v17, v17, v18
v_cvt_pk_bf16_f32 v22, v18, v19
v_add_f32 v17, v17, v19
v_mfma_f32_32x32x16_bf16 v[192:207], v[252:255], v[108:111], v[192:207]
ds_read_b64_tr_b16 v[244:245], v12 offset:6144
v_exp_f32 v20, v190
v_exp_f32 v21, v191
v_accvgpr_write_b32 a238, v22
v_add_f32 v17, v17, v20
v_mfma_f32_32x32x16_bf16 v[208:223], v[252:255], v[156:159], v[208:223]
ds_read_b64_tr_b16 v[246:247], v12 offset:7168
v_cvt_pk_bf16_f32 v23, v20, v21
v_add_f32 v17, v17, v21
v_accvgpr_write_b32 a239, v23
v_add_f32 v22, v16, v17
v_cmp_nge_f32 vcc, s54, v22
s_cbranch_vccnz STUB14
RET14:
v_mfma_f32_32x32x16_bf16 v[64:79], v[224:227], a[0:3], 0
ds_read_b64_tr_b16 v[248:249], v13 offset:4096
v_mfma_f32_32x32x16_bf16 v[96:111], v[224:227], a[8:11], 0
ds_read_b64_tr_b16 v[250:251], v13 offset:5120
v_exp_f32 v18, v192
v_exp_f32 v19, v193
v_add_f32 v14, v14, v16
v_cvt_pk_bf16_f32 v22, v18, v19
s_waitcnt lgkmcnt(6)
v_mfma_f32_32x32x16_bf16 v[64:79], v[228:231], a[4:7], v[64:79]
ds_read_b64_tr_b16 v[252:253], v13 offset:6144
v_add_f32 v16, v18, v19
v_exp_f32 v20, v194
v_exp_f32 v21, v195
v_mfma_f32_32x32x16_bf16 v[96:111], v[228:231], a[12:15], v[96:111]
ds_read_b64_tr_b16 v[254:255], v13 offset:7168
v_accvgpr_write_b32 a240, v22
v_add_f32 v16, v16, v20
v_cvt_pk_bf16_f32 v23, v20, v21
v_add_f32 v16, v16, v21
v_exp_f32 v18, v196
v_mfma_f32_32x32x16_bf16 v[80:95], v[232:235], a[0:3], 0
ds_read_b64_tr_b16 v[224:225], v12 offset:8192
v_exp_f32 v19, v197
v_accvgpr_write_b32 a241, v23
v_add_f32 v16, v16, v18
v_cvt_pk_bf16_f32 v22, v18, v19
v_add_f32 v16, v16, v19
v_mfma_f32_32x32x16_bf16 v[112:127], v[232:235], a[8:11], 0
ds_read_b64_tr_b16 v[226:227], v12 offset:9216
v_exp_f32 v20, v198
v_exp_f32 v21, v199
v_accvgpr_write_b32 a242, v22
v_mfma_f32_32x32x16_bf16 v[80:95], v[236:239], a[4:7], v[80:95]
ds_read_b64_tr_b16 v[228:229], v12 offset:10240
v_add_f32 v16, v16, v20
v_cvt_pk_bf16_f32 v23, v20, v21
v_add_f32 v16, v16, v21
v_exp_f32 v18, v200
v_exp_f32 v19, v201
v_mfma_f32_32x32x16_bf16 v[112:127], v[236:239], a[12:15], v[112:127]
ds_read_b64_tr_b16 v[230:231], v12 offset:11264
v_accvgpr_write_b32 a243, v23
v_add_f32 v16, v16, v18
v_cvt_pk_bf16_f32 v22, v18, v19
v_add_f32 v16, v16, v19
s_waitcnt lgkmcnt(6)
v_mfma_f32_32x32x16_bf16 v[64:79], v[240:243], a[16:19], v[64:79]
ds_read_b64_tr_b16 v[232:233], v13 offset:8192
v_exp_f32 v20, v202
v_exp_f32 v21, v203
v_accvgpr_write_b32 a244, v22
v_add_f32 v16, v16, v20
v_cvt_pk_bf16_f32 v23, v20, v21
v_mfma_f32_32x32x16_bf16 v[96:111], v[240:243], a[24:27], v[96:111]
ds_read_b64_tr_b16 v[234:235], v13 offset:9216
v_add_f32 v16, v16, v21
v_exp_f32 v18, v204
v_exp_f32 v19, v205
v_mfma_f32_32x32x16_bf16 v[64:79], v[244:247], a[20:23], v[64:79]
ds_read_b64_tr_b16 v[236:237], v13 offset:10240
v_accvgpr_write_b32 a245, v23
v_add_f32 v16, v16, v18
v_cvt_pk_bf16_f32 v22, v18, v19
v_add_f32 v16, v16, v19
v_exp_f32 v20, v206
v_mfma_f32_32x32x16_bf16 v[96:111], v[244:247], a[28:31], v[96:111]
ds_read_b64_tr_b16 v[238:239], v13 offset:11264
v_exp_f32 v21, v207
v_accvgpr_write_b32 a246, v22
v_add_f32 v16, v16, v20
v_cvt_pk_bf16_f32 v23, v20, v21
v_add_f32 v16, v16, v21
v_mfma_f32_32x32x16_bf16 v[80:95], v[248:251], a[16:19], v[80:95]
ds_read_b64_tr_b16 v[240:241], v12 offset:12288
buffer_load_dword v55, v30, s[24:27], s48 offen offset:1024
v_accvgpr_write_b32 a247, v23
v_exp_f32 v18, v208
v_exp_f32 v19, v209
v_mfma_f32_32x32x16_bf16 v[112:127], v[248:251], a[24:27], v[112:127]
ds_read_b64_tr_b16 v[242:243], v12 offset:13312
v_add_f32 v15, v15, v17
v_cvt_pk_bf16_f32 v22, v18, v19
v_add_f32 v17, v18, v19
v_exp_f32 v20, v210
s_waitcnt lgkmcnt(6)
v_mfma_f32_32x32x16_bf16 v[80:95], v[252:255], a[20:23], v[80:95]
ds_read_b64_tr_b16 v[244:245], v12 offset:14336
v_exp_f32 v21, v211
v_accvgpr_write_b32 a248, v22
v_add_f32 v17, v17, v20
v_cvt_pk_bf16_f32 v23, v20, v21
v_add_f32 v17, v17, v21
v_mfma_f32_32x32x16_bf16 v[112:127], v[252:255], a[28:31], v[112:127]
ds_read_b64_tr_b16 v[246:247], v12 offset:15360
v_exp_f32 v18, v212
v_exp_f32 v19, v213
v_accvgpr_write_b32 a249, v23
v_mfma_f32_32x32x16_bf16 v[64:79], v[224:227], a[32:35], v[64:79]
ds_read_b64_tr_b16 v[248:249], v13 offset:12288
v_add_f32 v17, v17, v18
v_cvt_pk_bf16_f32 v22, v18, v19
v_add_f32 v17, v17, v19
v_exp_f32 v20, v214
v_exp_f32 v21, v215
v_mfma_f32_32x32x16_bf16 v[96:111], v[224:227], a[40:43], v[96:111]
ds_read_b64_tr_b16 v[250:251], v13 offset:13312
v_accvgpr_write_b32 a250, v22
v_add_f32 v17, v17, v20
v_cvt_pk_bf16_f32 v23, v20, v21
v_add_f32 v17, v17, v21
v_mfma_f32_32x32x16_bf16 v[64:79], v[228:231], a[36:39], v[64:79]
ds_read_b64_tr_b16 v[252:253], v13 offset:14336
v_exp_f32 v18, v216
v_exp_f32 v19, v217
v_accvgpr_write_b32 a251, v23
v_add_f32 v17, v17, v18
v_cvt_pk_bf16_f32 v22, v18, v19
v_mfma_f32_32x32x16_bf16 v[96:111], v[228:231], a[44:47], v[96:111]
ds_read_b64_tr_b16 v[254:255], v13 offset:15360
v_add_f32 v17, v17, v19
v_exp_f32 v20, v218
v_exp_f32 v21, v219
s_waitcnt lgkmcnt(6)
v_mfma_f32_32x32x16_bf16 v[80:95], v[232:235], a[32:35], v[80:95]
ds_read_b64_tr_b16 v[224:225], v12 offset:16384
v_accvgpr_write_b32 a252, v22
v_add_f32 v17, v17, v20
v_cvt_pk_bf16_f32 v23, v20, v21
v_add_f32 v17, v17, v21
v_exp_f32 v18, v220
v_mfma_f32_32x32x16_bf16 v[112:127], v[232:235], a[40:43], v[112:127]
ds_read_b64_tr_b16 v[226:227], v12 offset:17408
v_exp_f32 v19, v221
v_accvgpr_write_b32 a253, v23
v_add_f32 v17, v17, v18
v_cvt_pk_bf16_f32 v22, v18, v19
v_add_f32 v17, v17, v19
v_mfma_f32_32x32x16_bf16 v[80:95], v[236:239], a[36:39], v[80:95]
ds_read_b64_tr_b16 v[228:229], v12 offset:18432
v_exp_f32 v20, v222
v_exp_f32 v21, v223
v_accvgpr_write_b32 a254, v22
v_mfma_f32_32x32x16_bf16 v[112:127], v[236:239], a[44:47], v[112:127]
ds_read_b64_tr_b16 v[230:231], v12 offset:19456
v_add_f32 v17, v17, v20
v_cvt_pk_bf16_f32 v23, v20, v21
v_add_f32 v17, v17, v21
v_accvgpr_write_b32 a255, v23
v_add_f32 v22, v16, v17
v_cmp_nge_f32 vcc, s54, v22
s_cbranch_vccnz STUB15
RET15:
v_mfma_f32_32x32x16_bf16 v[64:79], v[240:243], a[48:51], v[64:79]
ds_read_b64_tr_b16 v[232:233], v13 offset:16384
v_add_f32 v14, v14, v16
v_add_f32 v15, v15, v17
v_mov_b32 v16, v14
v_add_u32 v7, 128, v7
s_add_u32 m0, s51, 65536
v_mfma_f32_32x32x16_bf16 v[96:111], v[240:243], a[56:59], v[96:111]
ds_read_b64_tr_b16 v[234:235], v13 offset:17408
v_mov_b32 v17, v15
v_add_u32 v8, 61440, v31
buffer_load_dwordx4 v7, s[20:23], s50 offen lds
s_waitcnt lgkmcnt(6)
v_mfma_f32_32x32x16_bf16 v[64:79], v[244:247], a[52:55], v[64:79]
ds_read_b64_tr_b16 v[236:237], v13 offset:18432
v_add_u32 v9, 122880, v31
v_permlane32_swap_b32 v14, v16
s_add_u32 s50, s50, 12288
v_mfma_f32_32x32x16_bf16 v[96:111], v[244:247], a[60:63], v[96:111]
ds_read_b64_tr_b16 v[238:239], v13 offset:19456
v_permlane32_swap_b32 v15, v17
v_add_f32 v14, v14, v16
s_add_u32 m0, s51, 69632
v_mfma_f32_32x32x16_bf16 v[80:95], v[248:251], a[48:51], v[80:95]
ds_read_b64_tr_b16 v[240:241], v12 offset:20480
v_add_f32 v15, v15, v17
v_rcp_f32 v14, v14
buffer_load_dwordx4 v7, s[20:23], s50 offen lds
v_mfma_f32_32x32x16_bf16 v[112:127], v[248:251], a[56:59], v[112:127]
ds_read_b64_tr_b16 v[242:243], v12 offset:21504
v_rcp_f32 v15, v15
v_add_u32 v22, 0, v0
s_add_u32 s50, s50, 12288
s_cmp_ge_u32 s50, 196608
s_cselect_b32 s50, 0, s50
v_mfma_f32_32x32x16_bf16 v[80:95], v[252:255], a[52:55], v[80:95]
ds_read_b64_tr_b16 v[244:245], v12 offset:22528
v_mul_u32_u24 v23, 3277, v22
v_lshrrev_b32 v23, 16, v23
v_mfma_f32_32x32x16_bf16 v[112:127], v[252:255], a[60:63], v[112:127]
ds_read_b64_tr_b16 v[246:247], v12 offset:23552
v_mul_u32_u24 v23, 960, v23
s_waitcnt vmcnt(14)
v_lshl_add_u32 v1, v22, 4, v23
s_add_u32 m0, s51, 73728
s_waitcnt lgkmcnt(6)
v_mfma_f32_32x32x16_bf16 v[64:79], v[224:227], a[64:67], v[64:79]
ds_read_b64_tr_b16 v[248:249], v13 offset:20480
v_add_u32 v22, 64, v0
v_mul_u32_u24 v23, 3277, v22
buffer_load_dwordx4 v7, s[20:23], s50 offen lds
v_mfma_f32_32x32x16_bf16 v[96:111], v[224:227], a[72:75], v[96:111]
ds_read_b64_tr_b16 v[250:251], v13 offset:21504
v_lshrrev_b32 v23, 16, v23
v_mul_u32_u24 v23, 960, v23
s_add_u32 s50, s50, 12288
v_mfma_f32_32x32x16_bf16 v[64:79], v[228:231], a[68:71], v[64:79]
ds_read_b64_tr_b16 v[252:253], v13 offset:22528
s_waitcnt vmcnt(12)
v_lshl_add_u32 v2, v22, 4, v23
v_add_u32 v22, 128, v0
s_add_u32 m0, s51, 77824
v_mfma_f32_32x32x16_bf16 v[96:111], v[228:231], a[76:79], v[96:111]
ds_read_b64_tr_b16 v[254:255], v13 offset:23552
v_mul_u32_u24 v23, 3277, v22
v_lshrrev_b32 v23, 16, v23
buffer_load_dwordx4 v7, s[20:23], s50 offen lds
v_mfma_f32_32x32x16_bf16 v[80:95], v[232:235], a[64:67], v[80:95]
ds_read_b64_tr_b16 v[224:225], v12 offset:24576
buffer_load_dword v56, v30, s[24:27], s48 offen offset:2048
v_mul_u32_u24 v23, 960, v23
s_waitcnt vmcnt(11)
v_lshl_add_u32 v3, v22, 4, v23
s_add_u32 s50, s50, 12288
s_cmp_ge_u32 s50, 196608
s_cselect_b32 s50, 0, s50
v_mfma_f32_32x32x16_bf16 v[112:127], v[232:235], a[72:75], v[112:127]
ds_read_b64_tr_b16 v[226:227], v12 offset:25600
v_add_u32 v22, 192, v0
v_mul_u32_u24 v23, 3277, v22
s_waitcnt lgkmcnt(6)
v_mfma_f32_32x32x16_bf16 v[80:95], v[236:239], a[68:71], v[80:95]
ds_read_b64_tr_b16 v[228:229], v12 offset:26624
v_lshrrev_b32 v23, 16, v23
v_mul_u32_u24 v23, 960, v23
s_add_u32 m0, s51, 81920
v_mfma_f32_32x32x16_bf16 v[112:127], v[236:239], a[76:79], v[112:127]
ds_read_b64_tr_b16 v[230:231], v12 offset:27648
v_lshl_add_u32 v4, v22, 4, v23
v_add_u32 v22, 256, v0
buffer_load_dwordx4 v7, s[20:23], s50 offen lds
v_mfma_f32_32x32x16_bf16 v[64:79], v[240:243], a[80:83], v[64:79]
ds_read_b64_tr_b16 v[232:233], v13 offset:24576
v_mul_u32_u24 v23, 3277, v22
v_lshrrev_b32 v23, 16, v23
s_add_u32 s50, s50, 12288
v_mfma_f32_32x32x16_bf16 v[96:111], v[240:243], a[88:91], v[96:111]
ds_read_b64_tr_b16 v[234:235], v13 offset:25600
v_mul_u32_u24 v23, 960, v23
v_lshl_add_u32 v5, v22, 4, v23
s_add_u32 m0, s51, 86016
v_mfma_f32_32x32x16_bf16 v[64:79], v[244:247], a[84:87], v[64:79]
ds_read_b64_tr_b16 v[236:237], v13 offset:26624
s_mul_i32 s47, s3, 5120
s_mul_i32 s44, s4, 983040
buffer_load_dwordx4 v7, s[20:23], s50 offen lds
v_mfma_f32_32x32x16_bf16 v[96:111], v[244:247], a[92:95], v[96:111]
ds_read_b64_tr_b16 v[238:239], v13 offset:27648
s_mul_i32 s63, s3, 20480
s_add_u32 s44, s44, s63
s_add_u32 s50, s50, 12288
s_cmp_ge_u32 s50, 196608
s_cselect_b32 s50, 0, s50
s_waitcnt lgkmcnt(6)
v_mfma_f32_32x32x16_bf16 v[80:95], v[248:251], a[80:83], v[80:95]
ds_read_b64_tr_b16 v[240:241], v12 offset:28672
s_lshr_b32 s46, s4, 1
s_mul_i32 s46, s46, 491520
v_mfma_f32_32x32x16_bf16 v[112:127], v[248:251], a[88:91], v[112:127]
ds_read_b64_tr_b16 v[242:243], v12 offset:29696
s_add_u32 s46, s46, s63
s_mul_i32 s59, s7, 12288
s_add_u32 m0, s51, 90112
v_mfma_f32_32x32x16_bf16 v[80:95], v[252:255], a[84:87], v[80:95]
ds_read_b64_tr_b16 v[244:245], v12 offset:30720
s_add_u32 s60, s59, 4096
s_add_u32 s61, s59, 8192
buffer_load_dwordx4 v7, s[20:23], s50 offen lds
v_mfma_f32_32x32x16_bf16 v[112:127], v[252:255], a[92:95], v[112:127]
ds_read_b64_tr_b16 v[246:247], v12 offset:31744
s_lshl_b32 s95, s3, 2
s_add_u32 s95, s95, 67108864
s_add_u32 s50, s50, 12288
v_mfma_f32_32x32x16_bf16 v[64:79], v[224:227], a[96:99], v[64:79]
ds_read_b64_tr_b16 v[248:249], v13 offset:28672
s_lshl_b32 s63, s2, 7
s_add_u32 s63, s63, s95
s_add_u32 m0, s51, 94208
v_mfma_f32_32x32x16_bf16 v[96:111], v[224:227], a[104:107], v[96:111]
ds_read_b64_tr_b16 v[250:251], v13 offset:29696
v_mov_b32 v28, 1073741824
v_mov_b32 v29, s63
buffer_load_dwordx4 v7, s[20:23], s50 offen lds
s_waitcnt lgkmcnt(6)
v_mfma_f32_32x32x16_bf16 v[64:79], v[228:231], a[100:103], v[64:79]
ds_read_b64_tr_b16 v[252:253], v13 offset:30720
v_cmp_eq_u32 vcc, 0, v0
v_cndmask_b32 v28, v28, v29, vcc
s_add_u32 s50, s50, 12288
s_cmp_ge_u32 s50, 196608
s_cselect_b32 s50, 0, s50
v_mfma_f32_32x32x16_bf16 v[96:111], v[228:231], a[108:111], v[96:111]
ds_read_b64_tr_b16 v[254:255], v13 offset:31744
v_mfma_f32_32x32x16_bf16 v[80:95], v[232:235], a[96:99], v[80:95]
s_waitcnt vmcnt(12)
s_barrier
ds_read_b64_tr_b16 v[224:225], v12 offset:32768
v_mov_b32 v29, 2
buffer_store_dword v29, v28, s[12:15], 0 offen sc1
v_mfma_f32_32x32x16_bf16 v[112:127], v[232:235], a[104:107], v[112:127]
ds_read_b64_tr_b16 v[226:227], v12 offset:33792
s_add_u32 m0, s51, 98304
v_mfma_f32_32x32x16_bf16 v[80:95], v[236:239], a[100:103], v[80:95]
ds_read_b64_tr_b16 v[228:229], v12 offset:34816
buffer_load_dwordx4 v7, s[20:23], s50 offen lds
v_mfma_f32_32x32x16_bf16 v[112:127], v[236:239], a[108:111], v[112:127]
ds_read_b64_tr_b16 v[230:231], v12 offset:35840
s_waitcnt lgkmcnt(6)
v_mfma_f32_32x32x16_bf16 v[64:79], v[240:243], a[112:115], v[64:79]
ds_read_b64_tr_b16 v[232:233], v13 offset:32768
s_add_u32 s50, s50, 12288
v_mfma_f32_32x32x16_bf16 v[96:111], v[240:243], a[120:123], v[96:111]
ds_read_b64_tr_b16 v[234:235], v13 offset:33792
v_mfma_f32_32x32x16_bf16 v[64:79], v[244:247], a[116:119], v[64:79]
ds_read_b64_tr_b16 v[236:237], v13 offset:34816
s_add_u32 m0, s51, 102400
v_mfma_f32_32x32x16_bf16 v[96:111], v[244:247], a[124:127], v[96:111]
ds_read_b64_tr_b16 v[238:239], v13 offset:35840
v_mfma_f32_32x32x16_bf16 v[80:95], v[248:251], a[112:115], v[80:95]
ds_read_b64_tr_b16 v[240:241], v12 offset:36864
buffer_load_dword v57, v30, s[24:27], s48 offen offset:3072
buffer_load_dwordx4 v7, s[20:23], s50 offen lds
v_mfma_f32_32x32x16_bf16 v[112:127], v[248:251], a[120:123], v[112:127]
ds_read_b64_tr_b16 v[242:243], v12 offset:37888
s_add_u32 s50, s50, 12288
s_cmp_ge_u32 s50, 196608
s_cselect_b32 s50, 0, s50
s_waitcnt lgkmcnt(6)
v_mfma_f32_32x32x16_bf16 v[80:95], v[252:255], a[116:119], v[80:95]
ds_read_b64_tr_b16 v[244:245], v12 offset:38912
v_mfma_f32_32x32x16_bf16 v[112:127], v[252:255], a[124:127], v[112:127]
ds_read_b64_tr_b16 v[246:247], v12 offset:39936
s_add_u32 m0, s51, 106496
v_mfma_f32_32x32x16_bf16 v[64:79], v[224:227], a[128:131], v[64:79]
ds_read_b64_tr_b16 v[248:249], v13 offset:36864
v_mfma_f32_32x32x16_bf16 v[96:111], v[224:227], a[136:139], v[96:111]
ds_read_b64_tr_b16 v[250:251], v13 offset:37888
buffer_load_dwordx4 v7, s[20:23], s50 offen lds
v_mfma_f32_32x32x16_bf16 v[64:79], v[228:231], a[132:135], v[64:79]
ds_read_b64_tr_b16 v[252:253], v13 offset:38912
v_mfma_f32_32x32x16_bf16 v[96:111], v[228:231], a[140:143], v[96:111]
ds_read_b64_tr_b16 v[254:255], v13 offset:39936
s_add_u32 s50, s50, 12288
s_waitcnt lgkmcnt(6)
v_mfma_f32_32x32x16_bf16 v[80:95], v[232:235], a[128:131], v[80:95]
ds_read_b64_tr_b16 v[224:225], v12 offset:40960
s_add_u32 m0, s51, 110592
v_mfma_f32_32x32x16_bf16 v[112:127], v[232:235], a[136:139], v[112:127]
ds_read_b64_tr_b16 v[226:227], v12 offset:41984
v_mfma_f32_32x32x16_bf16 v[80:95], v[236:239], a[132:135], v[80:95]
ds_read_b64_tr_b16 v[228:229], v12 offset:43008
buffer_load_dwordx4 v7, s[20:23], s50 offen lds
v_mfma_f32_32x32x16_bf16 v[112:127], v[236:239], a[140:143], v[112:127]
ds_read_b64_tr_b16 v[230:231], v12 offset:44032
v_mfma_f32_32x32x16_bf16 v[64:79], v[240:243], a[144:147], v[64:79]
ds_read_b64_tr_b16 v[232:233], v13 offset:40960
s_add_u32 s50, s50, 12288
s_cmp_ge_u32 s50, 196608
s_cselect_b32 s50, 0, s50
v_mfma_f32_32x32x16_bf16 v[96:111], v[240:243], a[152:155], v[96:111]
ds_read_b64_tr_b16 v[234:235], v13 offset:41984
s_waitcnt lgkmcnt(6)
v_mfma_f32_32x32x16_bf16 v[64:79], v[244:247], a[148:151], v[64:79]
ds_read_b64_tr_b16 v[236:237], v13 offset:43008
s_add_u32 m0, s51, 114688
v_mfma_f32_32x32x16_bf16 v[96:111], v[244:247], a[156:159], v[96:111]
ds_read_b64_tr_b16 v[238:239], v13 offset:44032
buffer_load_dwordx4 v7, s[20:23], s50 offen lds
v_mfma_f32_32x32x16_bf16 v[80:95], v[248:251], a[144:147], v[80:95]
ds_read_b64_tr_b16 v[240:241], v12 offset:45056
v_mfma_f32_32x32x16_bf16 v[112:127], v[248:251], a[152:155], v[112:127]
ds_read_b64_tr_b16 v[242:243], v12 offset:46080
s_add_u32 s50, s50, 12288
v_mfma_f32_32x32x16_bf16 v[80:95], v[252:255], a[148:151], v[80:95]
ds_read_b64_tr_b16 v[244:245], v12 offset:47104
s_lshr_b32 s62, s2, 3
s_lshl_b32 s62, s62, 2
s_add_u32 s62, s62, s3
s_and_b32 s62, s62, 15
s_lshl_b32 s62, s62, 11
s_add_u32 s62, s62, 6144
v_lshl_add_u32 v22, v0, 5, s62
v_mfma_f32_32x32x16_bf16 v[112:127], v[252:255], a[156:159], v[112:127]
ds_read_b64_tr_b16 v[246:247], v12 offset:48128
s_add_u32 m0, s51, 118784
s_waitcnt lgkmcnt(6)
v_mfma_f32_32x32x16_bf16 v[64:79], v[224:227], a[160:163], v[64:79]
ds_read_b64_tr_b16 v[248:249], v13 offset:45056
v_min_u32 v22, RARE0-CP2, v22
v_mov_b32 v23, 0
v_mfma_f32_32x32x16_bf16 v[96:111], v[224:227], a[168:171], v[96:111]
ds_read_b64_tr_b16 v[250:251], v13 offset:46080
buffer_load_dwordx4 v7, s[20:23], s50 offen lds
v_mfma_f32_32x32x16_bf16 v[64:79], v[228:231], a[164:167], v[64:79]
ds_read_b64_tr_b16 v[252:253], v13 offset:47104
s_add_u32 s50, s50, 12288
s_cmp_ge_u32 s50, 196608
s_cselect_b32 s50, 0, s50
s_getpc_b64 s[62:63]
CP2:
v_lshl_add_u64 v[22:23], v[22:23], 0, s[62:63]
v_mfma_f32_32x32x16_bf16 v[96:111], v[228:231], a[172:175], v[96:111]
ds_read_b64_tr_b16 v[254:255], v13 offset:48128
v_mfma_f32_32x32x16_bf16 v[80:95], v[232:235], a[160:163], v[80:95]
ds_read_b64_tr_b16 v[224:225], v12 offset:49152
s_add_u32 m0, s51, 122880
global_load_dword v36, v[22:23], off
v_mfma_f32_32x32x16_bf16 v[112:127], v[232:235], a[168:171], v[112:127]
ds_read_b64_tr_b16 v[226:227], v12 offset:50176
s_waitcnt lgkmcnt(6)
v_mfma_f32_32x32x16_bf16 v[80:95], v[236:239], a[164:167], v[80:95]
ds_read_b64_tr_b16 v[228:229], v12 offset:51200
buffer_load_dwordx4 v7, s[20:23], s50 offen lds
v_mfma_f32_32x32x16_bf16 v[112:127], v[236:239], a[172:175], v[112:127]
ds_read_b64_tr_b16 v[230:231], v12 offset:52224
v_mfma_f32_32x32x16_bf16 v[64:79], v[240:243], a[176:179], v[64:79]
ds_read_b64_tr_b16 v[232:233], v13 offset:49152
s_add_u32 s50, s50, 12288
v_mfma_f32_32x32x16_bf16 v[96:111], v[240:243], a[184:187], v[96:111]
ds_read_b64_tr_b16 v[234:235], v13 offset:50176
s_add_u32 m0, s51, 126976
v_mfma_f32_32x32x16_bf16 v[64:79], v[244:247], a[180:183], v[64:79]
ds_read_b64_tr_b16 v[236:237], v13 offset:51200
v_mfma_f32_32x32x16_bf16 v[96:111], v[244:247], a[188:191], v[96:111]
ds_read_b64_tr_b16 v[238:239], v13 offset:52224
buffer_load_dwordx4 v7, s[20:23], s50 offen lds
s_waitcnt lgkmcnt(6)
v_mfma_f32_32x32x16_bf16 v[80:95], v[248:251], a[176:179], v[80:95]
ds_read_b64_tr_b16 v[240:241], v12 offset:53248
v_mfma_f32_32x32x16_bf16 v[112:127], v[248:251], a[184:187], v[112:127]
ds_read_b64_tr_b16 v[242:243], v12 offset:54272
s_add_u32 s50, s50, 12288
s_cmp_ge_u32 s50, 196608
s_cselect_b32 s50, 0, s50
v_mfma_f32_32x32x16_bf16 v[80:95], v[252:255], a[180:183], v[80:95]
ds_read_b64_tr_b16 v[244:245], v12 offset:55296
v_mfma_f32_32x32x16_bf16 v[112:127], v[252:255], a[188:191], v[112:127]
ds_read_b64_tr_b16 v[246:247], v12 offset:56320
v_mfma_f32_32x32x16_bf16 v[64:79], v[224:227], a[192:195], v[64:79]
ds_read_b64_tr_b16 v[248:249], v13 offset:53248
s_add_u32 m0, s47, 143360
v_mfma_f32_32x32x16_bf16 v[96:111], v[224:227], a[200:203], v[96:111]
ds_read_b64_tr_b16 v[250:251], v13 offset:54272
s_waitcnt lgkmcnt(6)
v_mfma_f32_32x32x16_bf16 v[64:79], v[228:231], a[196:199], v[64:79]
ds_read_b64_tr_b16 v[252:253], v13 offset:55296
buffer_load_dwordx4 v1, s[28:31], s46 offen lds
v_mfma_f32_32x32x16_bf16 v[96:111], v[228:231], a[204:207], v[96:111]
ds_read_b64_tr_b16 v[254:255], v13 offset:56320
v_mfma_f32_32x32x16_bf16 v[80:95], v[232:235], a[192:195], v[80:95]
ds_read_b64_tr_b16 v[224:225], v12 offset:57344
s_add_u32 m0, s47, 144384
v_mfma_f32_32x32x16_bf16 v[112:127], v[232:235], a[200:203], v[112:127]
ds_read_b64_tr_b16 v[226:227], v12 offset:58368
v_mfma_f32_32x32x16_bf16 v[80:95], v[236:239], a[196:199], v[80:95]
ds_read_b64_tr_b16 v[228:229], v12 offset:59392
buffer_load_dwordx4 v2, s[28:31], s46 offen lds
v_mfma_f32_32x32x16_bf16 v[112:127], v[236:239], a[204:207], v[112:127]
ds_read_b64_tr_b16 v[230:231], v12 offset:60416
s_waitcnt lgkmcnt(6)
v_mfma_f32_32x32x16_bf16 v[64:79], v[240:243], a[208:211], v[64:79]
ds_read_b64_tr_b16 v[232:233], v13 offset:57344
s_add_u32 m0, s47, 145408
v_mfma_f32_32x32x16_bf16 v[96:111], v[240:243], a[216:219], v[96:111]
ds_read_b64_tr_b16 v[234:235], v13 offset:58368
v_mfma_f32_32x32x16_bf16 v[64:79], v[244:247], a[212:215], v[64:79]
ds_read_b64_tr_b16 v[236:237], v13 offset:59392
buffer_load_dwordx4 v3, s[28:31], s46 offen lds
s_and_b32 s63, s2, 0xe0
v_and_b32 v24, 31, v0
v_add_u32 v24, s63, v24
v_lshlrev_b32 v24, 7, v24
buffer_load_dword v25, v24, s[12:15], s95 offen sc1
v_mfma_f32_32x32x16_bf16 v[96:111], v[244:247], a[220:223], v[96:111]
ds_read_b64_tr_b16 v[238:239], v13 offset:60416
v_mfma_f32_32x32x16_bf16 v[80:95], v[248:251], a[208:211], v[80:95]
ds_read_b64_tr_b16 v[240:241], v12 offset:61440
s_add_u32 m0, s47, 146432
v_mfma_f32_32x32x16_bf16 v[112:127], v[248:251], a[216:219], v[112:127]
ds_read_b64_tr_b16 v[242:243], v12 offset:62464
s_waitcnt lgkmcnt(6)
v_mfma_f32_32x32x16_bf16 v[80:95], v[252:255], a[212:215], v[80:95]
ds_read_b64_tr_b16 v[244:245], v12 offset:63488
buffer_load_dwordx4 v4, s[28:31], s46 offen lds
v_mfma_f32_32x32x16_bf16 v[112:127], v[252:255], a[220:223], v[112:127]
ds_read_b64_tr_b16 v[246:247], v12 offset:64512
v_mfma_f32_32x32x16_bf16 v[64:79], v[224:227], a[224:227], v[64:79]
ds_read_b64_tr_b16 v[248:249], v13 offset:61440
s_add_u32 m0, s47, 147456
v_mfma_f32_32x32x16_bf16 v[96:111], v[224:227], a[232:235], v[96:111]
ds_read_b64_tr_b16 v[250:251], v13 offset:62464
v_mfma_f32_32x32x16_bf16 v[64:79], v[228:231], a[228:231], v[64:79]
ds_read_b64_tr_b16 v[252:253], v13 offset:63488
buffer_load_dwordx4 v5, s[28:31], s46 offen lds
v_mfma_f32_32x32x16_bf16 v[96:111], v[228:231], a[236:239], v[96:111]
ds_read_b64_tr_b16 v[254:255], v13 offset:64512
s_waitcnt lgkmcnt(6)
v_mfma_f32_32x32x16_bf16 v[80:95], v[232:235], a[224:227], v[80:95]
s_waitcnt vmcnt(17)
s_barrier
v_xor_b32 v12, 0x10000, v12
ds_read_b64_tr_b16 v[224:225], v12 offset:0
v_mfma_f32_32x32x16_bf16 v[112:127], v[232:235], a[232:235], v[112:127]
ds_read_b64_tr_b16 v[226:227], v12 offset:1024
v_add_u32 v7, 128, v7
s_add_u32 m0, s51, 0
v_mfma_f32_32x32x16_bf16 v[80:95], v[236:239], a[228:231], v[80:95]
ds_read_b64_tr_b16 v[228:229], v12 offset:2048
v_mfma_f32_32x32x16_bf16 v[112:127], v[236:239], a[236:239], v[112:127]
ds_read_b64_tr_b16 v[230:231], v12 offset:3072
buffer_load_dwordx4 v7, s[20:23], s50 offen lds
v_mfma_f32_32x32x16_bf16 v[64:79], v[240:243], a[240:243], v[64:79]
v_xor_b32 v13, 0x10000, v13
ds_read_b64_tr_b16 v[232:233], v13 offset:0
v_mfma_f32_32x32x16_bf16 v[96:111], v[240:243], a[248:251], v[96:111]
ds_read_b64_tr_b16 v[234:235], v13 offset:1024
s_waitcnt lgkmcnt(6)
v_mfma_f32_32x32x16_bf16 v[64:79], v[244:247], a[244:247], v[64:79]
ds_read_b64_tr_b16 v[236:237], v13 offset:2048
s_add_u32 s50, s50, 12288
v_mfma_f32_32x32x16_bf16 v[96:111], v[244:247], a[252:255], v[96:111]
ds_read_b64_tr_b16 v[238:239], v13 offset:3072
v_mfma_f32_32x32x16_bf16 v[80:95], v[248:251], a[240:243], v[80:95]
ds_read_b64_tr_b16 v[240:241], v12 offset:4096
s_add_u32 m0, s51, 4096
v_mfma_f32_32x32x16_bf16 v[112:127], v[248:251], a[248:251], v[112:127]
ds_read_b64_tr_b16 v[242:243], v12 offset:5120
v_mfma_f32_32x32x16_bf16 v[80:95], v[252:255], a[244:247], v[80:95]
ds_read_b64_tr_b16 v[244:245], v12 offset:6144
v_mfma_f32_32x32x16_bf16 v[112:127], v[252:255], a[252:255], v[112:127]
ds_read_b64_tr_b16 v[246:247], v12 offset:7168
buffer_load_dwordx4 v7, s[20:23], s50 offen lds
s_waitcnt lgkmcnt(6)
v_mfma_f32_32x32x16_bf16 v[128:143], v[224:227], a[0:3], 0
ds_read_b64_tr_b16 v[248:249], v13 offset:4096
v_mfma_f32_32x32x16_bf16 v[160:175], v[224:227], a[8:11], 0
ds_read_b64_tr_b16 v[250:251], v13 offset:5120
v_mfma_f32_32x32x16_bf16 v[128:143], v[228:231], a[4:7], v[128:143]
ds_read_b64_tr_b16 v[252:253], v13 offset:6144
s_add_u32 s50, s50, 12288
s_cmp_ge_u32 s50, 196608
s_cselect_b32 s50, 0, s50
v_mfma_f32_32x32x16_bf16 v[160:175], v[228:231], a[12:15], v[160:175]
ds_read_b64_tr_b16 v[254:255], v13 offset:7168
v_mul_f32 v64, v64, v14
v_mul_f32 v65, v65, v14
v_mfma_f32_32x32x16_bf16 v[144:159], v[232:235], a[0:3], 0
ds_read_b64_tr_b16 v[224:225], v12 offset:8192
s_add_u32 m0, s51, 8192
v_mul_f32 v66, v66, v14
v_mfma_f32_32x32x16_bf16 v[176:191], v[232:235], a[8:11], 0
ds_read_b64_tr_b16 v[226:227], v12 offset:9216
v_mul_f32 v67, v67, v14
s_waitcnt lgkmcnt(6)
v_mfma_f32_32x32x16_bf16 v[144:159], v[236:239], a[4:7], v[144:159]
ds_read_b64_tr_b16 v[228:229], v12 offset:10240
v_cvt_pk_bf16_f32 v64, v64, v65
v_mfma_f32_32x32x16_bf16 v[176:191], v[236:239], a[12:15], v[176:191]
ds_read_b64_tr_b16 v[230:231], v12 offset:11264
buffer_load_dwordx4 v7, s[20:23], s50 offen lds
v_cvt_pk_bf16_f32 v65, v66, v67
v_mfma_f32_32x32x16_bf16 v[128:143], v[240:243], a[16:19], v[128:143]
ds_read_b64_tr_b16 v[232:233], v13 offset:8192
v_mul_f32 v68, v68, v14
v_mfma_f32_32x32x16_bf16 v[160:175], v[240:243], a[24:27], v[160:175]
ds_read_b64_tr_b16 v[234:235], v13 offset:9216
v_mul_f32 v69, v69, v14
v_mfma_f32_32x32x16_bf16 v[128:143], v[244:247], a[20:23], v[128:143]
ds_read_b64_tr_b16 v[236:237], v13 offset:10240
s_add_u32 s50, s50, 12288
v_mul_f32 v70, v70, v14
v_mul_f32 v71, v71, v14
v_mfma_f32_32x32x16_bf16 v[160:175], v[244:247], a[28:31], v[160:175]
ds_read_b64_tr_b16 v[238:239], v13 offset:11264
v_cvt_pk_bf16_f32 v66, v68, v69
s_waitcnt lgkmcnt(6)
v_mfma_f32_32x32x16_bf16 v[144:159], v[248:251], a[16:19], v[144:159]
ds_read_b64_tr_b16 v[240:241], v12 offset:12288
s_add_u32 m0, s51, 12288
v_cvt_pk_bf16_f32 v67, v70, v71
v_mfma_f32_32x32x16_bf16 v[176:191], v[248:251], a[24:27], v[176:191]
ds_read_b64_tr_b16 v[242:243], v12 offset:13312
buffer_store_dwordx4 v[64:67], v26, s[12:15], s59 offen offset:0 sc1
v_mfma_f32_32x32x16_bf16 v[144:159], v[252:255], a[20:23], v[144:159]
ds_read_b64_tr_b16 v[244:245], v12 offset:14336
v_mul_f32 v72, v72, v14
v_mfma_f32_32x32x16_bf16 v[176:191], v[252:255], a[28:31], v[176:191]
ds_read_b64_tr_b16 v[246:247], v12 offset:15360
buffer_load_dwordx4 v7, s[20:23], s50 offen lds
v_mul_f32 v73, v73, v14
v_mfma_f32_32x32x16_bf16 v[128:143], v[224:227], a[32:35], v[128:143]
ds_read_b64_tr_b16 v[248:249], v13 offset:12288
v_mul_f32 v74, v74, v14
v_mfma_f32_32x32x16_bf16 v[160:175], v[224:227], a[40:43], v[160:175]
ds_read_b64_tr_b16 v[250:251], v13 offset:13312
s_add_u32 s50, s50, 12288
s_cmp_ge_u32 s50, 196608
s_cselect_b32 s50, 0, s50
v_mul_f32 v75, v75, v14
v_cvt_pk_bf16_f32 v68, v72, v73
s_waitcnt lgkmcnt(6)
v_mfma_f32_32x32x16_bf16 v[128:143], v[228:231], a[36:39], v[128:143]
ds_read_b64_tr_b16 v[252:253], v13 offset:14336
v_cvt_pk_bf16_f32 v69, v74, v75
v_mfma_f32_32x32x16_bf16 v[160:175], v[228:231], a[44:47], v[160:175]
ds_read_b64_tr_b16 v[254:255], v13 offset:15360
v_mul_f32 v76, v76, v14
v_mfma_f32_32x32x16_bf16 v[144:159], v[232:235], a[32:35], v[144:159]
ds_read_b64_tr_b16 v[224:225], v12 offset:16384
s_add_u32 m0, s51, 16384
v_mul_f32 v77, v77, v14
v_mfma_f32_32x32x16_bf16 v[176:191], v[232:235], a[40:43], v[176:191]
ds_read_b64_tr_b16 v[226:227], v12 offset:17408
v_mul_f32 v78, v78, v14
v_mfma_f32_32x32x16_bf16 v[144:159], v[236:239], a[36:39], v[144:159]
ds_read_b64_tr_b16 v[228:229], v12 offset:18432
v_mul_f32 v79, v79, v14
v_mfma_f32_32x32x16_bf16 v[176:191], v[236:239], a[44:47], v[176:191]
ds_read_b64_tr_b16 v[230:231], v12 offset:19456
buffer_load_dwordx4 v7, s[20:23], s50 offen lds
v_cvt_pk_bf16_f32 v70, v76, v77
s_waitcnt lgkmcnt(6)
v_mfma_f32_32x32x16_bf16 v[128:143], v[240:243], a[48:51], v[128:143]
ds_read_b64_tr_b16 v[232:233], v13 offset:16384
v_cvt_pk_bf16_f32 v71, v78, v79
buffer_store_dwordx4 v[68:71], v26, s[12:15], s59 offen offset:1024 sc1
v_mfma_f32_32x32x16_bf16 v[160:175], v[240:243], a[56:59], v[160:175]
ds_read_b64_tr_b16 v[234:235], v13 offset:17408
s_add_u32 s50, s50, 12288
v_mul_f32 v80, v80, v14
v_mfma_f32_32x32x16_bf16 v[128:143], v[244:247], a[52:55], v[128:143]
ds_read_b64_tr_b16 v[236:237], v13 offset:18432
v_mul_f32 v81, v81, v14
v_mfma_f32_32x32x16_bf16 v[160:175], v[244:247], a[60:63], v[160:175]
ds_read_b64_tr_b16 v[238:239], v13 offset:19456
v_mul_f32 v82, v82, v14
v_mfma_f32_32x32x16_bf16 v[144:159], v[248:251], a[48:51], v[144:159]
ds_read_b64_tr_b16 v[240:241], v12 offset:20480
s_add_u32 m0, s51, 20480
v_mul_f32 v83, v83, v14
s_waitcnt vmcnt(9)
v_cmp_gt_u32 vcc, 2, v25
s_cbranch_vccnz SLOWH2
GOH2:
v_mfma_f32_32x32x16_bf16 v[176:191], v[248:251], a[56:59], v[176:191]
ds_read_b64_tr_b16 v[242:243], v12 offset:21504
v_cvt_pk_bf16_f32 v72, v80, v81
s_waitcnt lgkmcnt(6)
v_mfma_f32_32x32x16_bf16 v[144:159], v[252:255], a[52:55], v[144:159]
ds_read_b64_tr_b16 v[244:245], v12 offset:22528
v_cvt_pk_bf16_f32 v73, v82, v83
s_and_b32 s63, s4, 1
s_lshl_b32 s63, s63, 2
v_mfma_f32_32x32x16_bf16 v[176:191], v[252:255], a[60:63], v[176:191]
ds_read_b64_tr_b16 v[246:247], v12 offset:23552
buffer_load_dwordx4 v7, s[20:23], s50 offen lds
v_mul_f32 v84, v84, v14
v_mul_f32 v85, v85, v14
s_add_u32 s63, s63, s3
s_lshl_b32 s48, s6, 3
v_mfma_f32_32x32x16_bf16 v[128:143], v[224:227], a[64:67], v[128:143]
ds_read_b64_tr_b16 v[248:249], v13 offset:20480
v_mul_f32 v86, v86, v14
s_add_u32 s48, s48, s63
s_mul_i32 s48, s48, 98304
v_mfma_f32_32x32x16_bf16 v[160:175], v[224:227], a[72:75], v[160:175]
ds_read_b64_tr_b16 v[250:251], v13 offset:21504
s_add_u32 s50, s50, 12288
s_cmp_ge_u32 s50, 196608
s_cselect_b32 s50, 0, s50
v_mul_f32 v87, v87, v14
s_lshr_b32 s62, s4, 1
v_mfma_f32_32x32x16_bf16 v[128:143], v[228:231], a[68:71], v[128:143]
ds_read_b64_tr_b16 v[252:253], v13 offset:22528
v_cvt_pk_bf16_f32 v74, v84, v85
s_mul_i32 s93, s62, 24576
s_add_u32 s48, s48, s93
v_mfma_f32_32x32x16_bf16 v[160:175], v[228:231], a[76:79], v[160:175]
ds_read_b64_tr_b16 v[254:255], v13 offset:23552
v_cvt_pk_bf16_f32 v75, v86, v87
s_add_u32 s48, s48, 29360128
s_mul_i32 s93, s5, 6144
s_waitcnt lgkmcnt(6)
v_mfma_f32_32x32x16_bf16 v[144:159], v[232:235], a[64:67], v[144:159]
ds_read_b64_tr_b16 v[224:225], v12 offset:24576
s_add_u32 m0, s51, 24576
buffer_store_dwordx4 v[72:75], v26, s[12:15], s59 offen offset:2048 sc1
s_add_u32 s93, s93, s48
v_mfma_f32_32x32x16_bf16 v[176:191], v[232:235], a[72:75], v[176:191]
ds_read_b64_tr_b16 v[226:227], v12 offset:25600
v_mul_f32 v88, v88, v14
buffer_load_dword v58, v30, s[12:15], s93 offen offset:0 sc1
v_mfma_f32_32x32x16_bf16 v[144:159], v[236:239], a[68:71], v[144:159]
ds_read_b64_tr_b16 v[228:229], v12 offset:26624
buffer_load_dwordx4 v7, s[20:23], s50 offen lds
v_mul_f32 v89, v89, v14
v_mul_f32 v90, v90, v14
v_mfma_f32_32x32x16_bf16 v[176:191], v[236:239], a[76:79], v[176:191]
ds_read_b64_tr_b16 v[230:231], v12 offset:27648
v_mul_f32 v91, v91, v14
v_mfma_f32_32x32x16_bf16 v[128:143], v[240:243], a[80:83], v[128:143]
ds_read_b64_tr_b16 v[232:233], v13 offset:24576
v_cvt_pk_bf16_f32 v76, v88, v89
v_mfma_f32_32x32x16_bf16 v[160:175], v[240:243], a[88:91], v[160:175]
ds_read_b64_tr_b16 v[234:235], v13 offset:25600
s_add_u32 s50, s50, 12288
v_cvt_pk_bf16_f32 v77, v90, v91
s_waitcnt lgkmcnt(6)
v_mfma_f32_32x32x16_bf16 v[128:143], v[244:247], a[84:87], v[128:143]
ds_read_b64_tr_b16 v[236:237], v13 offset:26624
v_mul_f32 v92, v92, v14
v_mfma_f32_32x32x16_bf16 v[160:175], v[244:247], a[92:95], v[160:175]
ds_read_b64_tr_b16 v[238:239], v13 offset:27648
v_mul_f32 v93, v93, v14
v_mfma_f32_32x32x16_bf16 v[144:159], v[248:251], a[80:83], v[144:159]
ds_read_b64_tr_b16 v[240:241], v12 offset:28672
s_add_u32 m0, s51, 28672
v_mul_f32 v94, v94, v14
v_mfma_f32_32x32x16_bf16 v[176:191], v[248:251], a[88:91], v[176:191]
ds_read_b64_tr_b16 v[242:243], v12 offset:29696
v_mul_f32 v95, v95, v14
v_cvt_pk_bf16_f32 v78, v92, v93
v_mfma_f32_32x32x16_bf16 v[144:159], v[252:255], a[84:87], v[144:159]
ds_read_b64_tr_b16 v[244:245], v12 offset:30720
buffer_load_dwordx4 v7, s[20:23], s50 offen lds
v_cvt_pk_bf16_f32 v79, v94, v95
v_mfma_f32_32x32x16_bf16 v[176:191], v[252:255], a[92:95], v[176:191]
ds_read_b64_tr_b16 v[246:247], v12 offset:31744
buffer_store_dwordx4 v[76:79], v26, s[12:15], s59 offen offset:3072 sc1
s_waitcnt lgkmcnt(6)
v_mfma_f32_32x32x16_bf16 v[128:143], v[224:227], a[96:99], v[128:143]
ds_read_b64_tr_b16 v[248:249], v13 offset:28672
v_mul_f32 v96, v96, v15
v_mfma_f32_32x32x16_bf16 v[160:175], v[224:227], a[104:107], v[160:175]
ds_read_b64_tr_b16 v[250:251], v13 offset:29696
s_add_u32 s50, s50, 12288
s_cmp_ge_u32 s50, 196608
s_cselect_b32 s50, 0, s50
v_mul_f32 v97, v97, v15
v_mfma_f32_32x32x16_bf16 v[128:143], v[228:231], a[100:103], v[128:143]
ds_read_b64_tr_b16 v[252:253], v13 offset:30720
v_mul_f32 v98, v98, v15
v_mfma_f32_32x32x16_bf16 v[160:175], v[228:231], a[108:111], v[160:175]
ds_read_b64_tr_b16 v[254:255], v13 offset:31744
v_mul_f32 v99, v99, v15
buffer_load_dword v59, v30, s[12:15], s93 offen offset:1024 sc1
v_mfma_f32_32x32x16_bf16 v[144:159], v[232:235], a[96:99], v[144:159]
s_barrier
ds_read_b64_tr_b16 v[224:225], v12 offset:32768
v_cvt_pk_bf16_f32 v80, v96, v97
v_cvt_pk_bf16_f32 v81, v98, v99
v_mfma_f32_32x32x16_bf16 v[176:191], v[232:235], a[104:107], v[176:191]
ds_read_b64_tr_b16 v[226:227], v12 offset:33792
s_add_u32 m0, s51, 32768
v_mul_f32 v100, v100, v15
s_waitcnt lgkmcnt(6)
v_mfma_f32_32x32x16_bf16 v[144:159], v[236:239], a[100:103], v[144:159]
ds_read_b64_tr_b16 v[228:229], v12 offset:34816
v_mul_f32 v101, v101, v15
v_mfma_f32_32x32x16_bf16 v[176:191], v[236:239], a[108:111], v[176:191]
ds_read_b64_tr_b16 v[230:231], v12 offset:35840
buffer_load_dwordx4 v7, s[20:23], s50 offen lds
v_mul_f32 v102, v102, v15
v_mfma_f32_32x32x16_bf16 v[128:143], v[240:243], a[112:115], v[128:143]
ds_read_b64_tr_b16 v[232:233], v13 offset:32768
v_mul_f32 v103, v103, v15
v_mfma_f32_32x32x16_bf16 v[160:175], v[240:243], a[120:123], v[160:175]
ds_read_b64_tr_b16 v[234:235], v13 offset:33792
v_cvt_pk_bf16_f32 v82, v100, v101
v_mfma_f32_32x32x16_bf16 v[128:143], v[244:247], a[116:119], v[128:143]
ds_read_b64_tr_b16 v[236:237], v13 offset:34816
s_add_u32 s50, s50, 12288
v_cvt_pk_bf16_f32 v83, v102, v103
v_mfma_f32_32x32x16_bf16 v[160:175], v[244:247], a[124:127], v[160:175]
ds_read_b64_tr_b16 v[238:239], v13 offset:35840
buffer_store_dwordx4 v[80:83], v27, s[12:15], s59 offen offset:0 sc1
v_mul_f32 v104, v104, v15
s_waitcnt lgkmcnt(6)
v_mfma_f32_32x32x16_bf16 v[144:159], v[248:251], a[112:115], v[144:159]
ds_read_b64_tr_b16 v[240:241], v12 offset:36864
s_add_u32 m0, s51, 36864
v_mul_f32 v105, v105, v15
v_mfma_f32_32x32x16_bf16 v[176:191], v[248:251], a[120:123], v[176:191]
ds_read_b64_tr_b16 v[242:243], v12 offset:37888
v_mul_f32 v106, v106, v15
v_mfma_f32_32x32x16_bf16 v[144:159], v[252:255], a[116:119], v[144:159]
ds_read_b64_tr_b16 v[244:245], v12 offset:38912
v_mul_f32 v107, v107, v15
v_mfma_f32_32x32x16_bf16 v[176:191], v[252:255], a[124:127], v[176:191]
ds_read_b64_tr_b16 v[246:247], v12 offset:39936
buffer_load_dwordx4 v7, s[20:23], s50 offen lds
v_cvt_pk_bf16_f32 v84, v104, v105
v_mfma_f32_32x32x16_bf16 v[128:143], v[224:227], a[128:131], v[128:143]
ds_read_b64_tr_b16 v[248:249], v13 offset:36864
v_cvt_pk_bf16_f32 v85, v106, v107
v_mfma_f32_32x32x16_bf16 v[160:175], v[224:227], a[136:139], v[160:175]
ds_read_b64_tr_b16 v[250:251], v13 offset:37888
v_mul_f32 v108, v108, v15
buffer_load_dword v60, v30, s[12:15], s93 offen offset:2048 sc1
s_waitcnt lgkmcnt(6)
v_mfma_f32_32x32x16_bf16 v[128:143], v[228:231], a[132:135], v[128:143]
ds_read_b64_tr_b16 v[252:253], v13 offset:38912
s_add_u32 s50, s50, 12288
s_cmp_ge_u32 s50, 196608
s_cselect_b32 s50, 0, s50
v_mul_f32 v109, v109, v15
v_mul_f32 v110, v110, v15
v_mfma_f32_32x32x16_bf16 v[160:175], v[228:231], a[140:143], v[160:175]
ds_read_b64_tr_b16 v[254:255], v13 offset:39936
v_mul_f32 v111, v111, v15
v_mfma_f32_32x32x16_bf16 v[144:159], v[232:235], a[128:131], v[144:159]
ds_read_b64_tr_b16 v[224:225], v12 offset:40960
s_add_u32 m0, s51, 40960
v_cvt_pk_bf16_f32 v86, v108, v109
v_mfma_f32_32x32x16_bf16 v[176:191], v[232:235], a[136:139], v[176:191]
ds_read_b64_tr_b16 v[226:227], v12 offset:41984
v_cvt_pk_bf16_f32 v87, v110, v111
v_mfma_f32_32x32x16_bf16 v[144:159], v[236:239], a[132:135], v[144:159]
ds_read_b64_tr_b16 v[228:229], v12 offset:43008
buffer_store_dwordx4 v[84:87], v27, s[12:15], s59 offen offset:1024 sc1
v_mfma_f32_32x32x16_bf16 v[176:191], v[236:239], a[140:143], v[176:191]
ds_read_b64_tr_b16 v[230:231], v12 offset:44032
buffer_load_dwordx4 v7, s[20:23], s50 offen lds
v_mul_f32 v112, v112, v15
s_waitcnt lgkmcnt(6)
v_mfma_f32_32x32x16_bf16 v[128:143], v[240:243], a[144:147], v[128:143]
ds_read_b64_tr_b16 v[232:233], v13 offset:40960
v_mul_f32 v113, v113, v15
v_mfma_f32_32x32x16_bf16 v[160:175], v[240:243], a[152:155], v[160:175]
ds_read_b64_tr_b16 v[234:235], v13 offset:41984
v_mul_f32 v114, v114, v15
v_mul_f32 v115, v115, v15
v_mfma_f32_32x32x16_bf16 v[128:143], v[244:247], a[148:151], v[128:143]
ds_read_b64_tr_b16 v[236:237], v13 offset:43008
s_add_u32 s50, s50, 12288
v_cvt_pk_bf16_f32 v88, v112, v113
v_mfma_f32_32x32x16_bf16 v[160:175], v[244:247], a[156:159], v[160:175]
ds_read_b64_tr_b16 v[238:239], v13 offset:44032
v_cvt_pk_bf16_f32 v89, v114, v115
v_mfma_f32_32x32x16_bf16 v[144:159], v[248:251], a[144:147], v[144:159]
ds_read_b64_tr_b16 v[240:241], v12 offset:45056
s_add_u32 m0, s51, 45056
v_mul_f32 v116, v116, v15
v_mfma_f32_32x32x16_bf16 v[176:191], v[248:251], a[152:155], v[176:191]
ds_read_b64_tr_b16 v[242:243], v12 offset:46080
v_mul_f32 v117, v117, v15
s_waitcnt lgkmcnt(6)
v_mfma_f32_32x32x16_bf16 v[144:159], v[252:255], a[148:151], v[144:159]
ds_read_b64_tr_b16 v[244:245], v12 offset:47104
v_mul_f32 v118, v118, v15
v_mfma_f32_32x32x16_bf16 v[176:191], v[252:255], a[156:159], v[176:191]
ds_read_b64_tr_b16 v[246:247], v12 offset:48128
buffer_load_dwordx4 v7, s[20:23], s50 offen lds
v_mul_f32 v119, v119, v15
buffer_load_dword v61, v30, s[12:15], s93 offen offset:3072 sc1
s_add_u32 s93, s93, 4096
v_mfma_f32_32x32x16_bf16 v[128:143], v[224:227], a[160:163], v[128:143]
ds_read_b64_tr_b16 v[248:249], v13 offset:45056
v_cvt_pk_bf16_f32 v90, v116, v117
v_cvt_pk_bf16_f32 v91, v118, v119
v_mfma_f32_32x32x16_bf16 v[160:175], v[224:227], a[168:171], v[160:175]
ds_read_b64_tr_b16 v[250:251], v13 offset:46080
s_add_u32 s50, s50, 12288
s_cmp_ge_u32 s50, 196608
s_cselect_b32 s50, 0, s50
buffer_store_dwordx4 v[88:91], v27, s[12:15], s59 offen offset:2048 sc1
v_mfma_f32_32x32x16_bf16 v[128:143], v[228:231], a[164:167], v[128:143]
ds_read_b64_tr_b16 v[252:253], v13 offset:47104
v_mul_f32 v120, v120, v15
v_mfma_f32_32x32x16_bf16 v[160:175], v[228:231], a[172:175], v[160:175]
ds_read_b64_tr_b16 v[254:255], v13 offset:48128
v_mul_f32 v121, v121, v15
s_waitcnt lgkmcnt(6)
v_mfma_f32_32x32x16_bf16 v[144:159], v[232:235], a[160:163], v[144:159]
ds_read_b64_tr_b16 v[224:225], v12 offset:49152
s_add_u32 m0, s51, 49152
v_mul_f32 v122, v122, v15
v_mfma_f32_32x32x16_bf16 v[176:191], v[232:235], a[168:171], v[176:191]
ds_read_b64_tr_b16 v[226:227], v12 offset:50176
v_mul_f32 v123, v123, v15
v_mfma_f32_32x32x16_bf16 v[144:159], v[236:239], a[164:167], v[144:159]
ds_read_b64_tr_b16 v[228:229], v12 offset:51200
v_cvt_pk_bf16_f32 v92, v120, v121
v_mfma_f32_32x32x16_bf16 v[176:191], v[236:239], a[172:175], v[176:191]
ds_read_b64_tr_b16 v[230:231], v12 offset:52224
buffer_load_dwordx4 v7, s[20:23], s50 offen lds
v_cvt_pk_bf16_f32 v93, v122, v123
v_mul_f32 v124, v124, v15
v_mfma_f32_32x32x16_bf16 v[128:143], v[240:243], a[176:179], v[128:143]
ds_read_b64_tr_b16 v[232:233], v13 offset:49152
v_mul_f32 v125, v125, v15
v_mfma_f32_32x32x16_bf16 v[160:175], v[240:243], a[184:187], v[160:175]
ds_read_b64_tr_b16 v[234:235], v13 offset:50176
s_add_u32 s50, s50, 12288
v_mul_f32 v126, v126, v15
s_waitcnt lgkmcnt(6)
v_mfma_f32_32x32x16_bf16 v[128:143], v[244:247], a[180:183], v[128:143]
ds_read_b64_tr_b16 v[236:237], v13 offset:51200
v_mul_f32 v127, v127, v15
v_mfma_f32_32x32x16_bf16 v[160:175], v[244:247], a[188:191], v[160:175]
ds_read_b64_tr_b16 v[238:239], v13 offset:52224
v_cvt_pk_bf16_f32 v94, v124, v125
v_mfma_f32_32x32x16_bf16 v[144:159], v[248:251], a[176:179], v[144:159]
ds_read_b64_tr_b16 v[240:241], v12 offset:53248
s_add_u32 m0, s51, 53248
v_cvt_pk_bf16_f32 v95, v126, v127
v_mfma_f32_32x32x16_bf16 v[176:191], v[248:251], a[184:187], v[176:191]
ds_read_b64_tr_b16 v[242:243], v12 offset:54272
buffer_store_dwordx4 v[92:95], v27, s[12:15], s59 offen offset:3072 sc1
buffer_load_dword v62, v30, s[12:15], s93 offen offset:0 sc1
v_mfma_f32_32x32x16_bf16 v[144:159], v[252:255], a[180:183], v[144:159]
ds_read_b64_tr_b16 v[244:245], v12 offset:55296
v_mfma_f32_32x32x16_bf16 v[176:191], v[252:255], a[188:191], v[176:191]
ds_read_b64_tr_b16 v[246:247], v12 offset:56320
buffer_load_dwordx4 v7, s[20:23], s50 offen lds
s_waitcnt lgkmcnt(6)
v_mfma_f32_32x32x16_bf16 v[128:143], v[224:227], a[192:195], v[128:143]
ds_read_b64_tr_b16 v[248:249], v13 offset:53248
v_mfma_f32_32x32x16_bf16 v[160:175], v[224:227], a[200:203], v[160:175]
ds_read_b64_tr_b16 v[250:251], v13 offset:54272
s_add_u32 s50, s50, 12288
s_cmp_ge_u32 s50, 196608
s_cselect_b32 s50, 0, s50
v_mfma_f32_32x32x16_bf16 v[128:143], v[228:231], a[196:199], v[128:143]
ds_read_b64_tr_b16 v[252:253], v13 offset:55296
v_mfma_f32_32x32x16_bf16 v[160:175], v[228:231], a[204:207], v[160:175]
ds_read_b64_tr_b16 v[254:255], v13 offset:56320
v_mfma_f32_32x32x16_bf16 v[144:159], v[232:235], a[192:195], v[144:159]
ds_read_b64_tr_b16 v[224:225], v12 offset:57344
s_add_u32 m0, s51, 57344
v_mfma_f32_32x32x16_bf16 v[176:191], v[232:235], a[200:203], v[176:191]
ds_read_b64_tr_b16 v[226:227], v12 offset:58368
s_waitcnt lgkmcnt(6)
v_mfma_f32_32x32x16_bf16 v[144:159], v[236:239], a[196:199], v[144:159]
ds_read_b64_tr_b16 v[228:229], v12 offset:59392
buffer_load_dwordx4 v7, s[20:23], s50 offen lds
v_mfma_f32_32x32x16_bf16 v[176:191], v[236:239], a[204:207], v[176:191]
ds_read_b64_tr_b16 v[230:231], v12 offset:60416
v_mfma_f32_32x32x16_bf16 v[128:143], v[240:243], a[208:211], v[128:143]
ds_read_b64_tr_b16 v[232:233], v13 offset:57344
v_mfma_f32_32x32x16_bf16 v[160:175], v[240:243], a[216:219], v[160:175]
ds_read_b64_tr_b16 v[234:235], v13 offset:58368
s_add_u32 s50, s50, 12288
v_mfma_f32_32x32x16_bf16 v[128:143], v[244:247], a[212:215], v[128:143]
ds_read_b64_tr_b16 v[236:237], v13 offset:59392
v_mfma_f32_32x32x16_bf16 v[160:175], v[244:247], a[220:223], v[160:175]
ds_read_b64_tr_b16 v[238:239], v13 offset:60416
buffer_load_dword v63, v30, s[12:15], s93 offen offset:1024 sc1
s_waitcnt lgkmcnt(6)
v_mfma_f32_32x32x16_bf16 v[144:159], v[248:251], a[208:211], v[144:159]
ds_read_b64_tr_b16 v[240:241], v12 offset:61440
s_add_u32 m0, s51, 61440
v_mfma_f32_32x32x16_bf16 v[176:191], v[248:251], a[216:219], v[176:191]
ds_read_b64_tr_b16 v[242:243], v12 offset:62464
v_mfma_f32_32x32x16_bf16 v[144:159], v[252:255], a[212:215], v[144:159]
ds_read_b64_tr_b16 v[244:245], v12 offset:63488
buffer_load_dwordx4 v7, s[20:23], s50 offen lds
v_mfma_f32_32x32x16_bf16 v[176:191], v[252:255], a[220:223], v[176:191]
ds_read_b64_tr_b16 v[246:247], v12 offset:64512
v_mfma_f32_32x32x16_bf16 v[128:143], v[224:227], a[224:227], v[128:143]
ds_read_b64_tr_b16 v[248:249], v13 offset:61440
v_mfma_f32_32x32x16_bf16 v[160:175], v[224:227], a[232:235], v[160:175]
ds_read_b64_tr_b16 v[250:251], v13 offset:62464
s_add_u32 s50, s50, 12288
s_cmp_ge_u32 s50, 196608
s_cselect_b32 s50, 0, s50
s_waitcnt lgkmcnt(6)
v_mfma_f32_32x32x16_bf16 v[128:143], v[228:231], a[228:231], v[128:143]
ds_read_b64_tr_b16 v[252:253], v13 offset:63488
v_mfma_f32_32x32x16_bf16 v[160:175], v[228:231], a[236:239], v[160:175]
ds_read_b64_tr_b16 v[254:255], v13 offset:64512
v_mfma_f32_32x32x16_bf16 v[144:159], v[232:235], a[224:227], v[144:159]
s_waitcnt vmcnt(18)
s_waitcnt lgkmcnt(0)
s_barrier
v_xor_b32 v12, 0x10000, v12
ds_read_b64_tr_b16 v[224:225], v12 offset:0
v_mfma_f32_32x32x16_bf16 v[176:191], v[232:235], a[232:235], v[176:191]
ds_read_b64_tr_b16 v[226:227], v12 offset:1024
s_add_u32 s46, s46, 81920
s_add_u32 m0, s47, 81920
v_mfma_f32_32x32x16_bf16 v[144:159], v[236:239], a[228:231], v[144:159]
ds_read_b64_tr_b16 v[228:229], v12 offset:2048
s_and_b32 s63, s4, 1
s_lshl_b32 s63, s63, 2
v_mfma_f32_32x32x16_bf16 v[176:191], v[236:239], a[236:239], v[176:191]
ds_read_b64_tr_b16 v[230:231], v12 offset:3072
buffer_load_dwordx4 v1, s[28:31], s46 offen lds
s_add_u32 s63, s63, s3
v_mfma_f32_32x32x16_bf16 v[128:143], v[240:243], a[240:243], v[128:143]
v_xor_b32 v13, 0x10000, v13
ds_read_b64_tr_b16 v[232:233], v13 offset:0
s_lshr_b32 s49, s4, 1
v_mfma_f32_32x32x16_bf16 v[160:175], v[240:243], a[248:251], v[160:175]
ds_read_b64_tr_b16 v[234:235], v13 offset:1024
s_add_u32 m0, s47, 82944
s_lshr_b32 s90, s2, 3
v_mfma_f32_32x32x16_bf16 v[128:143], v[244:247], a[244:247], v[128:143]
ds_read_b64_tr_b16 v[236:237], v13 offset:2048
s_mul_i32 s90, s90, 983040
v_mfma_f32_32x32x16_bf16 v[160:175], v[244:247], a[252:255], v[160:175]
ds_read_b64_tr_b16 v[238:239], v13 offset:3072
buffer_load_dwordx4 v2, s[28:31], s46 offen lds
s_add_u32 s90, s90, 35651584
v_mfma_f32_32x32x16_bf16 v[144:159], v[248:251], a[240:243], v[144:159]
ds_read_b64_tr_b16 v[240:241], v12 offset:4096
s_mul_i32 s63, s63, 12
s_add_u32 s63, s63, s49
v_mfma_f32_32x32x16_bf16 v[176:191], v[248:251], a[248:251], v[176:191]
ds_read_b64_tr_b16 v[242:243], v12 offset:5120
s_add_u32 m0, s47, 83968
s_add_u32 s63, s63, 8
v_mfma_f32_32x32x16_bf16 v[144:159], v[252:255], a[244:247], v[144:159]
ds_read_b64_tr_b16 v[244:245], v12 offset:6144
s_mul_i32 s63, s63, 10240
v_mfma_f32_32x32x16_bf16 v[176:191], v[252:255], a[252:255], v[176:191]
ds_read_b64_tr_b16 v[246:247], v12 offset:7168
buffer_load_dwordx4 v3, s[28:31], s46 offen lds
s_add_u32 s63, s63, s90
s_waitcnt lgkmcnt(6)
v_mfma_f32_32x32x16_bf16 v[96:111], v[224:227], a[0:3], 0
ds_read_b64_tr_b16 v[248:249], v13 offset:4096
v_add_u32 v10, s63, v30
v_mfma_f32_32x32x16_bf16 v[192:207], v[224:227], a[8:11], 0
ds_read_b64_tr_b16 v[250:251], v13 offset:5120
s_add_u32 m0, s47, 84992
s_add_u32 s49, s5, 1
v_mfma_f32_32x32x16_bf16 v[96:111], v[228:231], a[4:7], v[96:111]
ds_read_b64_tr_b16 v[252:253], v13 offset:6144
s_and_b32 s49, s49, 3
v_mfma_f32_32x32x16_bf16 v[192:207], v[228:231], a[12:15], v[192:207]
ds_read_b64_tr_b16 v[254:255], v13 offset:7168
buffer_load_dwordx4 v4, s[28:31], s46 offen lds
v_mul_f32 v128, v128, v14
v_mul_f32 v129, v129, v14
s_lshl_b32 s63, s4, 2
s_add_u32 s49, s49, s63
v_mfma_f32_32x32x16_bf16 v[112:127], v[232:235], a[0:3], 0
ds_read_b64_tr_b16 v[224:225], v12 offset:8192
v_mul_f32 v130, v130, v14
s_mul_i32 s49, s49, 12288
v_mfma_f32_32x32x16_bf16 v[208:223], v[232:235], a[8:11], 0
ds_read_b64_tr_b16 v[226:227], v12 offset:9216
s_add_u32 m0, s47, 86016
v_mul_f32 v131, v131, v14
s_waitcnt vmcnt(9)
v_mov_b32 v29, 3
buffer_store_dword v29, v28, s[12:15], 0 offen sc1
s_add_u32 s51, s5, 2
s_waitcnt lgkmcnt(6)
v_mfma_f32_32x32x16_bf16 v[112:127], v[236:239], a[4:7], v[112:127]
ds_read_b64_tr_b16 v[228:229], v12 offset:10240
v_cvt_pk_bf16_f32 v128, v128, v129
s_and_b32 s51, s51, 3
v_mfma_f32_32x32x16_bf16 v[208:223], v[236:239], a[12:15], v[208:223]
ds_read_b64_tr_b16 v[230:231], v12 offset:11264
buffer_load_dwordx4 v5, s[28:31], s46 offen lds
v_cvt_pk_bf16_f32 v129, v130, v131
s_lshl_b32 s63, s4, 2
v_mfma_f32_32x32x16_bf16 v[96:111], v[240:243], a[16:19], v[96:111]
ds_read_b64_tr_b16 v[232:233], v13 offset:8192
v_mul_f32 v132, v132, v14
s_add_u32 s51, s51, s63
v_mfma_f32_32x32x16_bf16 v[192:207], v[240:243], a[24:27], v[192:207]
ds_read_b64_tr_b16 v[234:235], v13 offset:9216
v_mul_f32 v133, v133, v14
s_mul_i32 s51, s51, 12288
v_mfma_f32_32x32x16_bf16 v[96:111], v[244:247], a[20:23], v[96:111]
ds_read_b64_tr_b16 v[236:237], v13 offset:10240
s_add_u32 s46, s46, 81920
s_add_u32 m0, s47, 102400
v_mul_f32 v134, v134, v14
v_mul_f32 v135, v135, v14
s_add_u32 s58, s5, 3
s_and_b32 s58, s58, 3
v_mfma_f32_32x32x16_bf16 v[192:207], v[244:247], a[28:31], v[192:207]
ds_read_b64_tr_b16 v[238:239], v13 offset:11264
v_cvt_pk_bf16_f32 v130, v132, v133
s_lshl_b32 s63, s4, 2
s_waitcnt lgkmcnt(6)
v_mfma_f32_32x32x16_bf16 v[112:127], v[248:251], a[16:19], v[112:127]
ds_read_b64_tr_b16 v[240:241], v12 offset:12288
buffer_load_dwordx4 v1, s[28:31], s46 offen lds
v_cvt_pk_bf16_f32 v131, v134, v135
s_add_u32 s58, s58, s63
v_mfma_f32_32x32x16_bf16 v[208:223], v[248:251], a[24:27], v[208:223]
ds_read_b64_tr_b16 v[242:243], v12 offset:13312
buffer_store_dwordx4 v[128:131], v26, s[12:15], s60 offen offset:0 sc1
s_mul_i32 s58, s58, 12288
v_mfma_f32_32x32x16_bf16 v[112:127], v[252:255], a[20:23], v[112:127]
ds_read_b64_tr_b16 v[244:245], v12 offset:14336
s_add_u32 m0, s47, 103424
v_mul_f32 v136, v136, v14
s_mul_i32 s63, s4, 122880
v_mfma_f32_32x32x16_bf16 v[208:223], v[252:255], a[28:31], v[208:223]
ds_read_b64_tr_b16 v[246:247], v12 offset:15360
v_mul_f32 v137, v137, v14
s_add_u32 s50, s90, s63
v_mfma_f32_32x32x16_bf16 v[96:111], v[224:227], a[32:35], v[96:111]
ds_read_b64_tr_b16 v[248:249], v13 offset:12288
buffer_load_dwordx4 v2, s[28:31], s46 offen lds
v_mul_f32 v138, v138, v14
s_lshl_b32 s63, s3, 9
v_mfma_f32_32x32x16_bf16 v[192:207], v[224:227], a[40:43], v[192:207]
ds_read_b64_tr_b16 v[250:251], v13 offset:13312
v_mul_f32 v139, v139, v14
v_cvt_pk_bf16_f32 v132, v136, v137
s_add_u32 s50, s50, s63
v_and_b32 v6, 31, v0
s_waitcnt lgkmcnt(6)
v_mfma_f32_32x32x16_bf16 v[96:111], v[228:231], a[36:39], v[96:111]
ds_read_b64_tr_b16 v[252:253], v13 offset:14336
s_add_u32 m0, s47, 104448
v_cvt_pk_bf16_f32 v133, v138, v139
v_lshrrev_b32 v7, 5, v0
v_mfma_f32_32x32x16_bf16 v[192:207], v[228:231], a[44:47], v[192:207]
ds_read_b64_tr_b16 v[254:255], v13 offset:15360
v_mul_f32 v140, v140, v14
v_mul_u32_u24 v11, 10240, v7
v_mfma_f32_32x32x16_bf16 v[112:127], v[232:235], a[32:35], v[112:127]
ds_read_b64_tr_b16 v[224:225], v12 offset:16384
buffer_load_dwordx4 v3, s[28:31], s46 offen lds
v_mul_f32 v141, v141, v14
buffer_load_dwordx4 a[0:3], v30, s[12:15], s48 offen offset:0 sc1
v_lshl_add_u32 v11, v6, 4, v11
v_mfma_f32_32x32x16_bf16 v[208:223], v[232:235], a[40:43], v[208:223]
ds_read_b64_tr_b16 v[226:227], v12 offset:17408
v_mul_f32 v142, v142, v14
v_lshlrev_b32 v7, 3, v7
v_mfma_f32_32x32x16_bf16 v[112:127], v[236:239], a[36:39], v[112:127]
ds_read_b64_tr_b16 v[228:229], v12 offset:18432
s_add_u32 m0, s47, 105472
v_mul_f32 v143, v143, v14
s_mul_i32 s53, s5, 320
v_mfma_f32_32x32x16_bf16 v[208:223], v[236:239], a[44:47], v[208:223]
ds_read_b64_tr_b16 v[230:231], v12 offset:19456
v_cvt_pk_bf16_f32 v134, v140, v141
s_lshl_b32 s63, s3, 4
s_waitcnt lgkmcnt(6)
v_mfma_f32_32x32x16_bf16 v[96:111], v[240:243], a[48:51], v[96:111]
ds_read_b64_tr_b16 v[232:233], v13 offset:16384
buffer_load_dwordx4 v4, s[28:31], s46 offen lds
v_cvt_pk_bf16_f32 v135, v142, v143
buffer_store_dwordx4 v[132:135], v26, s[12:15], s60 offen offset:1024 sc1
s_add_u32 s53, s53, s63
s_lshl_b32 s63, s6, 3
v_mfma_f32_32x32x16_bf16 v[192:207], v[240:243], a[56:59], v[192:207]
ds_read_b64_tr_b16 v[234:235], v13 offset:17408
v_mul_f32 v144, v144, v14
buffer_load_dwordx4 a[4:7], v30, s[12:15], s48 offen offset:1024 sc1
s_add_u32 s63, s63, s4
v_mfma_f32_32x32x16_bf16 v[96:111], v[244:247], a[52:55], v[96:111]
ds_read_b64_tr_b16 v[236:237], v13 offset:18432
s_add_u32 m0, s47, 106496
v_mul_f32 v145, v145, v14
s_mul_i32 s63, s63, 40960
v_mfma_f32_32x32x16_bf16 v[192:207], v[244:247], a[60:63], v[192:207]
ds_read_b64_tr_b16 v[238:239], v13 offset:19456
v_mul_f32 v146, v146, v14
s_add_u32 s63, s63, s53
v_mfma_f32_32x32x16_bf16 v[112:127], v[248:251], a[48:51], v[112:127]
ds_read_b64_tr_b16 v[240:241], v12 offset:20480
buffer_load_dwordx4 v5, s[28:31], s46 offen lds
v_mul_f32 v147, v147, v14
v_mul_u32_u24 v6, 1280, v6
v_mfma_f32_32x32x16_bf16 v[208:223], v[248:251], a[56:59], v[208:223]
ds_read_b64_tr_b16 v[242:243], v12 offset:21504
v_cvt_pk_bf16_f32 v136, v144, v145
v_add3_u32 v6, v6, v7, s63
s_waitcnt lgkmcnt(6)
v_mfma_f32_32x32x16_bf16 v[112:127], v[252:255], a[52:55], v[112:127]
ds_read_b64_tr_b16 v[244:245], v12 offset:22528
v_cvt_pk_bf16_f32 v137, v146, v147
buffer_load_dwordx4 a[8:11], v30, s[12:15], s48 offen offset:2048 sc1
s_mov_b32 s52, 0xbfb8aa3b
v_mfma_f32_32x32x16_bf16 v[208:223], v[252:255], a[60:63], v[208:223]
ds_read_b64_tr_b16 v[246:247], v12 offset:23552
s_add_u32 s46, s46, 81920
s_add_u32 m0, s47, 122880
v_mul_f32 v148, v148, v14
v_mul_f32 v149, v149, v14
v_mfma_f32_32x32x16_bf16 v[96:111], v[224:227], a[64:67], v[96:111]
ds_read_b64_tr_b16 v[248:249], v13 offset:20480
v_mul_f32 v150, v150, v14
v_mfma_f32_32x32x16_bf16 v[192:207], v[224:227], a[72:75], v[192:207]
ds_read_b64_tr_b16 v[250:251], v13 offset:21504
buffer_load_dwordx4 v1, s[28:31], s46 offen lds
v_mul_f32 v151, v151, v14
v_mfma_f32_32x32x16_bf16 v[96:111], v[228:231], a[68:71], v[96:111]
ds_read_b64_tr_b16 v[252:253], v13 offset:22528
v_cvt_pk_bf16_f32 v138, v148, v149
v_mfma_f32_32x32x16_bf16 v[192:207], v[228:231], a[76:79], v[192:207]
ds_read_b64_tr_b16 v[254:255], v13 offset:23552
s_add_u32 m0, s47, 123904
v_cvt_pk_bf16_f32 v139, v150, v151
buffer_load_dwordx4 a[12:15], v30, s[12:15], s48 offen offset:3072 sc1
s_add_u32 s48, s48, 4096
s_waitcnt lgkmcnt(6)
v_mfma_f32_32x32x16_bf16 v[112:127], v[232:235], a[64:67], v[112:127]
ds_read_b64_tr_b16 v[224:225], v12 offset:24576
buffer_store_dwordx4 v[136:139], v26, s[12:15], s60 offen offset:2048 sc1
v_mfma_f32_32x32x16_bf16 v[208:223], v[232:235], a[72:75], v[208:223]
ds_read_b64_tr_b16 v[226:227], v12 offset:25600
buffer_load_dwordx4 v2, s[28:31], s46 offen lds
v_mul_f32 v152, v152, v14
v_mfma_f32_32x32x16_bf16 v[112:127], v[236:239], a[68:71], v[112:127]
ds_read_b64_tr_b16 v[228:229], v12 offset:26624
v_mul_f32 v153, v153, v14
v_mul_f32 v154, v154, v14
v_mfma_f32_32x32x16_bf16 v[208:223], v[236:239], a[76:79], v[208:223]
ds_read_b64_tr_b16 v[230:231], v12 offset:27648
s_add_u32 m0, s47, 124928
v_mul_f32 v155, v155, v14
v_mfma_f32_32x32x16_bf16 v[96:111], v[240:243], a[80:83], v[96:111]
ds_read_b64_tr_b16 v[232:233], v13 offset:24576
v_cvt_pk_bf16_f32 v140, v152, v153
buffer_load_dwordx4 a[16:19], v30, s[12:15], s48 offen offset:0 sc1
v_mfma_f32_32x32x16_bf16 v[192:207], v[240:243], a[88:91], v[192:207]
ds_read_b64_tr_b16 v[234:235], v13 offset:25600
buffer_load_dwordx4 v3, s[28:31], s46 offen lds
v_cvt_pk_bf16_f32 v141, v154, v155
s_waitcnt lgkmcnt(6)
v_mfma_f32_32x32x16_bf16 v[96:111], v[244:247], a[84:87], v[96:111]
ds_read_b64_tr_b16 v[236:237], v13 offset:26624
v_mul_f32 v156, v156, v14
v_mfma_f32_32x32x16_bf16 v[192:207], v[244:247], a[92:95], v[192:207]
ds_read_b64_tr_b16 v[238:239], v13 offset:27648
s_add_u32 m0, s47, 125952
v_mul_f32 v157, v157, v14
v_mfma_f32_32x32x16_bf16 v[112:127], v[248:251], a[80:83], v[112:127]
ds_read_b64_tr_b16 v[240:241], v12 offset:28672
v_mul_f32 v158, v158, v14
v_mfma_f32_32x32x16_bf16 v[208:223], v[248:251], a[88:91], v[208:223]
ds_read_b64_tr_b16 v[242:243], v12 offset:29696
buffer_load_dwordx4 v4, s[28:31], s46 offen lds
v_mul_f32 v159, v159, v14
v_cvt_pk_bf16_f32 v142, v156, v157
buffer_load_dwordx4 a[20:23], v30, s[12:15], s48 offen offset:1024 sc1
v_mfma_f32_32x32x16_bf16 v[112:127], v[252:255], a[84:87], v[112:127]
ds_read_b64_tr_b16 v[244:245], v12 offset:30720
v_cvt_pk_bf16_f32 v143, v158, v159
v_mfma_f32_32x32x16_bf16 v[208:223], v[252:255], a[92:95], v[208:223]
ds_read_b64_tr_b16 v[246:247], v12 offset:31744
s_add_u32 m0, s47, 126976
buffer_store_dwordx4 v[140:143], v26, s[12:15], s60 offen offset:3072 sc1
s_waitcnt lgkmcnt(6)
v_mfma_f32_32x32x16_bf16 v[96:111], v[224:227], a[96:99], v[96:111]
ds_read_b64_tr_b16 v[248:249], v13 offset:28672
v_mul_f32 v160, v160, v15
v_mfma_f32_32x32x16_bf16 v[192:207], v[224:227], a[104:107], v[192:207]
ds_read_b64_tr_b16 v[250:251], v13 offset:29696
buffer_load_dwordx4 v5, s[28:31], s46 offen lds
v_mul_f32 v161, v161, v15
v_mfma_f32_32x32x16_bf16 v[96:111], v[228:231], a[100:103], v[96:111]
ds_read_b64_tr_b16 v[252:253], v13 offset:30720
v_mul_f32 v162, v162, v15
buffer_load_dwordx4 a[24:27], v30, s[12:15], s48 offen offset:2048 sc1
v_mfma_f32_32x32x16_bf16 v[192:207], v[228:231], a[108:111], v[192:207]
ds_read_b64_tr_b16 v[254:255], v13 offset:31744
v_mul_f32 v163, v163, v15
v_mfma_f32_32x32x16_bf16 v[112:127], v[232:235], a[96:99], v[112:127]
s_waitcnt vmcnt(27)
s_waitcnt lgkmcnt(0)
s_barrier
ds_read_b64_tr_b16 v[224:225], v12 offset:32768
v_cvt_pk_bf16_f32 v144, v160, v161
v_cvt_pk_bf16_f32 v145, v162, v163
v_mfma_f32_32x32x16_bf16 v[208:223], v[232:235], a[104:107], v[208:223]
ds_read_b64_tr_b16 v[226:227], v12 offset:33792
s_add_u32 s46, s46, 81920
s_add_u32 m0, s47, 0
v_mul_f32 v164, v164, v15
v_mfma_f32_32x32x16_bf16 v[112:127], v[236:239], a[100:103], v[112:127]
ds_read_b64_tr_b16 v[228:229], v12 offset:34816
v_mul_f32 v165, v165, v15
v_mfma_f32_32x32x16_bf16 v[208:223], v[236:239], a[108:111], v[208:223]
ds_read_b64_tr_b16 v[230:231], v12 offset:35840
v_mul_f32 v166, v166, v15
buffer_load_dwordx4 a[28:31], v30, s[12:15], s48 offen offset:3072 sc1
s_add_u32 s48, s48, 4096
v_mfma_f32_32x32x16_bf16 v[96:111], v[240:243], a[112:115], v[96:111]
ds_read_b64_tr_b16 v[232:233], v13 offset:32768
buffer_load_dwordx4 v1, s[28:31], s46 offen lds
v_mul_f32 v167, v167, v15
v_mfma_f32_32x32x16_bf16 v[192:207], v[240:243], a[120:123], v[192:207]
ds_read_b64_tr_b16 v[234:235], v13 offset:33792
v_cvt_pk_bf16_f32 v146, v164, v165
v_mfma_f32_32x32x16_bf16 v[96:111], v[244:247], a[116:119], v[96:111]
ds_read_b64_tr_b16 v[236:237], v13 offset:34816
v_cvt_pk_bf16_f32 v147, v166, v167
v_mfma_f32_32x32x16_bf16 v[192:207], v[244:247], a[124:127], v[192:207]
ds_read_b64_tr_b16 v[238:239], v13 offset:35840
s_add_u32 m0, s47, 1024
buffer_store_dwordx4 v[144:147], v27, s[12:15], s60 offen offset:0 sc1
v_mul_f32 v168, v168, v15
v_mfma_f32_32x32x16_bf16 v[112:127], v[248:251], a[112:115], v[112:127]
ds_read_b64_tr_b16 v[240:241], v12 offset:36864
v_mul_f32 v169, v169, v15
buffer_load_dwordx4 a[32:35], v30, s[12:15], s48 offen offset:0 sc1
s_and_b32 s63, s2, 0xe7
v_and_b32 v24, 3, v0
v_lshlrev_b32 v24, 3, v24
v_add_u32 v24, s63, v24
v_lshlrev_b32 v24, 7, v24
buffer_load_dword v25, v24, s[12:15], s95 offen sc1
v_mfma_f32_32x32x16_bf16 v[208:223], v[248:251], a[120:123], v[208:223]
ds_read_b64_tr_b16 v[242:243], v12 offset:37888
v_mul_f32 v170, v170, v15
v_mfma_f32_32x32x16_bf16 v[112:127], v[252:255], a[116:119], v[112:127]
ds_read_b64_tr_b16 v[244:245], v12 offset:38912
buffer_load_dwordx4 v2, s[28:31], s46 offen lds
v_mul_f32 v171, v171, v15
v_mfma_f32_32x32x16_bf16 v[208:223], v[252:255], a[124:127], v[208:223]
ds_read_b64_tr_b16 v[246:247], v12 offset:39936
v_cvt_pk_bf16_f32 v148, v168, v169
s_waitcnt lgkmcnt(6)
v_mfma_f32_32x32x16_bf16 v[96:111], v[224:227], a[128:131], v[96:111]
ds_read_b64_tr_b16 v[248:249], v13 offset:36864
v_cvt_pk_bf16_f32 v149, v170, v171
v_mfma_f32_32x32x16_bf16 v[192:207], v[224:227], a[136:139], v[192:207]
ds_read_b64_tr_b16 v[250:251], v13 offset:37888
s_add_u32 m0, s47, 2048
v_mul_f32 v172, v172, v15
buffer_load_dwordx4 a[36:39], v30, s[12:15], s48 offen offset:1024 sc1
v_mfma_f32_32x32x16_bf16 v[96:111], v[228:231], a[132:135], v[96:111]
ds_read_b64_tr_b16 v[252:253], v13 offset:38912
v_mul_f32 v173, v173, v15
v_mul_f32 v174, v174, v15
v_mfma_f32_32x32x16_bf16 v[192:207], v[228:231], a[140:143], v[192:207]
ds_read_b64_tr_b16 v[254:255], v13 offset:39936
v_mul_f32 v175, v175, v15
v_mfma_f32_32x32x16_bf16 v[112:127], v[232:235], a[128:131], v[112:127]
ds_read_b64_tr_b16 v[224:225], v12 offset:40960
buffer_load_dwordx4 v3, s[28:31], s46 offen lds
v_cvt_pk_bf16_f32 v150, v172, v173
v_mfma_f32_32x32x16_bf16 v[208:223], v[232:235], a[136:139], v[208:223]
ds_read_b64_tr_b16 v[226:227], v12 offset:41984
v_cvt_pk_bf16_f32 v151, v174, v175
s_waitcnt lgkmcnt(6)
v_mfma_f32_32x32x16_bf16 v[112:127], v[236:239], a[132:135], v[112:127]
ds_read_b64_tr_b16 v[228:229], v12 offset:43008
buffer_store_dwordx4 v[148:151], v27, s[12:15], s60 offen offset:1024 sc1
buffer_load_dwordx4 a[40:43], v30, s[12:15], s48 offen offset:2048 sc1
v_mfma_f32_32x32x16_bf16 v[208:223], v[236:239], a[140:143], v[208:223]
ds_read_b64_tr_b16 v[230:231], v12 offset:44032
s_add_u32 m0, s47, 3072
v_mul_f32 v176, v176, v15
v_mfma_f32_32x32x16_bf16 v[96:111], v[240:243], a[144:147], v[96:111]
ds_read_b64_tr_b16 v[232:233], v13 offset:40960
v_mul_f32 v177, v177, v15
v_mfma_f32_32x32x16_bf16 v[192:207], v[240:243], a[152:155], v[192:207]
ds_read_b64_tr_b16 v[234:235], v13 offset:41984
v_mul_f32 v178, v178, v15
v_mul_f32 v179, v179, v15
v_mfma_f32_32x32x16_bf16 v[96:111], v[244:247], a[148:151], v[96:111]
ds_read_b64_tr_b16 v[236:237], v13 offset:43008
buffer_load_dwordx4 v4, s[28:31], s46 offen lds
v_cvt_pk_bf16_f32 v152, v176, v177
v_mfma_f32_32x32x16_bf16 v[192:207], v[244:247], a[156:159], v[192:207]
ds_read_b64_tr_b16 v[238:239], v13 offset:44032
v_cvt_pk_bf16_f32 v153, v178, v179
buffer_load_dwordx4 a[44:47], v30, s[12:15], s48 offen offset:3072 sc1
s_add_u32 s48, s48, 4096
s_waitcnt lgkmcnt(6)
v_mfma_f32_32x32x16_bf16 v[112:127], v[248:251], a[144:147], v[112:127]
ds_read_b64_tr_b16 v[240:241], v12 offset:45056
v_mul_f32 v180, v180, v15
v_mfma_f32_32x32x16_bf16 v[208:223], v[248:251], a[152:155], v[208:223]
ds_read_b64_tr_b16 v[242:243], v12 offset:46080
s_add_u32 m0, s47, 4096
v_mul_f32 v181, v181, v15
v_mfma_f32_32x32x16_bf16 v[112:127], v[252:255], a[148:151], v[112:127]
ds_read_b64_tr_b16 v[244:245], v12 offset:47104
v_mul_f32 v182, v182, v15
v_mfma_f32_32x32x16_bf16 v[208:223], v[252:255], a[156:159], v[208:223]
ds_read_b64_tr_b16 v[246:247], v12 offset:48128
v_mul_f32 v183, v183, v15
v_mfma_f32_32x32x16_bf16 v[96:111], v[224:227], a[160:163], v[96:111]
ds_read_b64_tr_b16 v[248:249], v13 offset:45056
buffer_load_dwordx4 v5, s[28:31], s46 offen lds
v_cvt_pk_bf16_f32 v154, v180, v181
v_cvt_pk_bf16_f32 v155, v182, v183
buffer_load_dwordx4 a[48:51], v30, s[12:15], s48 offen offset:0 sc1
v_mfma_f32_32x32x16_bf16 v[192:207], v[224:227], a[168:171], v[192:207]
ds_read_b64_tr_b16 v[250:251], v13 offset:46080
buffer_store_dwordx4 v[152:155], v27, s[12:15], s60 offen offset:2048 sc1
s_waitcnt lgkmcnt(6)
v_mfma_f32_32x32x16_bf16 v[96:111], v[228:231], a[164:167], v[96:111]
ds_read_b64_tr_b16 v[252:253], v13 offset:47104
v_mul_f32 v184, v184, v15
v_mfma_f32_32x32x16_bf16 v[192:207], v[228:231], a[172:175], v[192:207]
ds_read_b64_tr_b16 v[254:255], v13 offset:48128
v_mul_f32 v185, v185, v15
v_mfma_f32_32x32x16_bf16 v[112:127], v[232:235], a[160:163], v[112:127]
ds_read_b64_tr_b16 v[224:225], v12 offset:49152
v_mul_f32 v186, v186, v15
v_mfma_f32_32x32x16_bf16 v[208:223], v[232:235], a[168:171], v[208:223]
ds_read_b64_tr_b16 v[226:227], v12 offset:50176
v_mul_f32 v187, v187, v15
buffer_load_dwordx4 a[52:55], v30, s[12:15], s48 offen offset:1024 sc1
v_mfma_f32_32x32x16_bf16 v[112:127], v[236:239], a[164:167], v[112:127]
ds_read_b64_tr_b16 v[228:229], v12 offset:51200
v_cvt_pk_bf16_f32 v156, v184, v185
v_mfma_f32_32x32x16_bf16 v[208:223], v[236:239], a[172:175], v[208:223]
ds_read_b64_tr_b16 v[230:231], v12 offset:52224
v_cvt_pk_bf16_f32 v157, v186, v187
v_mul_f32 v188, v188, v15
s_waitcnt lgkmcnt(6)
v_mfma_f32_32x32x16_bf16 v[96:111], v[240:243], a[176:179], v[96:111]
ds_read_b64_tr_b16 v[232:233], v13 offset:49152
v_mul_f32 v189, v189, v15
v_mfma_f32_32x32x16_bf16 v[192:207], v[240:243], a[184:187], v[192:207]
ds_read_b64_tr_b16 v[234:235], v13 offset:50176
v_mul_f32 v190, v190, v15
v_mfma_f32_32x32x16_bf16 v[96:111], v[244:247], a[180:183], v[96:111]
ds_read_b64_tr_b16 v[236:237], v13 offset:51200
v_mul_f32 v191, v191, v15
buffer_load_dwordx4 a[56:59], v30, s[12:15], s48 offen offset:2048 sc1
v_mfma_f32_32x32x16_bf16 v[192:207], v[244:247], a[188:191], v[192:207]
ds_read_b64_tr_b16 v[238:239], v13 offset:52224
v_cvt_pk_bf16_f32 v158, v188, v189
v_mfma_f32_32x32x16_bf16 v[112:127], v[248:251], a[176:179], v[112:127]
ds_read_b64_tr_b16 v[240:241], v12 offset:53248
v_cvt_pk_bf16_f32 v159, v190, v191
v_mfma_f32_32x32x16_bf16 v[208:223], v[248:251], a[184:187], v[208:223]
ds_read_b64_tr_b16 v[242:243], v12 offset:54272
buffer_store_dwordx4 v[156:159], v27, s[12:15], s60 offen offset:3072 sc1
s_waitcnt lgkmcnt(6)
v_mfma_f32_32x32x16_bf16 v[112:127], v[252:255], a[180:183], v[112:127]
ds_read_b64_tr_b16 v[244:245], v12 offset:55296
v_mfma_f32_32x32x16_bf16 v[208:223], v[252:255], a[188:191], v[208:223]
ds_read_b64_tr_b16 v[246:247], v12 offset:56320
buffer_load_dwordx4 a[60:63], v30, s[12:15], s48 offen offset:3072 sc1
s_add_u32 s48, s48, 4096
v_mfma_f32_32x32x16_bf16 v[96:111], v[224:227], a[192:195], v[96:111]
ds_read_b64_tr_b16 v[248:249], v13 offset:53248
v_mfma_f32_32x32x16_bf16 v[192:207], v[224:227], a[200:203], v[192:207]
ds_read_b64_tr_b16 v[250:251], v13 offset:54272
v_mfma_f32_32x32x16_bf16 v[96:111], v[228:231], a[196:199], v[96:111]
ds_read_b64_tr_b16 v[252:253], v13 offset:55296
v_mfma_f32_32x32x16_bf16 v[192:207], v[228:231], a[204:207], v[192:207]
ds_read_b64_tr_b16 v[254:255], v13 offset:56320
s_waitcnt lgkmcnt(6)
v_mfma_f32_32x32x16_bf16 v[112:127], v[232:235], a[192:195], v[112:127]
ds_read_b64_tr_b16 v[224:225], v12 offset:57344
buffer_load_dwordx4 a[64:67], v30, s[12:15], s48 offen offset:0 sc1
s_waitcnt vmcnt(15)
v_cmp_gt_u32 vcc, 3, v25
s_cbranch_vccnz SLOWO3
GOO3:
v_mfma_f32_32x32x16_bf16 v[208:223], v[232:235], a[200:203], v[208:223]
ds_read_b64_tr_b16 v[226:227], v12 offset:58368
v_mfma_f32_32x32x16_bf16 v[112:127], v[236:239], a[196:199], v[112:127]
ds_read_b64_tr_b16 v[228:229], v12 offset:59392
v_mfma_f32_32x32x16_bf16 v[208:223], v[236:239], a[204:207], v[208:223]
ds_read_b64_tr_b16 v[230:231], v12 offset:60416
v_mfma_f32_32x32x16_bf16 v[96:111], v[240:243], a[208:211], v[96:111]
ds_read_b64_tr_b16 v[232:233], v13 offset:57344
v_mfma_f32_32x32x16_bf16 v[192:207], v[240:243], a[216:219], v[192:207]
ds_read_b64_tr_b16 v[234:235], v13 offset:58368
buffer_load_dwordx4 a[68:71], v30, s[12:15], s48 offen offset:1024 sc1
s_waitcnt lgkmcnt(6)
v_mfma_f32_32x32x16_bf16 v[96:111], v[244:247], a[212:215], v[96:111]
ds_read_b64_tr_b16 v[236:237], v13 offset:59392
v_mfma_f32_32x32x16_bf16 v[192:207], v[244:247], a[220:223], v[192:207]
ds_read_b64_tr_b16 v[238:239], v13 offset:60416
v_mfma_f32_32x32x16_bf16 v[112:127], v[248:251], a[208:211], v[112:127]
ds_read_b64_tr_b16 v[240:241], v12 offset:61440
v_mfma_f32_32x32x16_bf16 v[208:223], v[248:251], a[216:219], v[208:223]
ds_read_b64_tr_b16 v[242:243], v12 offset:62464
v_mfma_f32_32x32x16_bf16 v[112:127], v[252:255], a[212:215], v[112:127]
ds_read_b64_tr_b16 v[244:245], v12 offset:63488
buffer_load_dwordx4 a[72:75], v30, s[12:15], s48 offen offset:2048 sc1
v_mfma_f32_32x32x16_bf16 v[208:223], v[252:255], a[220:223], v[208:223]
ds_read_b64_tr_b16 v[246:247], v12 offset:64512
s_waitcnt lgkmcnt(6)
v_mfma_f32_32x32x16_bf16 v[96:111], v[224:227], a[224:227], v[96:111]
ds_read_b64_tr_b16 v[248:249], v13 offset:61440
v_mfma_f32_32x32x16_bf16 v[192:207], v[224:227], a[232:235], v[192:207]
ds_read_b64_tr_b16 v[250:251], v13 offset:62464
v_mfma_f32_32x32x16_bf16 v[96:111], v[228:231], a[228:231], v[96:111]
ds_read_b64_tr_b16 v[252:253], v13 offset:63488
v_mfma_f32_32x32x16_bf16 v[192:207], v[228:231], a[236:239], v[192:207]
ds_read_b64_tr_b16 v[254:255], v13 offset:64512
buffer_load_dwordx4 a[76:79], v30, s[12:15], s48 offen offset:3072 sc1
s_add_u32 s48, s48, 4096
v_mfma_f32_32x32x16_bf16 v[112:127], v[232:235], a[224:227], v[112:127]
s_waitcnt lgkmcnt(0)
s_barrier
ds_read_b64_tr_b16 v[32:33], v9 offset:20480
v_mfma_f32_32x32x16_bf16 v[208:223], v[232:235], a[232:235], v[208:223]
s_add_u32 s46, s46, 81920
s_add_u32 m0, s47, 20480
ds_read_b64_tr_b16 v[34:35], v9 offset:21760
v_mfma_f32_32x32x16_bf16 v[112:127], v[236:239], a[228:231], v[112:127]
buffer_load_dwordx4 v1, s[28:31], s46 offen lds
ds_read_b64_tr_b16 v[36:37], v9 offset:20544
v_mfma_f32_32x32x16_bf16 v[208:223], v[236:239], a[236:239], v[208:223]
s_add_u32 m0, s47, 21504
ds_read_b64_tr_b16 v[38:39], v9 offset:21824
v_mfma_f32_32x32x16_bf16 v[96:111], v[240:243], a[240:243], v[96:111]
buffer_load_dwordx4 v2, s[28:31], s46 offen lds
buffer_load_dwordx4 a[80:83], v30, s[12:15], s48 offen offset:0 sc1
ds_read_b64_tr_b16 v[40:41], v9 offset:20608
v_mfma_f32_32x32x16_bf16 v[192:207], v[240:243], a[248:251], v[192:207]
s_add_u32 m0, s47, 22528
ds_read_b64_tr_b16 v[42:43], v9 offset:21888
v_mfma_f32_32x32x16_bf16 v[96:111], v[244:247], a[244:247], v[96:111]
buffer_load_dwordx4 v3, s[28:31], s46 offen lds
ds_read_b64_tr_b16 v[44:45], v9 offset:20672
v_mfma_f32_32x32x16_bf16 v[192:207], v[244:247], a[252:255], v[192:207]
s_add_u32 m0, s47, 23552
ds_read_b64_tr_b16 v[46:47], v9 offset:21952
v_mfma_f32_32x32x16_bf16 v[112:127], v[248:251], a[240:243], v[112:127]
buffer_load_dwordx4 v4, s[28:31], s46 offen lds
ds_read_b64_tr_b16 v[48:49], v9 offset:20736
v_mfma_f32_32x32x16_bf16 v[208:223], v[248:251], a[248:251], v[208:223]
s_add_u32 m0, s47, 24576
buffer_load_dwordx4 a[84:87], v30, s[12:15], s48 offen offset:1024 sc1
ds_read_b64_tr_b16 v[50:51], v9 offset:22016
v_mfma_f32_32x32x16_bf16 v[112:127], v[252:255], a[244:247], v[112:127]
buffer_load_dwordx4 v5, s[28:31], s46 offen lds
ds_read_b64_tr_b16 v[52:53], v9 offset:25600
v_mfma_f32_32x32x16_bf16 v[208:223], v[252:255], a[252:255], v[208:223]
ds_read_b64_tr_b16 v[54:55], v9 offset:26880
s_waitcnt lgkmcnt(6)
v_mfma_f32_32x32x16_bf16 a[96:111], v[32:35], a[0:3], 0
ds_read_b64_tr_b16 v[56:57], v9 offset:25664
ds_read_b64_tr_b16 v[58:59], v9 offset:26944
s_add_u32 s45, s5, 0
s_and_b32 s45, s45, 3
s_mul_i32 s45, s45, 245760
s_add_u32 s45, s45, s44
s_add_u32 m0, s47, 40960
v_mfma_f32_32x32x16_bf16 a[112:127], v[36:39], a[0:3], 0
ds_read_b64_tr_b16 v[60:61], v9 offset:25728
ds_read_b64_tr_b16 v[62:63], v9 offset:27008
buffer_load_dwordx4 v1, s[24:27], s45 offen lds
v_mfma_f32_32x32x16_bf16 a[128:143], v[40:43], a[0:3], 0
buffer_load_dwordx4 a[88:91], v30, s[12:15], s48 offen offset:2048 sc1
ds_read_b64_tr_b16 v[32:33], v9 offset:25792
ds_read_b64_tr_b16 v[34:35], v9 offset:27072
s_add_u32 s62, s49, 0
buffer_load_dwordx4 v[224:227], v26, s[12:15], s62 offen offset:0 sc1
s_waitcnt lgkmcnt(6)
v_mfma_f32_32x32x16_bf16 a[144:159], v[44:47], a[0:3], 0
ds_read_b64_tr_b16 v[36:37], v9 offset:25856
ds_read_b64_tr_b16 v[38:39], v9 offset:27136
s_add_u32 m0, s47, 41984
v_mul_f32 v96, v96, v14
v_mul_f32 v97, v97, v14
v_mul_f32 v98, v98, v14
v_mfma_f32_32x32x16_bf16 a[160:175], v[48:51], a[0:3], 0
ds_read_b64_tr_b16 v[40:41], v9 offset:30720
ds_read_b64_tr_b16 v[42:43], v9 offset:32000
buffer_load_dwordx4 v2, s[24:27], s45 offen lds
v_mul_f32 v99, v99, v14
v_cvt_pk_bf16_f32 v160, v96, v97
v_mfma_f32_32x32x16_bf16 a[96:111], v[52:55], a[4:7], a[96:111]
ds_read_b64_tr_b16 v[44:45], v9 offset:30784
ds_read_b64_tr_b16 v[46:47], v9 offset:32064
v_cvt_pk_bf16_f32 v161, v98, v99
v_mul_f32 v100, v100, v14
v_mul_f32 v101, v101, v14
s_waitcnt vmcnt(16)
v_mov_b32 v29, 4
buffer_store_dword v29, v28, s[12:15], 0 offen sc1
s_add_u32 s62, s49, 0
buffer_load_dwordx4 v[240:243], v27, s[12:15], s62 offen offset:0 sc1
s_waitcnt lgkmcnt(6)
v_mfma_f32_32x32x16_bf16 a[112:127], v[56:59], a[4:7], a[112:127]
ds_read_b64_tr_b16 v[48:49], v9 offset:30848
ds_read_b64_tr_b16 v[50:51], v9 offset:32128
s_add_u32 m0, s47, 43008
v_mul_f32 v102, v102, v14
v_mul_f32 v103, v103, v14
v_mfma_f32_32x32x16_bf16 a[128:143], v[60:63], a[4:7], a[128:143]
buffer_load_dwordx4 a[92:95], v30, s[12:15], s48 offen offset:3072 sc1
s_add_u32 s48, s48, 4096
ds_read_b64_tr_b16 v[52:53], v9 offset:30912
ds_read_b64_tr_b16 v[54:55], v9 offset:32192
v_cvt_pk_bf16_f32 v162, v100, v101
v_cvt_pk_bf16_f32 v163, v102, v103
v_mfma_f32_32x32x16_bf16 a[144:159], v[32:35], a[4:7], a[144:159]
ds_read_b64_tr_b16 v[56:57], v9 offset:30976
ds_read_b64_tr_b16 v[58:59], v9 offset:32256
buffer_load_dwordx4 v3, s[24:27], s45 offen lds
buffer_store_dwordx4 v[160:163], v26, s[12:15], s61 offen offset:0 sc1
v_mul_f32 v104, v104, v14
v_mul_f32 v105, v105, v14
v_mul_f32 v106, v106, v14
s_waitcnt lgkmcnt(6)
v_mfma_f32_32x32x16_bf16 a[160:175], v[36:39], a[4:7], a[160:175]
ds_read_b64_tr_b16 v[60:61], v9 offset:35840
ds_read_b64_tr_b16 v[62:63], v9 offset:37120
s_add_u32 m0, s47, 44032
v_mul_f32 v107, v107, v14
v_cvt_pk_bf16_f32 v164, v104, v105
s_add_u32 s62, s49, 0
buffer_load_dwordx4 v[228:231], v26, s[12:15], s62 offen offset:1024 sc1
v_mfma_f32_32x32x16_bf16 a[96:111], v[40:43], a[8:11], a[96:111]
ds_read_b64_tr_b16 v[32:33], v9 offset:35904
ds_read_b64_tr_b16 v[34:35], v9 offset:37184
v_cvt_pk_bf16_f32 v165, v106, v107
v_mul_f32 v108, v108, v14
v_mul_f32 v109, v109, v14
v_mfma_f32_32x32x16_bf16 a[112:127], v[44:47], a[8:11], a[112:127]
ds_read_b64_tr_b16 v[36:37], v9 offset:35968
ds_read_b64_tr_b16 v[38:39], v9 offset:37248
buffer_load_dwordx4 v4, s[24:27], s45 offen lds
v_mul_f32 v110, v110, v14
v_mul_f32 v111, v111, v14
s_waitcnt lgkmcnt(6)
v_mfma_f32_32x32x16_bf16 a[128:143], v[48:51], a[8:11], a[128:143]
ds_read_b64_tr_b16 v[40:41], v9 offset:36032
ds_read_b64_tr_b16 v[42:43], v9 offset:37312
v_cvt_pk_bf16_f32 v166, v108, v109
v_cvt_pk_bf16_f32 v167, v110, v111
s_add_u32 s62, s49, 0
buffer_load_dwordx4 v[244:247], v27, s[12:15], s62 offen offset:1024 sc1
v_mfma_f32_32x32x16_bf16 a[144:159], v[52:55], a[8:11], a[144:159]
ds_read_b64_tr_b16 v[44:45], v9 offset:36096
ds_read_b64_tr_b16 v[46:47], v9 offset:37376
s_add_u32 m0, s47, 45056
v_mul_f32 v112, v112, v14
v_mul_f32 v113, v113, v14
v_mul_f32 v114, v114, v14
v_mfma_f32_32x32x16_bf16 a[160:175], v[56:59], a[8:11], a[160:175]
ds_read_b64_tr_b16 v[48:49], v8 offset:20480
ds_read_b64_tr_b16 v[50:51], v8 offset:21760
buffer_load_dwordx4 v5, s[24:27], s45 offen lds
v_mul_f32 v115, v115, v14
v_cvt_pk_bf16_f32 v168, v112, v113
s_waitcnt lgkmcnt(6)
v_mfma_f32_32x32x16_bf16 a[96:111], v[60:63], a[12:15], a[96:111]
ds_read_b64_tr_b16 v[52:53], v8 offset:20544
ds_read_b64_tr_b16 v[54:55], v8 offset:21824
v_cvt_pk_bf16_f32 v169, v114, v115
v_mul_f32 v116, v116, v14
v_mul_f32 v117, v117, v14
v_mfma_f32_32x32x16_bf16 a[112:127], v[32:35], a[12:15], a[112:127]
ds_read_b64_tr_b16 v[56:57], v8 offset:20608
ds_read_b64_tr_b16 v[58:59], v8 offset:21888
s_add_u32 s45, s45, 81920
s_add_u32 m0, s47, 61440
buffer_store_dwordx4 v[164:167], v26, s[12:15], s61 offen offset:1024 sc1
v_mul_f32 v118, v118, v14
v_mul_f32 v119, v119, v14
s_add_u32 s62, s49, 0
buffer_load_dwordx4 v[232:235], v26, s[12:15], s62 offen offset:2048 sc1
v_mfma_f32_32x32x16_bf16 a[128:143], v[36:39], a[12:15], a[128:143]
ds_read_b64_tr_b16 v[60:61], v8 offset:20672
ds_read_b64_tr_b16 v[62:63], v8 offset:21952
v_cvt_pk_bf16_f32 v170, v116, v117
v_cvt_pk_bf16_f32 v171, v118, v119
s_waitcnt lgkmcnt(6)
v_mfma_f32_32x32x16_bf16 a[144:159], v[40:43], a[12:15], a[144:159]
ds_read_b64_tr_b16 v[32:33], v8 offset:20736
ds_read_b64_tr_b16 v[34:35], v8 offset:22016
buffer_load_dwordx4 v1, s[24:27], s45 offen lds
v_mul_f32 v120, v120, v14
v_mul_f32 v121, v121, v14
v_mul_f32 v122, v122, v14
v_mfma_f32_32x32x16_bf16 a[160:175], v[44:47], a[12:15], a[160:175]
ds_read_b64_tr_b16 v[36:37], v8 offset:25600
ds_read_b64_tr_b16 v[38:39], v8 offset:26880
s_add_u32 m0, s47, 62464
v_mul_f32 v123, v123, v14
v_cvt_pk_bf16_f32 v172, v120, v121
v_mfma_f32_32x32x16_bf16 a[96:111], v[48:51], a[16:19], a[96:111]
ds_read_b64_tr_b16 v[40:41], v8 offset:25664
ds_read_b64_tr_b16 v[42:43], v8 offset:26944
v_cvt_pk_bf16_f32 v173, v122, v123
v_mul_f32 v124, v124, v14
v_mul_f32 v125, v125, v14
s_add_u32 s62, s49, 0
buffer_load_dwordx4 v[248:251], v27, s[12:15], s62 offen offset:2048 sc1
s_waitcnt lgkmcnt(6)
v_mfma_f32_32x32x16_bf16 a[112:127], v[52:55], a[16:19], a[112:127]
ds_read_b64_tr_b16 v[44:45], v8 offset:25728
ds_read_b64_tr_b16 v[46:47], v8 offset:27008
buffer_load_dwordx4 v2, s[24:27], s45 offen lds
v_mul_f32 v126, v126, v14
v_mul_f32 v127, v127, v14
v_mfma_f32_32x32x16_bf16 a[128:143], v[56:59], a[16:19], a[128:143]
ds_read_b64_tr_b16 v[48:49], v8 offset:25792
ds_read_b64_tr_b16 v[50:51], v8 offset:27072
v_cvt_pk_bf16_f32 v174, v124, v125
v_cvt_pk_bf16_f32 v175, v126, v127
v_mfma_f32_32x32x16_bf16 a[144:159], v[60:63], a[16:19], a[144:159]
ds_read_b64_tr_b16 v[52:53], v8 offset:25856
ds_read_b64_tr_b16 v[54:55], v8 offset:27136
s_add_u32 m0, s47, 63488
v_mul_f32 v192, v192, v15
v_mul_f32 v193, v193, v15
v_mul_f32 v194, v194, v15
s_add_u32 s62, s49, 0
buffer_load_dwordx4 v[236:239], v26, s[12:15], s62 offen offset:3072 sc1
s_waitcnt lgkmcnt(6)
v_mfma_f32_32x32x16_bf16 a[160:175], v[32:35], a[16:19], a[160:175]
ds_read_b64_tr_b16 v[56:57], v8 offset:30720
ds_read_b64_tr_b16 v[58:59], v8 offset:32000
buffer_load_dwordx4 v3, s[24:27], s45 offen lds
buffer_store_dwordx4 v[168:171], v26, s[12:15], s61 offen offset:2048 sc1
v_mul_f32 v195, v195, v15
v_cvt_pk_bf16_f32 v176, v192, v193
v_mfma_f32_32x32x16_bf16 a[96:111], v[36:39], a[20:23], a[96:111]
ds_read_b64_tr_b16 v[60:61], v8 offset:30784
ds_read_b64_tr_b16 v[62:63], v8 offset:32064
v_cvt_pk_bf16_f32 v177, v194, v195
v_mul_f32 v196, v196, v15
v_mul_f32 v197, v197, v15
v_mfma_f32_32x32x16_bf16 a[112:127], v[40:43], a[20:23], a[112:127]
ds_read_b64_tr_b16 v[32:33], v8 offset:30848
ds_read_b64_tr_b16 v[34:35], v8 offset:32128
s_add_u32 m0, s47, 64512
v_mul_f32 v198, v198, v15
v_mul_f32 v199, v199, v15
s_waitcnt lgkmcnt(6)
v_mfma_f32_32x32x16_bf16 a[128:143], v[44:47], a[20:23], a[128:143]
ds_read_b64_tr_b16 v[36:37], v8 offset:30912
ds_read_b64_tr_b16 v[38:39], v8 offset:32192
v_cvt_pk_bf16_f32 v178, v196, v197
v_cvt_pk_bf16_f32 v179, v198, v199
s_add_u32 s62, s49, 0
buffer_load_dwordx4 v[252:255], v27, s[12:15], s62 offen offset:3072 sc1
v_mfma_f32_32x32x16_bf16 a[144:159], v[48:51], a[20:23], a[144:159]
ds_read_b64_tr_b16 v[40:41], v8 offset:30976
ds_read_b64_tr_b16 v[42:43], v8 offset:32256
buffer_load_dwordx4 v4, s[24:27], s45 offen lds
v_mul_f32 v200, v200, v15
v_mul_f32 v201, v201, v15
v_mul_f32 v202, v202, v15
v_mfma_f32_32x32x16_bf16 a[160:175], v[52:55], a[20:23], a[160:175]
ds_read_b64_tr_b16 v[44:45], v8 offset:35840
ds_read_b64_tr_b16 v[46:47], v8 offset:37120
s_add_u32 m0, s47, 65536
v_mul_f32 v203, v203, v15
v_cvt_pk_bf16_f32 v180, v200, v201
s_waitcnt lgkmcnt(6)
v_mfma_f32_32x32x16_bf16 a[96:111], v[56:59], a[24:27], a[96:111]
ds_read_b64_tr_b16 v[48:49], v8 offset:35904
ds_read_b64_tr_b16 v[50:51], v8 offset:37184
v_cvt_pk_bf16_f32 v181, v202, v203
v_mul_f32 v204, v204, v15
v_mul_f32 v205, v205, v15
v_mfma_f32_32x32x16_bf16 a[112:127], v[60:63], a[24:27], a[112:127]
ds_read_b64_tr_b16 v[52:53], v8 offset:35968
ds_read_b64_tr_b16 v[54:55], v8 offset:37248
buffer_load_dwordx4 v5, s[24:27], s45 offen lds
v_mul_f32 v206, v206, v15
v_mul_f32 v207, v207, v15
v_mfma_f32_32x32x16_bf16 a[128:143], v[32:35], a[24:27], a[128:143]
ds_read_b64_tr_b16 v[56:57], v8 offset:36032
ds_read_b64_tr_b16 v[58:59], v8 offset:37312
buffer_store_dwordx4 v[172:175], v26, s[12:15], s61 offen offset:3072 sc1
v_cvt_pk_bf16_f32 v182, v204, v205
v_cvt_pk_bf16_f32 v183, v206, v207
s_waitcnt lgkmcnt(6)
v_mfma_f32_32x32x16_bf16 a[144:159], v[36:39], a[24:27], a[144:159]
ds_read_b64_tr_b16 v[60:61], v8 offset:36096
ds_read_b64_tr_b16 v[62:63], v8 offset:37376
v_mul_f32 v208, v208, v15
v_mul_f32 v209, v209, v15
v_mul_f32 v210, v210, v15
v_mfma_f32_32x32x16_bf16 a[160:175], v[40:43], a[24:27], a[160:175]
s_barrier
ds_read_b64_tr_b16 v[32:33], v8 offset:40960
ds_read_b64_tr_b16 v[34:35], v8 offset:42240
v_mul_f32 v211, v211, v15
v_cvt_pk_bf16_f32 v184, v208, v209
v_mfma_f32_32x32x16_bf16 a[96:111], v[44:47], a[28:31], a[96:111]
ds_read_b64_tr_b16 v[36:37], v8 offset:41024
ds_read_b64_tr_b16 v[38:39], v8 offset:42304
s_add_u32 s45, s45, 81920
s_add_u32 m0, s47, 143360
v_cvt_pk_bf16_f32 v185, v210, v211
v_mul_f32 v212, v212, v15
v_mul_f32 v213, v213, v15
s_and_b32 s63, s2, 0xe7
v_and_b32 v24, 3, v0
v_lshlrev_b32 v24, 3, v24
v_add_u32 v24, s63, v24
v_lshlrev_b32 v24, 7, v24
buffer_load_dword v25, v24, s[12:15], s95 offen sc1
s_waitcnt lgkmcnt(6)
v_mfma_f32_32x32x16_bf16 a[112:127], v[48:51], a[28:31], a[112:127]
ds_read_b64_tr_b16 v[40:41], v8 offset:41088
ds_read_b64_tr_b16 v[42:43], v8 offset:42368
buffer_load_dwordx4 v1, s[24:27], s45 offen lds
v_mul_f32 v214, v214, v15
v_mul_f32 v215, v215, v15
v_mfma_f32_32x32x16_bf16 a[128:143], v[52:55], a[28:31], a[128:143]
ds_read_b64_tr_b16 v[44:45], v8 offset:41152
ds_read_b64_tr_b16 v[46:47], v8 offset:42432
v_cvt_pk_bf16_f32 v186, v212, v213
v_cvt_pk_bf16_f32 v187, v214, v215
v_mfma_f32_32x32x16_bf16 a[144:159], v[56:59], a[28:31], a[144:159]
ds_read_b64_tr_b16 v[48:49], v8 offset:41216
ds_read_b64_tr_b16 v[50:51], v8 offset:42496
s_add_u32 m0, s47, 144384
v_mul_f32 v216, v216, v15
v_mul_f32 v217, v217, v15
v_mul_f32 v218, v218, v15
s_waitcnt lgkmcnt(6)
v_mfma_f32_32x32x16_bf16 a[160:175], v[60:63], a[28:31], a[160:175]
ds_read_b64_tr_b16 v[52:53], v8 offset:46080
ds_read_b64_tr_b16 v[54:55], v8 offset:47360
v_mul_f32 v219, v219, v15
v_cvt_pk_bf16_f32 v188, v216, v217
v_mfma_f32_32x32x16_bf16 a[96:111], v[32:35], a[32:35], a[96:111]
ds_read_b64_tr_b16 v[56:57], v8 offset:46144
ds_read_b64_tr_b16 v[58:59], v8 offset:47424
buffer_load_dwordx4 v2, s[24:27], s45 offen lds
buffer_store_dwordx4 v[176:179], v27, s[12:15], s61 offen offset:0 sc1
v_cvt_pk_bf16_f32 v189, v218, v219
v_mul_f32 v220, v220, v15
v_mul_f32 v221, v221, v15
v_mfma_f32_32x32x16_bf16 a[112:127], v[36:39], a[32:35], a[112:127]
ds_read_b64_tr_b16 v[60:61], v8 offset:46208
ds_read_b64_tr_b16 v[62:63], v8 offset:47488
v_mul_f32 v222, v222, v15
v_mul_f32 v223, v223, v15
s_waitcnt lgkmcnt(6)
v_mfma_f32_32x32x16_bf16 a[128:143], v[40:43], a[32:35], a[128:143]
ds_read_b64_tr_b16 v[32:33], v8 offset:46272
ds_read_b64_tr_b16 v[34:35], v8 offset:47552
s_add_u32 m0, s47, 145408
v_cvt_pk_bf16_f32 v190, v220, v221
v_cvt_pk_bf16_f32 v191, v222, v223
v_mfma_f32_32x32x16_bf16 a[144:159], v[44:47], a[32:35], a[144:159]
ds_read_b64_tr_b16 v[36:37], v8 offset:46336
ds_read_b64_tr_b16 v[38:39], v8 offset:47616
v_mfma_f32_32x32x16_bf16 a[160:175], v[48:51], a[32:35], a[160:175]
ds_read_b64_tr_b16 v[40:41], v8 offset:51200
ds_read_b64_tr_b16 v[42:43], v8 offset:52480
buffer_load_dwordx4 v3, s[24:27], s45 offen lds
s_waitcnt lgkmcnt(6)
v_mfma_f32_32x32x16_bf16 a[96:111], v[52:55], a[36:39], a[96:111]
ds_read_b64_tr_b16 v[44:45], v8 offset:51264
ds_read_b64_tr_b16 v[46:47], v8 offset:52544
s_add_u32 m0, s47, 146432
v_mfma_f32_32x32x16_bf16 a[112:127], v[56:59], a[36:39], a[112:127]
ds_read_b64_tr_b16 v[48:49], v8 offset:51328
ds_read_b64_tr_b16 v[50:51], v8 offset:52608
v_mfma_f32_32x32x16_bf16 a[128:143], v[60:63], a[36:39], a[128:143]
ds_read_b64_tr_b16 v[52:53], v8 offset:51392
ds_read_b64_tr_b16 v[54:55], v8 offset:52672
buffer_load_dwordx4 v4, s[24:27], s45 offen lds
s_waitcnt lgkmcnt(6)
v_mfma_f32_32x32x16_bf16 a[144:159], v[32:35], a[36:39], a[144:159]
ds_read_b64_tr_b16 v[56:57], v8 offset:51456
ds_read_b64_tr_b16 v[58:59], v8 offset:52736
buffer_store_dwordx4 v[180:183], v27, s[12:15], s61 offen offset:1024 sc1
v_mfma_f32_32x32x16_bf16 a[160:175], v[36:39], a[36:39], a[160:175]
ds_read_b64_tr_b16 v[60:61], v8 offset:56320
ds_read_b64_tr_b16 v[62:63], v8 offset:57600
s_add_u32 m0, s47, 147456
v_mfma_f32_32x32x16_bf16 a[96:111], v[40:43], a[40:43], a[96:111]
ds_read_b64_tr_b16 v[32:33], v8 offset:56384
ds_read_b64_tr_b16 v[34:35], v8 offset:57664
s_waitcnt lgkmcnt(6)
v_mfma_f32_32x32x16_bf16 a[112:127], v[44:47], a[40:43], a[112:127]
ds_read_b64_tr_b16 v[36:37], v8 offset:56448
ds_read_b64_tr_b16 v[38:39], v8 offset:57728
buffer_load_dwordx4 v5, s[24:27], s45 offen lds
v_mfma_f32_32x32x16_bf16 a[128:143], v[48:51], a[40:43], a[128:143]
ds_read_b64_tr_b16 v[40:41], v8 offset:56512
ds_read_b64_tr_b16 v[42:43], v8 offset:57792
v_mfma_f32_32x32x16_bf16 a[144:159], v[52:55], a[40:43], a[144:159]
ds_read_b64_tr_b16 v[44:45], v8 offset:56576
ds_read_b64_tr_b16 v[46:47], v8 offset:57856
s_waitcnt lgkmcnt(6)
v_mfma_f32_32x32x16_bf16 a[160:175], v[56:59], a[40:43], a[160:175]
s_barrier
ds_read_b64_tr_b16 v[48:49], v9 offset:0
ds_read_b64_tr_b16 v[50:51], v9 offset:1280
v_mfma_f32_32x32x16_bf16 a[96:111], v[60:63], a[44:47], a[96:111]
ds_read_b64_tr_b16 v[52:53], v9 offset:64
ds_read_b64_tr_b16 v[54:55], v9 offset:1344
s_add_u32 s45, s5, 1
s_and_b32 s45, s45, 3
s_mul_i32 s45, s45, 245760
s_add_u32 s45, s45, s44
s_add_u32 m0, s47, 81920
v_mfma_f32_32x32x16_bf16 a[112:127], v[32:35], a[44:47], a[112:127]
ds_read_b64_tr_b16 v[56:57], v9 offset:128
ds_read_b64_tr_b16 v[58:59], v9 offset:1408
buffer_load_dwordx4 v1, s[24:27], s45 offen lds
buffer_store_dwordx4 v[184:187], v27, s[12:15], s61 offen offset:2048 sc1
s_waitcnt lgkmcnt(6)
v_mfma_f32_32x32x16_bf16 a[128:143], v[36:39], a[44:47], a[128:143]
ds_read_b64_tr_b16 v[60:61], v9 offset:192
ds_read_b64_tr_b16 v[62:63], v9 offset:1472
v_mfma_f32_32x32x16_bf16 a[144:159], v[40:43], a[44:47], a[144:159]
ds_read_b64_tr_b16 v[32:33], v9 offset:256
ds_read_b64_tr_b16 v[34:35], v9 offset:1536
s_add_u32 m0, s47, 82944
v_mfma_f32_32x32x16_bf16 a[160:175], v[44:47], a[44:47], a[160:175]
ds_read_b64_tr_b16 v[36:37], v9 offset:5120
ds_read_b64_tr_b16 v[38:39], v9 offset:6400
s_waitcnt lgkmcnt(6)
v_mfma_f32_32x32x16_bf16 a[96:111], v[48:51], a[48:51], a[96:111]
ds_read_b64_tr_b16 v[40:41], v9 offset:5184
ds_read_b64_tr_b16 v[42:43], v9 offset:6464
buffer_load_dwordx4 v2, s[24:27], s45 offen lds
v_mfma_f32_32x32x16_bf16 a[112:127], v[52:55], a[48:51], a[112:127]
ds_read_b64_tr_b16 v[44:45], v9 offset:5248
ds_read_b64_tr_b16 v[46:47], v9 offset:6528
v_mfma_f32_32x32x16_bf16 a[128:143], v[56:59], a[48:51], a[128:143]
ds_read_b64_tr_b16 v[48:49], v9 offset:5312
ds_read_b64_tr_b16 v[50:51], v9 offset:6592
s_add_u32 m0, s47, 83968
s_waitcnt lgkmcnt(6)
v_mfma_f32_32x32x16_bf16 a[144:159], v[60:63], a[48:51], a[144:159]
ds_read_b64_tr_b16 v[52:53], v9 offset:5376
ds_read_b64_tr_b16 v[54:55], v9 offset:6656
v_mfma_f32_32x32x16_bf16 a[160:175], v[32:35], a[48:51], a[160:175]
ds_read_b64_tr_b16 v[56:57], v9 offset:10240
ds_read_b64_tr_b16 v[58:59], v9 offset:11520
buffer_load_dwordx4 v3, s[24:27], s45 offen lds
buffer_store_dwordx4 v[188:191], v27, s[12:15], s61 offen offset:3072 sc1
v_mfma_f32_32x32x16_bf16 a[96:111], v[36:39], a[52:55], a[96:111]
ds_read_b64_tr_b16 v[60:61], v9 offset:10304
ds_read_b64_tr_b16 v[62:63], v9 offset:11584
s_add_u32 m0, s47, 84992
s_waitcnt vmcnt(12)
v_cmp_gt_u32 vcc, 4, v25
s_cbranch_vccnz SLOWO4
GOO4:
s_waitcnt lgkmcnt(6)
v_mfma_f32_32x32x16_bf16 a[112:127], v[40:43], a[52:55], a[112:127]
ds_read_b64_tr_b16 v[32:33], v9 offset:10368
ds_read_b64_tr_b16 v[34:35], v9 offset:11648
v_mfma_f32_32x32x16_bf16 a[128:143], v[44:47], a[52:55], a[128:143]
ds_read_b64_tr_b16 v[36:37], v9 offset:10432
ds_read_b64_tr_b16 v[38:39], v9 offset:11712
buffer_load_dwordx4 v4, s[24:27], s45 offen lds
v_mfma_f32_32x32x16_bf16 a[144:159], v[48:51], a[52:55], a[144:159]
ds_read_b64_tr_b16 v[40:41], v9 offset:10496
ds_read_b64_tr_b16 v[42:43], v9 offset:11776
s_waitcnt lgkmcnt(6)
v_mfma_f32_32x32x16_bf16 a[160:175], v[52:55], a[52:55], a[160:175]
ds_read_b64_tr_b16 v[44:45], v9 offset:15360
ds_read_b64_tr_b16 v[46:47], v9 offset:16640
s_add_u32 m0, s47, 86016
v_mfma_f32_32x32x16_bf16 a[96:111], v[56:59], a[56:59], a[96:111]
ds_read_b64_tr_b16 v[48:49], v9 offset:15424
ds_read_b64_tr_b16 v[50:51], v9 offset:16704
v_mfma_f32_32x32x16_bf16 a[112:127], v[60:63], a[56:59], a[112:127]
ds_read_b64_tr_b16 v[52:53], v9 offset:15488
ds_read_b64_tr_b16 v[54:55], v9 offset:16768
buffer_load_dwordx4 v5, s[24:27], s45 offen lds
s_waitcnt lgkmcnt(6)
v_mfma_f32_32x32x16_bf16 a[128:143], v[32:35], a[56:59], a[128:143]
ds_read_b64_tr_b16 v[56:57], v9 offset:15552
ds_read_b64_tr_b16 v[58:59], v9 offset:16832
v_mfma_f32_32x32x16_bf16 a[144:159], v[36:39], a[56:59], a[144:159]
ds_read_b64_tr_b16 v[60:61], v9 offset:15616
ds_read_b64_tr_b16 v[62:63], v9 offset:16896
v_mfma_f32_32x32x16_bf16 a[160:175], v[40:43], a[56:59], a[160:175]
s_barrier
ds_read_b64_tr_b16 v[32:33], v31 offset:0
ds_read_b64_tr_b16 v[34:35], v31 offset:1280
s_waitcnt lgkmcnt(6)
v_mfma_f32_32x32x16_bf16 a[96:111], v[44:47], a[60:63], a[96:111]
ds_read_b64_tr_b16 v[36:37], v31 offset:64
ds_read_b64_tr_b16 v[38:39], v31 offset:1344
s_add_u32 s45, s45, 81920
s_add_u32 m0, s47, 102400
v_mfma_f32_32x32x16_bf16 a[112:127], v[48:51], a[60:63], a[112:127]
ds_read_b64_tr_b16 v[40:41], v31 offset:128
ds_read_b64_tr_b16 v[42:43], v31 offset:1408
buffer_load_dwordx4 v1, s[24:27], s45 offen lds
v_mfma_f32_32x32x16_bf16 a[128:143], v[52:55], a[60:63], a[128:143]
ds_read_b64_tr_b16 v[44:45], v31 offset:192
ds_read_b64_tr_b16 v[46:47], v31 offset:1472
s_waitcnt lgkmcnt(6)
v_mfma_f32_32x32x16_bf16 a[144:159], v[56:59], a[60:63], a[144:159]
ds_read_b64_tr_b16 v[48:49], v31 offset:256
ds_read_b64_tr_b16 v[50:51], v31 offset:1536
s_add_u32 m0, s47, 103424
v_mfma_f32_32x32x16_bf16 a[160:175], v[60:63], a[60:63], a[160:175]
ds_read_b64_tr_b16 v[52:53], v31 offset:5120
ds_read_b64_tr_b16 v[54:55], v31 offset:6400
v_mfma_f32_32x32x16_bf16 a[96:111], v[32:35], a[64:67], a[96:111]
ds_read_b64_tr_b16 v[56:57], v31 offset:5184
ds_read_b64_tr_b16 v[58:59], v31 offset:6464
buffer_load_dwordx4 v2, s[24:27], s45 offen lds
s_waitcnt lgkmcnt(6)
v_mfma_f32_32x32x16_bf16 a[112:127], v[36:39], a[64:67], a[112:127]
ds_read_b64_tr_b16 v[60:61], v31 offset:5248
ds_read_b64_tr_b16 v[62:63], v31 offset:6528
v_mfma_f32_32x32x16_bf16 a[128:143], v[40:43], a[64:67], a[128:143]
ds_read_b64_tr_b16 v[32:33], v31 offset:5312
ds_read_b64_tr_b16 v[34:35], v31 offset:6592
s_add_u32 m0, s47, 104448
v_mfma_f32_32x32x16_bf16 a[144:159], v[44:47], a[64:67], a[144:159]
ds_read_b64_tr_b16 v[36:37], v31 offset:5376
ds_read_b64_tr_b16 v[38:39], v31 offset:6656
s_waitcnt lgkmcnt(6)
v_mfma_f32_32x32x16_bf16 a[160:175], v[48:51], a[64:67], a[160:175]
ds_read_b64_tr_b16 v[40:41], v31 offset:10240
ds_read_b64_tr_b16 v[42:43], v31 offset:11520
buffer_load_dwordx4 v3, s[24:27], s45 offen lds
v_mfma_f32_32x32x16_bf16 a[96:111], v[52:55], a[68:71], a[96:111]
ds_read_b64_tr_b16 v[44:45], v31 offset:10304
ds_read_b64_tr_b16 v[46:47], v31 offset:11584
s_add_u32 m0, s47, 105472
v_mfma_f32_32x32x16_bf16 a[112:127], v[56:59], a[68:71], a[112:127]
ds_read_b64_tr_b16 v[48:49], v31 offset:10368
ds_read_b64_tr_b16 v[50:51], v31 offset:11648
s_waitcnt lgkmcnt(6)
v_mfma_f32_32x32x16_bf16 a[128:143], v[60:63], a[68:71], a[128:143]
ds_read_b64_tr_b16 v[52:53], v31 offset:10432
ds_read_b64_tr_b16 v[54:55], v31 offset:11712
buffer_load_dwordx4 v4, s[24:27], s45 offen lds
v_mfma_f32_32x32x16_bf16 a[144:159], v[32:35], a[68:71], a[144:159]
ds_read_b64_tr_b16 v[56:57], v31 offset:10496
ds_read_b64_tr_b16 v[58:59], v31 offset:11776
v_mfma_f32_32x32x16_bf16 a[160:175], v[36:39], a[68:71], a[160:175]
ds_read_b64_tr_b16 v[60:61], v31 offset:15360
ds_read_b64_tr_b16 v[62:63], v31 offset:16640
s_add_u32 m0, s47, 106496
s_waitcnt lgkmcnt(6)
v_mfma_f32_32x32x16_bf16 a[96:111], v[40:43], a[72:75], a[96:111]
ds_read_b64_tr_b16 v[32:33], v31 offset:15424
ds_read_b64_tr_b16 v[34:35], v31 offset:16704
v_mfma_f32_32x32x16_bf16 a[112:127], v[44:47], a[72:75], a[112:127]
ds_read_b64_tr_b16 v[36:37], v31 offset:15488
ds_read_b64_tr_b16 v[38:39], v31 offset:16768
buffer_load_dwordx4 v5, s[24:27], s45 offen lds
v_mfma_f32_32x32x16_bf16 a[128:143], v[48:51], a[72:75], a[128:143]
ds_read_b64_tr_b16 v[40:41], v31 offset:15552
ds_read_b64_tr_b16 v[42:43], v31 offset:16832
s_waitcnt lgkmcnt(6)
v_mfma_f32_32x32x16_bf16 a[144:159], v[52:55], a[72:75], a[144:159]
ds_read_b64_tr_b16 v[44:45], v31 offset:15616
ds_read_b64_tr_b16 v[46:47], v31 offset:16896
v_mfma_f32_32x32x16_bf16 a[160:175], v[56:59], a[72:75], a[160:175]
s_barrier
ds_read_b64_tr_b16 v[48:49], v31 offset:20480
ds_read_b64_tr_b16 v[50:51], v31 offset:21760
v_mfma_f32_32x32x16_bf16 a[96:111], v[60:63], a[76:79], a[96:111]
ds_read_b64_tr_b16 v[52:53], v31 offset:20544
ds_read_b64_tr_b16 v[54:55], v31 offset:21824
s_add_u32 s45, s45, 81920
s_add_u32 m0, s47, 122880
s_waitcnt lgkmcnt(6)
v_mfma_f32_32x32x16_bf16 a[112:127], v[32:35], a[76:79], a[112:127]
ds_read_b64_tr_b16 v[56:57], v31 offset:20608
ds_read_b64_tr_b16 v[58:59], v31 offset:21888
buffer_load_dwordx4 v1, s[24:27], s45 offen lds
v_mfma_f32_32x32x16_bf16 a[128:143], v[36:39], a[76:79], a[128:143]
ds_read_b64_tr_b16 v[60:61], v31 offset:20672
ds_read_b64_tr_b16 v[62:63], v31 offset:21952
v_mfma_f32_32x32x16_bf16 a[144:159], v[40:43], a[76:79], a[144:159]
ds_read_b64_tr_b16 v[32:33], v31 offset:20736
ds_read_b64_tr_b16 v[34:35], v31 offset:22016
s_add_u32 m0, s47, 123904
s_waitcnt lgkmcnt(6)
v_mfma_f32_32x32x16_bf16 a[160:175], v[44:47], a[76:79], a[160:175]
ds_read_b64_tr_b16 v[36:37], v31 offset:25600
ds_read_b64_tr_b16 v[38:39], v31 offset:26880
v_mfma_f32_32x32x16_bf16 a[96:111], v[48:51], a[80:83], a[96:111]
ds_read_b64_tr_b16 v[40:41], v31 offset:25664
ds_read_b64_tr_b16 v[42:43], v31 offset:26944
buffer_load_dwordx4 v2, s[24:27], s45 offen lds
v_mfma_f32_32x32x16_bf16 a[112:127], v[52:55], a[80:83], a[112:127]
ds_read_b64_tr_b16 v[44:45], v31 offset:25728
ds_read_b64_tr_b16 v[46:47], v31 offset:27008
s_waitcnt lgkmcnt(6)
v_mfma_f32_32x32x16_bf16 a[128:143], v[56:59], a[80:83], a[128:143]
ds_read_b64_tr_b16 v[48:49], v31 offset:25792
ds_read_b64_tr_b16 v[50:51], v31 offset:27072
s_add_u32 m0, s47, 124928
v_mfma_f32_32x32x16_bf16 a[144:159], v[60:63], a[80:83], a[144:159]
ds_read_b64_tr_b16 v[52:53], v31 offset:25856
ds_read_b64_tr_b16 v[54:55], v31 offset:27136
v_mfma_f32_32x32x16_bf16 a[160:175], v[32:35], a[80:83], a[160:175]
ds_read_b64_tr_b16 v[56:57], v31 offset:30720
ds_read_b64_tr_b16 v[58:59], v31 offset:32000
buffer_load_dwordx4 v3, s[24:27], s45 offen lds
s_waitcnt vmcnt(10)
v_mov_b32 v29, 5
buffer_store_dword v29, v28, s[12:15], 0 offen sc1
s_waitcnt lgkmcnt(6)
v_mfma_f32_32x32x16_bf16 a[96:111], v[36:39], a[84:87], a[96:111]
ds_read_b64_tr_b16 v[60:61], v31 offset:30784
ds_read_b64_tr_b16 v[62:63], v31 offset:32064
s_add_u32 m0, s47, 125952
v_mfma_f32_32x32x16_bf16 a[112:127], v[40:43], a[84:87], a[112:127]
ds_read_b64_tr_b16 v[32:33], v31 offset:30848
ds_read_b64_tr_b16 v[34:35], v31 offset:32128
v_mfma_f32_32x32x16_bf16 a[128:143], v[44:47], a[84:87], a[128:143]
ds_read_b64_tr_b16 v[36:37], v31 offset:30912
ds_read_b64_tr_b16 v[38:39], v31 offset:32192
buffer_load_dwordx4 v4, s[24:27], s45 offen lds
s_waitcnt lgkmcnt(6)
v_mfma_f32_32x32x16_bf16 a[144:159], v[48:51], a[84:87], a[144:159]
ds_read_b64_tr_b16 v[40:41], v31 offset:30976
ds_read_b64_tr_b16 v[42:43], v31 offset:32256
v_mfma_f32_32x32x16_bf16 a[160:175], v[52:55], a[84:87], a[160:175]
ds_read_b64_tr_b16 v[44:45], v31 offset:35840
ds_read_b64_tr_b16 v[46:47], v31 offset:37120
s_add_u32 m0, s47, 126976
v_mfma_f32_32x32x16_bf16 a[96:111], v[56:59], a[88:91], a[96:111]
ds_read_b64_tr_b16 v[48:49], v31 offset:35904
ds_read_b64_tr_b16 v[50:51], v31 offset:37184
s_waitcnt lgkmcnt(6)
v_mfma_f32_32x32x16_bf16 a[112:127], v[60:63], a[88:91], a[112:127]
ds_read_b64_tr_b16 v[52:53], v31 offset:35968
ds_read_b64_tr_b16 v[54:55], v31 offset:37248
buffer_load_dwordx4 v5, s[24:27], s45 offen lds
v_mfma_f32_32x32x16_bf16 a[128:143], v[32:35], a[88:91], a[128:143]
ds_read_b64_tr_b16 v[56:57], v31 offset:36032
ds_read_b64_tr_b16 v[58:59], v31 offset:37312
v_mfma_f32_32x32x16_bf16 a[144:159], v[36:39], a[88:91], a[144:159]
ds_read_b64_tr_b16 v[60:61], v31 offset:36096
ds_read_b64_tr_b16 v[62:63], v31 offset:37376
s_waitcnt lgkmcnt(6)
v_mfma_f32_32x32x16_bf16 a[160:175], v[40:43], a[88:91], a[160:175]
s_barrier
ds_read_b64_tr_b16 v[32:33], v31 offset:40960
ds_read_b64_tr_b16 v[34:35], v31 offset:42240
v_mfma_f32_32x32x16_bf16 a[96:111], v[44:47], a[92:95], a[96:111]
ds_read_b64_tr_b16 v[36:37], v31 offset:41024
ds_read_b64_tr_b16 v[38:39], v31 offset:42304
s_add_u32 s45, s5, 2
s_and_b32 s45, s45, 3
s_mul_i32 s45, s45, 245760
s_add_u32 s45, s45, s44
s_add_u32 m0, s47, 0
v_mfma_f32_32x32x16_bf16 a[112:127], v[48:51], a[92:95], a[112:127]
ds_read_b64_tr_b16 v[40:41], v31 offset:41088
ds_read_b64_tr_b16 v[42:43], v31 offset:42368
s_waitcnt lgkmcnt(6)
v_mfma_f32_32x32x16_bf16 a[128:143], v[52:55], a[92:95], a[128:143]
ds_read_b64_tr_b16 v[44:45], v31 offset:41152
ds_read_b64_tr_b16 v[46:47], v31 offset:42432
v_mfma_f32_32x32x16_bf16 a[144:159], v[56:59], a[92:95], a[144:159]
ds_read_b64_tr_b16 v[48:49], v31 offset:41216
ds_read_b64_tr_b16 v[50:51], v31 offset:42496
buffer_load_dwordx4 v1, s[24:27], s45 offen lds
v_mfma_f32_32x32x16_bf16 a[160:175], v[60:63], a[92:95], a[160:175]
ds_read_b64_tr_b16 v[52:53], v31 offset:46080
ds_read_b64_tr_b16 v[54:55], v31 offset:47360
s_waitcnt lgkmcnt(6)
v_mfma_f32_32x32x16_bf16 a[0:15], v[32:35], v[64:67], 0
ds_read_b64_tr_b16 v[56:57], v31 offset:46144
s_add_u32 s62, s49, 4096
buffer_load_dwordx4 v[96:99], v26, s[12:15], s62 offen offset:0 sc1
v_mfma_f32_32x32x16_bf16 a[16:31], v[32:35], v[80:83], 0
ds_read_b64_tr_b16 v[58:59], v31 offset:47424
s_add_u32 m0, s47, 1024
v_mfma_f32_32x32x16_bf16 a[32:47], v[36:39], v[64:67], 0
ds_read_b64_tr_b16 v[60:61], v31 offset:46208
v_mfma_f32_32x32x16_bf16 a[48:63], v[36:39], v[80:83], 0
ds_read_b64_tr_b16 v[62:63], v31 offset:47488
v_mfma_f32_32x32x16_bf16 a[64:79], v[40:43], v[64:67], 0
ds_read_b64_tr_b16 v[32:33], v31 offset:46272
buffer_load_dwordx4 v2, s[24:27], s45 offen lds
s_add_u32 s62, s49, 4096
buffer_load_dwordx4 v[112:115], v27, s[12:15], s62 offen offset:0 sc1
v_mfma_f32_32x32x16_bf16 a[80:95], v[40:43], v[80:83], 0
ds_read_b64_tr_b16 v[34:35], v31 offset:47552
s_waitcnt lgkmcnt(6)
v_mfma_f32_32x32x16_bf16 a[176:191], v[44:47], v[64:67], 0
ds_read_b64_tr_b16 v[36:37], v31 offset:46336
v_mfma_f32_32x32x16_bf16 a[192:207], v[44:47], v[80:83], 0
ds_read_b64_tr_b16 v[38:39], v31 offset:47616
s_add_u32 m0, s47, 2048
v_mfma_f32_32x32x16_bf16 a[208:223], v[48:51], v[64:67], 0
ds_read_b64_tr_b16 v[40:41], v31 offset:51200
s_add_u32 s62, s49, 4096
buffer_load_dwordx4 v[100:103], v26, s[12:15], s62 offen offset:1024 sc1
v_mfma_f32_32x32x16_bf16 a[224:239], v[48:51], v[80:83], 0
ds_read_b64_tr_b16 v[42:43], v31 offset:52480
v_mfma_f32_32x32x16_bf16 a[0:15], v[52:55], v[68:71], a[0:15]
ds_read_b64_tr_b16 v[44:45], v31 offset:51264
buffer_load_dwordx4 v3, s[24:27], s45 offen lds
v_mfma_f32_32x32x16_bf16 a[16:31], v[52:55], v[84:87], a[16:31]
ds_read_b64_tr_b16 v[46:47], v31 offset:52544
s_add_u32 s62, s49, 4096
buffer_load_dwordx4 v[116:119], v27, s[12:15], s62 offen offset:1024 sc1
s_waitcnt lgkmcnt(6)
v_mfma_f32_32x32x16_bf16 a[32:47], v[56:59], v[68:71], a[32:47]
ds_read_b64_tr_b16 v[48:49], v31 offset:51328
v_mfma_f32_32x32x16_bf16 a[48:63], v[56:59], v[84:87], a[48:63]
ds_read_b64_tr_b16 v[50:51], v31 offset:52608
s_add_u32 m0, s47, 3072
v_mfma_f32_32x32x16_bf16 a[64:79], v[60:63], v[68:71], a[64:79]
ds_read_b64_tr_b16 v[52:53], v31 offset:51392
s_and_b32 s63, s2, 0xe7
v_and_b32 v24, 3, v0
v_lshlrev_b32 v24, 3, v24
v_add_u32 v24, s63, v24
v_lshlrev_b32 v24, 7, v24
buffer_load_dword v25, v24, s[12:15], s95 offen sc1
v_accvgpr_read_b32 v18, a96
v_accvgpr_read_b32 v19, a97
v_accvgpr_read_b32 v20, a98
v_mfma_f32_32x32x16_bf16 a[80:95], v[60:63], v[84:87], a[80:95]
ds_read_b64_tr_b16 v[54:55], v31 offset:52672
v_accvgpr_read_b32 v21, a99
v_cvt_pk_bf16_f32 v14, v18, v19
s_add_u32 s62, s49, 4096
buffer_load_dwordx4 v[104:107], v26, s[12:15], s62 offen offset:2048 sc1
v_mfma_f32_32x32x16_bf16 a[176:191], v[32:35], v[68:71], a[176:191]
ds_read_b64_tr_b16 v[56:57], v31 offset:51456
buffer_load_dwordx4 v4, s[24:27], s45 offen lds
v_cvt_pk_bf16_f32 v15, v20, v21
v_accvgpr_read_b32 v18, a100
v_mfma_f32_32x32x16_bf16 a[192:207], v[32:35], v[84:87], a[192:207]
ds_read_b64_tr_b16 v[58:59], v31 offset:52736
v_accvgpr_read_b32 v19, a101
v_accvgpr_read_b32 v20, a102
s_waitcnt lgkmcnt(6)
v_mfma_f32_32x32x16_bf16 a[208:223], v[36:39], v[68:71], a[208:223]
ds_read_b64_tr_b16 v[60:61], v31 offset:56320
v_accvgpr_read_b32 v21, a103
v_cvt_pk_bf16_f32 v16, v18, v19
s_add_u32 s62, s49, 4096
buffer_load_dwordx4 v[120:123], v27, s[12:15], s62 offen offset:2048 sc1
v_mfma_f32_32x32x16_bf16 a[224:239], v[36:39], v[84:87], a[224:239]
ds_read_b64_tr_b16 v[62:63], v31 offset:57600
s_add_u32 m0, s47, 4096
v_cvt_pk_bf16_f32 v17, v20, v21
buffer_store_dwordx4 v[14:17], v10, s[12:15], 0 offen offset:0 sc1
v_mfma_f32_32x32x16_bf16 a[0:15], v[40:43], v[72:75], a[0:15]
ds_read_b64_tr_b16 v[32:33], v31 offset:56384
v_mfma_f32_32x32x16_bf16 a[16:31], v[40:43], v[88:91], a[16:31]
ds_read_b64_tr_b16 v[34:35], v31 offset:57664
v_mfma_f32_32x32x16_bf16 a[32:47], v[44:47], v[72:75], a[32:47]
ds_read_b64_tr_b16 v[36:37], v31 offset:56448
buffer_load_dwordx4 v5, s[24:27], s45 offen lds
s_add_u32 s62, s49, 4096
buffer_load_dwordx4 v[108:111], v26, s[12:15], s62 offen offset:3072 sc1
v_mfma_f32_32x32x16_bf16 a[48:63], v[44:47], v[88:91], a[48:63]
ds_read_b64_tr_b16 v[38:39], v31 offset:57728
s_waitcnt lgkmcnt(6)
v_mfma_f32_32x32x16_bf16 a[64:79], v[48:51], v[72:75], a[64:79]
ds_read_b64_tr_b16 v[40:41], v31 offset:56512
v_accvgpr_read_b32 v18, a104
v_accvgpr_read_b32 v19, a105
v_accvgpr_read_b32 v20, a106
v_mfma_f32_32x32x16_bf16 a[80:95], v[48:51], v[88:91], a[80:95]
ds_read_b64_tr_b16 v[42:43], v31 offset:57792
v_accvgpr_read_b32 v21, a107
v_cvt_pk_bf16_f32 v14, v18, v19
s_add_u32 s62, s49, 4096
buffer_load_dwordx4 v[124:127], v27, s[12:15], s62 offen offset:3072 sc1
v_mfma_f32_32x32x16_bf16 a[176:191], v[52:55], v[72:75], a[176:191]
ds_read_b64_tr_b16 v[44:45], v31 offset:56576
v_cvt_pk_bf16_f32 v15, v20, v21
v_accvgpr_read_b32 v18, a108
v_mfma_f32_32x32x16_bf16 a[192:207], v[52:55], v[88:91], a[192:207]
ds_read_b64_tr_b16 v[46:47], v31 offset:57856
v_accvgpr_read_b32 v19, a109
v_accvgpr_read_b32 v20, a110
v_mfma_f32_32x32x16_bf16 a[208:223], v[56:59], v[72:75], a[208:223]
s_barrier
ds_read_b64_tr_b16 v[48:49], v8 offset:0
v_accvgpr_read_b32 v21, a111
v_cvt_pk_bf16_f32 v16, v18, v19
v_mfma_f32_32x32x16_bf16 a[224:239], v[56:59], v[88:91], a[224:239]
ds_read_b64_tr_b16 v[50:51], v8 offset:1280
s_add_u32 s45, s45, 81920
s_add_u32 m0, s47, 20480
v_cvt_pk_bf16_f32 v17, v20, v21
buffer_store_dwordx4 v[14:17], v10, s[12:15], 0 offen offset:1024 sc1
s_add_u32 s62, s51, 0
buffer_load_dwordx4 v[64:67], v26, s[12:15], s62 offen offset:0 sc1
s_waitcnt lgkmcnt(6)
v_mfma_f32_32x32x16_bf16 a[0:15], v[60:63], v[76:79], a[0:15]
ds_read_b64_tr_b16 v[52:53], v8 offset:64
v_mfma_f32_32x32x16_bf16 a[16:31], v[60:63], v[92:95], a[16:31]
ds_read_b64_tr_b16 v[54:55], v8 offset:1344
v_mfma_f32_32x32x16_bf16 a[32:47], v[32:35], v[76:79], a[32:47]
ds_read_b64_tr_b16 v[56:57], v8 offset:128
buffer_load_dwordx4 v1, s[24:27], s45 offen lds
v_mfma_f32_32x32x16_bf16 a[48:63], v[32:35], v[92:95], a[48:63]
ds_read_b64_tr_b16 v[58:59], v8 offset:1408
s_add_u32 s62, s51, 0
buffer_load_dwordx4 v[80:83], v27, s[12:15], s62 offen offset:0 sc1
v_mfma_f32_32x32x16_bf16 a[64:79], v[36:39], v[76:79], a[64:79]
ds_read_b64_tr_b16 v[60:61], v8 offset:192
v_accvgpr_read_b32 v18, a112
v_accvgpr_read_b32 v19, a113
v_accvgpr_read_b32 v20, a114
v_mfma_f32_32x32x16_bf16 a[80:95], v[36:39], v[92:95], a[80:95]
ds_read_b64_tr_b16 v[62:63], v8 offset:1472
s_add_u32 m0, s47, 21504
v_accvgpr_read_b32 v21, a115
v_cvt_pk_bf16_f32 v14, v18, v19
s_waitcnt lgkmcnt(6)
v_mfma_f32_32x32x16_bf16 a[176:191], v[40:43], v[76:79], a[176:191]
ds_read_b64_tr_b16 v[32:33], v8 offset:256
v_cvt_pk_bf16_f32 v15, v20, v21
v_accvgpr_read_b32 v18, a116
s_add_u32 s62, s51, 0
buffer_load_dwordx4 v[68:71], v26, s[12:15], s62 offen offset:1024 sc1
v_mfma_f32_32x32x16_bf16 a[192:207], v[40:43], v[92:95], a[192:207]
ds_read_b64_tr_b16 v[34:35], v8 offset:1536
v_accvgpr_read_b32 v19, a117
v_accvgpr_read_b32 v20, a118
v_mfma_f32_32x32x16_bf16 a[208:223], v[44:47], v[76:79], a[208:223]
ds_read_b64_tr_b16 v[36:37], v8 offset:5120
buffer_load_dwordx4 v2, s[24:27], s45 offen lds
v_accvgpr_read_b32 v21, a119
v_cvt_pk_bf16_f32 v16, v18, v19
v_mfma_f32_32x32x16_bf16 a[224:239], v[44:47], v[92:95], a[224:239]
ds_read_b64_tr_b16 v[38:39], v8 offset:6400
v_cvt_pk_bf16_f32 v17, v20, v21
buffer_store_dwordx4 v[14:17], v10, s[12:15], 0 offen offset:2048 sc1
v_mfma_f32_32x32x16_bf16 a[0:15], v[48:51], v[128:131], a[0:15]
ds_read_b64_tr_b16 v[40:41], v8 offset:5184
s_add_u32 s62, s51, 0
buffer_load_dwordx4 v[84:87], v27, s[12:15], s62 offen offset:1024 sc1
v_mfma_f32_32x32x16_bf16 a[16:31], v[48:51], v[144:147], a[16:31]
ds_read_b64_tr_b16 v[42:43], v8 offset:6464
s_add_u32 m0, s47, 22528
s_waitcnt lgkmcnt(6)
v_mfma_f32_32x32x16_bf16 a[32:47], v[52:55], v[128:131], a[32:47]
ds_read_b64_tr_b16 v[44:45], v8 offset:5248
v_mfma_f32_32x32x16_bf16 a[48:63], v[52:55], v[144:147], a[48:63]
ds_read_b64_tr_b16 v[46:47], v8 offset:6528
s_add_u32 s62, s51, 0
buffer_load_dwordx4 v[72:75], v26, s[12:15], s62 offen offset:2048 sc1
v_mfma_f32_32x32x16_bf16 a[64:79], v[56:59], v[128:131], a[64:79]
ds_read_b64_tr_b16 v[48:49], v8 offset:5312
buffer_load_dwordx4 v3, s[24:27], s45 offen lds
s_waitcnt vmcnt(17)
v_cmp_gt_u32 vcc, 5, v25
s_cbranch_vccnz SLOWO5
GOO5:
v_accvgpr_read_b32 v18, a120
v_accvgpr_read_b32 v19, a121
v_accvgpr_read_b32 v20, a122
v_mfma_f32_32x32x16_bf16 a[80:95], v[56:59], v[144:147], a[80:95]
ds_read_b64_tr_b16 v[50:51], v8 offset:6592
v_accvgpr_read_b32 v21, a123
v_cvt_pk_bf16_f32 v14, v18, v19
v_mfma_f32_32x32x16_bf16 a[176:191], v[60:63], v[128:131], a[176:191]
ds_read_b64_tr_b16 v[52:53], v8 offset:5376
v_cvt_pk_bf16_f32 v15, v20, v21
v_accvgpr_read_b32 v18, a124
v_mfma_f32_32x32x16_bf16 a[192:207], v[60:63], v[144:147], a[192:207]
ds_read_b64_tr_b16 v[54:55], v8 offset:6656
s_add_u32 m0, s47, 23552
v_accvgpr_read_b32 v19, a125
v_accvgpr_read_b32 v20, a126
s_add_u32 s62, s49, 8192
buffer_load_dwordx4 v[192:195], v26, s[12:15], s62 offen offset:0 sc1
s_waitcnt lgkmcnt(6)
v_mfma_f32_32x32x16_bf16 a[208:223], v[32:35], v[128:131], a[208:223]
ds_read_b64_tr_b16 v[56:57], v8 offset:10240
v_accvgpr_read_b32 v21, a127
v_cvt_pk_bf16_f32 v16, v18, v19
v_mfma_f32_32x32x16_bf16 a[224:239], v[32:35], v[144:147], a[224:239]
ds_read_b64_tr_b16 v[58:59], v8 offset:11520
v_cvt_pk_bf16_f32 v17, v20, v21
buffer_store_dwordx4 v[14:17], v10, s[12:15], 0 offen offset:3072 sc1
v_mfma_f32_32x32x16_bf16 a[0:15], v[36:39], v[132:135], a[0:15]
ds_read_b64_tr_b16 v[60:61], v8 offset:10304
buffer_load_dwordx4 v4, s[24:27], s45 offen lds
v_mfma_f32_32x32x16_bf16 a[16:31], v[36:39], v[148:151], a[16:31]
ds_read_b64_tr_b16 v[62:63], v8 offset:11584
s_add_u32 s62, s49, 8192
buffer_load_dwordx4 v[208:211], v27, s[12:15], s62 offen offset:0 sc1
v_mfma_f32_32x32x16_bf16 a[32:47], v[40:43], v[132:135], a[32:47]
ds_read_b64_tr_b16 v[32:33], v8 offset:10368
v_mfma_f32_32x32x16_bf16 a[48:63], v[40:43], v[148:151], a[48:63]
ds_read_b64_tr_b16 v[34:35], v8 offset:11648
s_add_u32 m0, s47, 24576
s_waitcnt lgkmcnt(6)
v_mfma_f32_32x32x16_bf16 a[64:79], v[44:47], v[132:135], a[64:79]
ds_read_b64_tr_b16 v[36:37], v8 offset:10432
v_accvgpr_read_b32 v18, a128
v_accvgpr_read_b32 v19, a129
v_accvgpr_read_b32 v20, a130
s_add_u32 s62, s49, 8192
buffer_load_dwordx4 v[196:199], v26, s[12:15], s62 offen offset:1024 sc1
v_mfma_f32_32x32x16_bf16 a[80:95], v[44:47], v[148:151], a[80:95]
ds_read_b64_tr_b16 v[38:39], v8 offset:11712
v_accvgpr_read_b32 v21, a131
v_cvt_pk_bf16_f32 v14, v18, v19
v_mfma_f32_32x32x16_bf16 a[176:191], v[48:51], v[132:135], a[176:191]
ds_read_b64_tr_b16 v[40:41], v8 offset:10496
buffer_load_dwordx4 v5, s[24:27], s45 offen lds
v_cvt_pk_bf16_f32 v15, v20, v21
v_accvgpr_read_b32 v18, a132
v_mfma_f32_32x32x16_bf16 a[192:207], v[48:51], v[148:151], a[192:207]
ds_read_b64_tr_b16 v[42:43], v8 offset:11776
v_accvgpr_read_b32 v19, a133
v_accvgpr_read_b32 v20, a134
v_mfma_f32_32x32x16_bf16 a[208:223], v[52:55], v[132:135], a[208:223]
ds_read_b64_tr_b16 v[44:45], v8 offset:15360
v_accvgpr_read_b32 v21, a135
v_cvt_pk_bf16_f32 v16, v18, v19
s_add_u32 s62, s49, 8192
buffer_load_dwordx4 v[212:215], v27, s[12:15], s62 offen offset:1024 sc1
v_mfma_f32_32x32x16_bf16 a[224:239], v[52:55], v[148:151], a[224:239]
ds_read_b64_tr_b16 v[46:47], v8 offset:16640
v_cvt_pk_bf16_f32 v17, v20, v21
buffer_store_dwordx4 v[14:17], v10, s[12:15], s56 offen offset:0 sc1
s_waitcnt lgkmcnt(6)
v_mfma_f32_32x32x16_bf16 a[0:15], v[56:59], v[136:139], a[0:15]
ds_read_b64_tr_b16 v[48:49], v8 offset:15424
v_mfma_f32_32x32x16_bf16 a[16:31], v[56:59], v[152:155], a[16:31]
ds_read_b64_tr_b16 v[50:51], v8 offset:16704
s_add_u32 s62, s49, 8192
buffer_load_dwordx4 v[200:203], v26, s[12:15], s62 offen offset:2048 sc1
v_mfma_f32_32x32x16_bf16 a[32:47], v[60:63], v[136:139], a[32:47]
ds_read_b64_tr_b16 v[52:53], v8 offset:15488
v_mfma_f32_32x32x16_bf16 a[48:63], v[60:63], v[152:155], a[48:63]
ds_read_b64_tr_b16 v[54:55], v8 offset:16768
v_mfma_f32_32x32x16_bf16 a[64:79], v[32:35], v[136:139], a[64:79]
ds_read_b64_tr_b16 v[56:57], v8 offset:15552
v_accvgpr_read_b32 v18, a136
v_accvgpr_read_b32 v19, a137
v_accvgpr_read_b32 v20, a138
v_mfma_f32_32x32x16_bf16 a[80:95], v[32:35], v[152:155], a[80:95]
ds_read_b64_tr_b16 v[58:59], v8 offset:16832
v_accvgpr_read_b32 v21, a139
v_cvt_pk_bf16_f32 v14, v18, v19
s_add_u32 s62, s49, 8192
buffer_load_dwordx4 v[216:219], v27, s[12:15], s62 offen offset:2048 sc1
s_waitcnt lgkmcnt(6)
v_mfma_f32_32x32x16_bf16 a[176:191], v[36:39], v[136:139], a[176:191]
ds_read_b64_tr_b16 v[60:61], v8 offset:15616
v_cvt_pk_bf16_f32 v15, v20, v21
v_accvgpr_read_b32 v18, a140
v_mfma_f32_32x32x16_bf16 a[192:207], v[36:39], v[152:155], a[192:207]
ds_read_b64_tr_b16 v[62:63], v8 offset:16896
v_accvgpr_read_b32 v19, a141
v_accvgpr_read_b32 v20, a142
v_mfma_f32_32x32x16_bf16 a[208:223], v[40:43], v[136:139], a[208:223]
s_barrier
ds_read_b64_tr_b16 v[32:33], v9 offset:20480
v_accvgpr_read_b32 v21, a143
v_cvt_pk_bf16_f32 v16, v18, v19
v_mfma_f32_32x32x16_bf16 a[224:239], v[40:43], v[152:155], a[224:239]
ds_read_b64_tr_b16 v[34:35], v9 offset:21760
s_add_u32 s45, s45, 81920
s_add_u32 m0, s47, 40960
v_cvt_pk_bf16_f32 v17, v20, v21
buffer_store_dwordx4 v[14:17], v10, s[12:15], s56 offen offset:1024 sc1
s_add_u32 s62, s49, 8192
buffer_load_dwordx4 v[204:207], v26, s[12:15], s62 offen offset:3072 sc1
v_mfma_f32_32x32x16_bf16 a[0:15], v[44:47], v[140:143], a[0:15]
ds_read_b64_tr_b16 v[36:37], v9 offset:20544
v_mfma_f32_32x32x16_bf16 a[16:31], v[44:47], v[156:159], a[16:31]
ds_read_b64_tr_b16 v[38:39], v9 offset:21824
s_waitcnt lgkmcnt(6)
v_mfma_f32_32x32x16_bf16 a[32:47], v[48:51], v[140:143], a[32:47]
ds_read_b64_tr_b16 v[40:41], v9 offset:20608
buffer_load_dwordx4 v1, s[24:27], s45 offen lds
s_add_u32 s62, s49, 8192
buffer_load_dwordx4 v[220:223], v27, s[12:15], s62 offen offset:3072 sc1
v_mfma_f32_32x32x16_bf16 a[48:63], v[48:51], v[156:159], a[48:63]
ds_read_b64_tr_b16 v[42:43], v9 offset:21888
v_mfma_f32_32x32x16_bf16 a[64:79], v[52:55], v[140:143], a[64:79]
ds_read_b64_tr_b16 v[44:45], v9 offset:20672
v_accvgpr_read_b32 v18, a144
v_accvgpr_read_b32 v19, a145
v_accvgpr_read_b32 v20, a146
v_mfma_f32_32x32x16_bf16 a[80:95], v[52:55], v[156:159], a[80:95]
ds_read_b64_tr_b16 v[46:47], v9 offset:21952
s_add_u32 m0, s47, 41984
v_accvgpr_read_b32 v21, a147
v_cvt_pk_bf16_f32 v14, v18, v19
v_mfma_f32_32x32x16_bf16 a[176:191], v[56:59], v[140:143], a[176:191]
ds_read_b64_tr_b16 v[48:49], v9 offset:20736
v_cvt_pk_bf16_f32 v15, v20, v21
v_accvgpr_read_b32 v18, a148
s_add_u32 s62, s51, 0
buffer_load_dwordx4 v[88:91], v27, s[12:15], s62 offen offset:2048 sc1
v_mfma_f32_32x32x16_bf16 a[192:207], v[56:59], v[156:159], a[192:207]
ds_read_b64_tr_b16 v[50:51], v9 offset:22016
v_accvgpr_read_b32 v19, a149
v_accvgpr_read_b32 v20, a150
s_waitcnt lgkmcnt(6)
v_mfma_f32_32x32x16_bf16 a[208:223], v[60:63], v[140:143], a[208:223]
ds_read_b64_tr_b16 v[52:53], v9 offset:25600
buffer_load_dwordx4 v2, s[24:27], s45 offen lds
v_accvgpr_read_b32 v21, a151
v_cvt_pk_bf16_f32 v16, v18, v19
v_mfma_f32_32x32x16_bf16 a[224:239], v[60:63], v[156:159], a[224:239]
ds_read_b64_tr_b16 v[54:55], v9 offset:26880
v_cvt_pk_bf16_f32 v17, v20, v21
buffer_store_dwordx4 v[14:17], v10, s[12:15], s56 offen offset:2048 sc1
s_add_u32 s62, s51, 0
buffer_load_dwordx4 v[76:79], v26, s[12:15], s62 offen offset:3072 sc1
v_mfma_f32_32x32x16_bf16 a[0:15], v[32:35], v[160:163], a[0:15]
ds_read_b64_tr_b16 v[56:57], v9 offset:25664
v_mfma_f32_32x32x16_bf16 a[16:31], v[32:35], v[176:179], a[16:31]
ds_read_b64_tr_b16 v[58:59], v9 offset:26944
s_add_u32 m0, s47, 43008
v_mfma_f32_32x32x16_bf16 a[32:47], v[36:39], v[160:163], a[32:47]
ds_read_b64_tr_b16 v[60:61], v9 offset:25728
v_mfma_f32_32x32x16_bf16 a[48:63], v[36:39], v[176:179], a[48:63]
ds_read_b64_tr_b16 v[62:63], v9 offset:27008
s_add_u32 s62, s51, 0
buffer_load_dwordx4 v[92:95], v27, s[12:15], s62 offen offset:3072 sc1
s_waitcnt lgkmcnt(6)
v_mfma_f32_32x32x16_bf16 a[64:79], v[40:43], v[160:163], a[64:79]
ds_read_b64_tr_b16 v[32:33], v9 offset:25792
buffer_load_dwordx4 v3, s[24:27], s45 offen lds
v_accvgpr_read_b32 v18, a152
v_accvgpr_read_b32 v19, a153
v_accvgpr_read_b32 v20, a154
v_mfma_f32_32x32x16_bf16 a[80:95], v[40:43], v[176:179], a[80:95]
ds_read_b64_tr_b16 v[34:35], v9 offset:27072
v_accvgpr_read_b32 v21, a155
v_cvt_pk_bf16_f32 v14, v18, v19
v_mfma_f32_32x32x16_bf16 a[176:191], v[44:47], v[160:163], a[176:191]
ds_read_b64_tr_b16 v[36:37], v9 offset:25856
v_cvt_pk_bf16_f32 v15, v20, v21
v_accvgpr_read_b32 v18, a156
v_mfma_f32_32x32x16_bf16 a[192:207], v[44:47], v[176:179], a[192:207]
ds_read_b64_tr_b16 v[38:39], v9 offset:27136
s_add_u32 m0, s47, 44032
v_accvgpr_read_b32 v19, a157
v_accvgpr_read_b32 v20, a158
s_add_u32 s62, s51, 4096
buffer_load_dwordx4 v[128:131], v26, s[12:15], s62 offen offset:0 sc1
v_mfma_f32_32x32x16_bf16 a[208:223], v[48:51], v[160:163], a[208:223]
ds_read_b64_tr_b16 v[40:41], v9 offset:30720
v_accvgpr_read_b32 v21, a159
v_cvt_pk_bf16_f32 v16, v18, v19
v_mfma_f32_32x32x16_bf16 a[224:239], v[48:51], v[176:179], a[224:239]
ds_read_b64_tr_b16 v[42:43], v9 offset:32000
v_cvt_pk_bf16_f32 v17, v20, v21
buffer_store_dwordx4 v[14:17], v10, s[12:15], s56 offen offset:3072 sc1
s_waitcnt lgkmcnt(6)
v_mfma_f32_32x32x16_bf16 a[0:15], v[52:55], v[164:167], a[0:15]
ds_read_b64_tr_b16 v[44:45], v9 offset:30784
buffer_load_dwordx4 v4, s[24:27], s45 offen lds
s_and_b32 s63, s91, 7
s_mul_i32 s63, s63, 12
s_add_u32 s63, s63, s4
s_mul_i32 s63, s63, 10240
s_add_u32 s63, s63, s90
v_add_u32 v12, s63, v30
s_add_u32 s62, s51, 4096
buffer_load_dwordx4 v[144:147], v27, s[12:15], s62 offen offset:0 sc1
v_mfma_f32_32x32x16_bf16 a[16:31], v[52:55], v[180:183], a[16:31]
ds_read_b64_tr_b16 v[46:47], v9 offset:32064
v_mfma_f32_32x32x16_bf16 a[32:47], v[56:59], v[164:167], a[32:47]
ds_read_b64_tr_b16 v[48:49], v9 offset:30848
v_mfma_f32_32x32x16_bf16 a[48:63], v[56:59], v[180:183], a[48:63]
ds_read_b64_tr_b16 v[50:51], v9 offset:32128
s_add_u32 m0, s47, 45056
v_mfma_f32_32x32x16_bf16 a[64:79], v[60:63], v[164:167], a[64:79]
ds_read_b64_tr_b16 v[52:53], v9 offset:30912
v_accvgpr_read_b32 v18, a160
v_accvgpr_read_b32 v19, a161
v_accvgpr_read_b32 v20, a162
s_add_u32 s62, s51, 4096
buffer_load_dwordx4 v[132:135], v26, s[12:15], s62 offen offset:1024 sc1
v_mfma_f32_32x32x16_bf16 a[80:95], v[60:63], v[180:183], a[80:95]
ds_read_b64_tr_b16 v[54:55], v9 offset:32192
s_and_b32 s63, s92, 7
s_mul_i32 s63, s63, 12
s_add_u32 s63, s63, s4
s_mul_i32 s63, s63, 10240
s_add_u32 s63, s63, s90
v_add_u32 v13, s63, v30
v_accvgpr_read_b32 v21, a163
v_cvt_pk_bf16_f32 v14, v18, v19
s_waitcnt lgkmcnt(6)
v_mfma_f32_32x32x16_bf16 a[176:191], v[32:35], v[164:167], a[176:191]
ds_read_b64_tr_b16 v[56:57], v9 offset:30976
buffer_load_dwordx4 v5, s[24:27], s45 offen lds
v_cvt_pk_bf16_f32 v15, v20, v21
v_accvgpr_read_b32 v18, a164
v_mfma_f32_32x32x16_bf16 a[192:207], v[32:35], v[180:183], a[192:207]
ds_read_b64_tr_b16 v[58:59], v9 offset:32256
v_accvgpr_read_b32 v19, a165
v_accvgpr_read_b32 v20, a166
s_add_u32 s62, s51, 4096
buffer_load_dwordx4 v[148:151], v27, s[12:15], s62 offen offset:1024 sc1
v_mfma_f32_32x32x16_bf16 a[208:223], v[36:39], v[164:167], a[208:223]
ds_read_b64_tr_b16 v[60:61], v9 offset:35840
v_accvgpr_read_b32 v21, a167
v_cvt_pk_bf16_f32 v16, v18, v19
v_mfma_f32_32x32x16_bf16 a[224:239], v[36:39], v[180:183], a[224:239]
ds_read_b64_tr_b16 v[62:63], v9 offset:37120
v_cvt_pk_bf16_f32 v17, v20, v21
buffer_store_dwordx4 v[14:17], v10, s[12:15], s57 offen offset:0 sc1
v_mfma_f32_32x32x16_bf16 a[0:15], v[40:43], v[168:171], a[0:15]
ds_read_b64_tr_b16 v[32:33], v9 offset:35904
v_mfma_f32_32x32x16_bf16 a[16:31], v[40:43], v[184:187], a[16:31]
ds_read_b64_tr_b16 v[34:35], v9 offset:37184
s_add_u32 s62, s51, 4096
buffer_load_dwordx4 v[136:139], v26, s[12:15], s62 offen offset:2048 sc1
s_waitcnt lgkmcnt(6)
v_mfma_f32_32x32x16_bf16 a[32:47], v[44:47], v[168:171], a[32:47]
ds_read_b64_tr_b16 v[36:37], v9 offset:35968
v_mfma_f32_32x32x16_bf16 a[48:63], v[44:47], v[184:187], a[48:63]
ds_read_b64_tr_b16 v[38:39], v9 offset:37248
v_mfma_f32_32x32x16_bf16 a[64:79], v[48:51], v[168:171], a[64:79]
ds_read_b64_tr_b16 v[40:41], v9 offset:36032
v_accvgpr_read_b32 v18, a168
v_accvgpr_read_b32 v19, a169
v_accvgpr_read_b32 v20, a170
v_mfma_f32_32x32x16_bf16 a[80:95], v[48:51], v[184:187], a[80:95]
ds_read_b64_tr_b16 v[42:43], v9 offset:37312
v_accvgpr_read_b32 v21, a171
v_cvt_pk_bf16_f32 v14, v18, v19
s_add_u32 s62, s51, 4096
buffer_load_dwordx4 v[152:155], v27, s[12:15], s62 offen offset:2048 sc1
v_mfma_f32_32x32x16_bf16 a[176:191], v[52:55], v[168:171], a[176:191]
ds_read_b64_tr_b16 v[44:45], v9 offset:36096
v_cvt_pk_bf16_f32 v15, v20, v21
v_accvgpr_read_b32 v18, a172
v_mfma_f32_32x32x16_bf16 a[192:207], v[52:55], v[184:187], a[192:207]
ds_read_b64_tr_b16 v[46:47], v9 offset:37376
v_accvgpr_read_b32 v19, a173
v_accvgpr_read_b32 v20, a174
s_waitcnt lgkmcnt(6)
v_mfma_f32_32x32x16_bf16 a[208:223], v[56:59], v[168:171], a[208:223]
s_barrier
ds_read_b64_tr_b16 v[48:49], v8 offset:20480
v_accvgpr_read_b32 v21, a175
v_cvt_pk_bf16_f32 v16, v18, v19
s_add_u32 s62, s51, 4096
buffer_load_dwordx4 v[140:143], v26, s[12:15], s62 offen offset:3072 sc1
v_mfma_f32_32x32x16_bf16 a[224:239], v[56:59], v[184:187], a[224:239]
ds_read_b64_tr_b16 v[50:51], v8 offset:21760
s_add_u32 s45, s5, 3
s_and_b32 s45, s45, 3
s_mul_i32 s45, s45, 245760
s_add_u32 s45, s45, s44
s_add_u32 m0, s47, 61440
v_cvt_pk_bf16_f32 v17, v20, v21
buffer_store_dwordx4 v[14:17], v10, s[12:15], s57 offen offset:1024 sc1
v_mfma_f32_32x32x16_bf16 a[0:15], v[60:63], v[172:175], a[0:15]
ds_read_b64_tr_b16 v[52:53], v8 offset:20544
v_mfma_f32_32x32x16_bf16 a[16:31], v[60:63], v[188:191], a[16:31]
ds_read_b64_tr_b16 v[54:55], v8 offset:21824
v_mfma_f32_32x32x16_bf16 a[32:47], v[32:35], v[172:175], a[32:47]
ds_read_b64_tr_b16 v[56:57], v8 offset:20608
buffer_load_dwordx4 v1, s[24:27], s45 offen lds
s_add_u32 s62, s51, 4096
buffer_load_dwordx4 v[156:159], v27, s[12:15], s62 offen offset:3072 sc1
v_mfma_f32_32x32x16_bf16 a[48:63], v[32:35], v[188:191], a[48:63]
ds_read_b64_tr_b16 v[58:59], v8 offset:21888
s_waitcnt lgkmcnt(6)
v_mfma_f32_32x32x16_bf16 a[64:79], v[36:39], v[172:175], a[64:79]
ds_read_b64_tr_b16 v[60:61], v8 offset:20672
v_mfma_f32_32x32x16_bf16 a[80:95], v[36:39], v[188:191], a[80:95]
ds_read_b64_tr_b16 v[62:63], v8 offset:21952
s_add_u32 m0, s47, 62464
s_add_u32 s62, s51, 8192
buffer_load_dwordx4 v[160:163], v26, s[12:15], s62 offen offset:0 sc1
v_mfma_f32_32x32x16_bf16 a[176:191], v[40:43], v[172:175], a[176:191]
ds_read_b64_tr_b16 v[32:33], v8 offset:20736
v_mfma_f32_32x32x16_bf16 a[192:207], v[40:43], v[188:191], a[192:207]
ds_read_b64_tr_b16 v[34:35], v8 offset:22016
v_mfma_f32_32x32x16_bf16 a[208:223], v[44:47], v[172:175], a[208:223]
ds_read_b64_tr_b16 v[36:37], v8 offset:25600
buffer_load_dwordx4 v2, s[24:27], s45 offen lds
v_mfma_f32_32x32x16_bf16 a[224:239], v[44:47], v[188:191], a[224:239]
ds_read_b64_tr_b16 v[38:39], v8 offset:26880
s_add_u32 s62, s51, 8192
buffer_load_dwordx4 v[176:179], v27, s[12:15], s62 offen offset:0 sc1
s_waitcnt lgkmcnt(6)
v_mfma_f32_32x32x16_bf16 a[0:15], v[48:51], v[224:227], a[0:15]
ds_read_b64_tr_b16 v[40:41], v8 offset:25664
v_mfma_f32_32x32x16_bf16 a[16:31], v[48:51], v[240:243], a[16:31]
ds_read_b64_tr_b16 v[42:43], v8 offset:26944
s_add_u32 m0, s47, 63488
v_mfma_f32_32x32x16_bf16 a[32:47], v[52:55], v[224:227], a[32:47]
ds_read_b64_tr_b16 v[44:45], v8 offset:25728
v_mfma_f32_32x32x16_bf16 a[48:63], v[52:55], v[240:243], a[48:63]
ds_read_b64_tr_b16 v[46:47], v8 offset:27008
s_add_u32 s62, s51, 8192
buffer_load_dwordx4 v[164:167], v26, s[12:15], s62 offen offset:1024 sc1
v_mfma_f32_32x32x16_bf16 a[64:79], v[56:59], v[224:227], a[64:79]
ds_read_b64_tr_b16 v[48:49], v8 offset:25792
buffer_load_dwordx4 v3, s[24:27], s45 offen lds
v_mfma_f32_32x32x16_bf16 a[80:95], v[56:59], v[240:243], a[80:95]
ds_read_b64_tr_b16 v[50:51], v8 offset:27072
s_waitcnt lgkmcnt(6)
v_mfma_f32_32x32x16_bf16 a[176:191], v[60:63], v[224:227], a[176:191]
ds_read_b64_tr_b16 v[52:53], v8 offset:25856
s_add_u32 s62, s51, 8192
buffer_load_dwordx4 v[180:183], v27, s[12:15], s62 offen offset:1024 sc1
v_mfma_f32_32x32x16_bf16 a[192:207], v[60:63], v[240:243], a[192:207]
ds_read_b64_tr_b16 v[54:55], v8 offset:27136
s_add_u32 m0, s47, 64512
v_mfma_f32_32x32x16_bf16 a[208:223], v[32:35], v[224:227], a[208:223]
ds_read_b64_tr_b16 v[56:57], v8 offset:30720
v_mfma_f32_32x32x16_bf16 a[224:239], v[32:35], v[240:243], a[224:239]
ds_read_b64_tr_b16 v[58:59], v8 offset:32000
v_mfma_f32_32x32x16_bf16 a[0:15], v[36:39], v[228:231], a[0:15]
ds_read_b64_tr_b16 v[60:61], v8 offset:30784
buffer_load_dwordx4 v4, s[24:27], s45 offen lds
s_add_u32 s62, s51, 8192
buffer_load_dwordx4 v[168:171], v26, s[12:15], s62 offen offset:2048 sc1
v_mfma_f32_32x32x16_bf16 a[16:31], v[36:39], v[244:247], a[16:31]
ds_read_b64_tr_b16 v[62:63], v8 offset:32064
s_waitcnt lgkmcnt(6)
v_mfma_f32_32x32x16_bf16 a[32:47], v[40:43], v[228:231], a[32:47]
ds_read_b64_tr_b16 v[32:33], v8 offset:30848
v_mfma_f32_32x32x16_bf16 a[48:63], v[40:43], v[244:247], a[48:63]
ds_read_b64_tr_b16 v[34:35], v8 offset:32128
s_add_u32 m0, s47, 65536
s_add_u32 s62, s51, 8192
buffer_load_dwordx4 v[184:187], v27, s[12:15], s62 offen offset:2048 sc1
v_mfma_f32_32x32x16_bf16 a[64:79], v[44:47], v[228:231], a[64:79]
ds_read_b64_tr_b16 v[36:37], v8 offset:30912
v_mfma_f32_32x32x16_bf16 a[80:95], v[44:47], v[244:247], a[80:95]
ds_read_b64_tr_b16 v[38:39], v8 offset:32192
v_mfma_f32_32x32x16_bf16 a[176:191], v[48:51], v[228:231], a[176:191]
ds_read_b64_tr_b16 v[40:41], v8 offset:30976
buffer_load_dwordx4 v5, s[24:27], s45 offen lds
v_mfma_f32_32x32x16_bf16 a[192:207], v[48:51], v[244:247], a[192:207]
ds_read_b64_tr_b16 v[42:43], v8 offset:32256
s_add_u32 s62, s51, 8192
buffer_load_dwordx4 v[172:175], v26, s[12:15], s62 offen offset:3072 sc1
s_waitcnt lgkmcnt(6)
v_mfma_f32_32x32x16_bf16 a[208:223], v[52:55], v[228:231], a[208:223]
ds_read_b64_tr_b16 v[44:45], v8 offset:35840
v_mfma_f32_32x32x16_bf16 a[224:239], v[52:55], v[244:247], a[224:239]
ds_read_b64_tr_b16 v[46:47], v8 offset:37120
v_mfma_f32_32x32x16_bf16 a[0:15], v[56:59], v[232:235], a[0:15]
ds_read_b64_tr_b16 v[48:49], v8 offset:35904
v_mfma_f32_32x32x16_bf16 a[16:31], v[56:59], v[248:251], a[16:31]
ds_read_b64_tr_b16 v[50:51], v8 offset:37184
s_add_u32 s62, s51, 8192
buffer_load_dwordx4 v[188:191], v27, s[12:15], s62 offen offset:3072 sc1
v_mfma_f32_32x32x16_bf16 a[32:47], v[60:63], v[232:235], a[32:47]
ds_read_b64_tr_b16 v[52:53], v8 offset:35968
v_mfma_f32_32x32x16_bf16 a[48:63], v[60:63], v[248:251], a[48:63]
ds_read_b64_tr_b16 v[54:55], v8 offset:37248
s_waitcnt lgkmcnt(6)
v_mfma_f32_32x32x16_bf16 a[64:79], v[32:35], v[232:235], a[64:79]
ds_read_b64_tr_b16 v[56:57], v8 offset:36032
s_add_u32 s62, s58, 0
buffer_load_dwordx4 a[96:99], v26, s[12:15], s62 offen offset:0 sc1
v_mfma_f32_32x32x16_bf16 a[80:95], v[32:35], v[248:251], a[80:95]
ds_read_b64_tr_b16 v[58:59], v8 offset:37312
v_mfma_f32_32x32x16_bf16 a[176:191], v[36:39], v[232:235], a[176:191]
ds_read_b64_tr_b16 v[60:61], v8 offset:36096
v_mfma_f32_32x32x16_bf16 a[192:207], v[36:39], v[248:251], a[192:207]
ds_read_b64_tr_b16 v[62:63], v8 offset:37376
v_mfma_f32_32x32x16_bf16 a[208:223], v[40:43], v[232:235], a[208:223]
s_barrier
ds_read_b64_tr_b16 v[32:33], v8 offset:40960
s_add_u32 s62, s58, 0
buffer_load_dwordx4 a[112:115], v27, s[12:15], s62 offen offset:0 sc1
v_mfma_f32_32x32x16_bf16 a[224:239], v[40:43], v[248:251], a[224:239]
ds_read_b64_tr_b16 v[34:35], v8 offset:42240
s_add_u32 s45, s45, 81920
s_add_u32 m0, s47, 143360
s_waitcnt vmcnt(16)
v_mov_b32 v29, 6
buffer_store_dword v29, v28, s[12:15], 0 offen sc1
s_waitcnt lgkmcnt(6)
v_mfma_f32_32x32x16_bf16 a[0:15], v[44:47], v[236:239], a[0:15]
ds_read_b64_tr_b16 v[36:37], v8 offset:41024
v_mfma_f32_32x32x16_bf16 a[16:31], v[44:47], v[252:255], a[16:31]
ds_read_b64_tr_b16 v[38:39], v8 offset:42304
s_add_u32 s62, s58, 0
buffer_load_dwordx4 a[100:103], v26, s[12:15], s62 offen offset:1024 sc1
v_mfma_f32_32x32x16_bf16 a[32:47], v[48:51], v[236:239], a[32:47]
ds_read_b64_tr_b16 v[40:41], v8 offset:41088
buffer_load_dwordx4 v1, s[24:27], s45 offen lds
v_mfma_f32_32x32x16_bf16 a[48:63], v[48:51], v[252:255], a[48:63]
ds_read_b64_tr_b16 v[42:43], v8 offset:42368
v_mfma_f32_32x32x16_bf16 a[64:79], v[52:55], v[236:239], a[64:79]
ds_read_b64_tr_b16 v[44:45], v8 offset:41152
v_mfma_f32_32x32x16_bf16 a[80:95], v[52:55], v[252:255], a[80:95]
ds_read_b64_tr_b16 v[46:47], v8 offset:42432
s_add_u32 m0, s47, 144384
s_add_u32 s62, s58, 0
buffer_load_dwordx4 a[116:119], v27, s[12:15], s62 offen offset:1024 sc1
s_waitcnt lgkmcnt(6)
v_mfma_f32_32x32x16_bf16 a[176:191], v[56:59], v[236:239], a[176:191]
ds_read_b64_tr_b16 v[48:49], v8 offset:41216
v_mfma_f32_32x32x16_bf16 a[192:207], v[56:59], v[252:255], a[192:207]
ds_read_b64_tr_b16 v[50:51], v8 offset:42496
v_mfma_f32_32x32x16_bf16 a[208:223], v[60:63], v[236:239], a[208:223]
ds_read_b64_tr_b16 v[52:53], v8 offset:46080
buffer_load_dwordx4 v2, s[24:27], s45 offen lds
v_mfma_f32_32x32x16_bf16 a[224:239], v[60:63], v[252:255], a[224:239]
ds_read_b64_tr_b16 v[54:55], v8 offset:47360
s_add_u32 s62, s58, 0
buffer_load_dwordx4 a[104:107], v26, s[12:15], s62 offen offset:2048 sc1
v_mfma_f32_32x32x16_bf16 a[0:15], v[32:35], v[96:99], a[0:15]
ds_read_b64_tr_b16 v[56:57], v8 offset:46144
v_mfma_f32_32x32x16_bf16 a[16:31], v[32:35], v[112:115], a[16:31]
ds_read_b64_tr_b16 v[58:59], v8 offset:47424
s_add_u32 m0, s47, 145408
s_waitcnt lgkmcnt(6)
v_mfma_f32_32x32x16_bf16 a[32:47], v[36:39], v[96:99], a[32:47]
ds_read_b64_tr_b16 v[60:61], v8 offset:46208
s_add_u32 s62, s58, 0
buffer_load_dwordx4 a[120:123], v27, s[12:15], s62 offen offset:2048 sc1
v_mfma_f32_32x32x16_bf16 a[48:63], v[36:39], v[112:115], a[48:63]
ds_read_b64_tr_b16 v[62:63], v8 offset:47488
v_mfma_f32_32x32x16_bf16 a[64:79], v[40:43], v[96:99], a[64:79]
ds_read_b64_tr_b16 v[32:33], v8 offset:46272
buffer_load_dwordx4 v3, s[24:27], s45 offen lds
v_mfma_f32_32x32x16_bf16 a[80:95], v[40:43], v[112:115], a[80:95]
ds_read_b64_tr_b16 v[34:35], v8 offset:47552
v_mfma_f32_32x32x16_bf16 a[176:191], v[44:47], v[96:99], a[176:191]
ds_read_b64_tr_b16 v[36:37], v8 offset:46336
s_add_u32 s62, s58, 0
buffer_load_dwordx4 a[108:111], v26, s[12:15], s62 offen offset:3072 sc1
v_mfma_f32_32x32x16_bf16 a[192:207], v[44:47], v[112:115], a[192:207]
ds_read_b64_tr_b16 v[38:39], v8 offset:47616
s_add_u32 m0, s47, 146432
s_waitcnt lgkmcnt(6)
v_mfma_f32_32x32x16_bf16 a[208:223], v[48:51], v[96:99], a[208:223]
ds_read_b64_tr_b16 v[40:41], v8 offset:51200
v_mfma_f32_32x32x16_bf16 a[224:239], v[48:51], v[112:115], a[224:239]
ds_read_b64_tr_b16 v[42:43], v8 offset:52480
v_mfma_f32_32x32x16_bf16 a[0:15], v[52:55], v[100:103], a[0:15]
ds_read_b64_tr_b16 v[44:45], v8 offset:51264
buffer_load_dwordx4 v4, s[24:27], s45 offen lds
s_add_u32 s62, s58, 0
buffer_load_dwordx4 a[124:127], v27, s[12:15], s62 offen offset:3072 sc1
v_mfma_f32_32x32x16_bf16 a[16:31], v[52:55], v[116:119], a[16:31]
ds_read_b64_tr_b16 v[46:47], v8 offset:52544
v_mfma_f32_32x32x16_bf16 a[32:47], v[56:59], v[100:103], a[32:47]
ds_read_b64_tr_b16 v[48:49], v8 offset:51328
v_mfma_f32_32x32x16_bf16 a[48:63], v[56:59], v[116:119], a[48:63]
ds_read_b64_tr_b16 v[50:51], v8 offset:52608
s_add_u32 m0, s47, 147456
s_add_u32 s62, s58, 4096
buffer_load_dwordx4 a[128:131], v26, s[12:15], s62 offen offset:0 sc1
s_waitcnt lgkmcnt(6)
v_mfma_f32_32x32x16_bf16 a[64:79], v[60:63], v[100:103], a[64:79]
ds_read_b64_tr_b16 v[52:53], v8 offset:51392
v_mfma_f32_32x32x16_bf16 a[80:95], v[60:63], v[116:119], a[80:95]
ds_read_b64_tr_b16 v[54:55], v8 offset:52672
v_mfma_f32_32x32x16_bf16 a[176:191], v[32:35], v[100:103], a[176:191]
ds_read_b64_tr_b16 v[56:57], v8 offset:51456
buffer_load_dwordx4 v5, s[24:27], s45 offen lds
v_mfma_f32_32x32x16_bf16 a[192:207], v[32:35], v[116:119], a[192:207]
ds_read_b64_tr_b16 v[58:59], v8 offset:52736
s_add_u32 s62, s58, 4096
buffer_load_dwordx4 a[144:147], v27, s[12:15], s62 offen offset:0 sc1
v_mfma_f32_32x32x16_bf16 a[208:223], v[36:39], v[100:103], a[208:223]
ds_read_b64_tr_b16 v[60:61], v8 offset:56320
v_mfma_f32_32x32x16_bf16 a[224:239], v[36:39], v[116:119], a[224:239]
ds_read_b64_tr_b16 v[62:63], v8 offset:57600
s_waitcnt lgkmcnt(6)
v_mfma_f32_32x32x16_bf16 a[0:15], v[40:43], v[104:107], a[0:15]
ds_read_b64_tr_b16 v[32:33], v8 offset:56384
s_add_u32 s62, s58, 4096
buffer_load_dwordx4 a[132:135], v26, s[12:15], s62 offen offset:1024 sc1
v_mfma_f32_32x32x16_bf16 a[16:31], v[40:43], v[120:123], a[16:31]
ds_read_b64_tr_b16 v[34:35], v8 offset:57664
v_mfma_f32_32x32x16_bf16 a[32:47], v[44:47], v[104:107], a[32:47]
ds_read_b64_tr_b16 v[36:37], v8 offset:56448
v_mfma_f32_32x32x16_bf16 a[48:63], v[44:47], v[120:123], a[48:63]
ds_read_b64_tr_b16 v[38:39], v8 offset:57728
v_mfma_f32_32x32x16_bf16 a[64:79], v[48:51], v[104:107], a[64:79]
ds_read_b64_tr_b16 v[40:41], v8 offset:56512
s_add_u32 s62, s58, 4096
buffer_load_dwordx4 a[148:151], v27, s[12:15], s62 offen offset:1024 sc1
v_mfma_f32_32x32x16_bf16 a[80:95], v[48:51], v[120:123], a[80:95]
ds_read_b64_tr_b16 v[42:43], v8 offset:57792
s_waitcnt lgkmcnt(6)
v_mfma_f32_32x32x16_bf16 a[176:191], v[52:55], v[104:107], a[176:191]
ds_read_b64_tr_b16 v[44:45], v8 offset:56576
v_mfma_f32_32x32x16_bf16 a[192:207], v[52:55], v[120:123], a[192:207]
ds_read_b64_tr_b16 v[46:47], v8 offset:57856
v_mfma_f32_32x32x16_bf16 a[208:223], v[56:59], v[104:107], a[208:223]
s_barrier
ds_read_b64_tr_b16 v[48:49], v9 offset:0
s_add_u32 s62, s58, 4096
buffer_load_dwordx4 a[136:139], v26, s[12:15], s62 offen offset:2048 sc1
v_mfma_f32_32x32x16_bf16 a[224:239], v[56:59], v[120:123], a[224:239]
ds_read_b64_tr_b16 v[50:51], v9 offset:1280
s_add_u32 s45, s45, 81920
s_add_u32 m0, s47, 81920
v_mfma_f32_32x32x16_bf16 a[0:15], v[60:63], v[108:111], a[0:15]
ds_read_b64_tr_b16 v[52:53], v9 offset:64
v_mfma_f32_32x32x16_bf16 a[16:31], v[60:63], v[124:127], a[16:31]
ds_read_b64_tr_b16 v[54:55], v9 offset:1344
s_add_u32 s62, s58, 4096
buffer_load_dwordx4 a[152:155], v27, s[12:15], s62 offen offset:2048 sc1
s_waitcnt lgkmcnt(6)
v_mfma_f32_32x32x16_bf16 a[32:47], v[32:35], v[108:111], a[32:47]
ds_read_b64_tr_b16 v[56:57], v9 offset:128
buffer_load_dwordx4 v1, s[24:27], s45 offen lds
v_mfma_f32_32x32x16_bf16 a[48:63], v[32:35], v[124:127], a[48:63]
ds_read_b64_tr_b16 v[58:59], v9 offset:1408
v_mfma_f32_32x32x16_bf16 a[64:79], v[36:39], v[108:111], a[64:79]
ds_read_b64_tr_b16 v[60:61], v9 offset:192
v_mfma_f32_32x32x16_bf16 a[80:95], v[36:39], v[124:127], a[80:95]
ds_read_b64_tr_b16 v[62:63], v9 offset:1472
s_add_u32 m0, s47, 82944
s_add_u32 s62, s58, 4096
buffer_load_dwordx4 a[140:143], v26, s[12:15], s62 offen offset:3072 sc1
v_mfma_f32_32x32x16_bf16 a[176:191], v[40:43], v[108:111], a[176:191]
ds_read_b64_tr_b16 v[32:33], v9 offset:256
v_mfma_f32_32x32x16_bf16 a[192:207], v[40:43], v[124:127], a[192:207]
ds_read_b64_tr_b16 v[34:35], v9 offset:1536
s_waitcnt lgkmcnt(6)
v_mfma_f32_32x32x16_bf16 a[208:223], v[44:47], v[108:111], a[208:223]
ds_read_b64_tr_b16 v[36:37], v9 offset:5120
buffer_load_dwordx4 v2, s[24:27], s45 offen lds
s_add_u32 s62, s58, 4096
buffer_load_dwordx4 a[156:159], v27, s[12:15], s62 offen offset:3072 sc1
v_mfma_f32_32x32x16_bf16 a[224:239], v[44:47], v[124:127], a[224:239]
ds_read_b64_tr_b16 v[38:39], v9 offset:6400
v_mfma_f32_32x32x16_bf16 a[0:15], v[48:51], v[192:195], a[0:15]
ds_read_b64_tr_b16 v[40:41], v9 offset:5184
v_mfma_f32_32x32x16_bf16 a[16:31], v[48:51], v[208:211], a[16:31]
ds_read_b64_tr_b16 v[42:43], v9 offset:6464
s_add_u32 m0, s47, 83968
v_mfma_f32_32x32x16_bf16 a[32:47], v[52:55], v[192:195], a[32:47]
ds_read_b64_tr_b16 v[44:45], v9 offset:5248
s_add_u32 s62, s58, 8192
buffer_load_dwordx4 a[160:163], v26, s[12:15], s62 offen offset:0 sc1
v_mfma_f32_32x32x16_bf16 a[48:63], v[52:55], v[208:211], a[48:63]
ds_read_b64_tr_b16 v[46:47], v9 offset:6528
s_waitcnt lgkmcnt(6)
v_mfma_f32_32x32x16_bf16 a[64:79], v[56:59], v[192:195], a[64:79]
ds_read_b64_tr_b16 v[48:49], v9 offset:5312
buffer_load_dwordx4 v3, s[24:27], s45 offen lds
v_mfma_f32_32x32x16_bf16 a[80:95], v[56:59], v[208:211], a[80:95]
ds_read_b64_tr_b16 v[50:51], v9 offset:6592
v_mfma_f32_32x32x16_bf16 a[176:191], v[60:63], v[192:195], a[176:191]
ds_read_b64_tr_b16 v[52:53], v9 offset:5376
s_add_u32 s62, s58, 8192
buffer_load_dwordx4 a[240:243], v27, s[12:15], s62 offen offset:0 sc1
v_mfma_f32_32x32x16_bf16 a[192:207], v[60:63], v[208:211], a[192:207]
ds_read_b64_tr_b16 v[54:55], v9 offset:6656
s_add_u32 m0, s47, 84992
v_mfma_f32_32x32x16_bf16 a[208:223], v[32:35], v[192:195], a[208:223]
ds_read_b64_tr_b16 v[56:57], v9 offset:10240
v_mfma_f32_32x32x16_bf16 a[224:239], v[32:35], v[208:211], a[224:239]
ds_read_b64_tr_b16 v[58:59], v9 offset:11520
s_add_u32 s62, s58, 8192
buffer_load_dwordx4 a[164:167], v26, s[12:15], s62 offen offset:1024 sc1
s_waitcnt lgkmcnt(6)
v_mfma_f32_32x32x16_bf16 a[0:15], v[36:39], v[196:199], a[0:15]
ds_read_b64_tr_b16 v[60:61], v9 offset:10304
buffer_load_dwordx4 v4, s[24:27], s45 offen lds
v_mfma_f32_32x32x16_bf16 a[16:31], v[36:39], v[212:215], a[16:31]
ds_read_b64_tr_b16 v[62:63], v9 offset:11584
s_and_b32 s63, s2, 0xf8
s_lshr_b32 s93, s4, 2
s_add_u32 s63, s63, s93
s_lshl_b32 s63, s63, 5
s_and_b32 s93, s4, 3
s_add_u32 s63, s63, s93
s_lshl_b32 s63, s63, 2
s_add_u32 s63, s63, 67108864
v_and_b32 v24, 3, v0
v_lshl_add_u32 v24, v24, 8, s63
buffer_load_dword v25, v24, s[12:15], 0 offen sc1
v_mfma_f32_32x32x16_bf16 a[32:47], v[40:43], v[196:199], a[32:47]
ds_read_b64_tr_b16 v[32:33], v9 offset:10368
buffer_load_dwordx2 v[96:97], v6, s[36:39], 0 offen offset:0
v_mfma_f32_32x32x16_bf16 a[48:63], v[40:43], v[212:215], a[48:63]
ds_read_b64_tr_b16 v[34:35], v9 offset:11648
s_add_u32 m0, s47, 86016
s_add_u32 s62, s58, 8192
buffer_load_dwordx4 a[244:247], v27, s[12:15], s62 offen offset:1024 sc1
v_mfma_f32_32x32x16_bf16 a[64:79], v[44:47], v[196:199], a[64:79]
ds_read_b64_tr_b16 v[36:37], v9 offset:10432
v_mfma_f32_32x32x16_bf16 a[80:95], v[44:47], v[212:215], a[80:95]
ds_read_b64_tr_b16 v[38:39], v9 offset:11712
buffer_load_dwordx2 v[248:249], v7, s[96:99], s53 offen offset:0
s_waitcnt lgkmcnt(6)
v_mfma_f32_32x32x16_bf16 a[176:191], v[48:51], v[196:199], a[176:191]
ds_read_b64_tr_b16 v[40:41], v9 offset:10496
buffer_load_dwordx4 v5, s[24:27], s45 offen lds
s_add_u32 s62, s58, 8192
buffer_load_dwordx4 a[168:171], v26, s[12:15], s62 offen offset:2048 sc1
v_mfma_f32_32x32x16_bf16 a[192:207], v[48:51], v[212:215], a[192:207]
ds_read_b64_tr_b16 v[42:43], v9 offset:11776
v_mfma_f32_32x32x16_bf16 a[208:223], v[52:55], v[196:199], a[208:223]
ds_read_b64_tr_b16 v[44:45], v9 offset:15360
buffer_load_dwordx2 v[98:99], v6, s[36:39], 0 offen offset:64
v_mfma_f32_32x32x16_bf16 a[224:239], v[52:55], v[212:215], a[224:239]
ds_read_b64_tr_b16 v[46:47], v9 offset:16640
v_mfma_f32_32x32x16_bf16 a[0:15], v[56:59], v[200:203], a[0:15]
ds_read_b64_tr_b16 v[48:49], v9 offset:15424
s_add_u32 s62, s58, 8192
buffer_load_dwordx4 a[248:251], v27, s[12:15], s62 offen offset:2048 sc1
v_mfma_f32_32x32x16_bf16 a[16:31], v[56:59], v[216:219], a[16:31]
ds_read_b64_tr_b16 v[50:51], v9 offset:16704
buffer_load_dwordx2 v[250:251], v7, s[96:99], s53 offen offset:64
s_waitcnt lgkmcnt(6)
v_mfma_f32_32x32x16_bf16 a[32:47], v[60:63], v[200:203], a[32:47]
ds_read_b64_tr_b16 v[52:53], v9 offset:15488
v_mfma_f32_32x32x16_bf16 a[48:63], v[60:63], v[216:219], a[48:63]
ds_read_b64_tr_b16 v[54:55], v9 offset:16768
v_mfma_f32_32x32x16_bf16 a[64:79], v[32:35], v[200:203], a[64:79]
ds_read_b64_tr_b16 v[56:57], v9 offset:15552
s_add_u32 s62, s58, 8192
buffer_load_dwordx4 a[172:175], v26, s[12:15], s62 offen offset:3072 sc1
buffer_load_dwordx2 v[100:101], v6, s[36:39], 0 offen offset:128
v_mfma_f32_32x32x16_bf16 a[80:95], v[32:35], v[216:219], a[80:95]
ds_read_b64_tr_b16 v[58:59], v9 offset:16832
v_mfma_f32_32x32x16_bf16 a[176:191], v[36:39], v[200:203], a[176:191]
ds_read_b64_tr_b16 v[60:61], v9 offset:15616
v_mfma_f32_32x32x16_bf16 a[192:207], v[36:39], v[216:219], a[192:207]
ds_read_b64_tr_b16 v[62:63], v9 offset:16896
s_add_u32 s62, s58, 8192
buffer_load_dwordx4 a[252:255], v27, s[12:15], s62 offen offset:3072 sc1
buffer_load_dwordx2 v[252:253], v7, s[96:99], s53 offen offset:128
s_waitcnt lgkmcnt(6)
v_mfma_f32_32x32x16_bf16 a[208:223], v[40:43], v[200:203], a[208:223]
s_barrier
ds_read_b64_tr_b16 v[32:33], v31 offset:0
v_mfma_f32_32x32x16_bf16 a[224:239], v[40:43], v[216:219], a[224:239]
ds_read_b64_tr_b16 v[34:35], v31 offset:1280
v_mfma_f32_32x32x16_bf16 a[0:15], v[44:47], v[204:207], a[0:15]
ds_read_b64_tr_b16 v[36:37], v31 offset:5120
buffer_load_dwordx2 v[102:103], v6, s[36:39], 0 offen offset:192
v_mfma_f32_32x32x16_bf16 a[16:31], v[44:47], v[220:223], a[16:31]
ds_read_b64_tr_b16 v[38:39], v31 offset:6400
v_mfma_f32_32x32x16_bf16 a[32:47], v[48:51], v[204:207], a[32:47]
ds_read_b64_tr_b16 v[40:41], v31 offset:10240
v_mfma_f32_32x32x16_bf16 a[48:63], v[48:51], v[220:223], a[48:63]
ds_read_b64_tr_b16 v[42:43], v31 offset:11520
buffer_load_dwordx2 v[254:255], v7, s[96:99], s53 offen offset:192
s_waitcnt lgkmcnt(6)
v_mfma_f32_32x32x16_bf16 a[64:79], v[52:55], v[204:207], a[64:79]
ds_read_b64_tr_b16 v[44:45], v31 offset:15360
v_mfma_f32_32x32x16_bf16 a[80:95], v[52:55], v[220:223], a[80:95]
ds_read_b64_tr_b16 v[46:47], v31 offset:16640
v_mfma_f32_32x32x16_bf16 a[176:191], v[56:59], v[204:207], a[176:191]
ds_read_b64_tr_b16 v[48:49], v31 offset:20480
buffer_load_dwordx2 v[104:105], v6, s[36:39], 0 offen offset:256
v_mfma_f32_32x32x16_bf16 a[192:207], v[56:59], v[220:223], a[192:207]
ds_read_b64_tr_b16 v[50:51], v31 offset:21760
v_mfma_f32_32x32x16_bf16 a[208:223], v[60:63], v[204:207], a[208:223]
ds_read_b64_tr_b16 v[52:53], v31 offset:25600
v_mfma_f32_32x32x16_bf16 a[224:239], v[60:63], v[220:223], a[224:239]
ds_read_b64_tr_b16 v[54:55], v31 offset:26880
buffer_load_dwordx2 v[126:127], v7, s[96:99], s53 offen offset:256
s_waitcnt lgkmcnt(6)
v_mfma_f32_32x32x16_bf16 a[0:15], v[32:35], v[64:67], a[0:15]
ds_read_b64_tr_b16 v[56:57], v31 offset:30720
v_mfma_f32_32x32x16_bf16 a[16:31], v[32:35], v[80:83], a[16:31]
ds_read_b64_tr_b16 v[58:59], v31 offset:32000
s_waitcnt vmcnt(16)
v_cmp_gt_u32 vcc, 6, v25
s_cbranch_vccnz SLOWF6
GOF6:
v_mfma_f32_32x32x16_bf16 a[0:15], v[36:39], v[68:71], a[0:15]
ds_read_b64_tr_b16 v[60:61], v31 offset:35840
s_add_u32 s63, s50, 81920
buffer_load_dwordx4 v[192:195], v11, s[12:15], s63 offen sc1
v_mfma_f32_32x32x16_bf16 a[16:31], v[36:39], v[84:87], a[16:31]
ds_read_b64_tr_b16 v[62:63], v31 offset:37120
s_add_u32 s63, s50, 102400
buffer_load_dwordx4 v[196:199], v11, s[12:15], s63 offen sc1
v_mfma_f32_32x32x16_bf16 a[0:15], v[40:43], v[72:75], a[0:15]
s_barrier
ds_read_b64_tr_b16 v[32:33], v31 offset:40960
v_mfma_f32_32x32x16_bf16 a[16:31], v[40:43], v[88:91], a[16:31]
ds_read_b64_tr_b16 v[34:35], v31 offset:42240
s_add_u32 s63, s50, 83968
buffer_load_dwordx4 v[200:203], v11, s[12:15], s63 offen sc1
s_waitcnt lgkmcnt(6)
v_mfma_f32_32x32x16_bf16 a[0:15], v[44:47], v[76:79], a[0:15]
ds_read_b64_tr_b16 v[36:37], v31 offset:46080
s_add_u32 s63, s50, 104448
buffer_load_dwordx4 v[204:207], v11, s[12:15], s63 offen sc1
v_mfma_f32_32x32x16_bf16 a[16:31], v[44:47], v[92:95], a[16:31]
ds_read_b64_tr_b16 v[38:39], v31 offset:47360
v_mfma_f32_32x32x16_bf16 a[0:15], v[48:51], v[128:131], a[0:15]
ds_read_b64_tr_b16 v[40:41], v31 offset:51200
s_add_u32 s63, s50, 86016
buffer_load_dwordx4 v[208:211], v11, s[12:15], s63 offen sc1
v_mfma_f32_32x32x16_bf16 a[16:31], v[48:51], v[144:147], a[16:31]
ds_read_b64_tr_b16 v[42:43], v31 offset:52480
v_mfma_f32_32x32x16_bf16 a[0:15], v[52:55], v[132:135], a[0:15]
ds_read_b64_tr_b16 v[44:45], v31 offset:56320
s_add_u32 s63, s50, 106496
buffer_load_dwordx4 v[212:215], v11, s[12:15], s63 offen sc1
v_mfma_f32_32x32x16_bf16 a[16:31], v[52:55], v[148:151], a[16:31]
ds_read_b64_tr_b16 v[46:47], v31 offset:57600
s_add_u32 s63, s50, 88064
buffer_load_dwordx4 v[216:219], v11, s[12:15], s63 offen sc1
s_waitcnt lgkmcnt(6)
v_mfma_f32_32x32x16_bf16 a[0:15], v[56:59], v[136:139], a[0:15]
ds_read_b64_tr_b16 v[48:49], v8 offset:0
v_mfma_f32_32x32x16_bf16 a[16:31], v[56:59], v[152:155], a[16:31]
ds_read_b64_tr_b16 v[50:51], v8 offset:1280
s_add_u32 s63, s50, 108544
buffer_load_dwordx4 v[220:223], v11, s[12:15], s63 offen sc1
v_mfma_f32_32x32x16_bf16 a[0:15], v[60:63], v[140:143], a[0:15]
ds_read_b64_tr_b16 v[52:53], v8 offset:5120
s_add_u32 s63, s50, 90112
buffer_load_dwordx4 v[224:227], v11, s[12:15], s63 offen sc1
v_mfma_f32_32x32x16_bf16 a[16:31], v[60:63], v[156:159], a[16:31]
ds_read_b64_tr_b16 v[54:55], v8 offset:6400
v_mfma_f32_32x32x16_bf16 a[0:15], v[32:35], v[160:163], a[0:15]
ds_read_b64_tr_b16 v[56:57], v8 offset:10240
s_add_u32 s63, s50, 110592
buffer_load_dwordx4 v[228:231], v11, s[12:15], s63 offen sc1
v_mfma_f32_32x32x16_bf16 a[16:31], v[32:35], v[176:179], a[16:31]
ds_read_b64_tr_b16 v[58:59], v8 offset:11520
s_waitcnt lgkmcnt(6)
v_mfma_f32_32x32x16_bf16 a[0:15], v[36:39], v[164:167], a[0:15]
ds_read_b64_tr_b16 v[60:61], v8 offset:15360
v_mfma_f32_32x32x16_bf16 a[16:31], v[36:39], v[180:183], a[16:31]
ds_read_b64_tr_b16 v[62:63], v8 offset:16640
v_mfma_f32_32x32x16_bf16 a[0:15], v[40:43], v[168:171], a[0:15]
s_waitcnt vmcnt(22)
s_barrier
ds_read_b64_tr_b16 v[32:33], v9 offset:20480
v_mfma_f32_32x32x16_bf16 a[16:31], v[40:43], v[184:187], a[16:31]
ds_read_b64_tr_b16 v[34:35], v9 offset:21760
v_mfma_f32_32x32x16_bf16 a[0:15], v[44:47], v[172:175], a[0:15]
ds_read_b64_tr_b16 v[36:37], v9 offset:25600
v_mfma_f32_32x32x16_bf16 a[16:31], v[44:47], v[188:191], a[16:31]
ds_read_b64_tr_b16 v[38:39], v9 offset:26880
s_waitcnt lgkmcnt(6)
v_mfma_f32_32x32x16_bf16 a[0:15], v[48:51], a[96:99], a[0:15]
ds_read_b64_tr_b16 v[40:41], v9 offset:30720
v_mfma_f32_32x32x16_bf16 a[16:31], v[48:51], a[112:115], a[16:31]
ds_read_b64_tr_b16 v[42:43], v9 offset:32000
v_mfma_f32_32x32x16_bf16 a[0:15], v[52:55], a[100:103], a[0:15]
ds_read_b64_tr_b16 v[44:45], v9 offset:35840
v_mfma_f32_32x32x16_bf16 a[16:31], v[52:55], a[116:119], a[16:31]
ds_read_b64_tr_b16 v[46:47], v9 offset:37120
v_mfma_f32_32x32x16_bf16 a[0:15], v[56:59], a[104:107], a[0:15]
ds_read_b64_tr_b16 v[48:49], v8 offset:20480
v_mfma_f32_32x32x16_bf16 a[16:31], v[56:59], a[120:123], a[16:31]
ds_read_b64_tr_b16 v[50:51], v8 offset:21760
s_waitcnt lgkmcnt(6)
v_mfma_f32_32x32x16_bf16 a[0:15], v[60:63], a[108:111], a[0:15]
ds_read_b64_tr_b16 v[52:53], v8 offset:25600
v_mfma_f32_32x32x16_bf16 a[16:31], v[60:63], a[124:127], a[16:31]
ds_read_b64_tr_b16 v[54:55], v8 offset:26880
v_mfma_f32_32x32x16_bf16 a[0:15], v[32:35], a[128:131], a[0:15]
ds_read_b64_tr_b16 v[56:57], v8 offset:30720
v_mfma_f32_32x32x16_bf16 a[16:31], v[32:35], a[144:147], a[16:31]
ds_read_b64_tr_b16 v[58:59], v8 offset:32000
v_mfma_f32_32x32x16_bf16 a[0:15], v[36:39], a[132:135], a[0:15]
ds_read_b64_tr_b16 v[60:61], v8 offset:35840
v_mfma_f32_32x32x16_bf16 a[16:31], v[36:39], a[148:151], a[16:31]
ds_read_b64_tr_b16 v[62:63], v8 offset:37120
s_waitcnt lgkmcnt(6)
v_mfma_f32_32x32x16_bf16 a[0:15], v[40:43], a[136:139], a[0:15]
ds_read_b64_tr_b16 v[32:33], v31 offset:64
v_mfma_f32_32x32x16_bf16 a[16:31], v[40:43], a[152:155], a[16:31]
ds_read_b64_tr_b16 v[34:35], v31 offset:1344
v_mfma_f32_32x32x16_bf16 a[0:15], v[44:47], a[140:143], a[0:15]
ds_read_b64_tr_b16 v[36:37], v31 offset:5184
v_mfma_f32_32x32x16_bf16 a[16:31], v[44:47], a[156:159], a[16:31]
ds_read_b64_tr_b16 v[38:39], v31 offset:6464
v_mfma_f32_32x32x16_bf16 a[0:15], v[48:51], a[160:163], a[0:15]
ds_read_b64_tr_b16 v[40:41], v31 offset:10304
v_mfma_f32_32x32x16_bf16 a[16:31], v[48:51], a[240:243], a[16:31]
ds_read_b64_tr_b16 v[42:43], v31 offset:11584
s_waitcnt lgkmcnt(6)
v_mfma_f32_32x32x16_bf16 a[0:15], v[52:55], a[164:167], a[0:15]
ds_read_b64_tr_b16 v[44:45], v31 offset:15424
v_mfma_f32_32x32x16_bf16 a[16:31], v[52:55], a[244:247], a[16:31]
ds_read_b64_tr_b16 v[46:47], v31 offset:16704
s_waitcnt vmcnt(21)
v_mfma_f32_32x32x16_bf16 a[0:15], v[56:59], a[168:171], a[0:15]
ds_read_b64_tr_b16 v[48:49], v31 offset:20544
s_waitcnt vmcnt(19)
v_mfma_f32_32x32x16_bf16 a[16:31], v[56:59], a[248:251], a[16:31]
ds_read_b64_tr_b16 v[50:51], v31 offset:21824
s_waitcnt vmcnt(17)
v_mfma_f32_32x32x16_bf16 a[0:15], v[60:63], a[172:175], a[0:15]
ds_read_b64_tr_b16 v[52:53], v31 offset:25664
s_waitcnt vmcnt(15)
v_mfma_f32_32x32x16_bf16 a[16:31], v[60:63], a[252:255], a[16:31]
ds_read_b64_tr_b16 v[54:55], v31 offset:26944
s_waitcnt lgkmcnt(6)
v_mfma_f32_32x32x16_bf16 a[32:47], v[32:35], v[64:67], a[32:47]
ds_read_b64_tr_b16 v[56:57], v31 offset:30784
v_mfma_f32_32x32x16_bf16 a[48:63], v[32:35], v[80:83], a[48:63]
ds_read_b64_tr_b16 v[58:59], v31 offset:32064
v_mfma_f32_32x32x16_bf16 a[32:47], v[36:39], v[68:71], a[32:47]
ds_read_b64_tr_b16 v[60:61], v31 offset:35904
v_mfma_f32_32x32x16_bf16 a[48:63], v[36:39], v[84:87], a[48:63]
ds_read_b64_tr_b16 v[62:63], v31 offset:37184
v_accvgpr_read_b32 v4, a0
v_accvgpr_read_b32 v5, a1
v_accvgpr_read_b32 v1, a2
v_accvgpr_read_b32 v10, a3
v_mfma_f32_32x32x16_bf16 a[32:47], v[40:43], v[72:75], a[32:47]
ds_read_b64_tr_b16 v[32:33], v31 offset:41024
v_cvt_pk_bf16_f32 v14, v4, v5
v_cvt_pk_bf16_f32 v15, v1, v10
v_accvgpr_read_b32 v4, a4
v_accvgpr_read_b32 v5, a5
v_mfma_f32_32x32x16_bf16 a[48:63], v[40:43], v[88:91], a[48:63]
ds_read_b64_tr_b16 v[34:35], v31 offset:42304
v_accvgpr_read_b32 v1, a6
v_accvgpr_read_b32 v10, a7
v_cvt_pk_bf16_f32 v16, v4, v5
v_cvt_pk_bf16_f32 v17, v1, v10
s_waitcnt lgkmcnt(6)
v_mfma_f32_32x32x16_bf16 a[32:47], v[44:47], v[76:79], a[32:47]
ds_read_b64_tr_b16 v[36:37], v31 offset:46144
buffer_store_dwordx4 v[14:17], v12, s[12:15], 0 offen offset:0 sc1
v_accvgpr_read_b32 v4, a8
v_accvgpr_read_b32 v5, a9
v_mfma_f32_32x32x16_bf16 a[48:63], v[44:47], v[92:95], a[48:63]
ds_read_b64_tr_b16 v[38:39], v31 offset:47424
v_accvgpr_read_b32 v1, a10
v_accvgpr_read_b32 v10, a11
v_cvt_pk_bf16_f32 v14, v4, v5
v_cvt_pk_bf16_f32 v15, v1, v10
v_mfma_f32_32x32x16_bf16 a[32:47], v[48:51], v[128:131], a[32:47]
ds_read_b64_tr_b16 v[40:41], v31 offset:51264
v_accvgpr_read_b32 v4, a12
v_accvgpr_read_b32 v5, a13
v_accvgpr_read_b32 v1, a14
v_accvgpr_read_b32 v10, a15
v_mfma_f32_32x32x16_bf16 a[48:63], v[48:51], v[144:147], a[48:63]
ds_read_b64_tr_b16 v[42:43], v31 offset:52544
s_waitcnt vmcnt(10)
v_lshlrev_b32 v18, 16, v192
v_and_b32 v19, 0xffff0000, v192
v_lshlrev_b32 v20, 16, v193
v_and_b32 v21, 0xffff0000, v193
v_lshlrev_b32 v22, 16, v194
v_cvt_pk_bf16_f32 v16, v4, v5
v_cvt_pk_bf16_f32 v17, v1, v10
buffer_store_dwordx4 v[14:17], v12, s[12:15], 0 offen offset:1024 sc1
v_mfma_f32_32x32x16_bf16 a[32:47], v[52:55], v[132:135], a[32:47]
ds_read_b64_tr_b16 v[44:45], v31 offset:56384
v_and_b32 v23, 0xffff0000, v194
v_lshlrev_b32 v24, 16, v195
v_and_b32 v25, 0xffff0000, v195
s_waitcnt vmcnt(10)
v_lshlrev_b32 v2, 16, v196
v_and_b32 v3, 0xffff0000, v196
v_accvgpr_read_b32 v4, a16
v_accvgpr_read_b32 v5, a17
v_accvgpr_read_b32 v1, a18
v_accvgpr_read_b32 v10, a19
v_mfma_f32_32x32x16_bf16 a[48:63], v[52:55], v[148:151], a[48:63]
ds_read_b64_tr_b16 v[46:47], v31 offset:57664
v_lshlrev_b32 v28, 16, v197
v_and_b32 v29, 0xffff0000, v197
v_add_f32 v18, v18, v2
v_add_f32 v19, v19, v3
v_add_f32 v20, v20, v28
v_cvt_pk_bf16_f32 v14, v4, v5
v_cvt_pk_bf16_f32 v15, v1, v10
v_accvgpr_read_b32 v4, a20
v_accvgpr_read_b32 v5, a21
s_waitcnt lgkmcnt(6)
v_mfma_f32_32x32x16_bf16 a[32:47], v[56:59], v[136:139], a[32:47]
ds_read_b64_tr_b16 v[48:49], v8 offset:64
v_add_f32 v21, v21, v29
v_lshlrev_b32 v2, 16, v198
v_and_b32 v3, 0xffff0000, v198
v_lshlrev_b32 v28, 16, v199
v_and_b32 v29, 0xffff0000, v199
v_accvgpr_read_b32 v1, a22
v_accvgpr_read_b32 v10, a23
v_cvt_pk_bf16_f32 v16, v4, v5
v_cvt_pk_bf16_f32 v17, v1, v10
v_mfma_f32_32x32x16_bf16 a[48:63], v[56:59], v[152:155], a[48:63]
ds_read_b64_tr_b16 v[50:51], v8 offset:1344
v_add_f32 v22, v22, v2
v_add_f32 v23, v23, v3
v_add_f32 v24, v24, v28
v_add_f32 v25, v25, v29
v_permlane32_swap_b32 v18, v22
buffer_store_dwordx4 v[14:17], v13, s[12:15], 0 offen offset:0 sc1
v_accvgpr_read_b32 v4, a24
v_accvgpr_read_b32 v5, a25
v_mfma_f32_32x32x16_bf16 a[32:47], v[60:63], v[140:143], a[32:47]
ds_read_b64_tr_b16 v[52:53], v8 offset:5184
v_permlane32_swap_b32 v19, v23
v_permlane32_swap_b32 v20, v24
v_permlane32_swap_b32 v21, v25
v_add_f32 v18, v18, v22
v_add_f32 v19, v19, v23
v_accvgpr_read_b32 v1, a26
v_accvgpr_read_b32 v10, a27
v_cvt_pk_bf16_f32 v14, v4, v5
v_cvt_pk_bf16_f32 v15, v1, v10
v_mfma_f32_32x32x16_bf16 a[48:63], v[60:63], v[156:159], a[48:63]
ds_read_b64_tr_b16 v[54:55], v8 offset:6464
v_add_f32 v20, v20, v24
v_add_f32 v21, v21, v25
v_lshlrev_b32 v22, 16, v248
v_and_b32 v23, 0xffff0000, v248
v_lshlrev_b32 v24, 16, v249
v_accvgpr_read_b32 v4, a28
v_accvgpr_read_b32 v5, a29
v_accvgpr_read_b32 v1, a30
v_accvgpr_read_b32 v10, a31
v_mfma_f32_32x32x16_bf16 a[32:47], v[32:35], v[160:163], a[32:47]
ds_read_b64_tr_b16 v[56:57], v8 offset:10304
v_and_b32 v25, 0xffff0000, v249
v_add_f32 v18, v18, v22
v_add_f32 v19, v19, v23
v_add_f32 v20, v20, v24
v_add_f32 v21, v21, v25
v_cvt_pk_bf16_f32 v16, v4, v5
v_cvt_pk_bf16_f32 v17, v1, v10
buffer_store_dwordx4 v[14:17], v13, s[12:15], 0 offen offset:1024 sc1
v_mfma_f32_32x32x16_bf16 a[48:63], v[32:35], v[176:179], a[48:63]
ds_read_b64_tr_b16 v[58:59], v8 offset:11584
v_mul_f32 v22, s52, v18
v_mul_f32 v23, s52, v19
v_mul_f32 v24, s52, v20
v_mul_f32 v25, s52, v21
v_exp_f32 v22, v22
s_waitcnt lgkmcnt(6)
v_mfma_f32_32x32x16_bf16 a[32:47], v[36:39], v[164:167], a[32:47]
ds_read_b64_tr_b16 v[60:61], v8 offset:15424
v_exp_f32 v23, v23
v_exp_f32 v24, v24
v_exp_f32 v25, v25
v_add_f32 v22, 1.0, v22
v_add_f32 v23, 1.0, v23
v_mfma_f32_32x32x16_bf16 a[48:63], v[36:39], v[180:183], a[48:63]
ds_read_b64_tr_b16 v[62:63], v8 offset:16704
v_add_f32 v24, 1.0, v24
v_add_f32 v25, 1.0, v25
v_rcp_f32 v22, v22
v_rcp_f32 v23, v23
v_rcp_f32 v24, v24
v_mfma_f32_32x32x16_bf16 a[32:47], v[40:43], v[168:171], a[32:47]
ds_read_b64_tr_b16 v[32:33], v9 offset:20544
v_rcp_f32 v25, v25
v_mul_f32 v106, v22, v18
v_mul_f32 v107, v23, v19
v_mul_f32 v108, v24, v20
v_mul_f32 v109, v25, v21
v_mfma_f32_32x32x16_bf16 a[48:63], v[40:43], v[184:187], a[48:63]
ds_read_b64_tr_b16 v[34:35], v9 offset:21824
s_waitcnt vmcnt(11)
v_lshlrev_b32 v18, 16, v200
v_and_b32 v19, 0xffff0000, v200
v_lshlrev_b32 v20, 16, v201
v_and_b32 v21, 0xffff0000, v201
v_mfma_f32_32x32x16_bf16 a[32:47], v[44:47], v[172:175], a[32:47]
ds_read_b64_tr_b16 v[36:37], v9 offset:25664
v_lshlrev_b32 v22, 16, v202
v_and_b32 v23, 0xffff0000, v202
v_lshlrev_b32 v24, 16, v203
v_and_b32 v25, 0xffff0000, v203
s_waitcnt vmcnt(10)
v_lshlrev_b32 v2, 16, v204
v_mfma_f32_32x32x16_bf16 a[48:63], v[44:47], v[188:191], a[48:63]
ds_read_b64_tr_b16 v[38:39], v9 offset:26944
v_and_b32 v3, 0xffff0000, v204
v_lshlrev_b32 v28, 16, v205
v_and_b32 v29, 0xffff0000, v205
v_add_f32 v18, v18, v2
v_add_f32 v19, v19, v3
s_waitcnt lgkmcnt(6)
v_mfma_f32_32x32x16_bf16 a[32:47], v[48:51], a[96:99], a[32:47]
ds_read_b64_tr_b16 v[40:41], v9 offset:30784
v_add_f32 v20, v20, v28
v_add_f32 v21, v21, v29
v_lshlrev_b32 v2, 16, v206
v_and_b32 v3, 0xffff0000, v206
v_lshlrev_b32 v28, 16, v207
v_mfma_f32_32x32x16_bf16 a[48:63], v[48:51], a[112:115], a[48:63]
ds_read_b64_tr_b16 v[42:43], v9 offset:32064
v_and_b32 v29, 0xffff0000, v207
v_add_f32 v22, v22, v2
v_add_f32 v23, v23, v3
v_add_f32 v24, v24, v28
v_add_f32 v25, v25, v29
v_mfma_f32_32x32x16_bf16 a[32:47], v[52:55], a[100:103], a[32:47]
ds_read_b64_tr_b16 v[44:45], v9 offset:35904
v_permlane32_swap_b32 v18, v22
v_permlane32_swap_b32 v19, v23
v_permlane32_swap_b32 v20, v24
v_permlane32_swap_b32 v21, v25
v_add_f32 v18, v18, v22
v_mfma_f32_32x32x16_bf16 a[48:63], v[52:55], a[116:119], a[48:63]
ds_read_b64_tr_b16 v[46:47], v9 offset:37184
v_add_f32 v19, v19, v23
v_add_f32 v20, v20, v24
v_add_f32 v21, v21, v25
v_lshlrev_b32 v22, 16, v250
v_and_b32 v23, 0xffff0000, v250
v_mfma_f32_32x32x16_bf16 a[32:47], v[56:59], a[104:107], a[32:47]
ds_read_b64_tr_b16 v[48:49], v8 offset:20544
v_lshlrev_b32 v24, 16, v251
v_and_b32 v25, 0xffff0000, v251
v_add_f32 v18, v18, v22
v_add_f32 v19, v19, v23
v_add_f32 v20, v20, v24
v_mfma_f32_32x32x16_bf16 a[48:63], v[56:59], a[120:123], a[48:63]
ds_read_b64_tr_b16 v[50:51], v8 offset:21824
v_add_f32 v21, v21, v25
v_mul_f32 v22, s52, v18
v_mul_f32 v23, s52, v19
v_mul_f32 v24, s52, v20
v_mul_f32 v25, s52, v21
s_waitcnt lgkmcnt(6)
v_mfma_f32_32x32x16_bf16 a[32:47], v[60:63], a[108:111], a[32:47]
ds_read_b64_tr_b16 v[52:53], v8 offset:25664
v_exp_f32 v22, v22
v_exp_f32 v23, v23
v_exp_f32 v24, v24
v_exp_f32 v25, v25
v_add_f32 v22, 1.0, v22
v_mfma_f32_32x32x16_bf16 a[48:63], v[60:63], a[124:127], a[48:63]
ds_read_b64_tr_b16 v[54:55], v8 offset:26944
v_add_f32 v23, 1.0, v23
v_add_f32 v24, 1.0, v24
v_add_f32 v25, 1.0, v25
v_rcp_f32 v22, v22
v_rcp_f32 v23, v23
v_mfma_f32_32x32x16_bf16 a[32:47], v[32:35], a[128:131], a[32:47]
ds_read_b64_tr_b16 v[56:57], v8 offset:30784
v_rcp_f32 v24, v24
v_rcp_f32 v25, v25
v_mul_f32 v110, v22, v18
v_mul_f32 v111, v23, v19
v_mul_f32 v112, v24, v20
v_mfma_f32_32x32x16_bf16 a[48:63], v[32:35], a[144:147], a[48:63]
ds_read_b64_tr_b16 v[58:59], v8 offset:32064
v_mul_f32 v113, v25, v21
s_waitcnt vmcnt(9)
v_lshlrev_b32 v18, 16, v208
v_and_b32 v19, 0xffff0000, v208
v_lshlrev_b32 v20, 16, v209
v_mfma_f32_32x32x16_bf16 a[32:47], v[36:39], a[132:135], a[32:47]
ds_read_b64_tr_b16 v[60:61], v8 offset:35904
v_and_b32 v21, 0xffff0000, v209
v_lshlrev_b32 v22, 16, v210
v_and_b32 v23, 0xffff0000, v210
v_lshlrev_b32 v24, 16, v211
v_and_b32 v25, 0xffff0000, v211
v_mfma_f32_32x32x16_bf16 a[48:63], v[36:39], a[148:151], a[48:63]
ds_read_b64_tr_b16 v[62:63], v8 offset:37184
s_waitcnt vmcnt(8)
v_lshlrev_b32 v2, 16, v212
v_and_b32 v3, 0xffff0000, v212
v_lshlrev_b32 v28, 16, v213
v_and_b32 v29, 0xffff0000, v213
v_add_f32 v18, v18, v2
s_waitcnt lgkmcnt(6)
v_mfma_f32_32x32x16_bf16 a[32:47], v[40:43], a[136:139], a[32:47]
ds_read_b64_tr_b16 v[32:33], v31 offset:128
v_add_f32 v19, v19, v3
v_add_f32 v20, v20, v28
v_add_f32 v21, v21, v29
v_lshlrev_b32 v2, 16, v214
v_and_b32 v3, 0xffff0000, v214
v_mfma_f32_32x32x16_bf16 a[48:63], v[40:43], a[152:155], a[48:63]
ds_read_b64_tr_b16 v[34:35], v31 offset:1408
v_lshlrev_b32 v28, 16, v215
v_and_b32 v29, 0xffff0000, v215
v_add_f32 v22, v22, v2
v_add_f32 v23, v23, v3
v_add_f32 v24, v24, v28
v_mfma_f32_32x32x16_bf16 a[32:47], v[44:47], a[140:143], a[32:47]
ds_read_b64_tr_b16 v[36:37], v31 offset:5248
v_add_f32 v25, v25, v29
v_permlane32_swap_b32 v18, v22
v_permlane32_swap_b32 v19, v23
v_permlane32_swap_b32 v20, v24
v_permlane32_swap_b32 v21, v25
v_mfma_f32_32x32x16_bf16 a[48:63], v[44:47], a[156:159], a[48:63]
ds_read_b64_tr_b16 v[38:39], v31 offset:6528
v_add_f32 v18, v18, v22
v_add_f32 v19, v19, v23
v_add_f32 v20, v20, v24
v_add_f32 v21, v21, v25
v_lshlrev_b32 v22, 16, v252
v_mfma_f32_32x32x16_bf16 a[32:47], v[48:51], a[160:163], a[32:47]
ds_read_b64_tr_b16 v[40:41], v31 offset:10368
v_and_b32 v23, 0xffff0000, v252
v_lshlrev_b32 v24, 16, v253
v_and_b32 v25, 0xffff0000, v253
v_add_f32 v18, v18, v22
v_add_f32 v19, v19, v23
v_mfma_f32_32x32x16_bf16 a[48:63], v[48:51], a[240:243], a[48:63]
ds_read_b64_tr_b16 v[42:43], v31 offset:11648
v_add_f32 v20, v20, v24
v_add_f32 v21, v21, v25
v_mul_f32 v22, s52, v18
v_mul_f32 v23, s52, v19
v_mul_f32 v24, s52, v20
s_waitcnt lgkmcnt(6)
v_mfma_f32_32x32x16_bf16 a[32:47], v[52:55], a[164:167], a[32:47]
ds_read_b64_tr_b16 v[44:45], v31 offset:15488
v_mul_f32 v25, s52, v21
v_exp_f32 v22, v22
v_exp_f32 v23, v23
v_exp_f32 v24, v24
v_exp_f32 v25, v25
v_mfma_f32_32x32x16_bf16 a[48:63], v[52:55], a[244:247], a[48:63]
ds_read_b64_tr_b16 v[46:47], v31 offset:16768
v_add_f32 v22, 1.0, v22
v_add_f32 v23, 1.0, v23
v_add_f32 v24, 1.0, v24
v_add_f32 v25, 1.0, v25
v_rcp_f32 v22, v22
v_mfma_f32_32x32x16_bf16 a[32:47], v[56:59], a[168:171], a[32:47]
ds_read_b64_tr_b16 v[48:49], v31 offset:20608
v_rcp_f32 v23, v23
v_rcp_f32 v24, v24
v_rcp_f32 v25, v25
v_mul_f32 v114, v22, v18
v_mul_f32 v115, v23, v19
v_mfma_f32_32x32x16_bf16 a[48:63], v[56:59], a[248:251], a[48:63]
ds_read_b64_tr_b16 v[50:51], v31 offset:21888
v_mul_f32 v116, v24, v20
v_mul_f32 v117, v25, v21
s_waitcnt vmcnt(7)
v_lshlrev_b32 v18, 16, v216
v_and_b32 v19, 0xffff0000, v216
v_mfma_f32_32x32x16_bf16 a[32:47], v[60:63], a[172:175], a[32:47]
ds_read_b64_tr_b16 v[52:53], v31 offset:25728
v_lshlrev_b32 v20, 16, v217
v_and_b32 v21, 0xffff0000, v217
v_lshlrev_b32 v22, 16, v218
v_and_b32 v23, 0xffff0000, v218
v_lshlrev_b32 v24, 16, v219
v_mfma_f32_32x32x16_bf16 a[48:63], v[60:63], a[252:255], a[48:63]
ds_read_b64_tr_b16 v[54:55], v31 offset:27008
v_and_b32 v25, 0xffff0000, v219
s_waitcnt vmcnt(6)
v_lshlrev_b32 v2, 16, v220
v_and_b32 v3, 0xffff0000, v220
v_lshlrev_b32 v28, 16, v221
v_and_b32 v29, 0xffff0000, v221
s_waitcnt lgkmcnt(6)
v_mfma_f32_32x32x16_bf16 a[64:79], v[32:35], v[64:67], a[64:79]
ds_read_b64_tr_b16 v[56:57], v31 offset:30848
v_add_f32 v18, v18, v2
v_add_f32 v19, v19, v3
v_add_f32 v20, v20, v28
v_add_f32 v21, v21, v29
v_lshlrev_b32 v2, 16, v222
v_mfma_f32_32x32x16_bf16 a[80:95], v[32:35], v[80:83], a[80:95]
ds_read_b64_tr_b16 v[58:59], v31 offset:32128
v_and_b32 v3, 0xffff0000, v222
v_lshlrev_b32 v28, 16, v223
v_and_b32 v29, 0xffff0000, v223
v_add_f32 v22, v22, v2
v_add_f32 v23, v23, v3
v_mfma_f32_32x32x16_bf16 a[64:79], v[36:39], v[68:71], a[64:79]
ds_read_b64_tr_b16 v[60:61], v31 offset:35968
v_add_f32 v24, v24, v28
v_add_f32 v25, v25, v29
v_permlane32_swap_b32 v18, v22
v_permlane32_swap_b32 v19, v23
v_permlane32_swap_b32 v20, v24
v_mfma_f32_32x32x16_bf16 a[80:95], v[36:39], v[84:87], a[80:95]
ds_read_b64_tr_b16 v[62:63], v31 offset:37248
v_permlane32_swap_b32 v21, v25
v_add_f32 v18, v18, v22
v_add_f32 v19, v19, v23
v_add_f32 v20, v20, v24
v_add_f32 v21, v21, v25
v_accvgpr_read_b32 v4, a32
v_accvgpr_read_b32 v5, a33
v_accvgpr_read_b32 v1, a34
v_accvgpr_read_b32 v10, a35
v_mfma_f32_32x32x16_bf16 a[64:79], v[40:43], v[72:75], a[64:79]
ds_read_b64_tr_b16 v[32:33], v31 offset:41088
v_lshlrev_b32 v22, 16, v254
v_and_b32 v23, 0xffff0000, v254
v_lshlrev_b32 v24, 16, v255
v_and_b32 v25, 0xffff0000, v255
v_add_f32 v18, v18, v22
v_cvt_pk_bf16_f32 v14, v4, v5
v_cvt_pk_bf16_f32 v15, v1, v10
v_accvgpr_read_b32 v4, a36
v_accvgpr_read_b32 v5, a37
v_mfma_f32_32x32x16_bf16 a[80:95], v[40:43], v[88:91], a[80:95]
ds_read_b64_tr_b16 v[34:35], v31 offset:42368
v_add_f32 v19, v19, v23
v_add_f32 v20, v20, v24
v_add_f32 v21, v21, v25
v_mul_f32 v22, s52, v18
v_mul_f32 v23, s52, v19
v_accvgpr_read_b32 v1, a38
v_accvgpr_read_b32 v10, a39
v_cvt_pk_bf16_f32 v16, v4, v5
v_cvt_pk_bf16_f32 v17, v1, v10
s_waitcnt lgkmcnt(6)
v_mfma_f32_32x32x16_bf16 a[64:79], v[44:47], v[76:79], a[64:79]
ds_read_b64_tr_b16 v[36:37], v31 offset:46208
v_mul_f32 v24, s52, v20
v_mul_f32 v25, s52, v21
v_exp_f32 v22, v22
v_exp_f32 v23, v23
v_exp_f32 v24, v24
buffer_store_dwordx4 v[14:17], v12, s[12:15], 0 offen offset:2048 sc1
v_accvgpr_read_b32 v4, a40
v_accvgpr_read_b32 v5, a41
v_mfma_f32_32x32x16_bf16 a[80:95], v[44:47], v[92:95], a[80:95]
ds_read_b64_tr_b16 v[38:39], v31 offset:47488
v_exp_f32 v25, v25
v_add_f32 v22, 1.0, v22
v_add_f32 v23, 1.0, v23
v_add_f32 v24, 1.0, v24
v_add_f32 v25, 1.0, v25
v_accvgpr_read_b32 v1, a42
v_accvgpr_read_b32 v10, a43
v_cvt_pk_bf16_f32 v14, v4, v5
v_cvt_pk_bf16_f32 v15, v1, v10
v_mfma_f32_32x32x16_bf16 a[64:79], v[48:51], v[128:131], a[64:79]
ds_read_b64_tr_b16 v[40:41], v31 offset:51328
v_rcp_f32 v22, v22
v_rcp_f32 v23, v23
v_rcp_f32 v24, v24
v_rcp_f32 v25, v25
v_mul_f32 v118, v22, v18
v_accvgpr_read_b32 v4, a44
v_accvgpr_read_b32 v5, a45
v_accvgpr_read_b32 v1, a46
v_accvgpr_read_b32 v10, a47
v_mfma_f32_32x32x16_bf16 a[80:95], v[48:51], v[144:147], a[80:95]
ds_read_b64_tr_b16 v[42:43], v31 offset:52608
v_mul_f32 v119, v23, v19
v_mul_f32 v120, v24, v20
v_mul_f32 v121, v25, v21
s_waitcnt vmcnt(6)
v_lshlrev_b32 v18, 16, v224
v_cvt_pk_bf16_f32 v16, v4, v5
v_cvt_pk_bf16_f32 v17, v1, v10
buffer_store_dwordx4 v[14:17], v12, s[12:15], 0 offen offset:3072 sc1
v_mfma_f32_32x32x16_bf16 a[64:79], v[52:55], v[132:135], a[64:79]
ds_read_b64_tr_b16 v[44:45], v31 offset:56448
v_and_b32 v19, 0xffff0000, v224
v_lshlrev_b32 v20, 16, v225
v_and_b32 v21, 0xffff0000, v225
v_lshlrev_b32 v22, 16, v226
v_and_b32 v23, 0xffff0000, v226
v_accvgpr_read_b32 v4, a48
v_accvgpr_read_b32 v5, a49
v_accvgpr_read_b32 v1, a50
v_accvgpr_read_b32 v10, a51
v_mfma_f32_32x32x16_bf16 a[80:95], v[52:55], v[148:151], a[80:95]
ds_read_b64_tr_b16 v[46:47], v31 offset:57728
v_lshlrev_b32 v24, 16, v227
v_and_b32 v25, 0xffff0000, v227
s_waitcnt vmcnt(6)
v_lshlrev_b32 v2, 16, v228
v_and_b32 v3, 0xffff0000, v228
v_lshlrev_b32 v28, 16, v229
v_cvt_pk_bf16_f32 v14, v4, v5
v_cvt_pk_bf16_f32 v15, v1, v10
v_accvgpr_read_b32 v4, a52
v_accvgpr_read_b32 v5, a53
s_waitcnt lgkmcnt(6)
v_mfma_f32_32x32x16_bf16 a[64:79], v[56:59], v[136:139], a[64:79]
ds_read_b64_tr_b16 v[48:49], v8 offset:128
v_and_b32 v29, 0xffff0000, v229
v_add_f32 v18, v18, v2
v_add_f32 v19, v19, v3
v_add_f32 v20, v20, v28
v_add_f32 v21, v21, v29
v_accvgpr_read_b32 v1, a54
v_accvgpr_read_b32 v10, a55
v_cvt_pk_bf16_f32 v16, v4, v5
v_cvt_pk_bf16_f32 v17, v1, v10
v_mfma_f32_32x32x16_bf16 a[80:95], v[56:59], v[152:155], a[80:95]
ds_read_b64_tr_b16 v[50:51], v8 offset:1408
v_lshlrev_b32 v2, 16, v230
v_and_b32 v3, 0xffff0000, v230
v_lshlrev_b32 v28, 16, v231
v_and_b32 v29, 0xffff0000, v231
v_add_f32 v22, v22, v2
buffer_store_dwordx4 v[14:17], v13, s[12:15], 0 offen offset:2048 sc1
v_accvgpr_read_b32 v4, a56
v_accvgpr_read_b32 v5, a57
v_mfma_f32_32x32x16_bf16 a[64:79], v[60:63], v[140:143], a[64:79]
ds_read_b64_tr_b16 v[52:53], v8 offset:5248
v_add_f32 v23, v23, v3
v_add_f32 v24, v24, v28
v_add_f32 v25, v25, v29
v_permlane32_swap_b32 v18, v22
v_permlane32_swap_b32 v19, v23
v_accvgpr_read_b32 v1, a58
v_accvgpr_read_b32 v10, a59
v_cvt_pk_bf16_f32 v14, v4, v5
v_cvt_pk_bf16_f32 v15, v1, v10
v_mfma_f32_32x32x16_bf16 a[80:95], v[60:63], v[156:159], a[80:95]
ds_read_b64_tr_b16 v[54:55], v8 offset:6528
v_permlane32_swap_b32 v20, v24
v_permlane32_swap_b32 v21, v25
v_add_f32 v18, v18, v22
v_add_f32 v19, v19, v23
v_add_f32 v20, v20, v24
v_accvgpr_read_b32 v4, a60
v_accvgpr_read_b32 v5, a61
v_accvgpr_read_b32 v1, a62
v_accvgpr_read_b32 v10, a63
v_mfma_f32_32x32x16_bf16 a[64:79], v[32:35], v[160:163], a[64:79]
ds_read_b64_tr_b16 v[56:57], v8 offset:10368
v_add_f32 v21, v21, v25
v_lshlrev_b32 v22, 16, v126
v_and_b32 v23, 0xffff0000, v126
v_lshlrev_b32 v24, 16, v127
v_and_b32 v25, 0xffff0000, v127
v_cvt_pk_bf16_f32 v16, v4, v5
v_cvt_pk_bf16_f32 v17, v1, v10
buffer_store_dwordx4 v[14:17], v13, s[12:15], 0 offen offset:3072 sc1
v_mfma_f32_32x32x16_bf16 a[80:95], v[32:35], v[176:179], a[80:95]
ds_read_b64_tr_b16 v[58:59], v8 offset:11648
v_add_f32 v18, v18, v22
v_add_f32 v19, v19, v23
v_add_f32 v20, v20, v24
v_add_f32 v21, v21, v25
v_mul_f32 v22, s52, v18
s_waitcnt lgkmcnt(6)
v_mfma_f32_32x32x16_bf16 a[64:79], v[36:39], v[164:167], a[64:79]
ds_read_b64_tr_b16 v[60:61], v8 offset:15488
v_mul_f32 v23, s52, v19
v_mul_f32 v24, s52, v20
v_mul_f32 v25, s52, v21
v_exp_f32 v22, v22
v_exp_f32 v23, v23
v_mfma_f32_32x32x16_bf16 a[80:95], v[36:39], v[180:183], a[80:95]
ds_read_b64_tr_b16 v[62:63], v8 offset:16768
v_exp_f32 v24, v24
v_exp_f32 v25, v25
v_add_f32 v22, 1.0, v22
v_add_f32 v23, 1.0, v23
v_add_f32 v24, 1.0, v24
v_mfma_f32_32x32x16_bf16 a[64:79], v[40:43], v[168:171], a[64:79]
ds_read_b64_tr_b16 v[32:33], v9 offset:20608
v_add_f32 v25, 1.0, v25
v_rcp_f32 v22, v22
v_rcp_f32 v23, v23
v_rcp_f32 v24, v24
v_rcp_f32 v25, v25
v_mfma_f32_32x32x16_bf16 a[80:95], v[40:43], v[184:187], a[80:95]
ds_read_b64_tr_b16 v[34:35], v9 offset:21888
v_mul_f32 v122, v22, v18
v_mul_f32 v123, v23, v19
v_mul_f32 v124, v24, v20
v_mul_f32 v125, v25, v21
v_mfma_f32_32x32x16_bf16 a[64:79], v[44:47], v[172:175], a[64:79]
ds_read_b64_tr_b16 v[36:37], v9 offset:25728
v_mfma_f32_32x32x16_bf16 a[80:95], v[44:47], v[188:191], a[80:95]
ds_read_b64_tr_b16 v[38:39], v9 offset:27008
s_waitcnt lgkmcnt(6)
v_mfma_f32_32x32x16_bf16 a[64:79], v[48:51], a[96:99], a[64:79]
ds_read_b64_tr_b16 v[40:41], v9 offset:30848
s_add_u32 s63, s50, 0
buffer_load_dwordx4 v[232:235], v11, s[12:15], s63 offen sc1
v_mfma_f32_32x32x16_bf16 a[80:95], v[48:51], a[112:115], a[80:95]
ds_read_b64_tr_b16 v[42:43], v9 offset:32128
s_add_u32 s63, s50, 20480
buffer_load_dwordx4 v[236:239], v11, s[12:15], s63 offen sc1
v_mfma_f32_32x32x16_bf16 a[64:79], v[52:55], a[100:103], a[64:79]
ds_read_b64_tr_b16 v[44:45], v9 offset:35968
s_add_u32 s63, s50, 40960
buffer_load_dwordx4 v[240:243], v11, s[12:15], s63 offen sc1
v_mfma_f32_32x32x16_bf16 a[80:95], v[52:55], a[116:119], a[80:95]
ds_read_b64_tr_b16 v[46:47], v9 offset:37248
s_add_u32 s63, s50, 61440
buffer_load_dwordx4 v[244:247], v11, s[12:15], s63 offen sc1
v_mfma_f32_32x32x16_bf16 a[64:79], v[56:59], a[104:107], a[64:79]
ds_read_b64_tr_b16 v[48:49], v8 offset:20608
v_mfma_f32_32x32x16_bf16 a[80:95], v[56:59], a[120:123], a[80:95]
ds_read_b64_tr_b16 v[50:51], v8 offset:21888
s_waitcnt lgkmcnt(6)
v_mfma_f32_32x32x16_bf16 a[64:79], v[60:63], a[108:111], a[64:79]
ds_read_b64_tr_b16 v[52:53], v8 offset:25728
v_mfma_f32_32x32x16_bf16 a[80:95], v[60:63], a[124:127], a[80:95]
ds_read_b64_tr_b16 v[54:55], v8 offset:27008
v_mfma_f32_32x32x16_bf16 a[64:79], v[32:35], a[128:131], a[64:79]
ds_read_b64_tr_b16 v[56:57], v8 offset:30848
v_mfma_f32_32x32x16_bf16 a[80:95], v[32:35], a[144:147], a[80:95]
ds_read_b64_tr_b16 v[58:59], v8 offset:32128
v_mfma_f32_32x32x16_bf16 a[64:79], v[36:39], a[132:135], a[64:79]
ds_read_b64_tr_b16 v[60:61], v8 offset:35968
v_mfma_f32_32x32x16_bf16 a[80:95], v[36:39], a[148:151], a[80:95]
ds_read_b64_tr_b16 v[62:63], v8 offset:37248
s_waitcnt lgkmcnt(6)
v_mfma_f32_32x32x16_bf16 a[64:79], v[40:43], a[136:139], a[64:79]
ds_read_b64_tr_b16 v[32:33], v31 offset:192
v_mfma_f32_32x32x16_bf16 a[80:95], v[40:43], a[152:155], a[80:95]
ds_read_b64_tr_b16 v[34:35], v31 offset:1472
v_mfma_f32_32x32x16_bf16 a[64:79], v[44:47], a[140:143], a[64:79]
ds_read_b64_tr_b16 v[36:37], v31 offset:5312
v_mfma_f32_32x32x16_bf16 a[80:95], v[44:47], a[156:159], a[80:95]
ds_read_b64_tr_b16 v[38:39], v31 offset:6592
v_mfma_f32_32x32x16_bf16 a[64:79], v[48:51], a[160:163], a[64:79]
ds_read_b64_tr_b16 v[40:41], v31 offset:10432
v_mfma_f32_32x32x16_bf16 a[80:95], v[48:51], a[240:243], a[80:95]
ds_read_b64_tr_b16 v[42:43], v31 offset:11712
s_waitcnt lgkmcnt(6)
v_mfma_f32_32x32x16_bf16 a[64:79], v[52:55], a[164:167], a[64:79]
ds_read_b64_tr_b16 v[44:45], v31 offset:15552
v_mfma_f32_32x32x16_bf16 a[80:95], v[52:55], a[244:247], a[80:95]
ds_read_b64_tr_b16 v[46:47], v31 offset:16832
v_mfma_f32_32x32x16_bf16 a[64:79], v[56:59], a[168:171], a[64:79]
ds_read_b64_tr_b16 v[48:49], v31 offset:20672
v_mfma_f32_32x32x16_bf16 a[80:95], v[56:59], a[248:251], a[80:95]
ds_read_b64_tr_b16 v[50:51], v31 offset:21952
v_mfma_f32_32x32x16_bf16 a[64:79], v[60:63], a[172:175], a[64:79]
ds_read_b64_tr_b16 v[52:53], v31 offset:25792
v_mfma_f32_32x32x16_bf16 a[80:95], v[60:63], a[252:255], a[80:95]
ds_read_b64_tr_b16 v[54:55], v31 offset:27072
s_waitcnt lgkmcnt(6)
v_mfma_f32_32x32x16_bf16 a[176:191], v[32:35], v[64:67], a[176:191]
ds_read_b64_tr_b16 v[56:57], v31 offset:30912
v_mfma_f32_32x32x16_bf16 a[192:207], v[32:35], v[80:83], a[192:207]
ds_read_b64_tr_b16 v[58:59], v31 offset:32192
v_mfma_f32_32x32x16_bf16 a[176:191], v[36:39], v[68:71], a[176:191]
ds_read_b64_tr_b16 v[60:61], v31 offset:36032
v_mfma_f32_32x32x16_bf16 a[192:207], v[36:39], v[84:87], a[192:207]
ds_read_b64_tr_b16 v[62:63], v31 offset:37312
v_accvgpr_read_b32 v4, a64
v_accvgpr_read_b32 v5, a65
v_accvgpr_read_b32 v1, a66
v_accvgpr_read_b32 v10, a67
v_mfma_f32_32x32x16_bf16 a[176:191], v[40:43], v[72:75], a[176:191]
ds_read_b64_tr_b16 v[32:33], v31 offset:41152
v_cvt_pk_bf16_f32 v14, v4, v5
v_cvt_pk_bf16_f32 v15, v1, v10
v_accvgpr_read_b32 v4, a68
v_accvgpr_read_b32 v5, a69
v_mfma_f32_32x32x16_bf16 a[192:207], v[40:43], v[88:91], a[192:207]
ds_read_b64_tr_b16 v[34:35], v31 offset:42432
v_accvgpr_read_b32 v1, a70
v_accvgpr_read_b32 v10, a71
v_cvt_pk_bf16_f32 v16, v4, v5
v_cvt_pk_bf16_f32 v17, v1, v10
s_waitcnt lgkmcnt(6)
v_mfma_f32_32x32x16_bf16 a[176:191], v[44:47], v[76:79], a[176:191]
ds_read_b64_tr_b16 v[36:37], v31 offset:46272
buffer_store_dwordx4 v[14:17], v12, s[12:15], s56 offen offset:0 sc1
v_accvgpr_read_b32 v4, a72
v_accvgpr_read_b32 v5, a73
v_mfma_f32_32x32x16_bf16 a[192:207], v[44:47], v[92:95], a[192:207]
ds_read_b64_tr_b16 v[38:39], v31 offset:47552
v_accvgpr_read_b32 v1, a74
v_accvgpr_read_b32 v10, a75
v_cvt_pk_bf16_f32 v14, v4, v5
v_cvt_pk_bf16_f32 v15, v1, v10
v_mfma_f32_32x32x16_bf16 a[176:191], v[48:51], v[128:131], a[176:191]
ds_read_b64_tr_b16 v[40:41], v31 offset:51392
v_accvgpr_read_b32 v4, a76
v_accvgpr_read_b32 v5, a77
v_accvgpr_read_b32 v1, a78
v_accvgpr_read_b32 v10, a79
v_mfma_f32_32x32x16_bf16 a[192:207], v[48:51], v[144:147], a[192:207]
ds_read_b64_tr_b16 v[42:43], v31 offset:52672
v_cvt_pk_bf16_f32 v16, v4, v5
v_cvt_pk_bf16_f32 v17, v1, v10
buffer_store_dwordx4 v[14:17], v12, s[12:15], s56 offen offset:1024 sc1
v_mfma_f32_32x32x16_bf16 a[176:191], v[52:55], v[132:135], a[176:191]
ds_read_b64_tr_b16 v[44:45], v31 offset:56512
v_accvgpr_read_b32 v4, a80
v_accvgpr_read_b32 v5, a81
v_accvgpr_read_b32 v1, a82
v_accvgpr_read_b32 v10, a83
v_mfma_f32_32x32x16_bf16 a[192:207], v[52:55], v[148:151], a[192:207]
ds_read_b64_tr_b16 v[46:47], v31 offset:57792
v_cvt_pk_bf16_f32 v14, v4, v5
v_cvt_pk_bf16_f32 v15, v1, v10
v_accvgpr_read_b32 v4, a84
v_accvgpr_read_b32 v5, a85
s_waitcnt lgkmcnt(6)
v_mfma_f32_32x32x16_bf16 a[176:191], v[56:59], v[136:139], a[176:191]
ds_read_b64_tr_b16 v[48:49], v8 offset:192
v_accvgpr_read_b32 v1, a86
v_accvgpr_read_b32 v10, a87
v_cvt_pk_bf16_f32 v16, v4, v5
v_cvt_pk_bf16_f32 v17, v1, v10
v_mfma_f32_32x32x16_bf16 a[192:207], v[56:59], v[152:155], a[192:207]
ds_read_b64_tr_b16 v[50:51], v8 offset:1472
buffer_store_dwordx4 v[14:17], v13, s[12:15], s56 offen offset:0 sc1
v_accvgpr_read_b32 v4, a88
v_accvgpr_read_b32 v5, a89
v_mfma_f32_32x32x16_bf16 a[176:191], v[60:63], v[140:143], a[176:191]
ds_read_b64_tr_b16 v[52:53], v8 offset:5312
v_accvgpr_read_b32 v1, a90
v_accvgpr_read_b32 v10, a91
v_cvt_pk_bf16_f32 v14, v4, v5
v_cvt_pk_bf16_f32 v15, v1, v10
v_mfma_f32_32x32x16_bf16 a[192:207], v[60:63], v[156:159], a[192:207]
ds_read_b64_tr_b16 v[54:55], v8 offset:6592
v_accvgpr_read_b32 v4, a92
v_accvgpr_read_b32 v5, a93
v_accvgpr_read_b32 v1, a94
v_accvgpr_read_b32 v10, a95
v_mfma_f32_32x32x16_bf16 a[176:191], v[32:35], v[160:163], a[176:191]
ds_read_b64_tr_b16 v[56:57], v8 offset:10432
v_cvt_pk_bf16_f32 v16, v4, v5
v_cvt_pk_bf16_f32 v17, v1, v10
buffer_store_dwordx4 v[14:17], v13, s[12:15], s56 offen offset:1024 sc1
v_mfma_f32_32x32x16_bf16 a[192:207], v[32:35], v[176:179], a[192:207]
ds_read_b64_tr_b16 v[58:59], v8 offset:11712
s_waitcnt lgkmcnt(6)
v_mfma_f32_32x32x16_bf16 a[176:191], v[36:39], v[164:167], a[176:191]
ds_read_b64_tr_b16 v[60:61], v8 offset:15552
v_mfma_f32_32x32x16_bf16 a[192:207], v[36:39], v[180:183], a[192:207]
ds_read_b64_tr_b16 v[62:63], v8 offset:16832
v_mfma_f32_32x32x16_bf16 a[176:191], v[40:43], v[168:171], a[176:191]
ds_read_b64_tr_b16 v[32:33], v9 offset:20672
s_waitcnt vmcnt(7)
v_max3_u32 v7, v232, v233, v234
s_waitcnt vmcnt(6)
v_max3_u32 v7, v7, v235, v236
v_max3_u32 v7, v7, v237, v238
s_waitcnt vmcnt(5)
v_max3_u32 v7, v7, v239, v240
v_mfma_f32_32x32x16_bf16 a[192:207], v[40:43], v[184:187], a[192:207]
ds_read_b64_tr_b16 v[34:35], v9 offset:21952
v_max3_u32 v7, v7, v241, v242
s_waitcnt vmcnt(4)
v_max3_u32 v7, v7, v243, v244
v_max3_u32 v7, v7, v245, v246
v_max_u32 v7, v7, v247
v_mfma_f32_32x32x16_bf16 a[176:191], v[44:47], v[172:175], a[176:191]
ds_read_b64_tr_b16 v[36:37], v9 offset:25792
v_cmp_eq_u32 vcc, -1, v7
s_cbranch_vccnz SLOWS0
GOS0:
v_lshlrev_b32 v18, 16, v232
v_and_b32 v19, 0xffff0000, v232
v_mfma_f32_32x32x16_bf16 a[192:207], v[44:47], v[188:191], a[192:207]
ds_read_b64_tr_b16 v[38:39], v9 offset:27072
v_lshlrev_b32 v20, 16, v233
v_and_b32 v21, 0xffff0000, v233
v_lshlrev_b32 v22, 16, v234
v_and_b32 v23, 0xffff0000, v234
s_waitcnt lgkmcnt(6)
v_mfma_f32_32x32x16_bf16 a[176:191], v[48:51], a[96:99], a[176:191]
ds_read_b64_tr_b16 v[40:41], v9 offset:30912
v_lshlrev_b32 v24, 16, v235
v_and_b32 v25, 0xffff0000, v235
v_lshlrev_b32 v2, 16, v236
v_and_b32 v3, 0xffff0000, v236
s_add_u32 s63, s50, 2048
buffer_load_dwordx4 v[192:195], v11, s[12:15], s63 offen sc1
v_mfma_f32_32x32x16_bf16 a[192:207], v[48:51], a[112:115], a[192:207]
ds_read_b64_tr_b16 v[42:43], v9 offset:32192
v_lshlrev_b32 v28, 16, v237
v_and_b32 v29, 0xffff0000, v237
v_add_f32 v18, v18, v2
s_add_u32 s63, s50, 22528
buffer_load_dwordx4 v[196:199], v11, s[12:15], s63 offen sc1
v_mfma_f32_32x32x16_bf16 a[176:191], v[52:55], a[100:103], a[176:191]
ds_read_b64_tr_b16 v[44:45], v9 offset:36032
v_add_f32 v19, v19, v3
v_add_f32 v20, v20, v28
v_add_f32 v21, v21, v29
v_lshlrev_b32 v2, 16, v238
s_add_u32 s63, s50, 43008
buffer_load_dwordx4 v[200:203], v11, s[12:15], s63 offen sc1
v_mfma_f32_32x32x16_bf16 a[192:207], v[52:55], a[116:119], a[192:207]
ds_read_b64_tr_b16 v[46:47], v9 offset:37312
v_and_b32 v3, 0xffff0000, v238
v_lshlrev_b32 v28, 16, v239
v_and_b32 v29, 0xffff0000, v239
v_add_f32 v22, v22, v2
s_add_u32 s63, s50, 63488
buffer_load_dwordx4 v[204:207], v11, s[12:15], s63 offen sc1
v_mfma_f32_32x32x16_bf16 a[176:191], v[56:59], a[104:107], a[176:191]
ds_read_b64_tr_b16 v[48:49], v8 offset:20672
v_add_f32 v23, v23, v3
v_add_f32 v24, v24, v28
v_add_f32 v25, v25, v29
v_mfma_f32_32x32x16_bf16 a[192:207], v[56:59], a[120:123], a[192:207]
ds_read_b64_tr_b16 v[50:51], v8 offset:21952
v_lshlrev_b32 v2, 16, v240
v_and_b32 v3, 0xffff0000, v240
v_lshlrev_b32 v28, 16, v241
v_and_b32 v29, 0xffff0000, v241
s_waitcnt lgkmcnt(6)
v_mfma_f32_32x32x16_bf16 a[176:191], v[60:63], a[108:111], a[176:191]
ds_read_b64_tr_b16 v[52:53], v8 offset:25792
v_add_f32 v18, v18, v2
v_add_f32 v19, v19, v3
v_add_f32 v20, v20, v28
v_add_f32 v21, v21, v29
v_mfma_f32_32x32x16_bf16 a[192:207], v[60:63], a[124:127], a[192:207]
ds_read_b64_tr_b16 v[54:55], v8 offset:27072
v_lshlrev_b32 v2, 16, v242
v_and_b32 v3, 0xffff0000, v242
v_lshlrev_b32 v28, 16, v243
v_mfma_f32_32x32x16_bf16 a[176:191], v[32:35], a[128:131], a[176:191]
ds_read_b64_tr_b16 v[56:57], v8 offset:30912
v_and_b32 v29, 0xffff0000, v243
v_add_f32 v22, v22, v2
v_add_f32 v23, v23, v3
v_add_f32 v24, v24, v28
v_mfma_f32_32x32x16_bf16 a[192:207], v[32:35], a[144:147], a[192:207]
ds_read_b64_tr_b16 v[58:59], v8 offset:32192
v_add_f32 v25, v25, v29
v_lshlrev_b32 v2, 16, v244
v_and_b32 v3, 0xffff0000, v244
v_lshlrev_b32 v28, 16, v245
v_mfma_f32_32x32x16_bf16 a[176:191], v[36:39], a[132:135], a[176:191]
ds_read_b64_tr_b16 v[60:61], v8 offset:36032
v_and_b32 v29, 0xffff0000, v245
v_add_f32 v18, v18, v2
v_add_f32 v19, v19, v3
v_mfma_f32_32x32x16_bf16 a[192:207], v[36:39], a[148:151], a[192:207]
ds_read_b64_tr_b16 v[62:63], v8 offset:37312
v_add_f32 v20, v20, v28
v_add_f32 v21, v21, v29
v_lshlrev_b32 v2, 16, v246
v_and_b32 v3, 0xffff0000, v246
s_waitcnt lgkmcnt(6)
v_mfma_f32_32x32x16_bf16 a[176:191], v[40:43], a[136:139], a[176:191]
ds_read_b64_tr_b16 v[32:33], v31 offset:256
v_lshlrev_b32 v28, 16, v247
v_and_b32 v29, 0xffff0000, v247
v_add_f32 v22, v22, v2
v_add_f32 v23, v23, v3
v_mfma_f32_32x32x16_bf16 a[192:207], v[40:43], a[152:155], a[192:207]
ds_read_b64_tr_b16 v[34:35], v31 offset:1536
v_add_f32 v24, v24, v28
v_add_f32 v25, v25, v29
v_permlane32_swap_b32 v18, v22
v_mfma_f32_32x32x16_bf16 a[176:191], v[44:47], a[140:143], a[176:191]
ds_read_b64_tr_b16 v[36:37], v31 offset:5376
v_permlane32_swap_b32 v19, v23
v_permlane32_swap_b32 v20, v24
v_permlane32_swap_b32 v21, v25
v_add_f32 v18, v18, v22
v_mfma_f32_32x32x16_bf16 a[192:207], v[44:47], a[156:159], a[192:207]
ds_read_b64_tr_b16 v[38:39], v31 offset:6656
v_add_f32 v19, v19, v23
v_add_f32 v20, v20, v24
v_add_f32 v21, v21, v25
v_lshlrev_b32 v22, 16, v96
v_mfma_f32_32x32x16_bf16 a[176:191], v[48:51], a[160:163], a[176:191]
ds_read_b64_tr_b16 v[40:41], v31 offset:10496
v_and_b32 v23, 0xffff0000, v96
v_lshlrev_b32 v24, 16, v97
v_and_b32 v25, 0xffff0000, v97
v_mfma_f32_32x32x16_bf16 a[192:207], v[48:51], a[240:243], a[192:207]
ds_read_b64_tr_b16 v[42:43], v31 offset:11776
v_fma_f32 v18, v18, v106, v22
v_fma_f32 v19, v19, v107, v23
v_fma_f32 v20, v20, v108, v24
v_fma_f32 v21, v21, v109, v25
s_waitcnt lgkmcnt(6)
v_mfma_f32_32x32x16_bf16 a[176:191], v[52:55], a[164:167], a[176:191]
ds_read_b64_tr_b16 v[44:45], v31 offset:15616
v_cvt_pk_bf16_f32 v96, v18, v19
v_cvt_pk_bf16_f32 v97, v20, v21
buffer_store_dwordx2 v[96:97], v6, s[40:43], 0 offen offset:0
v_mfma_f32_32x32x16_bf16 a[192:207], v[52:55], a[244:247], a[192:207]
ds_read_b64_tr_b16 v[46:47], v31 offset:16896
v_mfma_f32_32x32x16_bf16 a[176:191], v[56:59], a[168:171], a[176:191]
ds_read_b64_tr_b16 v[48:49], v31 offset:20736
v_mfma_f32_32x32x16_bf16 a[192:207], v[56:59], a[248:251], a[192:207]
ds_read_b64_tr_b16 v[50:51], v31 offset:22016
v_mfma_f32_32x32x16_bf16 a[176:191], v[60:63], a[172:175], a[176:191]
ds_read_b64_tr_b16 v[52:53], v31 offset:25856
v_mfma_f32_32x32x16_bf16 a[192:207], v[60:63], a[252:255], a[192:207]
ds_read_b64_tr_b16 v[54:55], v31 offset:27136
s_waitcnt lgkmcnt(6)
v_mfma_f32_32x32x16_bf16 a[208:223], v[32:35], v[64:67], a[208:223]
ds_read_b64_tr_b16 v[56:57], v31 offset:30976
v_mfma_f32_32x32x16_bf16 a[224:239], v[32:35], v[80:83], a[224:239]
ds_read_b64_tr_b16 v[58:59], v31 offset:32256
v_mfma_f32_32x32x16_bf16 a[208:223], v[36:39], v[68:71], a[208:223]
ds_read_b64_tr_b16 v[60:61], v31 offset:36096
v_mfma_f32_32x32x16_bf16 a[224:239], v[36:39], v[84:87], a[224:239]
ds_read_b64_tr_b16 v[62:63], v31 offset:37376
v_accvgpr_read_b32 v4, a176
v_accvgpr_read_b32 v5, a177
v_accvgpr_read_b32 v1, a178
v_accvgpr_read_b32 v10, a179
v_mfma_f32_32x32x16_bf16 a[208:223], v[40:43], v[72:75], a[208:223]
ds_read_b64_tr_b16 v[32:33], v31 offset:41216
v_cvt_pk_bf16_f32 v14, v4, v5
v_cvt_pk_bf16_f32 v15, v1, v10
v_accvgpr_read_b32 v4, a180
v_accvgpr_read_b32 v5, a181
v_mfma_f32_32x32x16_bf16 a[224:239], v[40:43], v[88:91], a[224:239]
ds_read_b64_tr_b16 v[34:35], v31 offset:42496
v_accvgpr_read_b32 v1, a182
v_accvgpr_read_b32 v10, a183
v_cvt_pk_bf16_f32 v16, v4, v5
v_cvt_pk_bf16_f32 v17, v1, v10
s_waitcnt lgkmcnt(6)
v_mfma_f32_32x32x16_bf16 a[208:223], v[44:47], v[76:79], a[208:223]
ds_read_b64_tr_b16 v[36:37], v31 offset:46336
buffer_store_dwordx4 v[14:17], v12, s[12:15], s56 offen offset:2048 sc1
v_accvgpr_read_b32 v4, a184
v_accvgpr_read_b32 v5, a185
v_mfma_f32_32x32x16_bf16 a[224:239], v[44:47], v[92:95], a[224:239]
ds_read_b64_tr_b16 v[38:39], v31 offset:47616
v_accvgpr_read_b32 v1, a186
v_accvgpr_read_b32 v10, a187
v_cvt_pk_bf16_f32 v14, v4, v5
v_cvt_pk_bf16_f32 v15, v1, v10
v_mfma_f32_32x32x16_bf16 a[208:223], v[48:51], v[128:131], a[208:223]
ds_read_b64_tr_b16 v[40:41], v31 offset:51456
v_accvgpr_read_b32 v4, a188
v_accvgpr_read_b32 v5, a189
v_accvgpr_read_b32 v1, a190
v_accvgpr_read_b32 v10, a191
v_mfma_f32_32x32x16_bf16 a[224:239], v[48:51], v[144:147], a[224:239]
ds_read_b64_tr_b16 v[42:43], v31 offset:52736
v_cvt_pk_bf16_f32 v16, v4, v5
v_cvt_pk_bf16_f32 v17, v1, v10
buffer_store_dwordx4 v[14:17], v12, s[12:15], s56 offen offset:3072 sc1
v_mfma_f32_32x32x16_bf16 a[208:223], v[52:55], v[132:135], a[208:223]
ds_read_b64_tr_b16 v[44:45], v31 offset:56576
v_accvgpr_read_b32 v4, a192
v_accvgpr_read_b32 v5, a193
v_accvgpr_read_b32 v1, a194
v_accvgpr_read_b32 v10, a195
v_mfma_f32_32x32x16_bf16 a[224:239], v[52:55], v[148:151], a[224:239]
ds_read_b64_tr_b16 v[46:47], v31 offset:57856
v_cvt_pk_bf16_f32 v14, v4, v5
v_cvt_pk_bf16_f32 v15, v1, v10
v_accvgpr_read_b32 v4, a196
v_accvgpr_read_b32 v5, a197
s_waitcnt lgkmcnt(6)
v_mfma_f32_32x32x16_bf16 a[208:223], v[56:59], v[136:139], a[208:223]
ds_read_b64_tr_b16 v[48:49], v8 offset:256
v_accvgpr_read_b32 v1, a198
v_accvgpr_read_b32 v10, a199
v_cvt_pk_bf16_f32 v16, v4, v5
v_cvt_pk_bf16_f32 v17, v1, v10
v_mfma_f32_32x32x16_bf16 a[224:239], v[56:59], v[152:155], a[224:239]
ds_read_b64_tr_b16 v[50:51], v8 offset:1536
buffer_store_dwordx4 v[14:17], v13, s[12:15], s56 offen offset:2048 sc1
v_accvgpr_read_b32 v4, a200
v_accvgpr_read_b32 v5, a201
v_mfma_f32_32x32x16_bf16 a[208:223], v[60:63], v[140:143], a[208:223]
ds_read_b64_tr_b16 v[52:53], v8 offset:5376
v_accvgpr_read_b32 v1, a202
v_accvgpr_read_b32 v10, a203
v_cvt_pk_bf16_f32 v14, v4, v5
v_cvt_pk_bf16_f32 v15, v1, v10
v_mfma_f32_32x32x16_bf16 a[224:239], v[60:63], v[156:159], a[224:239]
ds_read_b64_tr_b16 v[54:55], v8 offset:6656
v_accvgpr_read_b32 v4, a204
v_accvgpr_read_b32 v5, a205
v_accvgpr_read_b32 v1, a206
v_accvgpr_read_b32 v10, a207
v_mfma_f32_32x32x16_bf16 a[208:223], v[32:35], v[160:163], a[208:223]
ds_read_b64_tr_b16 v[56:57], v8 offset:10496
v_cvt_pk_bf16_f32 v16, v4, v5
v_cvt_pk_bf16_f32 v17, v1, v10
buffer_store_dwordx4 v[14:17], v13, s[12:15], s56 offen offset:3072 sc1
v_mfma_f32_32x32x16_bf16 a[224:239], v[32:35], v[176:179], a[224:239]
ds_read_b64_tr_b16 v[58:59], v8 offset:11776
s_waitcnt lgkmcnt(6)
v_mfma_f32_32x32x16_bf16 a[208:223], v[36:39], v[164:167], a[208:223]
ds_read_b64_tr_b16 v[60:61], v8 offset:15616
v_mfma_f32_32x32x16_bf16 a[224:239], v[36:39], v[180:183], a[224:239]
ds_read_b64_tr_b16 v[62:63], v8 offset:16896
v_mfma_f32_32x32x16_bf16 a[208:223], v[40:43], v[168:171], a[208:223]
ds_read_b64_tr_b16 v[32:33], v9 offset:20736
s_waitcnt vmcnt(8)
v_max3_u32 v7, v192, v193, v194
s_waitcnt vmcnt(7)
v_max3_u32 v7, v7, v195, v196
v_max3_u32 v7, v7, v197, v198
s_waitcnt vmcnt(6)
v_max3_u32 v7, v7, v199, v200
v_mfma_f32_32x32x16_bf16 a[224:239], v[40:43], v[184:187], a[224:239]
ds_read_b64_tr_b16 v[34:35], v9 offset:22016
v_max3_u32 v7, v7, v201, v202
s_waitcnt vmcnt(5)
v_max3_u32 v7, v7, v203, v204
v_max3_u32 v7, v7, v205, v206
v_max_u32 v7, v7, v207
v_mfma_f32_32x32x16_bf16 a[208:223], v[44:47], v[172:175], a[208:223]
ds_read_b64_tr_b16 v[36:37], v9 offset:25856
v_cmp_eq_u32 vcc, -1, v7
s_cbranch_vccnz SLOWS1
GOS1:
v_lshlrev_b32 v18, 16, v192
v_and_b32 v19, 0xffff0000, v192
v_mfma_f32_32x32x16_bf16 a[224:239], v[44:47], v[188:191], a[224:239]
ds_read_b64_tr_b16 v[38:39], v9 offset:27136
v_lshlrev_b32 v20, 16, v193
v_and_b32 v21, 0xffff0000, v193
v_lshlrev_b32 v22, 16, v194
v_and_b32 v23, 0xffff0000, v194
s_waitcnt lgkmcnt(6)
v_mfma_f32_32x32x16_bf16 a[208:223], v[48:51], a[96:99], a[208:223]
ds_read_b64_tr_b16 v[40:41], v9 offset:30976
v_lshlrev_b32 v24, 16, v195
v_and_b32 v25, 0xffff0000, v195
v_lshlrev_b32 v2, 16, v196
v_and_b32 v3, 0xffff0000, v196
s_add_u32 s63, s50, 4096
buffer_load_dwordx4 v[208:211], v11, s[12:15], s63 offen sc1
v_mfma_f32_32x32x16_bf16 a[224:239], v[48:51], a[112:115], a[224:239]
ds_read_b64_tr_b16 v[42:43], v9 offset:32256
v_lshlrev_b32 v28, 16, v197
v_and_b32 v29, 0xffff0000, v197
v_add_f32 v18, v18, v2
s_add_u32 s63, s50, 24576
buffer_load_dwordx4 v[212:215], v11, s[12:15], s63 offen sc1
v_mfma_f32_32x32x16_bf16 a[208:223], v[52:55], a[100:103], a[208:223]
ds_read_b64_tr_b16 v[44:45], v9 offset:36096
v_add_f32 v19, v19, v3
v_add_f32 v20, v20, v28
v_add_f32 v21, v21, v29
v_lshlrev_b32 v2, 16, v198
s_add_u32 s63, s50, 45056
buffer_load_dwordx4 v[216:219], v11, s[12:15], s63 offen sc1
v_mfma_f32_32x32x16_bf16 a[224:239], v[52:55], a[116:119], a[224:239]
ds_read_b64_tr_b16 v[46:47], v9 offset:37376
v_and_b32 v3, 0xffff0000, v198
v_lshlrev_b32 v28, 16, v199
v_and_b32 v29, 0xffff0000, v199
v_add_f32 v22, v22, v2
s_add_u32 s63, s50, 65536
buffer_load_dwordx4 v[220:223], v11, s[12:15], s63 offen sc1
v_mfma_f32_32x32x16_bf16 a[208:223], v[56:59], a[104:107], a[208:223]
ds_read_b64_tr_b16 v[48:49], v8 offset:20736
v_add_f32 v23, v23, v3
v_add_f32 v24, v24, v28
v_add_f32 v25, v25, v29
v_mfma_f32_32x32x16_bf16 a[224:239], v[56:59], a[120:123], a[224:239]
ds_read_b64_tr_b16 v[50:51], v8 offset:22016
v_lshlrev_b32 v2, 16, v200
v_and_b32 v3, 0xffff0000, v200
v_lshlrev_b32 v28, 16, v201
v_and_b32 v29, 0xffff0000, v201
s_waitcnt lgkmcnt(6)
v_mfma_f32_32x32x16_bf16 a[208:223], v[60:63], a[108:111], a[208:223]
ds_read_b64_tr_b16 v[52:53], v8 offset:25856
v_add_f32 v18, v18, v2
v_add_f32 v19, v19, v3
v_add_f32 v20, v20, v28
v_add_f32 v21, v21, v29
v_mfma_f32_32x32x16_bf16 a[224:239], v[60:63], a[124:127], a[224:239]
ds_read_b64_tr_b16 v[54:55], v8 offset:27136
v_lshlrev_b32 v2, 16, v202
v_and_b32 v3, 0xffff0000, v202
v_lshlrev_b32 v28, 16, v203
v_mfma_f32_32x32x16_bf16 a[208:223], v[32:35], a[128:131], a[208:223]
ds_read_b64_tr_b16 v[56:57], v8 offset:30976
v_and_b32 v29, 0xffff0000, v203
v_add_f32 v22, v22, v2
v_add_f32 v23, v23, v3
v_add_f32 v24, v24, v28
v_mfma_f32_32x32x16_bf16 a[224:239], v[32:35], a[144:147], a[224:239]
ds_read_b64_tr_b16 v[58:59], v8 offset:32256
v_add_f32 v25, v25, v29
v_lshlrev_b32 v2, 16, v204
v_and_b32 v3, 0xffff0000, v204
v_lshlrev_b32 v28, 16, v205
v_mfma_f32_32x32x16_bf16 a[208:223], v[36:39], a[132:135], a[208:223]
ds_read_b64_tr_b16 v[60:61], v8 offset:36096
v_and_b32 v29, 0xffff0000, v205
v_add_f32 v18, v18, v2
v_add_f32 v19, v19, v3
v_mfma_f32_32x32x16_bf16 a[224:239], v[36:39], a[148:151], a[224:239]
ds_read_b64_tr_b16 v[62:63], v8 offset:37376
v_add_f32 v20, v20, v28
v_add_f32 v21, v21, v29
v_lshlrev_b32 v2, 16, v206
v_and_b32 v3, 0xffff0000, v206
s_waitcnt lgkmcnt(6)
v_mfma_f32_32x32x16_bf16 a[208:223], v[40:43], a[136:139], a[208:223]
v_lshlrev_b32 v28, 16, v207
v_and_b32 v29, 0xffff0000, v207
v_add_f32 v22, v22, v2
v_add_f32 v23, v23, v3
v_mfma_f32_32x32x16_bf16 a[224:239], v[40:43], a[152:155], a[224:239]
v_add_f32 v24, v24, v28
v_add_f32 v25, v25, v29
v_permlane32_swap_b32 v18, v22
v_mfma_f32_32x32x16_bf16 a[208:223], v[44:47], a[140:143], a[208:223]
v_permlane32_swap_b32 v19, v23
v_permlane32_swap_b32 v20, v24
v_permlane32_swap_b32 v21, v25
v_add_f32 v18, v18, v22
v_mfma_f32_32x32x16_bf16 a[224:239], v[44:47], a[156:159], a[224:239]
v_add_f32 v19, v19, v23
v_add_f32 v20, v20, v24
v_add_f32 v21, v21, v25
v_lshlrev_b32 v22, 16, v98
v_mfma_f32_32x32x16_bf16 a[208:223], v[48:51], a[160:163], a[208:223]
v_and_b32 v23, 0xffff0000, v98
v_lshlrev_b32 v24, 16, v99
v_and_b32 v25, 0xffff0000, v99
v_mfma_f32_32x32x16_bf16 a[224:239], v[48:51], a[240:243], a[224:239]
v_fma_f32 v18, v18, v110, v22
v_fma_f32 v19, v19, v111, v23
v_fma_f32 v20, v20, v112, v24
v_fma_f32 v21, v21, v113, v25
s_waitcnt lgkmcnt(4)
v_mfma_f32_32x32x16_bf16 a[208:223], v[52:55], a[164:167], a[208:223]
v_cvt_pk_bf16_f32 v98, v18, v19
v_cvt_pk_bf16_f32 v99, v20, v21
buffer_store_dwordx2 v[98:99], v6, s[40:43], 0 offen offset:64
v_mfma_f32_32x32x16_bf16 a[224:239], v[52:55], a[244:247], a[224:239]
s_waitcnt lgkmcnt(2)
v_mfma_f32_32x32x16_bf16 a[208:223], v[56:59], a[168:171], a[208:223]
v_mfma_f32_32x32x16_bf16 a[224:239], v[56:59], a[248:251], a[224:239]
s_waitcnt lgkmcnt(0)
v_mfma_f32_32x32x16_bf16 a[208:223], v[60:63], a[172:175], a[208:223]
v_mfma_f32_32x32x16_bf16 a[224:239], v[60:63], a[252:255], a[224:239]
s_nop 7
v_accvgpr_read_b32 v4, a208
v_accvgpr_read_b32 v5, a209
v_accvgpr_read_b32 v1, a210
v_accvgpr_read_b32 v10, a211
v_cvt_pk_bf16_f32 v14, v4, v5
v_cvt_pk_bf16_f32 v15, v1, v10
v_accvgpr_read_b32 v4, a212
v_accvgpr_read_b32 v5, a213
v_accvgpr_read_b32 v1, a214
v_accvgpr_read_b32 v10, a215
v_cvt_pk_bf16_f32 v16, v4, v5
v_cvt_pk_bf16_f32 v17, v1, v10
buffer_store_dwordx4 v[14:17], v12, s[12:15], s57 offen offset:0 sc1
v_accvgpr_read_b32 v4, a216
v_accvgpr_read_b32 v5, a217
v_accvgpr_read_b32 v1, a218
v_accvgpr_read_b32 v10, a219
v_cvt_pk_bf16_f32 v14, v4, v5
v_cvt_pk_bf16_f32 v15, v1, v10
v_accvgpr_read_b32 v4, a220
v_accvgpr_read_b32 v5, a221
v_accvgpr_read_b32 v1, a222
v_accvgpr_read_b32 v10, a223
v_cvt_pk_bf16_f32 v16, v4, v5
v_cvt_pk_bf16_f32 v17, v1, v10
buffer_store_dwordx4 v[14:17], v12, s[12:15], s57 offen offset:1024 sc1
v_accvgpr_read_b32 v4, a224
v_accvgpr_read_b32 v5, a225
v_accvgpr_read_b32 v1, a226
v_accvgpr_read_b32 v10, a227
v_cvt_pk_bf16_f32 v14, v4, v5
v_cvt_pk_bf16_f32 v15, v1, v10
v_accvgpr_read_b32 v4, a228
v_accvgpr_read_b32 v5, a229
v_accvgpr_read_b32 v1, a230
v_accvgpr_read_b32 v10, a231
v_cvt_pk_bf16_f32 v16, v4, v5
v_cvt_pk_bf16_f32 v17, v1, v10
buffer_store_dwordx4 v[14:17], v13, s[12:15], s57 offen offset:0 sc1
v_accvgpr_read_b32 v4, a232
v_accvgpr_read_b32 v5, a233
v_accvgpr_read_b32 v1, a234
v_accvgpr_read_b32 v10, a235
v_cvt_pk_bf16_f32 v14, v4, v5
v_cvt_pk_bf16_f32 v15, v1, v10
v_accvgpr_read_b32 v4, a236
v_accvgpr_read_b32 v5, a237
v_accvgpr_read_b32 v1, a238
v_accvgpr_read_b32 v10, a239
v_cvt_pk_bf16_f32 v16, v4, v5
v_cvt_pk_bf16_f32 v17, v1, v10
buffer_store_dwordx4 v[14:17], v13, s[12:15], s57 offen offset:1024 sc1
s_add_u32 s63, s50, 6144
buffer_load_dwordx4 v[232:235], v11, s[12:15], s63 offen sc1
s_add_u32 s63, s50, 26624
buffer_load_dwordx4 v[236:239], v11, s[12:15], s63 offen sc1
s_add_u32 s63, s50, 47104
buffer_load_dwordx4 v[240:243], v11, s[12:15], s63 offen sc1
s_add_u32 s63, s50, 67584
buffer_load_dwordx4 v[244:247], v11, s[12:15], s63 offen sc1
s_waitcnt vmcnt(12)
v_max3_u32 v7, v208, v209, v210
s_waitcnt vmcnt(11)
v_max3_u32 v7, v7, v211, v212
v_max3_u32 v7, v7, v213, v214
s_waitcnt vmcnt(10)
v_max3_u32 v7, v7, v215, v216
v_max3_u32 v7, v7, v217, v218
s_waitcnt vmcnt(9)
v_max3_u32 v7, v7, v219, v220
v_max3_u32 v7, v7, v221, v222
v_max_u32 v7, v7, v223
v_cmp_eq_u32 vcc, -1, v7
s_cbranch_vccnz SLOWS2
GOS2:
v_lshlrev_b32 v18, 16, v208
v_and_b32 v19, 0xffff0000, v208
v_lshlrev_b32 v20, 16, v209
v_and_b32 v21, 0xffff0000, v209
v_lshlrev_b32 v22, 16, v210
v_and_b32 v23, 0xffff0000, v210
v_lshlrev_b32 v24, 16, v211
v_and_b32 v25, 0xffff0000, v211
v_lshlrev_b32 v2, 16, v212
v_and_b32 v3, 0xffff0000, v212
v_lshlrev_b32 v28, 16, v213
v_and_b32 v29, 0xffff0000, v213
v_add_f32 v18, v18, v2
v_add_f32 v19, v19, v3
v_add_f32 v20, v20, v28
v_add_f32 v21, v21, v29
v_lshlrev_b32 v2, 16, v214
v_and_b32 v3, 0xffff0000, v214
v_lshlrev_b32 v28, 16, v215
v_and_b32 v29, 0xffff0000, v215
v_add_f32 v22, v22, v2
v_add_f32 v23, v23, v3
v_add_f32 v24, v24, v28
v_add_f32 v25, v25, v29
v_lshlrev_b32 v2, 16, v216
v_and_b32 v3, 0xffff0000, v216
v_lshlrev_b32 v28, 16, v217
v_and_b32 v29, 0xffff0000, v217
v_add_f32 v18, v18, v2
v_add_f32 v19, v19, v3
v_add_f32 v20, v20, v28
v_add_f32 v21, v21, v29
v_lshlrev_b32 v2, 16, v218
v_and_b32 v3, 0xffff0000, v218
v_lshlrev_b32 v28, 16, v219
v_and_b32 v29, 0xffff0000, v219
v_add_f32 v22, v22, v2
v_add_f32 v23, v23, v3
v_add_f32 v24, v24, v28
v_add_f32 v25, v25, v29
v_lshlrev_b32 v2, 16, v220
v_and_b32 v3, 0xffff0000, v220
v_lshlrev_b32 v28, 16, v221
v_and_b32 v29, 0xffff0000, v221
v_add_f32 v18, v18, v2
v_add_f32 v19, v19, v3
v_add_f32 v20, v20, v28
v_add_f32 v21, v21, v29
v_lshlrev_b32 v2, 16, v222
v_and_b32 v3, 0xffff0000, v222
v_lshlrev_b32 v28, 16, v223
v_and_b32 v29, 0xffff0000, v223
v_add_f32 v22, v22, v2
v_add_f32 v23, v23, v3
v_add_f32 v24, v24, v28
v_add_f32 v25, v25, v29
v_permlane32_swap_b32 v18, v22
v_permlane32_swap_b32 v19, v23
v_permlane32_swap_b32 v20, v24
v_permlane32_swap_b32 v21, v25
v_add_f32 v18, v18, v22
v_add_f32 v19, v19, v23
v_add_f32 v20, v20, v24
v_add_f32 v21, v21, v25
v_lshlrev_b32 v22, 16, v100
v_and_b32 v23, 0xffff0000, v100
v_lshlrev_b32 v24, 16, v101
v_and_b32 v25, 0xffff0000, v101
v_fma_f32 v18, v18, v114, v22
v_fma_f32 v19, v19, v115, v23
v_fma_f32 v20, v20, v116, v24
v_fma_f32 v21, v21, v117, v25
v_cvt_pk_bf16_f32 v100, v18, v19
v_cvt_pk_bf16_f32 v101, v20, v21
buffer_store_dwordx2 v[100:101], v6, s[40:43], 0 offen offset:128
s_add_u32 s63, s50, 8192
buffer_load_dwordx4 v[192:195], v11, s[12:15], s63 offen sc1
s_add_u32 s63, s50, 28672
buffer_load_dwordx4 v[196:199], v11, s[12:15], s63 offen sc1
s_add_u32 s63, s50, 49152
buffer_load_dwordx4 v[200:203], v11, s[12:15], s63 offen sc1
s_add_u32 s63, s50, 69632
buffer_load_dwordx4 v[204:207], v11, s[12:15], s63 offen sc1
s_waitcnt vmcnt(8)
v_max3_u32 v7, v232, v233, v234
s_waitcnt vmcnt(7)
v_max3_u32 v7, v7, v235, v236
v_max3_u32 v7, v7, v237, v238
s_waitcnt vmcnt(6)
v_max3_u32 v7, v7, v239, v240
v_max3_u32 v7, v7, v241, v242
s_waitcnt vmcnt(5)
v_max3_u32 v7, v7, v243, v244
v_max3_u32 v7, v7, v245, v246
v_max_u32 v7, v7, v247
v_cmp_eq_u32 vcc, -1, v7
s_cbranch_vccnz SLOWS3
GOS3:
v_lshlrev_b32 v18, 16, v232
v_and_b32 v19, 0xffff0000, v232
v_lshlrev_b32 v20, 16, v233
v_and_b32 v21, 0xffff0000, v233
v_lshlrev_b32 v22, 16, v234
v_and_b32 v23, 0xffff0000, v234
v_lshlrev_b32 v24, 16, v235
v_and_b32 v25, 0xffff0000, v235
v_lshlrev_b32 v2, 16, v236
v_and_b32 v3, 0xffff0000, v236
v_lshlrev_b32 v28, 16, v237
v_and_b32 v29, 0xffff0000, v237
v_add_f32 v18, v18, v2
v_add_f32 v19, v19, v3
v_add_f32 v20, v20, v28
v_add_f32 v21, v21, v29
v_lshlrev_b32 v2, 16, v238
v_and_b32 v3, 0xffff0000, v238
v_lshlrev_b32 v28, 16, v239
v_and_b32 v29, 0xffff0000, v239
v_add_f32 v22, v22, v2
v_add_f32 v23, v23, v3
v_add_f32 v24, v24, v28
v_add_f32 v25, v25, v29
v_lshlrev_b32 v2, 16, v240
v_and_b32 v3, 0xffff0000, v240
v_lshlrev_b32 v28, 16, v241
v_and_b32 v29, 0xffff0000, v241
v_add_f32 v18, v18, v2
v_add_f32 v19, v19, v3
v_add_f32 v20, v20, v28
v_add_f32 v21, v21, v29
v_lshlrev_b32 v2, 16, v242
v_and_b32 v3, 0xffff0000, v242
v_lshlrev_b32 v28, 16, v243
v_and_b32 v29, 0xffff0000, v243
v_add_f32 v22, v22, v2
v_add_f32 v23, v23, v3
v_add_f32 v24, v24, v28
v_add_f32 v25, v25, v29
v_lshlrev_b32 v2, 16, v244
v_and_b32 v3, 0xffff0000, v244
v_lshlrev_b32 v28, 16, v245
v_and_b32 v29, 0xffff0000, v245
v_add_f32 v18, v18, v2
v_add_f32 v19, v19, v3
v_add_f32 v20, v20, v28
v_add_f32 v21, v21, v29
v_lshlrev_b32 v2, 16, v246
v_and_b32 v3, 0xffff0000, v246
v_lshlrev_b32 v28, 16, v247
v_and_b32 v29, 0xffff0000, v247
v_add_f32 v22, v22, v2
v_add_f32 v23, v23, v3
v_add_f32 v24, v24, v28
v_add_f32 v25, v25, v29
v_permlane32_swap_b32 v18, v22
v_permlane32_swap_b32 v19, v23
v_permlane32_swap_b32 v20, v24
v_permlane32_swap_b32 v21, v25
v_add_f32 v18, v18, v22
v_add_f32 v19, v19, v23
v_add_f32 v20, v20, v24
v_add_f32 v21, v21, v25
v_lshlrev_b32 v22, 16, v102
v_and_b32 v23, 0xffff0000, v102
v_lshlrev_b32 v24, 16, v103
v_and_b32 v25, 0xffff0000, v103
v_fma_f32 v18, v18, v118, v22
v_fma_f32 v19, v19, v119, v23
v_fma_f32 v20, v20, v120, v24
v_fma_f32 v21, v21, v121, v25
v_cvt_pk_bf16_f32 v102, v18, v19
v_cvt_pk_bf16_f32 v103, v20, v21
buffer_store_dwordx2 v[102:103], v6, s[40:43], 0 offen offset:192
s_waitcnt vmcnt(4)
v_max3_u32 v7, v192, v193, v194
s_waitcnt vmcnt(3)
v_max3_u32 v7, v7, v195, v196
v_max3_u32 v7, v7, v197, v198
s_waitcnt vmcnt(2)
v_max3_u32 v7, v7, v199, v200
v_max3_u32 v7, v7, v201, v202
s_waitcnt vmcnt(1)
v_max3_u32 v7, v7, v203, v204
v_max3_u32 v7, v7, v205, v206
v_max_u32 v7, v7, v207
v_cmp_eq_u32 vcc, -1, v7
s_cbranch_vccnz SLOWS4
GOS4:
v_lshlrev_b32 v18, 16, v192
v_and_b32 v19, 0xffff0000, v192
v_lshlrev_b32 v20, 16, v193
v_and_b32 v21, 0xffff0000, v193
v_lshlrev_b32 v22, 16, v194
v_and_b32 v23, 0xffff0000, v194
v_lshlrev_b32 v24, 16, v195
v_and_b32 v25, 0xffff0000, v195
v_lshlrev_b32 v2, 16, v196
v_and_b32 v3, 0xffff0000, v196
v_lshlrev_b32 v28, 16, v197
v_and_b32 v29, 0xffff0000, v197
v_add_f32 v18, v18, v2
v_add_f32 v19, v19, v3
v_add_f32 v20, v20, v28
v_add_f32 v21, v21, v29
v_lshlrev_b32 v2, 16, v198
v_and_b32 v3, 0xffff0000, v198
v_lshlrev_b32 v28, 16, v199
v_and_b32 v29, 0xffff0000, v199
v_add_f32 v22, v22, v2
v_add_f32 v23, v23, v3
v_add_f32 v24, v24, v28
v_add_f32 v25, v25, v29
v_lshlrev_b32 v2, 16, v200
v_and_b32 v3, 0xffff0000, v200
v_lshlrev_b32 v28, 16, v201
v_and_b32 v29, 0xffff0000, v201
v_add_f32 v18, v18, v2
v_add_f32 v19, v19, v3
v_add_f32 v20, v20, v28
v_add_f32 v21, v21, v29
v_lshlrev_b32 v2, 16, v202
v_and_b32 v3, 0xffff0000, v202
v_lshlrev_b32 v28, 16, v203
v_and_b32 v29, 0xffff0000, v203
v_add_f32 v22, v22, v2
v_add_f32 v23, v23, v3
v_add_f32 v24, v24, v28
v_add_f32 v25, v25, v29
v_lshlrev_b32 v2, 16, v204
v_and_b32 v3, 0xffff0000, v204
v_lshlrev_b32 v28, 16, v205
v_and_b32 v29, 0xffff0000, v205
v_add_f32 v18, v18, v2
v_add_f32 v19, v19, v3
v_add_f32 v20, v20, v28
v_add_f32 v21, v21, v29
v_lshlrev_b32 v2, 16, v206
v_and_b32 v3, 0xffff0000, v206
v_lshlrev_b32 v28, 16, v207
v_and_b32 v29, 0xffff0000, v207
v_add_f32 v22, v22, v2
v_add_f32 v23, v23, v3
v_add_f32 v24, v24, v28
v_add_f32 v25, v25, v29
v_permlane32_swap_b32 v18, v22
v_permlane32_swap_b32 v19, v23
v_permlane32_swap_b32 v20, v24
v_permlane32_swap_b32 v21, v25
v_add_f32 v18, v18, v22
v_add_f32 v19, v19, v23
v_add_f32 v20, v20, v24
v_add_f32 v21, v21, v25
v_lshlrev_b32 v22, 16, v104
v_and_b32 v23, 0xffff0000, v104
v_lshlrev_b32 v24, 16, v105
v_and_b32 v25, 0xffff0000, v105
v_fma_f32 v18, v18, v122, v22
v_fma_f32 v19, v19, v123, v23
v_fma_f32 v20, v20, v124, v24
v_fma_f32 v21, v21, v125, v25
v_cvt_pk_bf16_f32 v104, v18, v19
v_cvt_pk_bf16_f32 v105, v20, v21
buffer_store_dwordx2 v[104:105], v6, s[40:43], 0 offen offset:256
s_waitcnt vmcnt(0)
K1END:
s_endpgm
SLOWG:
s_mov_b32 s55, 0
SLPG:
buffer_load_dwordx4 v[132:135], v136, s[32:35], 0 offen sc1
s_waitcnt vmcnt(0)
v_and_b32 v132, v132, v133
v_and_b32 v134, v134, v135
v_and_b32 v132, v132, v134
v_cmp_ne_u32 vcc, 1, v132
s_add_u32 s55, s55, 1
s_cmp_ge_u32 s55, 0x40000
s_cbranch_scc1 GOG
s_cbranch_vccnz SLPG
s_branch GOG
SLOWH1:
s_mov_b32 s55, 0
SLPH1:
buffer_load_dword v25, v24, s[12:15], s95 offen sc1
s_waitcnt vmcnt(0)
v_cmp_gt_u32 vcc, s93, v25
s_add_u32 s55, s55, 1
s_cmp_ge_u32 s55, 0x40000
s_cbranch_scc1 GOH1
s_cbranch_vccnz SLPH1
s_branch GOH1
STUB1:
s_mov_b32 s55, 1
s_branch RARE1
STUB2:
s_mov_b32 s55, 2
s_branch RARE0
STUB3:
s_mov_b32 s55, 3
s_branch RARE1
STUB4:
s_mov_b32 s55, 4
s_branch RARE0
STUB5:
s_mov_b32 s55, 5
s_branch RARE1
STUB6:
s_mov_b32 s55, 6
s_branch RARE0
STUB7:
s_mov_b32 s55, 7
s_branch RARE1
STUB8:
s_mov_b32 s55, 8
s_branch RARE0
STUB9:
s_mov_b32 s55, 9
s_branch RARE1
STUB10:
s_mov_b32 s55, 10
s_branch RARE0
STUB11:
s_mov_b32 s55, 11
s_branch RARE1
STUB12:
s_mov_b32 s55, 12
s_branch RARE0
STUB13:
s_mov_b32 s55, 13
s_branch RARE1
STUB14:
s_mov_b32 s55, 14
s_branch RARE0
STUB15:
s_mov_b32 s55, 15
s_branch RARE1
SLOWH2:
s_mov_b32 s55, 0
SLPH2:
s_and_b32 s63, s2, 0xe0
v_and_b32 v24, 31, v0
v_add_u32 v24, s63, v24
v_lshlrev_b32 v24, 7, v24
buffer_load_dword v25, v24, s[12:15], s95 offen sc1
s_waitcnt vmcnt(0)
v_cmp_gt_u32 vcc, 2, v25
s_add_u32 s55, s55, 1
s_cmp_ge_u32 s55, 0x40000
s_cbranch_scc1 GOH2
s_cbranch_vccnz SLPH2
s_branch GOH2
SLOWO3:
s_mov_b32 s55, 0
SLPO3:
s_and_b32 s63, s2, 0xe7
v_and_b32 v24, 3, v0
v_lshlrev_b32 v24, 3, v24
v_add_u32 v24, s63, v24
v_lshlrev_b32 v24, 7, v24
buffer_load_dword v25, v24, s[12:15], s95 offen sc1
s_waitcnt vmcnt(0)
v_cmp_gt_u32 vcc, 3, v25
s_add_u32 s55, s55, 1
s_cmp_ge_u32 s55, 0x40000
s_cbranch_scc1 GOO3
s_cbranch_vccnz SLPO3
s_branch GOO3
SLOWO4:
s_mov_b32 s55, 0
SLPO4:
s_and_b32 s63, s2, 0xe7
v_and_b32 v24, 3, v0
v_lshlrev_b32 v24, 3, v24
v_add_u32 v24, s63, v24
v_lshlrev_b32 v24, 7, v24
buffer_load_dword v25, v24, s[12:15], s95 offen sc1
s_waitcnt vmcnt(0)
v_cmp_gt_u32 vcc, 4, v25
s_add_u32 s55, s55, 1
s_cmp_ge_u32 s55, 0x40000
s_cbranch_scc1 GOO4
s_cbranch_vccnz SLPO4
s_branch GOO4
SLOWO5:
s_mov_b32 s55, 0
SLPO5:
s_and_b32 s63, s2, 0xe7
v_and_b32 v24, 3, v0
v_lshlrev_b32 v24, 3, v24
v_add_u32 v24, s63, v24
v_lshlrev_b32 v24, 7, v24
buffer_load_dword v25, v24, s[12:15], s95 offen sc1
s_waitcnt vmcnt(0)
v_cmp_gt_u32 vcc, 5, v25
s_add_u32 s55, s55, 1
s_cmp_ge_u32 s55, 0x40000
s_cbranch_scc1 GOO5
s_cbranch_vccnz SLPO5
s_branch GOO5
SLOWF6:
s_mov_b32 s55, 0
SLPF6:
s_and_b32 s63, s2, 0xf8
s_lshr_b32 s93, s4, 2
s_add_u32 s63, s63, s93
s_lshl_b32 s63, s63, 5
s_and_b32 s93, s4, 3
s_add_u32 s63, s63, s93
s_lshl_b32 s63, s63, 2
s_add_u32 s63, s63, 67108864
v_and_b32 v24, 3, v0
v_lshl_add_u32 v24, v24, 8, s63
buffer_load_dword v25, v24, s[12:15], 0 offen sc1
s_waitcnt vmcnt(0)
v_cmp_gt_u32 vcc, 6, v25
s_add_u32 s55, s55, 1
s_cmp_ge_u32 s55, 0x40000
s_cbranch_scc1 GOF6
s_cbranch_vccnz SLPF6
s_branch GOF6
SLOWS0:
s_mov_b32 s55, 0
SLPS0:
s_add_u32 s63, s50, 0
buffer_load_dwordx4 v[232:235], v11, s[12:15], s63 offen sc1
s_add_u32 s63, s50, 20480
buffer_load_dwordx4 v[236:239], v11, s[12:15], s63 offen sc1
s_add_u32 s63, s50, 40960
buffer_load_dwordx4 v[240:243], v11, s[12:15], s63 offen sc1
s_add_u32 s63, s50, 61440
buffer_load_dwordx4 v[244:247], v11, s[12:15], s63 offen sc1
s_waitcnt vmcnt(0)
v_max3_u32 v7, v232, v233, v234
v_max3_u32 v7, v7, v235, v236
v_max3_u32 v7, v7, v237, v238
v_max3_u32 v7, v7, v239, v240
v_max3_u32 v7, v7, v241, v242
v_max3_u32 v7, v7, v243, v244
v_max3_u32 v7, v7, v245, v246
v_max_u32 v7, v7, v247
v_cmp_eq_u32 vcc, -1, v7
s_add_u32 s55, s55, 1
s_cmp_ge_u32 s55, 0x40000
s_cbranch_scc1 GOS0
s_cbranch_vccnz SLPS0
s_branch GOS0
SLOWS1:
s_mov_b32 s55, 0
SLPS1:
s_add_u32 s63, s50, 2048
buffer_load_dwordx4 v[192:195], v11, s[12:15], s63 offen sc1
s_add_u32 s63, s50, 22528
buffer_load_dwordx4 v[196:199], v11, s[12:15], s63 offen sc1
s_add_u32 s63, s50, 43008
buffer_load_dwordx4 v[200:203], v11, s[12:15], s63 offen sc1
s_add_u32 s63, s50, 63488
buffer_load_dwordx4 v[204:207], v11, s[12:15], s63 offen sc1
s_waitcnt vmcnt(0)
v_max3_u32 v7, v192, v193, v194
v_max3_u32 v7, v7, v195, v196
v_max3_u32 v7, v7, v197, v198
v_max3_u32 v7, v7, v199, v200
v_max3_u32 v7, v7, v201, v202
v_max3_u32 v7, v7, v203, v204
v_max3_u32 v7, v7, v205, v206
v_max_u32 v7, v7, v207
v_cmp_eq_u32 vcc, -1, v7
s_add_u32 s55, s55, 1
s_cmp_ge_u32 s55, 0x40000
s_cbranch_scc1 GOS1
s_cbranch_vccnz SLPS1
s_branch GOS1
SLOWS2:
s_mov_b32 s55, 0
SLPS2:
s_add_u32 s63, s50, 4096
buffer_load_dwordx4 v[208:211], v11, s[12:15], s63 offen sc1
s_add_u32 s63, s50, 24576
buffer_load_dwordx4 v[212:215], v11, s[12:15], s63 offen sc1
s_add_u32 s63, s50, 45056
buffer_load_dwordx4 v[216:219], v11, s[12:15], s63 offen sc1
s_add_u32 s63, s50, 65536
buffer_load_dwordx4 v[220:223], v11, s[12:15], s63 offen sc1
s_waitcnt vmcnt(0)
v_max3_u32 v7, v208, v209, v210
v_max3_u32 v7, v7, v211, v212
v_max3_u32 v7, v7, v213, v214
v_max3_u32 v7, v7, v215, v216
v_max3_u32 v7, v7, v217, v218
v_max3_u32 v7, v7, v219, v220
v_max3_u32 v7, v7, v221, v222
v_max_u32 v7, v7, v223
v_cmp_eq_u32 vcc, -1, v7
s_add_u32 s55, s55, 1
s_cmp_ge_u32 s55, 0x40000
s_cbranch_scc1 GOS2
s_cbranch_vccnz SLPS2
s_branch GOS2
SLOWS3:
s_mov_b32 s55, 0
SLPS3:
s_add_u32 s63, s50, 6144
buffer_load_dwordx4 v[232:235], v11, s[12:15], s63 offen sc1
s_add_u32 s63, s50, 26624
buffer_load_dwordx4 v[236:239], v11, s[12:15], s63 offen sc1
s_add_u32 s63, s50, 47104
buffer_load_dwordx4 v[240:243], v11, s[12:15], s63 offen sc1
s_add_u32 s63, s50, 67584
buffer_load_dwordx4 v[244:247], v11, s[12:15], s63 offen sc1
s_waitcnt vmcnt(0)
v_max3_u32 v7, v232, v233, v234
v_max3_u32 v7, v7, v235, v236
v_max3_u32 v7, v7, v237, v238
v_max3_u32 v7, v7, v239, v240
v_max3_u32 v7, v7, v241, v242
v_max3_u32 v7, v7, v243, v244
v_max3_u32 v7, v7, v245, v246
v_max_u32 v7, v7, v247
v_cmp_eq_u32 vcc, -1, v7
s_add_u32 s55, s55, 1
s_cmp_ge_u32 s55, 0x40000
s_cbranch_scc1 GOS3
s_cbranch_vccnz SLPS3
s_branch GOS3
SLOWS4:
s_mov_b32 s55, 0
SLPS4:
s_add_u32 s63, s50, 8192
buffer_load_dwordx4 v[192:195], v11, s[12:15], s63 offen sc1
s_add_u32 s63, s50, 28672
buffer_load_dwordx4 v[196:199], v11, s[12:15], s63 offen sc1
s_add_u32 s63, s50, 49152
buffer_load_dwordx4 v[200:203], v11, s[12:15], s63 offen sc1
s_add_u32 s63, s50, 69632
buffer_load_dwordx4 v[204:207], v11, s[12:15], s63 offen sc1
s_waitcnt vmcnt(0)
v_max3_u32 v7, v192, v193, v194
v_max3_u32 v7, v7, v195, v196
v_max3_u32 v7, v7, v197, v198
v_max3_u32 v7, v7, v199, v200
v_max3_u32 v7, v7, v201, v202
v_max3_u32 v7, v7, v203, v204
v_max3_u32 v7, v7, v205, v206
v_max_u32 v7, v7, v207
v_cmp_eq_u32 vcc, -1, v7
s_add_u32 s55, s55, 1
s_cmp_ge_u32 s55, 0x40000
s_cbranch_scc1 GOS4
s_cbranch_vccnz SLPS4
s_branch GOS4
RARE0:
s_nop 15
v_max3_f32 v22, v160, v161, v162
v_max3_f32 v22, v22, v163, v164
v_max3_f32 v22, v22, v165, v166
v_max3_f32 v22, v22, v167, v168
v_max3_f32 v22, v22, v169, v170
v_max3_f32 v22, v22, v171, v172
v_max3_f32 v22, v22, v173, v174
v_max_f32 v22, v22, v175
v_mov_b32 v23, v22
s_nop 1
v_permlane32_swap_b32 v22, v23
v_max_f32 v22, v22, v23
v_max_f32 v22, 0, v22
v_ceil_f32 v22, v22
v_sub_f32 v23, 0, v22
v_exp_f32 v24, v23
v_sub_f32 v160, v160, v22
v_sub_f32 v161, v161, v22
v_sub_f32 v162, v162, v22
v_sub_f32 v163, v163, v22
v_sub_f32 v164, v164, v22
v_sub_f32 v165, v165, v22
v_sub_f32 v166, v166, v22
v_sub_f32 v167, v167, v22
v_sub_f32 v168, v168, v22
v_sub_f32 v169, v169, v22
v_sub_f32 v170, v170, v22
v_sub_f32 v171, v171, v22
v_sub_f32 v172, v172, v22
v_sub_f32 v173, v173, v22
v_sub_f32 v174, v174, v22
v_sub_f32 v175, v175, v22
v_sub_f32 v192, v192, v22
v_sub_f32 v193, v193, v22
v_sub_f32 v194, v194, v22
v_sub_f32 v195, v195, v22
v_sub_f32 v196, v196, v22
v_sub_f32 v197, v197, v22
v_sub_f32 v198, v198, v22
v_sub_f32 v199, v199, v22
v_sub_f32 v200, v200, v22
v_sub_f32 v201, v201, v22
v_sub_f32 v202, v202, v22
v_sub_f32 v203, v203, v22
v_sub_f32 v204, v204, v22
v_sub_f32 v205, v205, v22
v_sub_f32 v206, v206, v22
v_sub_f32 v207, v207, v22
v_sub_f32 v32, v32, v22
v_sub_f32 v33, v33, v22
v_sub_f32 v34, v34, v22
v_sub_f32 v35, v35, v22
v_sub_f32 v36, v36, v22
v_sub_f32 v37, v37, v22
v_sub_f32 v38, v38, v22
v_sub_f32 v39, v39, v22
v_sub_f32 v40, v40, v22
v_sub_f32 v41, v41, v22
v_sub_f32 v42, v42, v22
v_sub_f32 v43, v43, v22
v_sub_f32 v44, v44, v22
v_sub_f32 v45, v45, v22
v_sub_f32 v46, v46, v22
v_sub_f32 v47, v47, v22
v_mul_f32 v14, v14, v24
v_accvgpr_read_b32 v18, a0
v_and_b32 v19, 0xffff0000, v18
v_lshlrev_b32 v18, 16, v18
v_mul_f32 v18, v18, v24
v_mul_f32 v19, v19, v24
v_cvt_pk_bf16_f32 v18, v18, v19
v_accvgpr_write_b32 a0, v18
v_accvgpr_read_b32 v18, a1
v_and_b32 v19, 0xffff0000, v18
v_lshlrev_b32 v18, 16, v18
v_mul_f32 v18, v18, v24
v_mul_f32 v19, v19, v24
v_cvt_pk_bf16_f32 v18, v18, v19
v_accvgpr_write_b32 a1, v18
v_accvgpr_read_b32 v18, a2
v_and_b32 v19, 0xffff0000, v18
v_lshlrev_b32 v18, 16, v18
v_mul_f32 v18, v18, v24
v_mul_f32 v19, v19, v24
v_cvt_pk_bf16_f32 v18, v18, v19
v_accvgpr_write_b32 a2, v18
v_accvgpr_read_b32 v18, a3
v_and_b32 v19, 0xffff0000, v18
v_lshlrev_b32 v18, 16, v18
v_mul_f32 v18, v18, v24
v_mul_f32 v19, v19, v24
v_cvt_pk_bf16_f32 v18, v18, v19
v_accvgpr_write_b32 a3, v18
v_accvgpr_read_b32 v18, a4
v_and_b32 v19, 0xffff0000, v18
v_lshlrev_b32 v18, 16, v18
v_mul_f32 v18, v18, v24
v_mul_f32 v19, v19, v24
v_cvt_pk_bf16_f32 v18, v18, v19
v_accvgpr_write_b32 a4, v18
v_accvgpr_read_b32 v18, a5
v_and_b32 v19, 0xffff0000, v18
v_lshlrev_b32 v18, 16, v18
v_mul_f32 v18, v18, v24
v_mul_f32 v19, v19, v24
v_cvt_pk_bf16_f32 v18, v18, v19
v_accvgpr_write_b32 a5, v18
v_accvgpr_read_b32 v18, a6
v_and_b32 v19, 0xffff0000, v18
v_lshlrev_b32 v18, 16, v18
v_mul_f32 v18, v18, v24
v_mul_f32 v19, v19, v24
v_cvt_pk_bf16_f32 v18, v18, v19
v_accvgpr_write_b32 a6, v18
v_accvgpr_read_b32 v18, a7
v_and_b32 v19, 0xffff0000, v18
v_lshlrev_b32 v18, 16, v18
v_mul_f32 v18, v18, v24
v_mul_f32 v19, v19, v24
v_cvt_pk_bf16_f32 v18, v18, v19
v_accvgpr_write_b32 a7, v18
v_accvgpr_read_b32 v18, a16
v_and_b32 v19, 0xffff0000, v18
v_lshlrev_b32 v18, 16, v18
v_mul_f32 v18, v18, v24
v_mul_f32 v19, v19, v24
v_cvt_pk_bf16_f32 v18, v18, v19
v_accvgpr_write_b32 a16, v18
v_accvgpr_read_b32 v18, a17
v_and_b32 v19, 0xffff0000, v18
v_lshlrev_b32 v18, 16, v18
v_mul_f32 v18, v18, v24
v_mul_f32 v19, v19, v24
v_cvt_pk_bf16_f32 v18, v18, v19
v_accvgpr_write_b32 a17, v18
v_accvgpr_read_b32 v18, a18
v_and_b32 v19, 0xffff0000, v18
v_lshlrev_b32 v18, 16, v18
v_mul_f32 v18, v18, v24
v_mul_f32 v19, v19, v24
v_cvt_pk_bf16_f32 v18, v18, v19
v_accvgpr_write_b32 a18, v18
v_accvgpr_read_b32 v18, a19
v_and_b32 v19, 0xffff0000, v18
v_lshlrev_b32 v18, 16, v18
v_mul_f32 v18, v18, v24
v_mul_f32 v19, v19, v24
v_cvt_pk_bf16_f32 v18, v18, v19
v_accvgpr_write_b32 a19, v18
v_accvgpr_read_b32 v18, a20
v_and_b32 v19, 0xffff0000, v18
v_lshlrev_b32 v18, 16, v18
v_mul_f32 v18, v18, v24
v_mul_f32 v19, v19, v24
v_cvt_pk_bf16_f32 v18, v18, v19
v_accvgpr_write_b32 a20, v18
v_accvgpr_read_b32 v18, a21
v_and_b32 v19, 0xffff0000, v18
v_lshlrev_b32 v18, 16, v18
v_mul_f32 v18, v18, v24
v_mul_f32 v19, v19, v24
v_cvt_pk_bf16_f32 v18, v18, v19
v_accvgpr_write_b32 a21, v18
v_accvgpr_read_b32 v18, a22
v_and_b32 v19, 0xffff0000, v18
v_lshlrev_b32 v18, 16, v18
v_mul_f32 v18, v18, v24
v_mul_f32 v19, v19, v24
v_cvt_pk_bf16_f32 v18, v18, v19
v_accvgpr_write_b32 a22, v18
v_accvgpr_read_b32 v18, a23
v_and_b32 v19, 0xffff0000, v18
v_lshlrev_b32 v18, 16, v18
v_mul_f32 v18, v18, v24
v_mul_f32 v19, v19, v24
v_cvt_pk_bf16_f32 v18, v18, v19
v_accvgpr_write_b32 a23, v18
v_accvgpr_read_b32 v18, a32
v_and_b32 v19, 0xffff0000, v18
v_lshlrev_b32 v18, 16, v18
v_mul_f32 v18, v18, v24
v_mul_f32 v19, v19, v24
v_cvt_pk_bf16_f32 v18, v18, v19
v_accvgpr_write_b32 a32, v18
v_accvgpr_read_b32 v18, a33
v_and_b32 v19, 0xffff0000, v18
v_lshlrev_b32 v18, 16, v18
v_mul_f32 v18, v18, v24
v_mul_f32 v19, v19, v24
v_cvt_pk_bf16_f32 v18, v18, v19
v_accvgpr_write_b32 a33, v18
v_accvgpr_read_b32 v18, a34
v_and_b32 v19, 0xffff0000, v18
v_lshlrev_b32 v18, 16, v18
v_mul_f32 v18, v18, v24
v_mul_f32 v19, v19, v24
v_cvt_pk_bf16_f32 v18, v18, v19
v_accvgpr_write_b32 a34, v18
v_accvgpr_read_b32 v18, a35
v_and_b32 v19, 0xffff0000, v18
v_lshlrev_b32 v18, 16, v18
v_mul_f32 v18, v18, v24
v_mul_f32 v19, v19, v24
v_cvt_pk_bf16_f32 v18, v18, v19
v_accvgpr_write_b32 a35, v18
v_accvgpr_read_b32 v18, a36
v_and_b32 v19, 0xffff0000, v18
v_lshlrev_b32 v18, 16, v18
v_mul_f32 v18, v18, v24
v_mul_f32 v19, v19, v24
v_cvt_pk_bf16_f32 v18, v18, v19
v_accvgpr_write_b32 a36, v18
v_accvgpr_read_b32 v18, a37
v_and_b32 v19, 0xffff0000, v18
v_lshlrev_b32 v18, 16, v18
v_mul_f32 v18, v18, v24
v_mul_f32 v19, v19, v24
v_cvt_pk_bf16_f32 v18, v18, v19
v_accvgpr_write_b32 a37, v18
v_accvgpr_read_b32 v18, a38
v_and_b32 v19, 0xffff0000, v18
v_lshlrev_b32 v18, 16, v18
v_mul_f32 v18, v18, v24
v_mul_f32 v19, v19, v24
v_cvt_pk_bf16_f32 v18, v18, v19
v_accvgpr_write_b32 a38, v18
v_accvgpr_read_b32 v18, a39
v_and_b32 v19, 0xffff0000, v18
v_lshlrev_b32 v18, 16, v18
v_mul_f32 v18, v18, v24
v_mul_f32 v19, v19, v24
v_cvt_pk_bf16_f32 v18, v18, v19
v_accvgpr_write_b32 a39, v18
v_accvgpr_read_b32 v18, a48
v_and_b32 v19, 0xffff0000, v18
v_lshlrev_b32 v18, 16, v18
v_mul_f32 v18, v18, v24
v_mul_f32 v19, v19, v24
v_cvt_pk_bf16_f32 v18, v18, v19
v_accvgpr_write_b32 a48, v18
v_accvgpr_read_b32 v18, a49
v_and_b32 v19, 0xffff0000, v18
v_lshlrev_b32 v18, 16, v18
v_mul_f32 v18, v18, v24
v_mul_f32 v19, v19, v24
v_cvt_pk_bf16_f32 v18, v18, v19
v_accvgpr_write_b32 a49, v18
v_accvgpr_read_b32 v18, a50
v_and_b32 v19, 0xffff0000, v18
v_lshlrev_b32 v18, 16, v18
v_mul_f32 v18, v18, v24
v_mul_f32 v19, v19, v24
v_cvt_pk_bf16_f32 v18, v18, v19
v_accvgpr_write_b32 a50, v18
v_accvgpr_read_b32 v18, a51
v_and_b32 v19, 0xffff0000, v18
v_lshlrev_b32 v18, 16, v18
v_mul_f32 v18, v18, v24
v_mul_f32 v19, v19, v24
v_cvt_pk_bf16_f32 v18, v18, v19
v_accvgpr_write_b32 a51, v18
v_accvgpr_read_b32 v18, a52
v_and_b32 v19, 0xffff0000, v18
v_lshlrev_b32 v18, 16, v18
v_mul_f32 v18, v18, v24
v_mul_f32 v19, v19, v24
v_cvt_pk_bf16_f32 v18, v18, v19
v_accvgpr_write_b32 a52, v18
v_accvgpr_read_b32 v18, a53
v_and_b32 v19, 0xffff0000, v18
v_lshlrev_b32 v18, 16, v18
v_mul_f32 v18, v18, v24
v_mul_f32 v19, v19, v24
v_cvt_pk_bf16_f32 v18, v18, v19
v_accvgpr_write_b32 a53, v18
v_accvgpr_read_b32 v18, a54
v_and_b32 v19, 0xffff0000, v18
v_lshlrev_b32 v18, 16, v18
v_mul_f32 v18, v18, v24
v_mul_f32 v19, v19, v24
v_cvt_pk_bf16_f32 v18, v18, v19
v_accvgpr_write_b32 a54, v18
v_accvgpr_read_b32 v18, a55
v_and_b32 v19, 0xffff0000, v18
v_lshlrev_b32 v18, 16, v18
v_mul_f32 v18, v18, v24
v_mul_f32 v19, v19, v24
v_cvt_pk_bf16_f32 v18, v18, v19
v_accvgpr_write_b32 a55, v18
v_accvgpr_read_b32 v18, a64
v_and_b32 v19, 0xffff0000, v18
v_lshlrev_b32 v18, 16, v18
v_mul_f32 v18, v18, v24
v_mul_f32 v19, v19, v24
v_cvt_pk_bf16_f32 v18, v18, v19
v_accvgpr_write_b32 a64, v18
v_accvgpr_read_b32 v18, a65
v_and_b32 v19, 0xffff0000, v18
v_lshlrev_b32 v18, 16, v18
v_mul_f32 v18, v18, v24
v_mul_f32 v19, v19, v24
v_cvt_pk_bf16_f32 v18, v18, v19
v_accvgpr_write_b32 a65, v18
v_accvgpr_read_b32 v18, a66
v_and_b32 v19, 0xffff0000, v18
v_lshlrev_b32 v18, 16, v18
v_mul_f32 v18, v18, v24
v_mul_f32 v19, v19, v24
v_cvt_pk_bf16_f32 v18, v18, v19
v_accvgpr_write_b32 a66, v18
v_accvgpr_read_b32 v18, a67
v_and_b32 v19, 0xffff0000, v18
v_lshlrev_b32 v18, 16, v18
v_mul_f32 v18, v18, v24
v_mul_f32 v19, v19, v24
v_cvt_pk_bf16_f32 v18, v18, v19
v_accvgpr_write_b32 a67, v18
v_accvgpr_read_b32 v18, a68
v_and_b32 v19, 0xffff0000, v18
v_lshlrev_b32 v18, 16, v18
v_mul_f32 v18, v18, v24
v_mul_f32 v19, v19, v24
v_cvt_pk_bf16_f32 v18, v18, v19
v_accvgpr_write_b32 a68, v18
v_accvgpr_read_b32 v18, a69
v_and_b32 v19, 0xffff0000, v18
v_lshlrev_b32 v18, 16, v18
v_mul_f32 v18, v18, v24
v_mul_f32 v19, v19, v24
v_cvt_pk_bf16_f32 v18, v18, v19
v_accvgpr_write_b32 a69, v18
v_accvgpr_read_b32 v18, a70
v_and_b32 v19, 0xffff0000, v18
v_lshlrev_b32 v18, 16, v18
v_mul_f32 v18, v18, v24
v_mul_f32 v19, v19, v24
v_cvt_pk_bf16_f32 v18, v18, v19
v_accvgpr_write_b32 a70, v18
v_accvgpr_read_b32 v18, a71
v_and_b32 v19, 0xffff0000, v18
v_lshlrev_b32 v18, 16, v18
v_mul_f32 v18, v18, v24
v_mul_f32 v19, v19, v24
v_cvt_pk_bf16_f32 v18, v18, v19
v_accvgpr_write_b32 a71, v18
v_accvgpr_read_b32 v18, a80
v_and_b32 v19, 0xffff0000, v18
v_lshlrev_b32 v18, 16, v18
v_mul_f32 v18, v18, v24
v_mul_f32 v19, v19, v24
v_cvt_pk_bf16_f32 v18, v18, v19
v_accvgpr_write_b32 a80, v18
v_accvgpr_read_b32 v18, a81
v_and_b32 v19, 0xffff0000, v18
v_lshlrev_b32 v18, 16, v18
v_mul_f32 v18, v18, v24
v_mul_f32 v19, v19, v24
v_cvt_pk_bf16_f32 v18, v18, v19
v_accvgpr_write_b32 a81, v18
v_accvgpr_read_b32 v18, a82
v_and_b32 v19, 0xffff0000, v18
v_lshlrev_b32 v18, 16, v18
v_mul_f32 v18, v18, v24
v_mul_f32 v19, v19, v24
v_cvt_pk_bf16_f32 v18, v18, v19
v_accvgpr_write_b32 a82, v18
v_accvgpr_read_b32 v18, a83
v_and_b32 v19, 0xffff0000, v18
v_lshlrev_b32 v18, 16, v18
v_mul_f32 v18, v18, v24
v_mul_f32 v19, v19, v24
v_cvt_pk_bf16_f32 v18, v18, v19
v_accvgpr_write_b32 a83, v18
v_accvgpr_read_b32 v18, a84
v_and_b32 v19, 0xffff0000, v18
v_lshlrev_b32 v18, 16, v18
v_mul_f32 v18, v18, v24
v_mul_f32 v19, v19, v24
v_cvt_pk_bf16_f32 v18, v18, v19
v_accvgpr_write_b32 a84, v18
v_accvgpr_read_b32 v18, a85
v_and_b32 v19, 0xffff0000, v18
v_lshlrev_b32 v18, 16, v18
v_mul_f32 v18, v18, v24
v_mul_f32 v19, v19, v24
v_cvt_pk_bf16_f32 v18, v18, v19
v_accvgpr_write_b32 a85, v18
v_accvgpr_read_b32 v18, a86
v_and_b32 v19, 0xffff0000, v18
v_lshlrev_b32 v18, 16, v18
v_mul_f32 v18, v18, v24
v_mul_f32 v19, v19, v24
v_cvt_pk_bf16_f32 v18, v18, v19
v_accvgpr_write_b32 a86, v18
v_accvgpr_read_b32 v18, a87
v_and_b32 v19, 0xffff0000, v18
v_lshlrev_b32 v18, 16, v18
v_mul_f32 v18, v18, v24
v_mul_f32 v19, v19, v24
v_cvt_pk_bf16_f32 v18, v18, v19
v_accvgpr_write_b32 a87, v18
v_accvgpr_read_b32 v18, a96
v_and_b32 v19, 0xffff0000, v18
v_lshlrev_b32 v18, 16, v18
v_mul_f32 v18, v18, v24
v_mul_f32 v19, v19, v24
v_cvt_pk_bf16_f32 v18, v18, v19
v_accvgpr_write_b32 a96, v18
v_accvgpr_read_b32 v18, a97
v_and_b32 v19, 0xffff0000, v18
v_lshlrev_b32 v18, 16, v18
v_mul_f32 v18, v18, v24
v_mul_f32 v19, v19, v24
v_cvt_pk_bf16_f32 v18, v18, v19
v_accvgpr_write_b32 a97, v18
v_accvgpr_read_b32 v18, a98
v_and_b32 v19, 0xffff0000, v18
v_lshlrev_b32 v18, 16, v18
v_mul_f32 v18, v18, v24
v_mul_f32 v19, v19, v24
v_cvt_pk_bf16_f32 v18, v18, v19
v_accvgpr_write_b32 a98, v18
v_accvgpr_read_b32 v18, a99
v_and_b32 v19, 0xffff0000, v18
v_lshlrev_b32 v18, 16, v18
v_mul_f32 v18, v18, v24
v_mul_f32 v19, v19, v24
v_cvt_pk_bf16_f32 v18, v18, v19
v_accvgpr_write_b32 a99, v18
v_accvgpr_read_b32 v18, a100
v_and_b32 v19, 0xffff0000, v18
v_lshlrev_b32 v18, 16, v18
v_mul_f32 v18, v18, v24
v_mul_f32 v19, v19, v24
v_cvt_pk_bf16_f32 v18, v18, v19
v_accvgpr_write_b32 a100, v18
v_accvgpr_read_b32 v18, a101
v_and_b32 v19, 0xffff0000, v18
v_lshlrev_b32 v18, 16, v18
v_mul_f32 v18, v18, v24
v_mul_f32 v19, v19, v24
v_cvt_pk_bf16_f32 v18, v18, v19
v_accvgpr_write_b32 a101, v18
v_accvgpr_read_b32 v18, a102
v_and_b32 v19, 0xffff0000, v18
v_lshlrev_b32 v18, 16, v18
v_mul_f32 v18, v18, v24
v_mul_f32 v19, v19, v24
v_cvt_pk_bf16_f32 v18, v18, v19
v_accvgpr_write_b32 a102, v18
v_accvgpr_read_b32 v18, a103
v_and_b32 v19, 0xffff0000, v18
v_lshlrev_b32 v18, 16, v18
v_mul_f32 v18, v18, v24
v_mul_f32 v19, v19, v24
v_cvt_pk_bf16_f32 v18, v18, v19
v_accvgpr_write_b32 a103, v18
v_accvgpr_read_b32 v18, a112
v_and_b32 v19, 0xffff0000, v18
v_lshlrev_b32 v18, 16, v18
v_mul_f32 v18, v18, v24
v_mul_f32 v19, v19, v24
v_cvt_pk_bf16_f32 v18, v18, v19
v_accvgpr_write_b32 a112, v18
v_accvgpr_read_b32 v18, a113
v_and_b32 v19, 0xffff0000, v18
v_lshlrev_b32 v18, 16, v18
v_mul_f32 v18, v18, v24
v_mul_f32 v19, v19, v24
v_cvt_pk_bf16_f32 v18, v18, v19
v_accvgpr_write_b32 a113, v18
v_accvgpr_read_b32 v18, a114
v_and_b32 v19, 0xffff0000, v18
v_lshlrev_b32 v18, 16, v18
v_mul_f32 v18, v18, v24
v_mul_f32 v19, v19, v24
v_cvt_pk_bf16_f32 v18, v18, v19
v_accvgpr_write_b32 a114, v18
v_accvgpr_read_b32 v18, a115
v_and_b32 v19, 0xffff0000, v18
v_lshlrev_b32 v18, 16, v18
v_mul_f32 v18, v18, v24
v_mul_f32 v19, v19, v24
v_cvt_pk_bf16_f32 v18, v18, v19
v_accvgpr_write_b32 a115, v18
v_accvgpr_read_b32 v18, a116
v_and_b32 v19, 0xffff0000, v18
v_lshlrev_b32 v18, 16, v18
v_mul_f32 v18, v18, v24
v_mul_f32 v19, v19, v24
v_cvt_pk_bf16_f32 v18, v18, v19
v_accvgpr_write_b32 a116, v18
v_accvgpr_read_b32 v18, a117
v_and_b32 v19, 0xffff0000, v18
v_lshlrev_b32 v18, 16, v18
v_mul_f32 v18, v18, v24
v_mul_f32 v19, v19, v24
v_cvt_pk_bf16_f32 v18, v18, v19
v_accvgpr_write_b32 a117, v18
v_accvgpr_read_b32 v18, a118
v_and_b32 v19, 0xffff0000, v18
v_lshlrev_b32 v18, 16, v18
v_mul_f32 v18, v18, v24
v_mul_f32 v19, v19, v24
v_cvt_pk_bf16_f32 v18, v18, v19
v_accvgpr_write_b32 a118, v18
v_accvgpr_read_b32 v18, a119
v_and_b32 v19, 0xffff0000, v18
v_lshlrev_b32 v18, 16, v18
v_mul_f32 v18, v18, v24
v_mul_f32 v19, v19, v24
v_cvt_pk_bf16_f32 v18, v18, v19
v_accvgpr_write_b32 a119, v18
v_accvgpr_read_b32 v18, a128
v_and_b32 v19, 0xffff0000, v18
v_lshlrev_b32 v18, 16, v18
v_mul_f32 v18, v18, v24
v_mul_f32 v19, v19, v24
v_cvt_pk_bf16_f32 v18, v18, v19
v_accvgpr_write_b32 a128, v18
v_accvgpr_read_b32 v18, a129
v_and_b32 v19, 0xffff0000, v18
v_lshlrev_b32 v18, 16, v18
v_mul_f32 v18, v18, v24
v_mul_f32 v19, v19, v24
v_cvt_pk_bf16_f32 v18, v18, v19
v_accvgpr_write_b32 a129, v18
v_accvgpr_read_b32 v18, a130
v_and_b32 v19, 0xffff0000, v18
v_lshlrev_b32 v18, 16, v18
v_mul_f32 v18, v18, v24
v_mul_f32 v19, v19, v24
v_cvt_pk_bf16_f32 v18, v18, v19
v_accvgpr_write_b32 a130, v18
v_accvgpr_read_b32 v18, a131
v_and_b32 v19, 0xffff0000, v18
v_lshlrev_b32 v18, 16, v18
v_mul_f32 v18, v18, v24
v_mul_f32 v19, v19, v24
v_cvt_pk_bf16_f32 v18, v18, v19
v_accvgpr_write_b32 a131, v18
v_accvgpr_read_b32 v18, a132
v_and_b32 v19, 0xffff0000, v18
v_lshlrev_b32 v18, 16, v18
v_mul_f32 v18, v18, v24
v_mul_f32 v19, v19, v24
v_cvt_pk_bf16_f32 v18, v18, v19
v_accvgpr_write_b32 a132, v18
v_accvgpr_read_b32 v18, a133
v_and_b32 v19, 0xffff0000, v18
v_lshlrev_b32 v18, 16, v18
v_mul_f32 v18, v18, v24
v_mul_f32 v19, v19, v24
v_cvt_pk_bf16_f32 v18, v18, v19
v_accvgpr_write_b32 a133, v18
v_accvgpr_read_b32 v18, a134
v_and_b32 v19, 0xffff0000, v18
v_lshlrev_b32 v18, 16, v18
v_mul_f32 v18, v18, v24
v_mul_f32 v19, v19, v24
v_cvt_pk_bf16_f32 v18, v18, v19
v_accvgpr_write_b32 a134, v18
v_accvgpr_read_b32 v18, a135
v_and_b32 v19, 0xffff0000, v18
v_lshlrev_b32 v18, 16, v18
v_mul_f32 v18, v18, v24
v_mul_f32 v19, v19, v24
v_cvt_pk_bf16_f32 v18, v18, v19
v_accvgpr_write_b32 a135, v18
v_accvgpr_read_b32 v18, a144
v_and_b32 v19, 0xffff0000, v18
v_lshlrev_b32 v18, 16, v18
v_mul_f32 v18, v18, v24
v_mul_f32 v19, v19, v24
v_cvt_pk_bf16_f32 v18, v18, v19
v_accvgpr_write_b32 a144, v18
v_accvgpr_read_b32 v18, a145
v_and_b32 v19, 0xffff0000, v18
v_lshlrev_b32 v18, 16, v18
v_mul_f32 v18, v18, v24
v_mul_f32 v19, v19, v24
v_cvt_pk_bf16_f32 v18, v18, v19
v_accvgpr_write_b32 a145, v18
v_accvgpr_read_b32 v18, a146
v_and_b32 v19, 0xffff0000, v18
v_lshlrev_b32 v18, 16, v18
v_mul_f32 v18, v18, v24
v_mul_f32 v19, v19, v24
v_cvt_pk_bf16_f32 v18, v18, v19
v_accvgpr_write_b32 a146, v18
v_accvgpr_read_b32 v18, a147
v_and_b32 v19, 0xffff0000, v18
v_lshlrev_b32 v18, 16, v18
v_mul_f32 v18, v18, v24
v_mul_f32 v19, v19, v24
v_cvt_pk_bf16_f32 v18, v18, v19
v_accvgpr_write_b32 a147, v18
v_accvgpr_read_b32 v18, a148
v_and_b32 v19, 0xffff0000, v18
v_lshlrev_b32 v18, 16, v18
v_mul_f32 v18, v18, v24
v_mul_f32 v19, v19, v24
v_cvt_pk_bf16_f32 v18, v18, v19
v_accvgpr_write_b32 a148, v18
v_accvgpr_read_b32 v18, a149
v_and_b32 v19, 0xffff0000, v18
v_lshlrev_b32 v18, 16, v18
v_mul_f32 v18, v18, v24
v_mul_f32 v19, v19, v24
v_cvt_pk_bf16_f32 v18, v18, v19
v_accvgpr_write_b32 a149, v18
v_accvgpr_read_b32 v18, a150
v_and_b32 v19, 0xffff0000, v18
v_lshlrev_b32 v18, 16, v18
v_mul_f32 v18, v18, v24
v_mul_f32 v19, v19, v24
v_cvt_pk_bf16_f32 v18, v18, v19
v_accvgpr_write_b32 a150, v18
v_accvgpr_read_b32 v18, a151
v_and_b32 v19, 0xffff0000, v18
v_lshlrev_b32 v18, 16, v18
v_mul_f32 v18, v18, v24
v_mul_f32 v19, v19, v24
v_cvt_pk_bf16_f32 v18, v18, v19
v_accvgpr_write_b32 a151, v18
v_accvgpr_read_b32 v18, a160
v_and_b32 v19, 0xffff0000, v18
v_lshlrev_b32 v18, 16, v18
v_mul_f32 v18, v18, v24
v_mul_f32 v19, v19, v24
v_cvt_pk_bf16_f32 v18, v18, v19
v_accvgpr_write_b32 a160, v18
v_accvgpr_read_b32 v18, a161
v_and_b32 v19, 0xffff0000, v18
v_lshlrev_b32 v18, 16, v18
v_mul_f32 v18, v18, v24
v_mul_f32 v19, v19, v24
v_cvt_pk_bf16_f32 v18, v18, v19
v_accvgpr_write_b32 a161, v18
v_accvgpr_read_b32 v18, a162
v_and_b32 v19, 0xffff0000, v18
v_lshlrev_b32 v18, 16, v18
v_mul_f32 v18, v18, v24
v_mul_f32 v19, v19, v24
v_cvt_pk_bf16_f32 v18, v18, v19
v_accvgpr_write_b32 a162, v18
v_accvgpr_read_b32 v18, a163
v_and_b32 v19, 0xffff0000, v18
v_lshlrev_b32 v18, 16, v18
v_mul_f32 v18, v18, v24
v_mul_f32 v19, v19, v24
v_cvt_pk_bf16_f32 v18, v18, v19
v_accvgpr_write_b32 a163, v18
v_accvgpr_read_b32 v18, a164
v_and_b32 v19, 0xffff0000, v18
v_lshlrev_b32 v18, 16, v18
v_mul_f32 v18, v18, v24
v_mul_f32 v19, v19, v24
v_cvt_pk_bf16_f32 v18, v18, v19
v_accvgpr_write_b32 a164, v18
v_accvgpr_read_b32 v18, a165
v_and_b32 v19, 0xffff0000, v18
v_lshlrev_b32 v18, 16, v18
v_mul_f32 v18, v18, v24
v_mul_f32 v19, v19, v24
v_cvt_pk_bf16_f32 v18, v18, v19
v_accvgpr_write_b32 a165, v18
v_accvgpr_read_b32 v18, a166
v_and_b32 v19, 0xffff0000, v18
v_lshlrev_b32 v18, 16, v18
v_mul_f32 v18, v18, v24
v_mul_f32 v19, v19, v24
v_cvt_pk_bf16_f32 v18, v18, v19
v_accvgpr_write_b32 a166, v18
v_accvgpr_read_b32 v18, a167
v_and_b32 v19, 0xffff0000, v18
v_lshlrev_b32 v18, 16, v18
v_mul_f32 v18, v18, v24
v_mul_f32 v19, v19, v24
v_cvt_pk_bf16_f32 v18, v18, v19
v_accvgpr_write_b32 a167, v18
v_accvgpr_read_b32 v18, a176
v_and_b32 v19, 0xffff0000, v18
v_lshlrev_b32 v18, 16, v18
v_mul_f32 v18, v18, v24
v_mul_f32 v19, v19, v24
v_cvt_pk_bf16_f32 v18, v18, v19
v_accvgpr_write_b32 a176, v18
v_accvgpr_read_b32 v18, a177
v_and_b32 v19, 0xffff0000, v18
v_lshlrev_b32 v18, 16, v18
v_mul_f32 v18, v18, v24
v_mul_f32 v19, v19, v24
v_cvt_pk_bf16_f32 v18, v18, v19
v_accvgpr_write_b32 a177, v18
v_accvgpr_read_b32 v18, a178
v_and_b32 v19, 0xffff0000, v18
v_lshlrev_b32 v18, 16, v18
v_mul_f32 v18, v18, v24
v_mul_f32 v19, v19, v24
v_cvt_pk_bf16_f32 v18, v18, v19
v_accvgpr_write_b32 a178, v18
v_accvgpr_read_b32 v18, a179
v_and_b32 v19, 0xffff0000, v18
v_lshlrev_b32 v18, 16, v18
v_mul_f32 v18, v18, v24
v_mul_f32 v19, v19, v24
v_cvt_pk_bf16_f32 v18, v18, v19
v_accvgpr_write_b32 a179, v18
v_accvgpr_read_b32 v18, a180
v_and_b32 v19, 0xffff0000, v18
v_lshlrev_b32 v18, 16, v18
v_mul_f32 v18, v18, v24
v_mul_f32 v19, v19, v24
v_cvt_pk_bf16_f32 v18, v18, v19
v_accvgpr_write_b32 a180, v18
v_accvgpr_read_b32 v18, a181
v_and_b32 v19, 0xffff0000, v18
v_lshlrev_b32 v18, 16, v18
v_mul_f32 v18, v18, v24
v_mul_f32 v19, v19, v24
v_cvt_pk_bf16_f32 v18, v18, v19
v_accvgpr_write_b32 a181, v18
v_accvgpr_read_b32 v18, a182
v_and_b32 v19, 0xffff0000, v18
v_lshlrev_b32 v18, 16, v18
v_mul_f32 v18, v18, v24
v_mul_f32 v19, v19, v24
v_cvt_pk_bf16_f32 v18, v18, v19
v_accvgpr_write_b32 a182, v18
v_accvgpr_read_b32 v18, a183
v_and_b32 v19, 0xffff0000, v18
v_lshlrev_b32 v18, 16, v18
v_mul_f32 v18, v18, v24
v_mul_f32 v19, v19, v24
v_cvt_pk_bf16_f32 v18, v18, v19
v_accvgpr_write_b32 a183, v18
v_accvgpr_read_b32 v18, a192
v_and_b32 v19, 0xffff0000, v18
v_lshlrev_b32 v18, 16, v18
v_mul_f32 v18, v18, v24
v_mul_f32 v19, v19, v24
v_cvt_pk_bf16_f32 v18, v18, v19
v_accvgpr_write_b32 a192, v18
v_accvgpr_read_b32 v18, a193
v_and_b32 v19, 0xffff0000, v18
v_lshlrev_b32 v18, 16, v18
v_mul_f32 v18, v18, v24
v_mul_f32 v19, v19, v24
v_cvt_pk_bf16_f32 v18, v18, v19
v_accvgpr_write_b32 a193, v18
v_accvgpr_read_b32 v18, a194
v_and_b32 v19, 0xffff0000, v18
v_lshlrev_b32 v18, 16, v18
v_mul_f32 v18, v18, v24
v_mul_f32 v19, v19, v24
v_cvt_pk_bf16_f32 v18, v18, v19
v_accvgpr_write_b32 a194, v18
v_accvgpr_read_b32 v18, a195
v_and_b32 v19, 0xffff0000, v18
v_lshlrev_b32 v18, 16, v18
v_mul_f32 v18, v18, v24
v_mul_f32 v19, v19, v24
v_cvt_pk_bf16_f32 v18, v18, v19
v_accvgpr_write_b32 a195, v18
v_accvgpr_read_b32 v18, a196
v_and_b32 v19, 0xffff0000, v18
v_lshlrev_b32 v18, 16, v18
v_mul_f32 v18, v18, v24
v_mul_f32 v19, v19, v24
v_cvt_pk_bf16_f32 v18, v18, v19
v_accvgpr_write_b32 a196, v18
v_accvgpr_read_b32 v18, a197
v_and_b32 v19, 0xffff0000, v18
v_lshlrev_b32 v18, 16, v18
v_mul_f32 v18, v18, v24
v_mul_f32 v19, v19, v24
v_cvt_pk_bf16_f32 v18, v18, v19
v_accvgpr_write_b32 a197, v18
v_accvgpr_read_b32 v18, a198
v_and_b32 v19, 0xffff0000, v18
v_lshlrev_b32 v18, 16, v18
v_mul_f32 v18, v18, v24
v_mul_f32 v19, v19, v24
v_cvt_pk_bf16_f32 v18, v18, v19
v_accvgpr_write_b32 a198, v18
v_accvgpr_read_b32 v18, a199
v_and_b32 v19, 0xffff0000, v18
v_lshlrev_b32 v18, 16, v18
v_mul_f32 v18, v18, v24
v_mul_f32 v19, v19, v24
v_cvt_pk_bf16_f32 v18, v18, v19
v_accvgpr_write_b32 a199, v18
v_accvgpr_read_b32 v18, a208
v_and_b32 v19, 0xffff0000, v18
v_lshlrev_b32 v18, 16, v18
v_mul_f32 v18, v18, v24
v_mul_f32 v19, v19, v24
v_cvt_pk_bf16_f32 v18, v18, v19
v_accvgpr_write_b32 a208, v18
v_accvgpr_read_b32 v18, a209
v_and_b32 v19, 0xffff0000, v18
v_lshlrev_b32 v18, 16, v18
v_mul_f32 v18, v18, v24
v_mul_f32 v19, v19, v24
v_cvt_pk_bf16_f32 v18, v18, v19
v_accvgpr_write_b32 a209, v18
v_accvgpr_read_b32 v18, a210
v_and_b32 v19, 0xffff0000, v18
v_lshlrev_b32 v18, 16, v18
v_mul_f32 v18, v18, v24
v_mul_f32 v19, v19, v24
v_cvt_pk_bf16_f32 v18, v18, v19
v_accvgpr_write_b32 a210, v18
v_accvgpr_read_b32 v18, a211
v_and_b32 v19, 0xffff0000, v18
v_lshlrev_b32 v18, 16, v18
v_mul_f32 v18, v18, v24
v_mul_f32 v19, v19, v24
v_cvt_pk_bf16_f32 v18, v18, v19
v_accvgpr_write_b32 a211, v18
v_accvgpr_read_b32 v18, a212
v_and_b32 v19, 0xffff0000, v18
v_lshlrev_b32 v18, 16, v18
v_mul_f32 v18, v18, v24
v_mul_f32 v19, v19, v24
v_cvt_pk_bf16_f32 v18, v18, v19
v_accvgpr_write_b32 a212, v18
v_accvgpr_read_b32 v18, a213
v_and_b32 v19, 0xffff0000, v18
v_lshlrev_b32 v18, 16, v18
v_mul_f32 v18, v18, v24
v_mul_f32 v19, v19, v24
v_cvt_pk_bf16_f32 v18, v18, v19
v_accvgpr_write_b32 a213, v18
v_accvgpr_read_b32 v18, a214
v_and_b32 v19, 0xffff0000, v18
v_lshlrev_b32 v18, 16, v18
v_mul_f32 v18, v18, v24
v_mul_f32 v19, v19, v24
v_cvt_pk_bf16_f32 v18, v18, v19
v_accvgpr_write_b32 a214, v18
v_accvgpr_read_b32 v18, a215
v_and_b32 v19, 0xffff0000, v18
v_lshlrev_b32 v18, 16, v18
v_mul_f32 v18, v18, v24
v_mul_f32 v19, v19, v24
v_cvt_pk_bf16_f32 v18, v18, v19
v_accvgpr_write_b32 a215, v18
v_accvgpr_read_b32 v18, a224
v_and_b32 v19, 0xffff0000, v18
v_lshlrev_b32 v18, 16, v18
v_mul_f32 v18, v18, v24
v_mul_f32 v19, v19, v24
v_cvt_pk_bf16_f32 v18, v18, v19
v_accvgpr_write_b32 a224, v18
v_accvgpr_read_b32 v18, a225
v_and_b32 v19, 0xffff0000, v18
v_lshlrev_b32 v18, 16, v18
v_mul_f32 v18, v18, v24
v_mul_f32 v19, v19, v24
v_cvt_pk_bf16_f32 v18, v18, v19
v_accvgpr_write_b32 a225, v18
v_accvgpr_read_b32 v18, a226
v_and_b32 v19, 0xffff0000, v18
v_lshlrev_b32 v18, 16, v18
v_mul_f32 v18, v18, v24
v_mul_f32 v19, v19, v24
v_cvt_pk_bf16_f32 v18, v18, v19
v_accvgpr_write_b32 a226, v18
v_accvgpr_read_b32 v18, a227
v_and_b32 v19, 0xffff0000, v18
v_lshlrev_b32 v18, 16, v18
v_mul_f32 v18, v18, v24
v_mul_f32 v19, v19, v24
v_cvt_pk_bf16_f32 v18, v18, v19
v_accvgpr_write_b32 a227, v18
v_accvgpr_read_b32 v18, a228
v_and_b32 v19, 0xffff0000, v18
v_lshlrev_b32 v18, 16, v18
v_mul_f32 v18, v18, v24
v_mul_f32 v19, v19, v24
v_cvt_pk_bf16_f32 v18, v18, v19
v_accvgpr_write_b32 a228, v18
v_accvgpr_read_b32 v18, a229
v_and_b32 v19, 0xffff0000, v18
v_lshlrev_b32 v18, 16, v18
v_mul_f32 v18, v18, v24
v_mul_f32 v19, v19, v24
v_cvt_pk_bf16_f32 v18, v18, v19
v_accvgpr_write_b32 a229, v18
v_accvgpr_read_b32 v18, a230
v_and_b32 v19, 0xffff0000, v18
v_lshlrev_b32 v18, 16, v18
v_mul_f32 v18, v18, v24
v_mul_f32 v19, v19, v24
v_cvt_pk_bf16_f32 v18, v18, v19
v_accvgpr_write_b32 a230, v18
v_accvgpr_read_b32 v18, a231
v_and_b32 v19, 0xffff0000, v18
v_lshlrev_b32 v18, 16, v18
v_mul_f32 v18, v18, v24
v_mul_f32 v19, v19, v24
v_cvt_pk_bf16_f32 v18, v18, v19
v_accvgpr_write_b32 a231, v18
v_exp_f32 v18, v160
v_exp_f32 v19, v161
s_nop 0
v_cvt_pk_bf16_f32 v160, v18, v19
v_add_f32 v16, v18, v19
v_exp_f32 v20, v162
v_exp_f32 v21, v163
v_add_f32 v16, v16, v20
v_cvt_pk_bf16_f32 v161, v20, v21
v_add_f32 v16, v16, v21
v_exp_f32 v18, v164
v_exp_f32 v19, v165
v_add_f32 v16, v16, v18
v_cvt_pk_bf16_f32 v162, v18, v19
v_add_f32 v16, v16, v19
v_exp_f32 v20, v166
v_exp_f32 v21, v167
v_add_f32 v16, v16, v20
v_cvt_pk_bf16_f32 v163, v20, v21
v_add_f32 v16, v16, v21
v_exp_f32 v18, v168
v_exp_f32 v19, v169
v_add_f32 v16, v16, v18
v_cvt_pk_bf16_f32 v164, v18, v19
v_add_f32 v16, v16, v19
v_exp_f32 v20, v170
v_exp_f32 v21, v171
v_add_f32 v16, v16, v20
v_cvt_pk_bf16_f32 v165, v20, v21
v_add_f32 v16, v16, v21
v_exp_f32 v18, v172
v_exp_f32 v19, v173
v_add_f32 v16, v16, v18
v_cvt_pk_bf16_f32 v166, v18, v19
v_add_f32 v16, v16, v19
v_exp_f32 v20, v174
v_exp_f32 v21, v175
v_add_f32 v16, v16, v20
v_cvt_pk_bf16_f32 v167, v20, v21
v_add_f32 v16, v16, v21
v_max3_f32 v22, v176, v177, v178
v_max3_f32 v22, v22, v179, v180
v_max3_f32 v22, v22, v181, v182
v_max3_f32 v22, v22, v183, v184
v_max3_f32 v22, v22, v185, v186
v_max3_f32 v22, v22, v187, v188
v_max3_f32 v22, v22, v189, v190
v_max_f32 v22, v22, v191
v_mov_b32 v23, v22
s_nop 1
v_permlane32_swap_b32 v22, v23
v_max_f32 v22, v22, v23
v_max_f32 v22, 0, v22
v_ceil_f32 v22, v22
v_sub_f32 v23, 0, v22
v_exp_f32 v25, v23
v_sub_f32 v176, v176, v22
v_sub_f32 v177, v177, v22
v_sub_f32 v178, v178, v22
v_sub_f32 v179, v179, v22
v_sub_f32 v180, v180, v22
v_sub_f32 v181, v181, v22
v_sub_f32 v182, v182, v22
v_sub_f32 v183, v183, v22
v_sub_f32 v184, v184, v22
v_sub_f32 v185, v185, v22
v_sub_f32 v186, v186, v22
v_sub_f32 v187, v187, v22
v_sub_f32 v188, v188, v22
v_sub_f32 v189, v189, v22
v_sub_f32 v190, v190, v22
v_sub_f32 v191, v191, v22
v_sub_f32 v208, v208, v22
v_sub_f32 v209, v209, v22
v_sub_f32 v210, v210, v22
v_sub_f32 v211, v211, v22
v_sub_f32 v212, v212, v22
v_sub_f32 v213, v213, v22
v_sub_f32 v214, v214, v22
v_sub_f32 v215, v215, v22
v_sub_f32 v216, v216, v22
v_sub_f32 v217, v217, v22
v_sub_f32 v218, v218, v22
v_sub_f32 v219, v219, v22
v_sub_f32 v220, v220, v22
v_sub_f32 v221, v221, v22
v_sub_f32 v222, v222, v22
v_sub_f32 v223, v223, v22
v_sub_f32 v48, v48, v22
v_sub_f32 v49, v49, v22
v_sub_f32 v50, v50, v22
v_sub_f32 v51, v51, v22
v_sub_f32 v52, v52, v22
v_sub_f32 v53, v53, v22
v_sub_f32 v54, v54, v22
v_sub_f32 v55, v55, v22
v_sub_f32 v56, v56, v22
v_sub_f32 v57, v57, v22
v_sub_f32 v58, v58, v22
v_sub_f32 v59, v59, v22
v_sub_f32 v60, v60, v22
v_sub_f32 v61, v61, v22
v_sub_f32 v62, v62, v22
v_sub_f32 v63, v63, v22
v_mul_f32 v15, v15, v25
v_accvgpr_read_b32 v18, a8
v_and_b32 v19, 0xffff0000, v18
v_lshlrev_b32 v18, 16, v18
v_mul_f32 v18, v18, v25
v_mul_f32 v19, v19, v25
v_cvt_pk_bf16_f32 v18, v18, v19
v_accvgpr_write_b32 a8, v18
v_accvgpr_read_b32 v18, a9
v_and_b32 v19, 0xffff0000, v18
v_lshlrev_b32 v18, 16, v18
v_mul_f32 v18, v18, v25
v_mul_f32 v19, v19, v25
v_cvt_pk_bf16_f32 v18, v18, v19
v_accvgpr_write_b32 a9, v18
v_accvgpr_read_b32 v18, a10
v_and_b32 v19, 0xffff0000, v18
v_lshlrev_b32 v18, 16, v18
v_mul_f32 v18, v18, v25
v_mul_f32 v19, v19, v25
v_cvt_pk_bf16_f32 v18, v18, v19
v_accvgpr_write_b32 a10, v18
v_accvgpr_read_b32 v18, a11
v_and_b32 v19, 0xffff0000, v18
v_lshlrev_b32 v18, 16, v18
v_mul_f32 v18, v18, v25
v_mul_f32 v19, v19, v25
v_cvt_pk_bf16_f32 v18, v18, v19
v_accvgpr_write_b32 a11, v18
v_accvgpr_read_b32 v18, a12
v_and_b32 v19, 0xffff0000, v18
v_lshlrev_b32 v18, 16, v18
v_mul_f32 v18, v18, v25
v_mul_f32 v19, v19, v25
v_cvt_pk_bf16_f32 v18, v18, v19
v_accvgpr_write_b32 a12, v18
v_accvgpr_read_b32 v18, a13
v_and_b32 v19, 0xffff0000, v18
v_lshlrev_b32 v18, 16, v18
v_mul_f32 v18, v18, v25
v_mul_f32 v19, v19, v25
v_cvt_pk_bf16_f32 v18, v18, v19
v_accvgpr_write_b32 a13, v18
v_accvgpr_read_b32 v18, a14
v_and_b32 v19, 0xffff0000, v18
v_lshlrev_b32 v18, 16, v18
v_mul_f32 v18, v18, v25
v_mul_f32 v19, v19, v25
v_cvt_pk_bf16_f32 v18, v18, v19
v_accvgpr_write_b32 a14, v18
v_accvgpr_read_b32 v18, a15
v_and_b32 v19, 0xffff0000, v18
v_lshlrev_b32 v18, 16, v18
v_mul_f32 v18, v18, v25
v_mul_f32 v19, v19, v25
v_cvt_pk_bf16_f32 v18, v18, v19
v_accvgpr_write_b32 a15, v18
v_accvgpr_read_b32 v18, a24
v_and_b32 v19, 0xffff0000, v18
v_lshlrev_b32 v18, 16, v18
v_mul_f32 v18, v18, v25
v_mul_f32 v19, v19, v25
v_cvt_pk_bf16_f32 v18, v18, v19
v_accvgpr_write_b32 a24, v18
v_accvgpr_read_b32 v18, a25
v_and_b32 v19, 0xffff0000, v18
v_lshlrev_b32 v18, 16, v18
v_mul_f32 v18, v18, v25
v_mul_f32 v19, v19, v25
v_cvt_pk_bf16_f32 v18, v18, v19
v_accvgpr_write_b32 a25, v18
v_accvgpr_read_b32 v18, a26
v_and_b32 v19, 0xffff0000, v18
v_lshlrev_b32 v18, 16, v18
v_mul_f32 v18, v18, v25
v_mul_f32 v19, v19, v25
v_cvt_pk_bf16_f32 v18, v18, v19
v_accvgpr_write_b32 a26, v18
v_accvgpr_read_b32 v18, a27
v_and_b32 v19, 0xffff0000, v18
v_lshlrev_b32 v18, 16, v18
v_mul_f32 v18, v18, v25
v_mul_f32 v19, v19, v25
v_cvt_pk_bf16_f32 v18, v18, v19
v_accvgpr_write_b32 a27, v18
v_accvgpr_read_b32 v18, a28
v_and_b32 v19, 0xffff0000, v18
v_lshlrev_b32 v18, 16, v18
v_mul_f32 v18, v18, v25
v_mul_f32 v19, v19, v25
v_cvt_pk_bf16_f32 v18, v18, v19
v_accvgpr_write_b32 a28, v18
v_accvgpr_read_b32 v18, a29
v_and_b32 v19, 0xffff0000, v18
v_lshlrev_b32 v18, 16, v18
v_mul_f32 v18, v18, v25
v_mul_f32 v19, v19, v25
v_cvt_pk_bf16_f32 v18, v18, v19
v_accvgpr_write_b32 a29, v18
v_accvgpr_read_b32 v18, a30
v_and_b32 v19, 0xffff0000, v18
v_lshlrev_b32 v18, 16, v18
v_mul_f32 v18, v18, v25
v_mul_f32 v19, v19, v25
v_cvt_pk_bf16_f32 v18, v18, v19
v_accvgpr_write_b32 a30, v18
v_accvgpr_read_b32 v18, a31
v_and_b32 v19, 0xffff0000, v18
v_lshlrev_b32 v18, 16, v18
v_mul_f32 v18, v18, v25
v_mul_f32 v19, v19, v25
v_cvt_pk_bf16_f32 v18, v18, v19
v_accvgpr_write_b32 a31, v18
v_accvgpr_read_b32 v18, a40
v_and_b32 v19, 0xffff0000, v18
v_lshlrev_b32 v18, 16, v18
v_mul_f32 v18, v18, v25
v_mul_f32 v19, v19, v25
v_cvt_pk_bf16_f32 v18, v18, v19
v_accvgpr_write_b32 a40, v18
v_accvgpr_read_b32 v18, a41
v_and_b32 v19, 0xffff0000, v18
v_lshlrev_b32 v18, 16, v18
v_mul_f32 v18, v18, v25
v_mul_f32 v19, v19, v25
v_cvt_pk_bf16_f32 v18, v18, v19
v_accvgpr_write_b32 a41, v18
v_accvgpr_read_b32 v18, a42
v_and_b32 v19, 0xffff0000, v18
v_lshlrev_b32 v18, 16, v18
v_mul_f32 v18, v18, v25
v_mul_f32 v19, v19, v25
v_cvt_pk_bf16_f32 v18, v18, v19
v_accvgpr_write_b32 a42, v18
v_accvgpr_read_b32 v18, a43
v_and_b32 v19, 0xffff0000, v18
v_lshlrev_b32 v18, 16, v18
v_mul_f32 v18, v18, v25
v_mul_f32 v19, v19, v25
v_cvt_pk_bf16_f32 v18, v18, v19
v_accvgpr_write_b32 a43, v18
v_accvgpr_read_b32 v18, a44
v_and_b32 v19, 0xffff0000, v18
v_lshlrev_b32 v18, 16, v18
v_mul_f32 v18, v18, v25
v_mul_f32 v19, v19, v25
v_cvt_pk_bf16_f32 v18, v18, v19
v_accvgpr_write_b32 a44, v18
v_accvgpr_read_b32 v18, a45
v_and_b32 v19, 0xffff0000, v18
v_lshlrev_b32 v18, 16, v18
v_mul_f32 v18, v18, v25
v_mul_f32 v19, v19, v25
v_cvt_pk_bf16_f32 v18, v18, v19
v_accvgpr_write_b32 a45, v18
v_accvgpr_read_b32 v18, a46
v_and_b32 v19, 0xffff0000, v18
v_lshlrev_b32 v18, 16, v18
v_mul_f32 v18, v18, v25
v_mul_f32 v19, v19, v25
v_cvt_pk_bf16_f32 v18, v18, v19
v_accvgpr_write_b32 a46, v18
v_accvgpr_read_b32 v18, a47
v_and_b32 v19, 0xffff0000, v18
v_lshlrev_b32 v18, 16, v18
v_mul_f32 v18, v18, v25
v_mul_f32 v19, v19, v25
v_cvt_pk_bf16_f32 v18, v18, v19
v_accvgpr_write_b32 a47, v18
v_accvgpr_read_b32 v18, a56
v_and_b32 v19, 0xffff0000, v18
v_lshlrev_b32 v18, 16, v18
v_mul_f32 v18, v18, v25
v_mul_f32 v19, v19, v25
v_cvt_pk_bf16_f32 v18, v18, v19
v_accvgpr_write_b32 a56, v18
v_accvgpr_read_b32 v18, a57
v_and_b32 v19, 0xffff0000, v18
v_lshlrev_b32 v18, 16, v18
v_mul_f32 v18, v18, v25
v_mul_f32 v19, v19, v25
v_cvt_pk_bf16_f32 v18, v18, v19
v_accvgpr_write_b32 a57, v18
v_accvgpr_read_b32 v18, a58
v_and_b32 v19, 0xffff0000, v18
v_lshlrev_b32 v18, 16, v18
v_mul_f32 v18, v18, v25
v_mul_f32 v19, v19, v25
v_cvt_pk_bf16_f32 v18, v18, v19
v_accvgpr_write_b32 a58, v18
v_accvgpr_read_b32 v18, a59
v_and_b32 v19, 0xffff0000, v18
v_lshlrev_b32 v18, 16, v18
v_mul_f32 v18, v18, v25
v_mul_f32 v19, v19, v25
v_cvt_pk_bf16_f32 v18, v18, v19
v_accvgpr_write_b32 a59, v18
v_accvgpr_read_b32 v18, a60
v_and_b32 v19, 0xffff0000, v18
v_lshlrev_b32 v18, 16, v18
v_mul_f32 v18, v18, v25
v_mul_f32 v19, v19, v25
v_cvt_pk_bf16_f32 v18, v18, v19
v_accvgpr_write_b32 a60, v18
v_accvgpr_read_b32 v18, a61
v_and_b32 v19, 0xffff0000, v18
v_lshlrev_b32 v18, 16, v18
v_mul_f32 v18, v18, v25
v_mul_f32 v19, v19, v25
v_cvt_pk_bf16_f32 v18, v18, v19
v_accvgpr_write_b32 a61, v18
v_accvgpr_read_b32 v18, a62
v_and_b32 v19, 0xffff0000, v18
v_lshlrev_b32 v18, 16, v18
v_mul_f32 v18, v18, v25
v_mul_f32 v19, v19, v25
v_cvt_pk_bf16_f32 v18, v18, v19
v_accvgpr_write_b32 a62, v18
v_accvgpr_read_b32 v18, a63
v_and_b32 v19, 0xffff0000, v18
v_lshlrev_b32 v18, 16, v18
v_mul_f32 v18, v18, v25
v_mul_f32 v19, v19, v25
v_cvt_pk_bf16_f32 v18, v18, v19
v_accvgpr_write_b32 a63, v18
v_accvgpr_read_b32 v18, a72
v_and_b32 v19, 0xffff0000, v18
v_lshlrev_b32 v18, 16, v18
v_mul_f32 v18, v18, v25
v_mul_f32 v19, v19, v25
v_cvt_pk_bf16_f32 v18, v18, v19
v_accvgpr_write_b32 a72, v18
v_accvgpr_read_b32 v18, a73
v_and_b32 v19, 0xffff0000, v18
v_lshlrev_b32 v18, 16, v18
v_mul_f32 v18, v18, v25
v_mul_f32 v19, v19, v25
v_cvt_pk_bf16_f32 v18, v18, v19
v_accvgpr_write_b32 a73, v18
v_accvgpr_read_b32 v18, a74
v_and_b32 v19, 0xffff0000, v18
v_lshlrev_b32 v18, 16, v18
v_mul_f32 v18, v18, v25
v_mul_f32 v19, v19, v25
v_cvt_pk_bf16_f32 v18, v18, v19
v_accvgpr_write_b32 a74, v18
v_accvgpr_read_b32 v18, a75
v_and_b32 v19, 0xffff0000, v18
v_lshlrev_b32 v18, 16, v18
v_mul_f32 v18, v18, v25
v_mul_f32 v19, v19, v25
v_cvt_pk_bf16_f32 v18, v18, v19
v_accvgpr_write_b32 a75, v18
v_accvgpr_read_b32 v18, a76
v_and_b32 v19, 0xffff0000, v18
v_lshlrev_b32 v18, 16, v18
v_mul_f32 v18, v18, v25
v_mul_f32 v19, v19, v25
v_cvt_pk_bf16_f32 v18, v18, v19
v_accvgpr_write_b32 a76, v18
v_accvgpr_read_b32 v18, a77
v_and_b32 v19, 0xffff0000, v18
v_lshlrev_b32 v18, 16, v18
v_mul_f32 v18, v18, v25
v_mul_f32 v19, v19, v25
v_cvt_pk_bf16_f32 v18, v18, v19
v_accvgpr_write_b32 a77, v18
v_accvgpr_read_b32 v18, a78
v_and_b32 v19, 0xffff0000, v18
v_lshlrev_b32 v18, 16, v18
v_mul_f32 v18, v18, v25
v_mul_f32 v19, v19, v25
v_cvt_pk_bf16_f32 v18, v18, v19
v_accvgpr_write_b32 a78, v18
v_accvgpr_read_b32 v18, a79
v_and_b32 v19, 0xffff0000, v18
v_lshlrev_b32 v18, 16, v18
v_mul_f32 v18, v18, v25
v_mul_f32 v19, v19, v25
v_cvt_pk_bf16_f32 v18, v18, v19
v_accvgpr_write_b32 a79, v18
v_accvgpr_read_b32 v18, a88
v_and_b32 v19, 0xffff0000, v18
v_lshlrev_b32 v18, 16, v18
v_mul_f32 v18, v18, v25
v_mul_f32 v19, v19, v25
v_cvt_pk_bf16_f32 v18, v18, v19
v_accvgpr_write_b32 a88, v18
v_accvgpr_read_b32 v18, a89
v_and_b32 v19, 0xffff0000, v18
v_lshlrev_b32 v18, 16, v18
v_mul_f32 v18, v18, v25
v_mul_f32 v19, v19, v25
v_cvt_pk_bf16_f32 v18, v18, v19
v_accvgpr_write_b32 a89, v18
v_accvgpr_read_b32 v18, a90
v_and_b32 v19, 0xffff0000, v18
v_lshlrev_b32 v18, 16, v18
v_mul_f32 v18, v18, v25
v_mul_f32 v19, v19, v25
v_cvt_pk_bf16_f32 v18, v18, v19
v_accvgpr_write_b32 a90, v18
v_accvgpr_read_b32 v18, a91
v_and_b32 v19, 0xffff0000, v18
v_lshlrev_b32 v18, 16, v18
v_mul_f32 v18, v18, v25
v_mul_f32 v19, v19, v25
v_cvt_pk_bf16_f32 v18, v18, v19
v_accvgpr_write_b32 a91, v18
v_accvgpr_read_b32 v18, a92
v_and_b32 v19, 0xffff0000, v18
v_lshlrev_b32 v18, 16, v18
v_mul_f32 v18, v18, v25
v_mul_f32 v19, v19, v25
v_cvt_pk_bf16_f32 v18, v18, v19
v_accvgpr_write_b32 a92, v18
v_accvgpr_read_b32 v18, a93
v_and_b32 v19, 0xffff0000, v18
v_lshlrev_b32 v18, 16, v18
v_mul_f32 v18, v18, v25
v_mul_f32 v19, v19, v25
v_cvt_pk_bf16_f32 v18, v18, v19
v_accvgpr_write_b32 a93, v18
v_accvgpr_read_b32 v18, a94
v_and_b32 v19, 0xffff0000, v18
v_lshlrev_b32 v18, 16, v18
v_mul_f32 v18, v18, v25
v_mul_f32 v19, v19, v25
v_cvt_pk_bf16_f32 v18, v18, v19
v_accvgpr_write_b32 a94, v18
v_accvgpr_read_b32 v18, a95
v_and_b32 v19, 0xffff0000, v18
v_lshlrev_b32 v18, 16, v18
v_mul_f32 v18, v18, v25
v_mul_f32 v19, v19, v25
v_cvt_pk_bf16_f32 v18, v18, v19
v_accvgpr_write_b32 a95, v18
v_accvgpr_read_b32 v18, a104
v_and_b32 v19, 0xffff0000, v18
v_lshlrev_b32 v18, 16, v18
v_mul_f32 v18, v18, v25
v_mul_f32 v19, v19, v25
v_cvt_pk_bf16_f32 v18, v18, v19
v_accvgpr_write_b32 a104, v18
v_accvgpr_read_b32 v18, a105
v_and_b32 v19, 0xffff0000, v18
v_lshlrev_b32 v18, 16, v18
v_mul_f32 v18, v18, v25
v_mul_f32 v19, v19, v25
v_cvt_pk_bf16_f32 v18, v18, v19
v_accvgpr_write_b32 a105, v18
v_accvgpr_read_b32 v18, a106
v_and_b32 v19, 0xffff0000, v18
v_lshlrev_b32 v18, 16, v18
v_mul_f32 v18, v18, v25
v_mul_f32 v19, v19, v25
v_cvt_pk_bf16_f32 v18, v18, v19
v_accvgpr_write_b32 a106, v18
v_accvgpr_read_b32 v18, a107
v_and_b32 v19, 0xffff0000, v18
v_lshlrev_b32 v18, 16, v18
v_mul_f32 v18, v18, v25
v_mul_f32 v19, v19, v25
v_cvt_pk_bf16_f32 v18, v18, v19
v_accvgpr_write_b32 a107, v18
v_accvgpr_read_b32 v18, a108
v_and_b32 v19, 0xffff0000, v18
v_lshlrev_b32 v18, 16, v18
v_mul_f32 v18, v18, v25
v_mul_f32 v19, v19, v25
v_cvt_pk_bf16_f32 v18, v18, v19
v_accvgpr_write_b32 a108, v18
v_accvgpr_read_b32 v18, a109
v_and_b32 v19, 0xffff0000, v18
v_lshlrev_b32 v18, 16, v18
v_mul_f32 v18, v18, v25
v_mul_f32 v19, v19, v25
v_cvt_pk_bf16_f32 v18, v18, v19
v_accvgpr_write_b32 a109, v18
v_accvgpr_read_b32 v18, a110
v_and_b32 v19, 0xffff0000, v18
v_lshlrev_b32 v18, 16, v18
v_mul_f32 v18, v18, v25
v_mul_f32 v19, v19, v25
v_cvt_pk_bf16_f32 v18, v18, v19
v_accvgpr_write_b32 a110, v18
v_accvgpr_read_b32 v18, a111
v_and_b32 v19, 0xffff0000, v18
v_lshlrev_b32 v18, 16, v18
v_mul_f32 v18, v18, v25
v_mul_f32 v19, v19, v25
v_cvt_pk_bf16_f32 v18, v18, v19
v_accvgpr_write_b32 a111, v18
v_accvgpr_read_b32 v18, a120
v_and_b32 v19, 0xffff0000, v18
v_lshlrev_b32 v18, 16, v18
v_mul_f32 v18, v18, v25
v_mul_f32 v19, v19, v25
v_cvt_pk_bf16_f32 v18, v18, v19
v_accvgpr_write_b32 a120, v18
v_accvgpr_read_b32 v18, a121
v_and_b32 v19, 0xffff0000, v18
v_lshlrev_b32 v18, 16, v18
v_mul_f32 v18, v18, v25
v_mul_f32 v19, v19, v25
v_cvt_pk_bf16_f32 v18, v18, v19
v_accvgpr_write_b32 a121, v18
v_accvgpr_read_b32 v18, a122
v_and_b32 v19, 0xffff0000, v18
v_lshlrev_b32 v18, 16, v18
v_mul_f32 v18, v18, v25
v_mul_f32 v19, v19, v25
v_cvt_pk_bf16_f32 v18, v18, v19
v_accvgpr_write_b32 a122, v18
v_accvgpr_read_b32 v18, a123
v_and_b32 v19, 0xffff0000, v18
v_lshlrev_b32 v18, 16, v18
v_mul_f32 v18, v18, v25
v_mul_f32 v19, v19, v25
v_cvt_pk_bf16_f32 v18, v18, v19
v_accvgpr_write_b32 a123, v18
v_accvgpr_read_b32 v18, a124
v_and_b32 v19, 0xffff0000, v18
v_lshlrev_b32 v18, 16, v18
v_mul_f32 v18, v18, v25
v_mul_f32 v19, v19, v25
v_cvt_pk_bf16_f32 v18, v18, v19
v_accvgpr_write_b32 a124, v18
v_accvgpr_read_b32 v18, a125
v_and_b32 v19, 0xffff0000, v18
v_lshlrev_b32 v18, 16, v18
v_mul_f32 v18, v18, v25
v_mul_f32 v19, v19, v25
v_cvt_pk_bf16_f32 v18, v18, v19
v_accvgpr_write_b32 a125, v18
v_accvgpr_read_b32 v18, a126
v_and_b32 v19, 0xffff0000, v18
v_lshlrev_b32 v18, 16, v18
v_mul_f32 v18, v18, v25
v_mul_f32 v19, v19, v25
v_cvt_pk_bf16_f32 v18, v18, v19
v_accvgpr_write_b32 a126, v18
v_accvgpr_read_b32 v18, a127
v_and_b32 v19, 0xffff0000, v18
v_lshlrev_b32 v18, 16, v18
v_mul_f32 v18, v18, v25
v_mul_f32 v19, v19, v25
v_cvt_pk_bf16_f32 v18, v18, v19
v_accvgpr_write_b32 a127, v18
v_accvgpr_read_b32 v18, a136
v_and_b32 v19, 0xffff0000, v18
v_lshlrev_b32 v18, 16, v18
v_mul_f32 v18, v18, v25
v_mul_f32 v19, v19, v25
v_cvt_pk_bf16_f32 v18, v18, v19
v_accvgpr_write_b32 a136, v18
v_accvgpr_read_b32 v18, a137
v_and_b32 v19, 0xffff0000, v18
v_lshlrev_b32 v18, 16, v18
v_mul_f32 v18, v18, v25
v_mul_f32 v19, v19, v25
v_cvt_pk_bf16_f32 v18, v18, v19
v_accvgpr_write_b32 a137, v18
v_accvgpr_read_b32 v18, a138
v_and_b32 v19, 0xffff0000, v18
v_lshlrev_b32 v18, 16, v18
v_mul_f32 v18, v18, v25
v_mul_f32 v19, v19, v25
v_cvt_pk_bf16_f32 v18, v18, v19
v_accvgpr_write_b32 a138, v18
v_accvgpr_read_b32 v18, a139
v_and_b32 v19, 0xffff0000, v18
v_lshlrev_b32 v18, 16, v18
v_mul_f32 v18, v18, v25
v_mul_f32 v19, v19, v25
v_cvt_pk_bf16_f32 v18, v18, v19
v_accvgpr_write_b32 a139, v18
v_accvgpr_read_b32 v18, a140
v_and_b32 v19, 0xffff0000, v18
v_lshlrev_b32 v18, 16, v18
v_mul_f32 v18, v18, v25
v_mul_f32 v19, v19, v25
v_cvt_pk_bf16_f32 v18, v18, v19
v_accvgpr_write_b32 a140, v18
v_accvgpr_read_b32 v18, a141
v_and_b32 v19, 0xffff0000, v18
v_lshlrev_b32 v18, 16, v18
v_mul_f32 v18, v18, v25
v_mul_f32 v19, v19, v25
v_cvt_pk_bf16_f32 v18, v18, v19
v_accvgpr_write_b32 a141, v18
v_accvgpr_read_b32 v18, a142
v_and_b32 v19, 0xffff0000, v18
v_lshlrev_b32 v18, 16, v18
v_mul_f32 v18, v18, v25
v_mul_f32 v19, v19, v25
v_cvt_pk_bf16_f32 v18, v18, v19
v_accvgpr_write_b32 a142, v18
v_accvgpr_read_b32 v18, a143
v_and_b32 v19, 0xffff0000, v18
v_lshlrev_b32 v18, 16, v18
v_mul_f32 v18, v18, v25
v_mul_f32 v19, v19, v25
v_cvt_pk_bf16_f32 v18, v18, v19
v_accvgpr_write_b32 a143, v18
v_accvgpr_read_b32 v18, a152
v_and_b32 v19, 0xffff0000, v18
v_lshlrev_b32 v18, 16, v18
v_mul_f32 v18, v18, v25
v_mul_f32 v19, v19, v25
v_cvt_pk_bf16_f32 v18, v18, v19
v_accvgpr_write_b32 a152, v18
v_accvgpr_read_b32 v18, a153
v_and_b32 v19, 0xffff0000, v18
v_lshlrev_b32 v18, 16, v18
v_mul_f32 v18, v18, v25
v_mul_f32 v19, v19, v25
v_cvt_pk_bf16_f32 v18, v18, v19
v_accvgpr_write_b32 a153, v18
v_accvgpr_read_b32 v18, a154
v_and_b32 v19, 0xffff0000, v18
v_lshlrev_b32 v18, 16, v18
v_mul_f32 v18, v18, v25
v_mul_f32 v19, v19, v25
v_cvt_pk_bf16_f32 v18, v18, v19
v_accvgpr_write_b32 a154, v18
v_accvgpr_read_b32 v18, a155
v_and_b32 v19, 0xffff0000, v18
v_lshlrev_b32 v18, 16, v18
v_mul_f32 v18, v18, v25
v_mul_f32 v19, v19, v25
v_cvt_pk_bf16_f32 v18, v18, v19
v_accvgpr_write_b32 a155, v18
v_accvgpr_read_b32 v18, a156
v_and_b32 v19, 0xffff0000, v18
v_lshlrev_b32 v18, 16, v18
v_mul_f32 v18, v18, v25
v_mul_f32 v19, v19, v25
v_cvt_pk_bf16_f32 v18, v18, v19
v_accvgpr_write_b32 a156, v18
v_accvgpr_read_b32 v18, a157
v_and_b32 v19, 0xffff0000, v18
v_lshlrev_b32 v18, 16, v18
v_mul_f32 v18, v18, v25
v_mul_f32 v19, v19, v25
v_cvt_pk_bf16_f32 v18, v18, v19
v_accvgpr_write_b32 a157, v18
v_accvgpr_read_b32 v18, a158
v_and_b32 v19, 0xffff0000, v18
v_lshlrev_b32 v18, 16, v18
v_mul_f32 v18, v18, v25
v_mul_f32 v19, v19, v25
v_cvt_pk_bf16_f32 v18, v18, v19
v_accvgpr_write_b32 a158, v18
v_accvgpr_read_b32 v18, a159
v_and_b32 v19, 0xffff0000, v18
v_lshlrev_b32 v18, 16, v18
v_mul_f32 v18, v18, v25
v_mul_f32 v19, v19, v25
v_cvt_pk_bf16_f32 v18, v18, v19
v_accvgpr_write_b32 a159, v18
v_accvgpr_read_b32 v18, a168
v_and_b32 v19, 0xffff0000, v18
v_lshlrev_b32 v18, 16, v18
v_mul_f32 v18, v18, v25
v_mul_f32 v19, v19, v25
v_cvt_pk_bf16_f32 v18, v18, v19
v_accvgpr_write_b32 a168, v18
v_accvgpr_read_b32 v18, a169
v_and_b32 v19, 0xffff0000, v18
v_lshlrev_b32 v18, 16, v18
v_mul_f32 v18, v18, v25
v_mul_f32 v19, v19, v25
v_cvt_pk_bf16_f32 v18, v18, v19
v_accvgpr_write_b32 a169, v18
v_accvgpr_read_b32 v18, a170
v_and_b32 v19, 0xffff0000, v18
v_lshlrev_b32 v18, 16, v18
v_mul_f32 v18, v18, v25
v_mul_f32 v19, v19, v25
v_cvt_pk_bf16_f32 v18, v18, v19
v_accvgpr_write_b32 a170, v18
v_accvgpr_read_b32 v18, a171
v_and_b32 v19, 0xffff0000, v18
v_lshlrev_b32 v18, 16, v18
v_mul_f32 v18, v18, v25
v_mul_f32 v19, v19, v25
v_cvt_pk_bf16_f32 v18, v18, v19
v_accvgpr_write_b32 a171, v18
v_accvgpr_read_b32 v18, a172
v_and_b32 v19, 0xffff0000, v18
v_lshlrev_b32 v18, 16, v18
v_mul_f32 v18, v18, v25
v_mul_f32 v19, v19, v25
v_cvt_pk_bf16_f32 v18, v18, v19
v_accvgpr_write_b32 a172, v18
v_accvgpr_read_b32 v18, a173
v_and_b32 v19, 0xffff0000, v18
v_lshlrev_b32 v18, 16, v18
v_mul_f32 v18, v18, v25
v_mul_f32 v19, v19, v25
v_cvt_pk_bf16_f32 v18, v18, v19
v_accvgpr_write_b32 a173, v18
v_accvgpr_read_b32 v18, a174
v_and_b32 v19, 0xffff0000, v18
v_lshlrev_b32 v18, 16, v18
v_mul_f32 v18, v18, v25
v_mul_f32 v19, v19, v25
v_cvt_pk_bf16_f32 v18, v18, v19
v_accvgpr_write_b32 a174, v18
v_accvgpr_read_b32 v18, a175
v_and_b32 v19, 0xffff0000, v18
v_lshlrev_b32 v18, 16, v18
v_mul_f32 v18, v18, v25
v_mul_f32 v19, v19, v25
v_cvt_pk_bf16_f32 v18, v18, v19
v_accvgpr_write_b32 a175, v18
v_accvgpr_read_b32 v18, a184
v_and_b32 v19, 0xffff0000, v18
v_lshlrev_b32 v18, 16, v18
v_mul_f32 v18, v18, v25
v_mul_f32 v19, v19, v25
v_cvt_pk_bf16_f32 v18, v18, v19
v_accvgpr_write_b32 a184, v18
v_accvgpr_read_b32 v18, a185
v_and_b32 v19, 0xffff0000, v18
v_lshlrev_b32 v18, 16, v18
v_mul_f32 v18, v18, v25
v_mul_f32 v19, v19, v25
v_cvt_pk_bf16_f32 v18, v18, v19
v_accvgpr_write_b32 a185, v18
v_accvgpr_read_b32 v18, a186
v_and_b32 v19, 0xffff0000, v18
v_lshlrev_b32 v18, 16, v18
v_mul_f32 v18, v18, v25
v_mul_f32 v19, v19, v25
v_cvt_pk_bf16_f32 v18, v18, v19
v_accvgpr_write_b32 a186, v18
v_accvgpr_read_b32 v18, a187
v_and_b32 v19, 0xffff0000, v18
v_lshlrev_b32 v18, 16, v18
v_mul_f32 v18, v18, v25
v_mul_f32 v19, v19, v25
v_cvt_pk_bf16_f32 v18, v18, v19
v_accvgpr_write_b32 a187, v18
v_accvgpr_read_b32 v18, a188
v_and_b32 v19, 0xffff0000, v18
v_lshlrev_b32 v18, 16, v18
v_mul_f32 v18, v18, v25
v_mul_f32 v19, v19, v25
v_cvt_pk_bf16_f32 v18, v18, v19
v_accvgpr_write_b32 a188, v18
v_accvgpr_read_b32 v18, a189
v_and_b32 v19, 0xffff0000, v18
v_lshlrev_b32 v18, 16, v18
v_mul_f32 v18, v18, v25
v_mul_f32 v19, v19, v25
v_cvt_pk_bf16_f32 v18, v18, v19
v_accvgpr_write_b32 a189, v18
v_accvgpr_read_b32 v18, a190
v_and_b32 v19, 0xffff0000, v18
v_lshlrev_b32 v18, 16, v18
v_mul_f32 v18, v18, v25
v_mul_f32 v19, v19, v25
v_cvt_pk_bf16_f32 v18, v18, v19
v_accvgpr_write_b32 a190, v18
v_accvgpr_read_b32 v18, a191
v_and_b32 v19, 0xffff0000, v18
v_lshlrev_b32 v18, 16, v18
v_mul_f32 v18, v18, v25
v_mul_f32 v19, v19, v25
v_cvt_pk_bf16_f32 v18, v18, v19
v_accvgpr_write_b32 a191, v18
v_accvgpr_read_b32 v18, a200
v_and_b32 v19, 0xffff0000, v18
v_lshlrev_b32 v18, 16, v18
v_mul_f32 v18, v18, v25
v_mul_f32 v19, v19, v25
v_cvt_pk_bf16_f32 v18, v18, v19
v_accvgpr_write_b32 a200, v18
v_accvgpr_read_b32 v18, a201
v_and_b32 v19, 0xffff0000, v18
v_lshlrev_b32 v18, 16, v18
v_mul_f32 v18, v18, v25
v_mul_f32 v19, v19, v25
v_cvt_pk_bf16_f32 v18, v18, v19
v_accvgpr_write_b32 a201, v18
v_accvgpr_read_b32 v18, a202
v_and_b32 v19, 0xffff0000, v18
v_lshlrev_b32 v18, 16, v18
v_mul_f32 v18, v18, v25
v_mul_f32 v19, v19, v25
v_cvt_pk_bf16_f32 v18, v18, v19
v_accvgpr_write_b32 a202, v18
v_accvgpr_read_b32 v18, a203
v_and_b32 v19, 0xffff0000, v18
v_lshlrev_b32 v18, 16, v18
v_mul_f32 v18, v18, v25
v_mul_f32 v19, v19, v25
v_cvt_pk_bf16_f32 v18, v18, v19
v_accvgpr_write_b32 a203, v18
v_accvgpr_read_b32 v18, a204
v_and_b32 v19, 0xffff0000, v18
v_lshlrev_b32 v18, 16, v18
v_mul_f32 v18, v18, v25
v_mul_f32 v19, v19, v25
v_cvt_pk_bf16_f32 v18, v18, v19
v_accvgpr_write_b32 a204, v18
v_accvgpr_read_b32 v18, a205
v_and_b32 v19, 0xffff0000, v18
v_lshlrev_b32 v18, 16, v18
v_mul_f32 v18, v18, v25
v_mul_f32 v19, v19, v25
v_cvt_pk_bf16_f32 v18, v18, v19
v_accvgpr_write_b32 a205, v18
v_accvgpr_read_b32 v18, a206
v_and_b32 v19, 0xffff0000, v18
v_lshlrev_b32 v18, 16, v18
v_mul_f32 v18, v18, v25
v_mul_f32 v19, v19, v25
v_cvt_pk_bf16_f32 v18, v18, v19
v_accvgpr_write_b32 a206, v18
v_accvgpr_read_b32 v18, a207
v_and_b32 v19, 0xffff0000, v18
v_lshlrev_b32 v18, 16, v18
v_mul_f32 v18, v18, v25
v_mul_f32 v19, v19, v25
v_cvt_pk_bf16_f32 v18, v18, v19
v_accvgpr_write_b32 a207, v18
v_accvgpr_read_b32 v18, a216
v_and_b32 v19, 0xffff0000, v18
v_lshlrev_b32 v18, 16, v18
v_mul_f32 v18, v18, v25
v_mul_f32 v19, v19, v25
v_cvt_pk_bf16_f32 v18, v18, v19
v_accvgpr_write_b32 a216, v18
v_accvgpr_read_b32 v18, a217
v_and_b32 v19, 0xffff0000, v18
v_lshlrev_b32 v18, 16, v18
v_mul_f32 v18, v18, v25
v_mul_f32 v19, v19, v25
v_cvt_pk_bf16_f32 v18, v18, v19
v_accvgpr_write_b32 a217, v18
v_accvgpr_read_b32 v18, a218
v_and_b32 v19, 0xffff0000, v18
v_lshlrev_b32 v18, 16, v18
v_mul_f32 v18, v18, v25
v_mul_f32 v19, v19, v25
v_cvt_pk_bf16_f32 v18, v18, v19
v_accvgpr_write_b32 a218, v18
v_accvgpr_read_b32 v18, a219
v_and_b32 v19, 0xffff0000, v18
v_lshlrev_b32 v18, 16, v18
v_mul_f32 v18, v18, v25
v_mul_f32 v19, v19, v25
v_cvt_pk_bf16_f32 v18, v18, v19
v_accvgpr_write_b32 a219, v18
v_accvgpr_read_b32 v18, a220
v_and_b32 v19, 0xffff0000, v18
v_lshlrev_b32 v18, 16, v18
v_mul_f32 v18, v18, v25
v_mul_f32 v19, v19, v25
v_cvt_pk_bf16_f32 v18, v18, v19
v_accvgpr_write_b32 a220, v18
v_accvgpr_read_b32 v18, a221
v_and_b32 v19, 0xffff0000, v18
v_lshlrev_b32 v18, 16, v18
v_mul_f32 v18, v18, v25
v_mul_f32 v19, v19, v25
v_cvt_pk_bf16_f32 v18, v18, v19
v_accvgpr_write_b32 a221, v18
v_accvgpr_read_b32 v18, a222
v_and_b32 v19, 0xffff0000, v18
v_lshlrev_b32 v18, 16, v18
v_mul_f32 v18, v18, v25
v_mul_f32 v19, v19, v25
v_cvt_pk_bf16_f32 v18, v18, v19
v_accvgpr_write_b32 a222, v18
v_accvgpr_read_b32 v18, a223
v_and_b32 v19, 0xffff0000, v18
v_lshlrev_b32 v18, 16, v18
v_mul_f32 v18, v18, v25
v_mul_f32 v19, v19, v25
v_cvt_pk_bf16_f32 v18, v18, v19
v_accvgpr_write_b32 a223, v18
v_accvgpr_read_b32 v18, a232
v_and_b32 v19, 0xffff0000, v18
v_lshlrev_b32 v18, 16, v18
v_mul_f32 v18, v18, v25
v_mul_f32 v19, v19, v25
v_cvt_pk_bf16_f32 v18, v18, v19
v_accvgpr_write_b32 a232, v18
v_accvgpr_read_b32 v18, a233
v_and_b32 v19, 0xffff0000, v18
v_lshlrev_b32 v18, 16, v18
v_mul_f32 v18, v18, v25
v_mul_f32 v19, v19, v25
v_cvt_pk_bf16_f32 v18, v18, v19
v_accvgpr_write_b32 a233, v18
v_accvgpr_read_b32 v18, a234
v_and_b32 v19, 0xffff0000, v18
v_lshlrev_b32 v18, 16, v18
v_mul_f32 v18, v18, v25
v_mul_f32 v19, v19, v25
v_cvt_pk_bf16_f32 v18, v18, v19
v_accvgpr_write_b32 a234, v18
v_accvgpr_read_b32 v18, a235
v_and_b32 v19, 0xffff0000, v18
v_lshlrev_b32 v18, 16, v18
v_mul_f32 v18, v18, v25
v_mul_f32 v19, v19, v25
v_cvt_pk_bf16_f32 v18, v18, v19
v_accvgpr_write_b32 a235, v18
v_accvgpr_read_b32 v18, a236
v_and_b32 v19, 0xffff0000, v18
v_lshlrev_b32 v18, 16, v18
v_mul_f32 v18, v18, v25
v_mul_f32 v19, v19, v25
v_cvt_pk_bf16_f32 v18, v18, v19
v_accvgpr_write_b32 a236, v18
v_accvgpr_read_b32 v18, a237
v_and_b32 v19, 0xffff0000, v18
v_lshlrev_b32 v18, 16, v18
v_mul_f32 v18, v18, v25
v_mul_f32 v19, v19, v25
v_cvt_pk_bf16_f32 v18, v18, v19
v_accvgpr_write_b32 a237, v18
v_accvgpr_read_b32 v18, a238
v_and_b32 v19, 0xffff0000, v18
v_lshlrev_b32 v18, 16, v18
v_mul_f32 v18, v18, v25
v_mul_f32 v19, v19, v25
v_cvt_pk_bf16_f32 v18, v18, v19
v_accvgpr_write_b32 a238, v18
v_accvgpr_read_b32 v18, a239
v_and_b32 v19, 0xffff0000, v18
v_lshlrev_b32 v18, 16, v18
v_mul_f32 v18, v18, v25
v_mul_f32 v19, v19, v25
v_cvt_pk_bf16_f32 v18, v18, v19
v_accvgpr_write_b32 a239, v18
v_exp_f32 v18, v176
v_exp_f32 v19, v177
s_nop 0
v_cvt_pk_bf16_f32 v176, v18, v19
v_add_f32 v17, v18, v19
v_exp_f32 v20, v178
v_exp_f32 v21, v179
v_add_f32 v17, v17, v20
v_cvt_pk_bf16_f32 v177, v20, v21
v_add_f32 v17, v17, v21
v_exp_f32 v18, v180
v_exp_f32 v19, v181
v_add_f32 v17, v17, v18
v_cvt_pk_bf16_f32 v178, v18, v19
v_add_f32 v17, v17, v19
v_exp_f32 v20, v182
v_exp_f32 v21, v183
v_add_f32 v17, v17, v20
v_cvt_pk_bf16_f32 v179, v20, v21
v_add_f32 v17, v17, v21
v_exp_f32 v18, v184
v_exp_f32 v19, v185
v_add_f32 v17, v17, v18
v_cvt_pk_bf16_f32 v180, v18, v19
v_add_f32 v17, v17, v19
v_exp_f32 v20, v186
v_exp_f32 v21, v187
v_add_f32 v17, v17, v20
v_cvt_pk_bf16_f32 v181, v20, v21
v_add_f32 v17, v17, v21
v_exp_f32 v18, v188
v_exp_f32 v19, v189
v_add_f32 v17, v17, v18
v_cvt_pk_bf16_f32 v182, v18, v19
v_add_f32 v17, v17, v19
v_exp_f32 v20, v190
v_exp_f32 v21, v191
v_add_f32 v17, v17, v20
v_cvt_pk_bf16_f32 v183, v20, v21
v_add_f32 v17, v17, v21
s_cmp_eq_u32 s55, 2
s_cbranch_scc0 RN2
v_accvgpr_write_b32 a32, v160
v_accvgpr_write_b32 a33, v161
v_accvgpr_write_b32 a34, v162
v_accvgpr_write_b32 a35, v163
v_accvgpr_write_b32 a36, v164
v_accvgpr_write_b32 a37, v165
v_accvgpr_write_b32 a38, v166
v_accvgpr_write_b32 a39, v167
v_accvgpr_write_b32 a40, v176
v_accvgpr_write_b32 a41, v177
v_accvgpr_write_b32 a42, v178
v_accvgpr_write_b32 a43, v179
v_accvgpr_write_b32 a44, v180
v_accvgpr_write_b32 a45, v181
v_accvgpr_write_b32 a46, v182
v_accvgpr_write_b32 a47, v183
s_nop 3
s_branch RET2
RN2:
s_cmp_eq_u32 s55, 4
s_cbranch_scc0 RN4
v_accvgpr_write_b32 a64, v160
v_accvgpr_write_b32 a65, v161
v_accvgpr_write_b32 a66, v162
v_accvgpr_write_b32 a67, v163
v_accvgpr_write_b32 a68, v164
v_accvgpr_write_b32 a69, v165
v_accvgpr_write_b32 a70, v166
v_accvgpr_write_b32 a71, v167
v_accvgpr_write_b32 a72, v176
v_accvgpr_write_b32 a73, v177
v_accvgpr_write_b32 a74, v178
v_accvgpr_write_b32 a75, v179
v_accvgpr_write_b32 a76, v180
v_accvgpr_write_b32 a77, v181
v_accvgpr_write_b32 a78, v182
v_accvgpr_write_b32 a79, v183
s_nop 3
s_branch RET4
RN4:
s_cmp_eq_u32 s55, 6
s_cbranch_scc0 RN6
v_accvgpr_write_b32 a96, v160
v_accvgpr_write_b32 a97, v161
v_accvgpr_write_b32 a98, v162
v_accvgpr_write_b32 a99, v163
v_accvgpr_write_b32 a100, v164
v_accvgpr_write_b32 a101, v165
v_accvgpr_write_b32 a102, v166
v_accvgpr_write_b32 a103, v167
v_accvgpr_write_b32 a104, v176
v_accvgpr_write_b32 a105, v177
v_accvgpr_write_b32 a106, v178
v_accvgpr_write_b32 a107, v179
v_accvgpr_write_b32 a108, v180
v_accvgpr_write_b32 a109, v181
v_accvgpr_write_b32 a110, v182
v_accvgpr_write_b32 a111, v183
s_nop 3
s_branch RET6
RN6:
s_cmp_eq_u32 s55, 8
s_cbranch_scc0 RN8
v_accvgpr_write_b32 a128, v160
v_accvgpr_write_b32 a129, v161
v_accvgpr_write_b32 a130, v162
v_accvgpr_write_b32 a131, v163
v_accvgpr_write_b32 a132, v164
v_accvgpr_write_b32 a133, v165
v_accvgpr_write_b32 a134, v166
v_accvgpr_write_b32 a135, v167
v_accvgpr_write_b32 a136, v176
v_accvgpr_write_b32 a137, v177
v_accvgpr_write_b32 a138, v178
v_accvgpr_write_b32 a139, v179
v_accvgpr_write_b32 a140, v180
v_accvgpr_write_b32 a141, v181
v_accvgpr_write_b32 a142, v182
v_accvgpr_write_b32 a143, v183
s_nop 3
s_branch RET8
RN8:
s_cmp_eq_u32 s55, 10
s_cbranch_scc0 RN10
v_accvgpr_write_b32 a160, v160
v_accvgpr_write_b32 a161, v161
v_accvgpr_write_b32 a162, v162
v_accvgpr_write_b32 a163, v163
v_accvgpr_write_b32 a164, v164
v_accvgpr_write_b32 a165, v165
v_accvgpr_write_b32 a166, v166
v_accvgpr_write_b32 a167, v167
v_accvgpr_write_b32 a168, v176
v_accvgpr_write_b32 a169, v177
v_accvgpr_write_b32 a170, v178
v_accvgpr_write_b32 a171, v179
v_accvgpr_write_b32 a172, v180
v_accvgpr_write_b32 a173, v181
v_accvgpr_write_b32 a174, v182
v_accvgpr_write_b32 a175, v183
s_nop 3
s_branch RET10
RN10:
s_cmp_eq_u32 s55, 12
s_cbranch_scc0 RN12
v_accvgpr_write_b32 a192, v160
v_accvgpr_write_b32 a193, v161
v_accvgpr_write_b32 a194, v162
v_accvgpr_write_b32 a195, v163
v_accvgpr_write_b32 a196, v164
v_accvgpr_write_b32 a197, v165
v_accvgpr_write_b32 a198, v166
v_accvgpr_write_b32 a199, v167
v_accvgpr_write_b32 a200, v176
v_accvgpr_write_b32 a201, v177
v_accvgpr_write_b32 a202, v178
v_accvgpr_write_b32 a203, v179
v_accvgpr_write_b32 a204, v180
v_accvgpr_write_b32 a205, v181
v_accvgpr_write_b32 a206, v182
v_accvgpr_write_b32 a207, v183
s_nop 3
s_branch RET12
RN12:
v_accvgpr_write_b32 a224, v160
v_accvgpr_write_b32 a225, v161
v_accvgpr_write_b32 a226, v162
v_accvgpr_write_b32 a227, v163
v_accvgpr_write_b32 a228, v164
v_accvgpr_write_b32 a229, v165
v_accvgpr_write_b32 a230, v166
v_accvgpr_write_b32 a231, v167
v_accvgpr_write_b32 a232, v176
v_accvgpr_write_b32 a233, v177
v_accvgpr_write_b32 a234, v178
v_accvgpr_write_b32 a235, v179
v_accvgpr_write_b32 a236, v180
v_accvgpr_write_b32 a237, v181
v_accvgpr_write_b32 a238, v182
v_accvgpr_write_b32 a239, v183
s_nop 3
s_branch RET14
RARE1:
s_nop 15
v_max3_f32 v22, v192, v193, v194
v_max3_f32 v22, v22, v195, v196
v_max3_f32 v22, v22, v197, v198
v_max3_f32 v22, v22, v199, v200
v_max3_f32 v22, v22, v201, v202
v_max3_f32 v22, v22, v203, v204
v_max3_f32 v22, v22, v205, v206
v_max_f32 v22, v22, v207
v_mov_b32 v23, v22
s_nop 1
v_permlane32_swap_b32 v22, v23
v_max_f32 v22, v22, v23
v_max_f32 v22, 0, v22
v_ceil_f32 v22, v22
v_sub_f32 v23, 0, v22
v_exp_f32 v24, v23
v_sub_f32 v160, v160, v22
v_sub_f32 v161, v161, v22
v_sub_f32 v162, v162, v22
v_sub_f32 v163, v163, v22
v_sub_f32 v164, v164, v22
v_sub_f32 v165, v165, v22
v_sub_f32 v166, v166, v22
v_sub_f32 v167, v167, v22
v_sub_f32 v168, v168, v22
v_sub_f32 v169, v169, v22
v_sub_f32 v170, v170, v22
v_sub_f32 v171, v171, v22
v_sub_f32 v172, v172, v22
v_sub_f32 v173, v173, v22
v_sub_f32 v174, v174, v22
v_sub_f32 v175, v175, v22
v_sub_f32 v192, v192, v22
v_sub_f32 v193, v193, v22
v_sub_f32 v194, v194, v22
v_sub_f32 v195, v195, v22
v_sub_f32 v196, v196, v22
v_sub_f32 v197, v197, v22
v_sub_f32 v198, v198, v22
v_sub_f32 v199, v199, v22
v_sub_f32 v200, v200, v22
v_sub_f32 v201, v201, v22
v_sub_f32 v202, v202, v22
v_sub_f32 v203, v203, v22
v_sub_f32 v204, v204, v22
v_sub_f32 v205, v205, v22
v_sub_f32 v206, v206, v22
v_sub_f32 v207, v207, v22
v_sub_f32 v32, v32, v22
v_sub_f32 v33, v33, v22
v_sub_f32 v34, v34, v22
v_sub_f32 v35, v35, v22
v_sub_f32 v36, v36, v22
v_sub_f32 v37, v37, v22
v_sub_f32 v38, v38, v22
v_sub_f32 v39, v39, v22
v_sub_f32 v40, v40, v22
v_sub_f32 v41, v41, v22
v_sub_f32 v42, v42, v22
v_sub_f32 v43, v43, v22
v_sub_f32 v44, v44, v22
v_sub_f32 v45, v45, v22
v_sub_f32 v46, v46, v22
v_sub_f32 v47, v47, v22
v_mul_f32 v14, v14, v24
v_accvgpr_read_b32 v18, a0
v_and_b32 v19, 0xffff0000, v18
v_lshlrev_b32 v18, 16, v18
v_mul_f32 v18, v18, v24
v_mul_f32 v19, v19, v24
v_cvt_pk_bf16_f32 v18, v18, v19
v_accvgpr_write_b32 a0, v18
v_accvgpr_read_b32 v18, a1
v_and_b32 v19, 0xffff0000, v18
v_lshlrev_b32 v18, 16, v18
v_mul_f32 v18, v18, v24
v_mul_f32 v19, v19, v24
v_cvt_pk_bf16_f32 v18, v18, v19
v_accvgpr_write_b32 a1, v18
v_accvgpr_read_b32 v18, a2
v_and_b32 v19, 0xffff0000, v18
v_lshlrev_b32 v18, 16, v18
v_mul_f32 v18, v18, v24
v_mul_f32 v19, v19, v24
v_cvt_pk_bf16_f32 v18, v18, v19
v_accvgpr_write_b32 a2, v18
v_accvgpr_read_b32 v18, a3
v_and_b32 v19, 0xffff0000, v18
v_lshlrev_b32 v18, 16, v18
v_mul_f32 v18, v18, v24
v_mul_f32 v19, v19, v24
v_cvt_pk_bf16_f32 v18, v18, v19
v_accvgpr_write_b32 a3, v18
v_accvgpr_read_b32 v18, a4
v_and_b32 v19, 0xffff0000, v18
v_lshlrev_b32 v18, 16, v18
v_mul_f32 v18, v18, v24
v_mul_f32 v19, v19, v24
v_cvt_pk_bf16_f32 v18, v18, v19
v_accvgpr_write_b32 a4, v18
v_accvgpr_read_b32 v18, a5
v_and_b32 v19, 0xffff0000, v18
v_lshlrev_b32 v18, 16, v18
v_mul_f32 v18, v18, v24
v_mul_f32 v19, v19, v24
v_cvt_pk_bf16_f32 v18, v18, v19
v_accvgpr_write_b32 a5, v18
v_accvgpr_read_b32 v18, a6
v_and_b32 v19, 0xffff0000, v18
v_lshlrev_b32 v18, 16, v18
v_mul_f32 v18, v18, v24
v_mul_f32 v19, v19, v24
v_cvt_pk_bf16_f32 v18, v18, v19
v_accvgpr_write_b32 a6, v18
v_accvgpr_read_b32 v18, a7
v_and_b32 v19, 0xffff0000, v18
v_lshlrev_b32 v18, 16, v18
v_mul_f32 v18, v18, v24
v_mul_f32 v19, v19, v24
v_cvt_pk_bf16_f32 v18, v18, v19
v_accvgpr_write_b32 a7, v18
v_accvgpr_read_b32 v18, a16
v_and_b32 v19, 0xffff0000, v18
v_lshlrev_b32 v18, 16, v18
v_mul_f32 v18, v18, v24
v_mul_f32 v19, v19, v24
v_cvt_pk_bf16_f32 v18, v18, v19
v_accvgpr_write_b32 a16, v18
v_accvgpr_read_b32 v18, a17
v_and_b32 v19, 0xffff0000, v18
v_lshlrev_b32 v18, 16, v18
v_mul_f32 v18, v18, v24
v_mul_f32 v19, v19, v24
v_cvt_pk_bf16_f32 v18, v18, v19
v_accvgpr_write_b32 a17, v18
v_accvgpr_read_b32 v18, a18
v_and_b32 v19, 0xffff0000, v18
v_lshlrev_b32 v18, 16, v18
v_mul_f32 v18, v18, v24
v_mul_f32 v19, v19, v24
v_cvt_pk_bf16_f32 v18, v18, v19
v_accvgpr_write_b32 a18, v18
v_accvgpr_read_b32 v18, a19
v_and_b32 v19, 0xffff0000, v18
v_lshlrev_b32 v18, 16, v18
v_mul_f32 v18, v18, v24
v_mul_f32 v19, v19, v24
v_cvt_pk_bf16_f32 v18, v18, v19
v_accvgpr_write_b32 a19, v18
v_accvgpr_read_b32 v18, a20
v_and_b32 v19, 0xffff0000, v18
v_lshlrev_b32 v18, 16, v18
v_mul_f32 v18, v18, v24
v_mul_f32 v19, v19, v24
v_cvt_pk_bf16_f32 v18, v18, v19
v_accvgpr_write_b32 a20, v18
v_accvgpr_read_b32 v18, a21
v_and_b32 v19, 0xffff0000, v18
v_lshlrev_b32 v18, 16, v18
v_mul_f32 v18, v18, v24
v_mul_f32 v19, v19, v24
v_cvt_pk_bf16_f32 v18, v18, v19
v_accvgpr_write_b32 a21, v18
v_accvgpr_read_b32 v18, a22
v_and_b32 v19, 0xffff0000, v18
v_lshlrev_b32 v18, 16, v18
v_mul_f32 v18, v18, v24
v_mul_f32 v19, v19, v24
v_cvt_pk_bf16_f32 v18, v18, v19
v_accvgpr_write_b32 a22, v18
v_accvgpr_read_b32 v18, a23
v_and_b32 v19, 0xffff0000, v18
v_lshlrev_b32 v18, 16, v18
v_mul_f32 v18, v18, v24
v_mul_f32 v19, v19, v24
v_cvt_pk_bf16_f32 v18, v18, v19
v_accvgpr_write_b32 a23, v18
v_accvgpr_read_b32 v18, a32
v_and_b32 v19, 0xffff0000, v18
v_lshlrev_b32 v18, 16, v18
v_mul_f32 v18, v18, v24
v_mul_f32 v19, v19, v24
v_cvt_pk_bf16_f32 v18, v18, v19
v_accvgpr_write_b32 a32, v18
v_accvgpr_read_b32 v18, a33
v_and_b32 v19, 0xffff0000, v18
v_lshlrev_b32 v18, 16, v18
v_mul_f32 v18, v18, v24
v_mul_f32 v19, v19, v24
v_cvt_pk_bf16_f32 v18, v18, v19
v_accvgpr_write_b32 a33, v18
v_accvgpr_read_b32 v18, a34
v_and_b32 v19, 0xffff0000, v18
v_lshlrev_b32 v18, 16, v18
v_mul_f32 v18, v18, v24
v_mul_f32 v19, v19, v24
v_cvt_pk_bf16_f32 v18, v18, v19
v_accvgpr_write_b32 a34, v18
v_accvgpr_read_b32 v18, a35
v_and_b32 v19, 0xffff0000, v18
v_lshlrev_b32 v18, 16, v18
v_mul_f32 v18, v18, v24
v_mul_f32 v19, v19, v24
v_cvt_pk_bf16_f32 v18, v18, v19
v_accvgpr_write_b32 a35, v18
v_accvgpr_read_b32 v18, a36
v_and_b32 v19, 0xffff0000, v18
v_lshlrev_b32 v18, 16, v18
v_mul_f32 v18, v18, v24
v_mul_f32 v19, v19, v24
v_cvt_pk_bf16_f32 v18, v18, v19
v_accvgpr_write_b32 a36, v18
v_accvgpr_read_b32 v18, a37
v_and_b32 v19, 0xffff0000, v18
v_lshlrev_b32 v18, 16, v18
v_mul_f32 v18, v18, v24
v_mul_f32 v19, v19, v24
v_cvt_pk_bf16_f32 v18, v18, v19
v_accvgpr_write_b32 a37, v18
v_accvgpr_read_b32 v18, a38
v_and_b32 v19, 0xffff0000, v18
v_lshlrev_b32 v18, 16, v18
v_mul_f32 v18, v18, v24
v_mul_f32 v19, v19, v24
v_cvt_pk_bf16_f32 v18, v18, v19
v_accvgpr_write_b32 a38, v18
v_accvgpr_read_b32 v18, a39
v_and_b32 v19, 0xffff0000, v18
v_lshlrev_b32 v18, 16, v18
v_mul_f32 v18, v18, v24
v_mul_f32 v19, v19, v24
v_cvt_pk_bf16_f32 v18, v18, v19
v_accvgpr_write_b32 a39, v18
v_accvgpr_read_b32 v18, a48
v_and_b32 v19, 0xffff0000, v18
v_lshlrev_b32 v18, 16, v18
v_mul_f32 v18, v18, v24
v_mul_f32 v19, v19, v24
v_cvt_pk_bf16_f32 v18, v18, v19
v_accvgpr_write_b32 a48, v18
v_accvgpr_read_b32 v18, a49
v_and_b32 v19, 0xffff0000, v18
v_lshlrev_b32 v18, 16, v18
v_mul_f32 v18, v18, v24
v_mul_f32 v19, v19, v24
v_cvt_pk_bf16_f32 v18, v18, v19
v_accvgpr_write_b32 a49, v18
v_accvgpr_read_b32 v18, a50
v_and_b32 v19, 0xffff0000, v18
v_lshlrev_b32 v18, 16, v18
v_mul_f32 v18, v18, v24
v_mul_f32 v19, v19, v24
v_cvt_pk_bf16_f32 v18, v18, v19
v_accvgpr_write_b32 a50, v18
v_accvgpr_read_b32 v18, a51
v_and_b32 v19, 0xffff0000, v18
v_lshlrev_b32 v18, 16, v18
v_mul_f32 v18, v18, v24
v_mul_f32 v19, v19, v24
v_cvt_pk_bf16_f32 v18, v18, v19
v_accvgpr_write_b32 a51, v18
v_accvgpr_read_b32 v18, a52
v_and_b32 v19, 0xffff0000, v18
v_lshlrev_b32 v18, 16, v18
v_mul_f32 v18, v18, v24
v_mul_f32 v19, v19, v24
v_cvt_pk_bf16_f32 v18, v18, v19
v_accvgpr_write_b32 a52, v18
v_accvgpr_read_b32 v18, a53
v_and_b32 v19, 0xffff0000, v18
v_lshlrev_b32 v18, 16, v18
v_mul_f32 v18, v18, v24
v_mul_f32 v19, v19, v24
v_cvt_pk_bf16_f32 v18, v18, v19
v_accvgpr_write_b32 a53, v18
v_accvgpr_read_b32 v18, a54
v_and_b32 v19, 0xffff0000, v18
v_lshlrev_b32 v18, 16, v18
v_mul_f32 v18, v18, v24
v_mul_f32 v19, v19, v24
v_cvt_pk_bf16_f32 v18, v18, v19
v_accvgpr_write_b32 a54, v18
v_accvgpr_read_b32 v18, a55
v_and_b32 v19, 0xffff0000, v18
v_lshlrev_b32 v18, 16, v18
v_mul_f32 v18, v18, v24
v_mul_f32 v19, v19, v24
v_cvt_pk_bf16_f32 v18, v18, v19
v_accvgpr_write_b32 a55, v18
v_accvgpr_read_b32 v18, a64
v_and_b32 v19, 0xffff0000, v18
v_lshlrev_b32 v18, 16, v18
v_mul_f32 v18, v18, v24
v_mul_f32 v19, v19, v24
v_cvt_pk_bf16_f32 v18, v18, v19
v_accvgpr_write_b32 a64, v18
v_accvgpr_read_b32 v18, a65
v_and_b32 v19, 0xffff0000, v18
v_lshlrev_b32 v18, 16, v18
v_mul_f32 v18, v18, v24
v_mul_f32 v19, v19, v24
v_cvt_pk_bf16_f32 v18, v18, v19
v_accvgpr_write_b32 a65, v18
v_accvgpr_read_b32 v18, a66
v_and_b32 v19, 0xffff0000, v18
v_lshlrev_b32 v18, 16, v18
v_mul_f32 v18, v18, v24
v_mul_f32 v19, v19, v24
v_cvt_pk_bf16_f32 v18, v18, v19
v_accvgpr_write_b32 a66, v18
v_accvgpr_read_b32 v18, a67
v_and_b32 v19, 0xffff0000, v18
v_lshlrev_b32 v18, 16, v18
v_mul_f32 v18, v18, v24
v_mul_f32 v19, v19, v24
v_cvt_pk_bf16_f32 v18, v18, v19
v_accvgpr_write_b32 a67, v18
v_accvgpr_read_b32 v18, a68
v_and_b32 v19, 0xffff0000, v18
v_lshlrev_b32 v18, 16, v18
v_mul_f32 v18, v18, v24
v_mul_f32 v19, v19, v24
v_cvt_pk_bf16_f32 v18, v18, v19
v_accvgpr_write_b32 a68, v18
v_accvgpr_read_b32 v18, a69
v_and_b32 v19, 0xffff0000, v18
v_lshlrev_b32 v18, 16, v18
v_mul_f32 v18, v18, v24
v_mul_f32 v19, v19, v24
v_cvt_pk_bf16_f32 v18, v18, v19
v_accvgpr_write_b32 a69, v18
v_accvgpr_read_b32 v18, a70
v_and_b32 v19, 0xffff0000, v18
v_lshlrev_b32 v18, 16, v18
v_mul_f32 v18, v18, v24
v_mul_f32 v19, v19, v24
v_cvt_pk_bf16_f32 v18, v18, v19
v_accvgpr_write_b32 a70, v18
v_accvgpr_read_b32 v18, a71
v_and_b32 v19, 0xffff0000, v18
v_lshlrev_b32 v18, 16, v18
v_mul_f32 v18, v18, v24
v_mul_f32 v19, v19, v24
v_cvt_pk_bf16_f32 v18, v18, v19
v_accvgpr_write_b32 a71, v18
v_accvgpr_read_b32 v18, a80
v_and_b32 v19, 0xffff0000, v18
v_lshlrev_b32 v18, 16, v18
v_mul_f32 v18, v18, v24
v_mul_f32 v19, v19, v24
v_cvt_pk_bf16_f32 v18, v18, v19
v_accvgpr_write_b32 a80, v18
v_accvgpr_read_b32 v18, a81
v_and_b32 v19, 0xffff0000, v18
v_lshlrev_b32 v18, 16, v18
v_mul_f32 v18, v18, v24
v_mul_f32 v19, v19, v24
v_cvt_pk_bf16_f32 v18, v18, v19
v_accvgpr_write_b32 a81, v18
v_accvgpr_read_b32 v18, a82
v_and_b32 v19, 0xffff0000, v18
v_lshlrev_b32 v18, 16, v18
v_mul_f32 v18, v18, v24
v_mul_f32 v19, v19, v24
v_cvt_pk_bf16_f32 v18, v18, v19
v_accvgpr_write_b32 a82, v18
v_accvgpr_read_b32 v18, a83
v_and_b32 v19, 0xffff0000, v18
v_lshlrev_b32 v18, 16, v18
v_mul_f32 v18, v18, v24
v_mul_f32 v19, v19, v24
v_cvt_pk_bf16_f32 v18, v18, v19
v_accvgpr_write_b32 a83, v18
v_accvgpr_read_b32 v18, a84
v_and_b32 v19, 0xffff0000, v18
v_lshlrev_b32 v18, 16, v18
v_mul_f32 v18, v18, v24
v_mul_f32 v19, v19, v24
v_cvt_pk_bf16_f32 v18, v18, v19
v_accvgpr_write_b32 a84, v18
v_accvgpr_read_b32 v18, a85
v_and_b32 v19, 0xffff0000, v18
v_lshlrev_b32 v18, 16, v18
v_mul_f32 v18, v18, v24
v_mul_f32 v19, v19, v24
v_cvt_pk_bf16_f32 v18, v18, v19
v_accvgpr_write_b32 a85, v18
v_accvgpr_read_b32 v18, a86
v_and_b32 v19, 0xffff0000, v18
v_lshlrev_b32 v18, 16, v18
v_mul_f32 v18, v18, v24
v_mul_f32 v19, v19, v24
v_cvt_pk_bf16_f32 v18, v18, v19
v_accvgpr_write_b32 a86, v18
v_accvgpr_read_b32 v18, a87
v_and_b32 v19, 0xffff0000, v18
v_lshlrev_b32 v18, 16, v18
v_mul_f32 v18, v18, v24
v_mul_f32 v19, v19, v24
v_cvt_pk_bf16_f32 v18, v18, v19
v_accvgpr_write_b32 a87, v18
v_accvgpr_read_b32 v18, a96
v_and_b32 v19, 0xffff0000, v18
v_lshlrev_b32 v18, 16, v18
v_mul_f32 v18, v18, v24
v_mul_f32 v19, v19, v24
v_cvt_pk_bf16_f32 v18, v18, v19
v_accvgpr_write_b32 a96, v18
v_accvgpr_read_b32 v18, a97
v_and_b32 v19, 0xffff0000, v18
v_lshlrev_b32 v18, 16, v18
v_mul_f32 v18, v18, v24
v_mul_f32 v19, v19, v24
v_cvt_pk_bf16_f32 v18, v18, v19
v_accvgpr_write_b32 a97, v18
v_accvgpr_read_b32 v18, a98
v_and_b32 v19, 0xffff0000, v18
v_lshlrev_b32 v18, 16, v18
v_mul_f32 v18, v18, v24
v_mul_f32 v19, v19, v24
v_cvt_pk_bf16_f32 v18, v18, v19
v_accvgpr_write_b32 a98, v18
v_accvgpr_read_b32 v18, a99
v_and_b32 v19, 0xffff0000, v18
v_lshlrev_b32 v18, 16, v18
v_mul_f32 v18, v18, v24
v_mul_f32 v19, v19, v24
v_cvt_pk_bf16_f32 v18, v18, v19
v_accvgpr_write_b32 a99, v18
v_accvgpr_read_b32 v18, a100
v_and_b32 v19, 0xffff0000, v18
v_lshlrev_b32 v18, 16, v18
v_mul_f32 v18, v18, v24
v_mul_f32 v19, v19, v24
v_cvt_pk_bf16_f32 v18, v18, v19
v_accvgpr_write_b32 a100, v18
v_accvgpr_read_b32 v18, a101
v_and_b32 v19, 0xffff0000, v18
v_lshlrev_b32 v18, 16, v18
v_mul_f32 v18, v18, v24
v_mul_f32 v19, v19, v24
v_cvt_pk_bf16_f32 v18, v18, v19
v_accvgpr_write_b32 a101, v18
v_accvgpr_read_b32 v18, a102
v_and_b32 v19, 0xffff0000, v18
v_lshlrev_b32 v18, 16, v18
v_mul_f32 v18, v18, v24
v_mul_f32 v19, v19, v24
v_cvt_pk_bf16_f32 v18, v18, v19
v_accvgpr_write_b32 a102, v18
v_accvgpr_read_b32 v18, a103
v_and_b32 v19, 0xffff0000, v18
v_lshlrev_b32 v18, 16, v18
v_mul_f32 v18, v18, v24
v_mul_f32 v19, v19, v24
v_cvt_pk_bf16_f32 v18, v18, v19
v_accvgpr_write_b32 a103, v18
v_accvgpr_read_b32 v18, a112
v_and_b32 v19, 0xffff0000, v18
v_lshlrev_b32 v18, 16, v18
v_mul_f32 v18, v18, v24
v_mul_f32 v19, v19, v24
v_cvt_pk_bf16_f32 v18, v18, v19
v_accvgpr_write_b32 a112, v18
v_accvgpr_read_b32 v18, a113
v_and_b32 v19, 0xffff0000, v18
v_lshlrev_b32 v18, 16, v18
v_mul_f32 v18, v18, v24
v_mul_f32 v19, v19, v24
v_cvt_pk_bf16_f32 v18, v18, v19
v_accvgpr_write_b32 a113, v18
v_accvgpr_read_b32 v18, a114
v_and_b32 v19, 0xffff0000, v18
v_lshlrev_b32 v18, 16, v18
v_mul_f32 v18, v18, v24
v_mul_f32 v19, v19, v24
v_cvt_pk_bf16_f32 v18, v18, v19
v_accvgpr_write_b32 a114, v18
v_accvgpr_read_b32 v18, a115
v_and_b32 v19, 0xffff0000, v18
v_lshlrev_b32 v18, 16, v18
v_mul_f32 v18, v18, v24
v_mul_f32 v19, v19, v24
v_cvt_pk_bf16_f32 v18, v18, v19
v_accvgpr_write_b32 a115, v18
v_accvgpr_read_b32 v18, a116
v_and_b32 v19, 0xffff0000, v18
v_lshlrev_b32 v18, 16, v18
v_mul_f32 v18, v18, v24
v_mul_f32 v19, v19, v24
v_cvt_pk_bf16_f32 v18, v18, v19
v_accvgpr_write_b32 a116, v18
v_accvgpr_read_b32 v18, a117
v_and_b32 v19, 0xffff0000, v18
v_lshlrev_b32 v18, 16, v18
v_mul_f32 v18, v18, v24
v_mul_f32 v19, v19, v24
v_cvt_pk_bf16_f32 v18, v18, v19
v_accvgpr_write_b32 a117, v18
v_accvgpr_read_b32 v18, a118
v_and_b32 v19, 0xffff0000, v18
v_lshlrev_b32 v18, 16, v18
v_mul_f32 v18, v18, v24
v_mul_f32 v19, v19, v24
v_cvt_pk_bf16_f32 v18, v18, v19
v_accvgpr_write_b32 a118, v18
v_accvgpr_read_b32 v18, a119
v_and_b32 v19, 0xffff0000, v18
v_lshlrev_b32 v18, 16, v18
v_mul_f32 v18, v18, v24
v_mul_f32 v19, v19, v24
v_cvt_pk_bf16_f32 v18, v18, v19
v_accvgpr_write_b32 a119, v18
v_accvgpr_read_b32 v18, a128
v_and_b32 v19, 0xffff0000, v18
v_lshlrev_b32 v18, 16, v18
v_mul_f32 v18, v18, v24
v_mul_f32 v19, v19, v24
v_cvt_pk_bf16_f32 v18, v18, v19
v_accvgpr_write_b32 a128, v18
v_accvgpr_read_b32 v18, a129
v_and_b32 v19, 0xffff0000, v18
v_lshlrev_b32 v18, 16, v18
v_mul_f32 v18, v18, v24
v_mul_f32 v19, v19, v24
v_cvt_pk_bf16_f32 v18, v18, v19
v_accvgpr_write_b32 a129, v18
v_accvgpr_read_b32 v18, a130
v_and_b32 v19, 0xffff0000, v18
v_lshlrev_b32 v18, 16, v18
v_mul_f32 v18, v18, v24
v_mul_f32 v19, v19, v24
v_cvt_pk_bf16_f32 v18, v18, v19
v_accvgpr_write_b32 a130, v18
v_accvgpr_read_b32 v18, a131
v_and_b32 v19, 0xffff0000, v18
v_lshlrev_b32 v18, 16, v18
v_mul_f32 v18, v18, v24
v_mul_f32 v19, v19, v24
v_cvt_pk_bf16_f32 v18, v18, v19
v_accvgpr_write_b32 a131, v18
v_accvgpr_read_b32 v18, a132
v_and_b32 v19, 0xffff0000, v18
v_lshlrev_b32 v18, 16, v18
v_mul_f32 v18, v18, v24
v_mul_f32 v19, v19, v24
v_cvt_pk_bf16_f32 v18, v18, v19
v_accvgpr_write_b32 a132, v18
v_accvgpr_read_b32 v18, a133
v_and_b32 v19, 0xffff0000, v18
v_lshlrev_b32 v18, 16, v18
v_mul_f32 v18, v18, v24
v_mul_f32 v19, v19, v24
v_cvt_pk_bf16_f32 v18, v18, v19
v_accvgpr_write_b32 a133, v18
v_accvgpr_read_b32 v18, a134
v_and_b32 v19, 0xffff0000, v18
v_lshlrev_b32 v18, 16, v18
v_mul_f32 v18, v18, v24
v_mul_f32 v19, v19, v24
v_cvt_pk_bf16_f32 v18, v18, v19
v_accvgpr_write_b32 a134, v18
v_accvgpr_read_b32 v18, a135
v_and_b32 v19, 0xffff0000, v18
v_lshlrev_b32 v18, 16, v18
v_mul_f32 v18, v18, v24
v_mul_f32 v19, v19, v24
v_cvt_pk_bf16_f32 v18, v18, v19
v_accvgpr_write_b32 a135, v18
v_accvgpr_read_b32 v18, a144
v_and_b32 v19, 0xffff0000, v18
v_lshlrev_b32 v18, 16, v18
v_mul_f32 v18, v18, v24
v_mul_f32 v19, v19, v24
v_cvt_pk_bf16_f32 v18, v18, v19
v_accvgpr_write_b32 a144, v18
v_accvgpr_read_b32 v18, a145
v_and_b32 v19, 0xffff0000, v18
v_lshlrev_b32 v18, 16, v18
v_mul_f32 v18, v18, v24
v_mul_f32 v19, v19, v24
v_cvt_pk_bf16_f32 v18, v18, v19
v_accvgpr_write_b32 a145, v18
v_accvgpr_read_b32 v18, a146
v_and_b32 v19, 0xffff0000, v18
v_lshlrev_b32 v18, 16, v18
v_mul_f32 v18, v18, v24
v_mul_f32 v19, v19, v24
v_cvt_pk_bf16_f32 v18, v18, v19
v_accvgpr_write_b32 a146, v18
v_accvgpr_read_b32 v18, a147
v_and_b32 v19, 0xffff0000, v18
v_lshlrev_b32 v18, 16, v18
v_mul_f32 v18, v18, v24
v_mul_f32 v19, v19, v24
v_cvt_pk_bf16_f32 v18, v18, v19
v_accvgpr_write_b32 a147, v18
v_accvgpr_read_b32 v18, a148
v_and_b32 v19, 0xffff0000, v18
v_lshlrev_b32 v18, 16, v18
v_mul_f32 v18, v18, v24
v_mul_f32 v19, v19, v24
v_cvt_pk_bf16_f32 v18, v18, v19
v_accvgpr_write_b32 a148, v18
v_accvgpr_read_b32 v18, a149
v_and_b32 v19, 0xffff0000, v18
v_lshlrev_b32 v18, 16, v18
v_mul_f32 v18, v18, v24
v_mul_f32 v19, v19, v24
v_cvt_pk_bf16_f32 v18, v18, v19
v_accvgpr_write_b32 a149, v18
v_accvgpr_read_b32 v18, a150
v_and_b32 v19, 0xffff0000, v18
v_lshlrev_b32 v18, 16, v18
v_mul_f32 v18, v18, v24
v_mul_f32 v19, v19, v24
v_cvt_pk_bf16_f32 v18, v18, v19
v_accvgpr_write_b32 a150, v18
v_accvgpr_read_b32 v18, a151
v_and_b32 v19, 0xffff0000, v18
v_lshlrev_b32 v18, 16, v18
v_mul_f32 v18, v18, v24
v_mul_f32 v19, v19, v24
v_cvt_pk_bf16_f32 v18, v18, v19
v_accvgpr_write_b32 a151, v18
v_accvgpr_read_b32 v18, a160
v_and_b32 v19, 0xffff0000, v18
v_lshlrev_b32 v18, 16, v18
v_mul_f32 v18, v18, v24
v_mul_f32 v19, v19, v24
v_cvt_pk_bf16_f32 v18, v18, v19
v_accvgpr_write_b32 a160, v18
v_accvgpr_read_b32 v18, a161
v_and_b32 v19, 0xffff0000, v18
v_lshlrev_b32 v18, 16, v18
v_mul_f32 v18, v18, v24
v_mul_f32 v19, v19, v24
v_cvt_pk_bf16_f32 v18, v18, v19
v_accvgpr_write_b32 a161, v18
v_accvgpr_read_b32 v18, a162
v_and_b32 v19, 0xffff0000, v18
v_lshlrev_b32 v18, 16, v18
v_mul_f32 v18, v18, v24
v_mul_f32 v19, v19, v24
v_cvt_pk_bf16_f32 v18, v18, v19
v_accvgpr_write_b32 a162, v18
v_accvgpr_read_b32 v18, a163
v_and_b32 v19, 0xffff0000, v18
v_lshlrev_b32 v18, 16, v18
v_mul_f32 v18, v18, v24
v_mul_f32 v19, v19, v24
v_cvt_pk_bf16_f32 v18, v18, v19
v_accvgpr_write_b32 a163, v18
v_accvgpr_read_b32 v18, a164
v_and_b32 v19, 0xffff0000, v18
v_lshlrev_b32 v18, 16, v18
v_mul_f32 v18, v18, v24
v_mul_f32 v19, v19, v24
v_cvt_pk_bf16_f32 v18, v18, v19
v_accvgpr_write_b32 a164, v18
v_accvgpr_read_b32 v18, a165
v_and_b32 v19, 0xffff0000, v18
v_lshlrev_b32 v18, 16, v18
v_mul_f32 v18, v18, v24
v_mul_f32 v19, v19, v24
v_cvt_pk_bf16_f32 v18, v18, v19
v_accvgpr_write_b32 a165, v18
v_accvgpr_read_b32 v18, a166
v_and_b32 v19, 0xffff0000, v18
v_lshlrev_b32 v18, 16, v18
v_mul_f32 v18, v18, v24
v_mul_f32 v19, v19, v24
v_cvt_pk_bf16_f32 v18, v18, v19
v_accvgpr_write_b32 a166, v18
v_accvgpr_read_b32 v18, a167
v_and_b32 v19, 0xffff0000, v18
v_lshlrev_b32 v18, 16, v18
v_mul_f32 v18, v18, v24
v_mul_f32 v19, v19, v24
v_cvt_pk_bf16_f32 v18, v18, v19
v_accvgpr_write_b32 a167, v18
v_accvgpr_read_b32 v18, a176
v_and_b32 v19, 0xffff0000, v18
v_lshlrev_b32 v18, 16, v18
v_mul_f32 v18, v18, v24
v_mul_f32 v19, v19, v24
v_cvt_pk_bf16_f32 v18, v18, v19
v_accvgpr_write_b32 a176, v18
v_accvgpr_read_b32 v18, a177
v_and_b32 v19, 0xffff0000, v18
v_lshlrev_b32 v18, 16, v18
v_mul_f32 v18, v18, v24
v_mul_f32 v19, v19, v24
v_cvt_pk_bf16_f32 v18, v18, v19
v_accvgpr_write_b32 a177, v18
v_accvgpr_read_b32 v18, a178
v_and_b32 v19, 0xffff0000, v18
v_lshlrev_b32 v18, 16, v18
v_mul_f32 v18, v18, v24
v_mul_f32 v19, v19, v24
v_cvt_pk_bf16_f32 v18, v18, v19
v_accvgpr_write_b32 a178, v18
v_accvgpr_read_b32 v18, a179
v_and_b32 v19, 0xffff0000, v18
v_lshlrev_b32 v18, 16, v18
v_mul_f32 v18, v18, v24
v_mul_f32 v19, v19, v24
v_cvt_pk_bf16_f32 v18, v18, v19
v_accvgpr_write_b32 a179, v18
v_accvgpr_read_b32 v18, a180
v_and_b32 v19, 0xffff0000, v18
v_lshlrev_b32 v18, 16, v18
v_mul_f32 v18, v18, v24
v_mul_f32 v19, v19, v24
v_cvt_pk_bf16_f32 v18, v18, v19
v_accvgpr_write_b32 a180, v18
v_accvgpr_read_b32 v18, a181
v_and_b32 v19, 0xffff0000, v18
v_lshlrev_b32 v18, 16, v18
v_mul_f32 v18, v18, v24
v_mul_f32 v19, v19, v24
v_cvt_pk_bf16_f32 v18, v18, v19
v_accvgpr_write_b32 a181, v18
v_accvgpr_read_b32 v18, a182
v_and_b32 v19, 0xffff0000, v18
v_lshlrev_b32 v18, 16, v18
v_mul_f32 v18, v18, v24
v_mul_f32 v19, v19, v24
v_cvt_pk_bf16_f32 v18, v18, v19
v_accvgpr_write_b32 a182, v18
v_accvgpr_read_b32 v18, a183
v_and_b32 v19, 0xffff0000, v18
v_lshlrev_b32 v18, 16, v18
v_mul_f32 v18, v18, v24
v_mul_f32 v19, v19, v24
v_cvt_pk_bf16_f32 v18, v18, v19
v_accvgpr_write_b32 a183, v18
v_accvgpr_read_b32 v18, a192
v_and_b32 v19, 0xffff0000, v18
v_lshlrev_b32 v18, 16, v18
v_mul_f32 v18, v18, v24
v_mul_f32 v19, v19, v24
v_cvt_pk_bf16_f32 v18, v18, v19
v_accvgpr_write_b32 a192, v18
v_accvgpr_read_b32 v18, a193
v_and_b32 v19, 0xffff0000, v18
v_lshlrev_b32 v18, 16, v18
v_mul_f32 v18, v18, v24
v_mul_f32 v19, v19, v24
v_cvt_pk_bf16_f32 v18, v18, v19
v_accvgpr_write_b32 a193, v18
v_accvgpr_read_b32 v18, a194
v_and_b32 v19, 0xffff0000, v18
v_lshlrev_b32 v18, 16, v18
v_mul_f32 v18, v18, v24
v_mul_f32 v19, v19, v24
v_cvt_pk_bf16_f32 v18, v18, v19
v_accvgpr_write_b32 a194, v18
v_accvgpr_read_b32 v18, a195
v_and_b32 v19, 0xffff0000, v18
v_lshlrev_b32 v18, 16, v18
v_mul_f32 v18, v18, v24
v_mul_f32 v19, v19, v24
v_cvt_pk_bf16_f32 v18, v18, v19
v_accvgpr_write_b32 a195, v18
v_accvgpr_read_b32 v18, a196
v_and_b32 v19, 0xffff0000, v18
v_lshlrev_b32 v18, 16, v18
v_mul_f32 v18, v18, v24
v_mul_f32 v19, v19, v24
v_cvt_pk_bf16_f32 v18, v18, v19
v_accvgpr_write_b32 a196, v18
v_accvgpr_read_b32 v18, a197
v_and_b32 v19, 0xffff0000, v18
v_lshlrev_b32 v18, 16, v18
v_mul_f32 v18, v18, v24
v_mul_f32 v19, v19, v24
v_cvt_pk_bf16_f32 v18, v18, v19
v_accvgpr_write_b32 a197, v18
v_accvgpr_read_b32 v18, a198
v_and_b32 v19, 0xffff0000, v18
v_lshlrev_b32 v18, 16, v18
v_mul_f32 v18, v18, v24
v_mul_f32 v19, v19, v24
v_cvt_pk_bf16_f32 v18, v18, v19
v_accvgpr_write_b32 a198, v18
v_accvgpr_read_b32 v18, a199
v_and_b32 v19, 0xffff0000, v18
v_lshlrev_b32 v18, 16, v18
v_mul_f32 v18, v18, v24
v_mul_f32 v19, v19, v24
v_cvt_pk_bf16_f32 v18, v18, v19
v_accvgpr_write_b32 a199, v18
v_accvgpr_read_b32 v18, a208
v_and_b32 v19, 0xffff0000, v18
v_lshlrev_b32 v18, 16, v18
v_mul_f32 v18, v18, v24
v_mul_f32 v19, v19, v24
v_cvt_pk_bf16_f32 v18, v18, v19
v_accvgpr_write_b32 a208, v18
v_accvgpr_read_b32 v18, a209
v_and_b32 v19, 0xffff0000, v18
v_lshlrev_b32 v18, 16, v18
v_mul_f32 v18, v18, v24
v_mul_f32 v19, v19, v24
v_cvt_pk_bf16_f32 v18, v18, v19
v_accvgpr_write_b32 a209, v18
v_accvgpr_read_b32 v18, a210
v_and_b32 v19, 0xffff0000, v18
v_lshlrev_b32 v18, 16, v18
v_mul_f32 v18, v18, v24
v_mul_f32 v19, v19, v24
v_cvt_pk_bf16_f32 v18, v18, v19
v_accvgpr_write_b32 a210, v18
v_accvgpr_read_b32 v18, a211
v_and_b32 v19, 0xffff0000, v18
v_lshlrev_b32 v18, 16, v18
v_mul_f32 v18, v18, v24
v_mul_f32 v19, v19, v24
v_cvt_pk_bf16_f32 v18, v18, v19
v_accvgpr_write_b32 a211, v18
v_accvgpr_read_b32 v18, a212
v_and_b32 v19, 0xffff0000, v18
v_lshlrev_b32 v18, 16, v18
v_mul_f32 v18, v18, v24
v_mul_f32 v19, v19, v24
v_cvt_pk_bf16_f32 v18, v18, v19
v_accvgpr_write_b32 a212, v18
v_accvgpr_read_b32 v18, a213
v_and_b32 v19, 0xffff0000, v18
v_lshlrev_b32 v18, 16, v18
v_mul_f32 v18, v18, v24
v_mul_f32 v19, v19, v24
v_cvt_pk_bf16_f32 v18, v18, v19
v_accvgpr_write_b32 a213, v18
v_accvgpr_read_b32 v18, a214
v_and_b32 v19, 0xffff0000, v18
v_lshlrev_b32 v18, 16, v18
v_mul_f32 v18, v18, v24
v_mul_f32 v19, v19, v24
v_cvt_pk_bf16_f32 v18, v18, v19
v_accvgpr_write_b32 a214, v18
v_accvgpr_read_b32 v18, a215
v_and_b32 v19, 0xffff0000, v18
v_lshlrev_b32 v18, 16, v18
v_mul_f32 v18, v18, v24
v_mul_f32 v19, v19, v24
v_cvt_pk_bf16_f32 v18, v18, v19
v_accvgpr_write_b32 a215, v18
v_accvgpr_read_b32 v18, a224
v_and_b32 v19, 0xffff0000, v18
v_lshlrev_b32 v18, 16, v18
v_mul_f32 v18, v18, v24
v_mul_f32 v19, v19, v24
v_cvt_pk_bf16_f32 v18, v18, v19
v_accvgpr_write_b32 a224, v18
v_accvgpr_read_b32 v18, a225
v_and_b32 v19, 0xffff0000, v18
v_lshlrev_b32 v18, 16, v18
v_mul_f32 v18, v18, v24
v_mul_f32 v19, v19, v24
v_cvt_pk_bf16_f32 v18, v18, v19
v_accvgpr_write_b32 a225, v18
v_accvgpr_read_b32 v18, a226
v_and_b32 v19, 0xffff0000, v18
v_lshlrev_b32 v18, 16, v18
v_mul_f32 v18, v18, v24
v_mul_f32 v19, v19, v24
v_cvt_pk_bf16_f32 v18, v18, v19
v_accvgpr_write_b32 a226, v18
v_accvgpr_read_b32 v18, a227
v_and_b32 v19, 0xffff0000, v18
v_lshlrev_b32 v18, 16, v18
v_mul_f32 v18, v18, v24
v_mul_f32 v19, v19, v24
v_cvt_pk_bf16_f32 v18, v18, v19
v_accvgpr_write_b32 a227, v18
v_accvgpr_read_b32 v18, a228
v_and_b32 v19, 0xffff0000, v18
v_lshlrev_b32 v18, 16, v18
v_mul_f32 v18, v18, v24
v_mul_f32 v19, v19, v24
v_cvt_pk_bf16_f32 v18, v18, v19
v_accvgpr_write_b32 a228, v18
v_accvgpr_read_b32 v18, a229
v_and_b32 v19, 0xffff0000, v18
v_lshlrev_b32 v18, 16, v18
v_mul_f32 v18, v18, v24
v_mul_f32 v19, v19, v24
v_cvt_pk_bf16_f32 v18, v18, v19
v_accvgpr_write_b32 a229, v18
v_accvgpr_read_b32 v18, a230
v_and_b32 v19, 0xffff0000, v18
v_lshlrev_b32 v18, 16, v18
v_mul_f32 v18, v18, v24
v_mul_f32 v19, v19, v24
v_cvt_pk_bf16_f32 v18, v18, v19
v_accvgpr_write_b32 a230, v18
v_accvgpr_read_b32 v18, a231
v_and_b32 v19, 0xffff0000, v18
v_lshlrev_b32 v18, 16, v18
v_mul_f32 v18, v18, v24
v_mul_f32 v19, v19, v24
v_cvt_pk_bf16_f32 v18, v18, v19
v_accvgpr_write_b32 a231, v18
v_exp_f32 v18, v192
v_exp_f32 v19, v193
s_nop 0
v_cvt_pk_bf16_f32 v192, v18, v19
v_add_f32 v16, v18, v19
v_exp_f32 v20, v194
v_exp_f32 v21, v195
v_add_f32 v16, v16, v20
v_cvt_pk_bf16_f32 v193, v20, v21
v_add_f32 v16, v16, v21
v_exp_f32 v18, v196
v_exp_f32 v19, v197
v_add_f32 v16, v16, v18
v_cvt_pk_bf16_f32 v194, v18, v19
v_add_f32 v16, v16, v19
v_exp_f32 v20, v198
v_exp_f32 v21, v199
v_add_f32 v16, v16, v20
v_cvt_pk_bf16_f32 v195, v20, v21
v_add_f32 v16, v16, v21
v_exp_f32 v18, v200
v_exp_f32 v19, v201
v_add_f32 v16, v16, v18
v_cvt_pk_bf16_f32 v196, v18, v19
v_add_f32 v16, v16, v19
v_exp_f32 v20, v202
v_exp_f32 v21, v203
v_add_f32 v16, v16, v20
v_cvt_pk_bf16_f32 v197, v20, v21
v_add_f32 v16, v16, v21
v_exp_f32 v18, v204
v_exp_f32 v19, v205
v_add_f32 v16, v16, v18
v_cvt_pk_bf16_f32 v198, v18, v19
v_add_f32 v16, v16, v19
v_exp_f32 v20, v206
v_exp_f32 v21, v207
v_add_f32 v16, v16, v20
v_cvt_pk_bf16_f32 v199, v20, v21
v_add_f32 v16, v16, v21
v_max3_f32 v22, v208, v209, v210
v_max3_f32 v22, v22, v211, v212
v_max3_f32 v22, v22, v213, v214
v_max3_f32 v22, v22, v215, v216
v_max3_f32 v22, v22, v217, v218
v_max3_f32 v22, v22, v219, v220
v_max3_f32 v22, v22, v221, v222
v_max_f32 v22, v22, v223
v_mov_b32 v23, v22
s_nop 1
v_permlane32_swap_b32 v22, v23
v_max_f32 v22, v22, v23
v_max_f32 v22, 0, v22
v_ceil_f32 v22, v22
v_sub_f32 v23, 0, v22
v_exp_f32 v25, v23
v_sub_f32 v176, v176, v22
v_sub_f32 v177, v177, v22
v_sub_f32 v178, v178, v22
v_sub_f32 v179, v179, v22
v_sub_f32 v180, v180, v22
v_sub_f32 v181, v181, v22
v_sub_f32 v182, v182, v22
v_sub_f32 v183, v183, v22
v_sub_f32 v184, v184, v22
v_sub_f32 v185, v185, v22
v_sub_f32 v186, v186, v22
v_sub_f32 v187, v187, v22
v_sub_f32 v188, v188, v22
v_sub_f32 v189, v189, v22
v_sub_f32 v190, v190, v22
v_sub_f32 v191, v191, v22
v_sub_f32 v208, v208, v22
v_sub_f32 v209, v209, v22
v_sub_f32 v210, v210, v22
v_sub_f32 v211, v211, v22
v_sub_f32 v212, v212, v22
v_sub_f32 v213, v213, v22
v_sub_f32 v214, v214, v22
v_sub_f32 v215, v215, v22
v_sub_f32 v216, v216, v22
v_sub_f32 v217, v217, v22
v_sub_f32 v218, v218, v22
v_sub_f32 v219, v219, v22
v_sub_f32 v220, v220, v22
v_sub_f32 v221, v221, v22
v_sub_f32 v222, v222, v22
v_sub_f32 v223, v223, v22
v_sub_f32 v48, v48, v22
v_sub_f32 v49, v49, v22
v_sub_f32 v50, v50, v22
v_sub_f32 v51, v51, v22
v_sub_f32 v52, v52, v22
v_sub_f32 v53, v53, v22
v_sub_f32 v54, v54, v22
v_sub_f32 v55, v55, v22
v_sub_f32 v56, v56, v22
v_sub_f32 v57, v57, v22
v_sub_f32 v58, v58, v22
v_sub_f32 v59, v59, v22
v_sub_f32 v60, v60, v22
v_sub_f32 v61, v61, v22
v_sub_f32 v62, v62, v22
v_sub_f32 v63, v63, v22
v_mul_f32 v15, v15, v25
v_accvgpr_read_b32 v18, a8
v_and_b32 v19, 0xffff0000, v18
v_lshlrev_b32 v18, 16, v18
v_mul_f32 v18, v18, v25
v_mul_f32 v19, v19, v25
v_cvt_pk_bf16_f32 v18, v18, v19
v_accvgpr_write_b32 a8, v18
v_accvgpr_read_b32 v18, a9
v_and_b32 v19, 0xffff0000, v18
v_lshlrev_b32 v18, 16, v18
v_mul_f32 v18, v18, v25
v_mul_f32 v19, v19, v25
v_cvt_pk_bf16_f32 v18, v18, v19
v_accvgpr_write_b32 a9, v18
v_accvgpr_read_b32 v18, a10
v_and_b32 v19, 0xffff0000, v18
v_lshlrev_b32 v18, 16, v18
v_mul_f32 v18, v18, v25
v_mul_f32 v19, v19, v25
v_cvt_pk_bf16_f32 v18, v18, v19
v_accvgpr_write_b32 a10, v18
v_accvgpr_read_b32 v18, a11
v_and_b32 v19, 0xffff0000, v18
v_lshlrev_b32 v18, 16, v18
v_mul_f32 v18, v18, v25
v_mul_f32 v19, v19, v25
v_cvt_pk_bf16_f32 v18, v18, v19
v_accvgpr_write_b32 a11, v18
v_accvgpr_read_b32 v18, a12
v_and_b32 v19, 0xffff0000, v18
v_lshlrev_b32 v18, 16, v18
v_mul_f32 v18, v18, v25
v_mul_f32 v19, v19, v25
v_cvt_pk_bf16_f32 v18, v18, v19
v_accvgpr_write_b32 a12, v18
v_accvgpr_read_b32 v18, a13
v_and_b32 v19, 0xffff0000, v18
v_lshlrev_b32 v18, 16, v18
v_mul_f32 v18, v18, v25
v_mul_f32 v19, v19, v25
v_cvt_pk_bf16_f32 v18, v18, v19
v_accvgpr_write_b32 a13, v18
v_accvgpr_read_b32 v18, a14
v_and_b32 v19, 0xffff0000, v18
v_lshlrev_b32 v18, 16, v18
v_mul_f32 v18, v18, v25
v_mul_f32 v19, v19, v25
v_cvt_pk_bf16_f32 v18, v18, v19
v_accvgpr_write_b32 a14, v18
v_accvgpr_read_b32 v18, a15
v_and_b32 v19, 0xffff0000, v18
v_lshlrev_b32 v18, 16, v18
v_mul_f32 v18, v18, v25
v_mul_f32 v19, v19, v25
v_cvt_pk_bf16_f32 v18, v18, v19
v_accvgpr_write_b32 a15, v18
v_accvgpr_read_b32 v18, a24
v_and_b32 v19, 0xffff0000, v18
v_lshlrev_b32 v18, 16, v18
v_mul_f32 v18, v18, v25
v_mul_f32 v19, v19, v25
v_cvt_pk_bf16_f32 v18, v18, v19
v_accvgpr_write_b32 a24, v18
v_accvgpr_read_b32 v18, a25
v_and_b32 v19, 0xffff0000, v18
v_lshlrev_b32 v18, 16, v18
v_mul_f32 v18, v18, v25
v_mul_f32 v19, v19, v25
v_cvt_pk_bf16_f32 v18, v18, v19
v_accvgpr_write_b32 a25, v18
v_accvgpr_read_b32 v18, a26
v_and_b32 v19, 0xffff0000, v18
v_lshlrev_b32 v18, 16, v18
v_mul_f32 v18, v18, v25
v_mul_f32 v19, v19, v25
v_cvt_pk_bf16_f32 v18, v18, v19
v_accvgpr_write_b32 a26, v18
v_accvgpr_read_b32 v18, a27
v_and_b32 v19, 0xffff0000, v18
v_lshlrev_b32 v18, 16, v18
v_mul_f32 v18, v18, v25
v_mul_f32 v19, v19, v25
v_cvt_pk_bf16_f32 v18, v18, v19
v_accvgpr_write_b32 a27, v18
v_accvgpr_read_b32 v18, a28
v_and_b32 v19, 0xffff0000, v18
v_lshlrev_b32 v18, 16, v18
v_mul_f32 v18, v18, v25
v_mul_f32 v19, v19, v25
v_cvt_pk_bf16_f32 v18, v18, v19
v_accvgpr_write_b32 a28, v18
v_accvgpr_read_b32 v18, a29
v_and_b32 v19, 0xffff0000, v18
v_lshlrev_b32 v18, 16, v18
v_mul_f32 v18, v18, v25
v_mul_f32 v19, v19, v25
v_cvt_pk_bf16_f32 v18, v18, v19
v_accvgpr_write_b32 a29, v18
v_accvgpr_read_b32 v18, a30
v_and_b32 v19, 0xffff0000, v18
v_lshlrev_b32 v18, 16, v18
v_mul_f32 v18, v18, v25
v_mul_f32 v19, v19, v25
v_cvt_pk_bf16_f32 v18, v18, v19
v_accvgpr_write_b32 a30, v18
v_accvgpr_read_b32 v18, a31
v_and_b32 v19, 0xffff0000, v18
v_lshlrev_b32 v18, 16, v18
v_mul_f32 v18, v18, v25
v_mul_f32 v19, v19, v25
v_cvt_pk_bf16_f32 v18, v18, v19
v_accvgpr_write_b32 a31, v18
v_accvgpr_read_b32 v18, a40
v_and_b32 v19, 0xffff0000, v18
v_lshlrev_b32 v18, 16, v18
v_mul_f32 v18, v18, v25
v_mul_f32 v19, v19, v25
v_cvt_pk_bf16_f32 v18, v18, v19
v_accvgpr_write_b32 a40, v18
v_accvgpr_read_b32 v18, a41
v_and_b32 v19, 0xffff0000, v18
v_lshlrev_b32 v18, 16, v18
v_mul_f32 v18, v18, v25
v_mul_f32 v19, v19, v25
v_cvt_pk_bf16_f32 v18, v18, v19
v_accvgpr_write_b32 a41, v18
v_accvgpr_read_b32 v18, a42
v_and_b32 v19, 0xffff0000, v18
v_lshlrev_b32 v18, 16, v18
v_mul_f32 v18, v18, v25
v_mul_f32 v19, v19, v25
v_cvt_pk_bf16_f32 v18, v18, v19
v_accvgpr_write_b32 a42, v18
v_accvgpr_read_b32 v18, a43
v_and_b32 v19, 0xffff0000, v18
v_lshlrev_b32 v18, 16, v18
v_mul_f32 v18, v18, v25
v_mul_f32 v19, v19, v25
v_cvt_pk_bf16_f32 v18, v18, v19
v_accvgpr_write_b32 a43, v18
v_accvgpr_read_b32 v18, a44
v_and_b32 v19, 0xffff0000, v18
v_lshlrev_b32 v18, 16, v18
v_mul_f32 v18, v18, v25
v_mul_f32 v19, v19, v25
v_cvt_pk_bf16_f32 v18, v18, v19
v_accvgpr_write_b32 a44, v18
v_accvgpr_read_b32 v18, a45
v_and_b32 v19, 0xffff0000, v18
v_lshlrev_b32 v18, 16, v18
v_mul_f32 v18, v18, v25
v_mul_f32 v19, v19, v25
v_cvt_pk_bf16_f32 v18, v18, v19
v_accvgpr_write_b32 a45, v18
v_accvgpr_read_b32 v18, a46
v_and_b32 v19, 0xffff0000, v18
v_lshlrev_b32 v18, 16, v18
v_mul_f32 v18, v18, v25
v_mul_f32 v19, v19, v25
v_cvt_pk_bf16_f32 v18, v18, v19
v_accvgpr_write_b32 a46, v18
v_accvgpr_read_b32 v18, a47
v_and_b32 v19, 0xffff0000, v18
v_lshlrev_b32 v18, 16, v18
v_mul_f32 v18, v18, v25
v_mul_f32 v19, v19, v25
v_cvt_pk_bf16_f32 v18, v18, v19
v_accvgpr_write_b32 a47, v18
v_accvgpr_read_b32 v18, a56
v_and_b32 v19, 0xffff0000, v18
v_lshlrev_b32 v18, 16, v18
v_mul_f32 v18, v18, v25
v_mul_f32 v19, v19, v25
v_cvt_pk_bf16_f32 v18, v18, v19
v_accvgpr_write_b32 a56, v18
v_accvgpr_read_b32 v18, a57
v_and_b32 v19, 0xffff0000, v18
v_lshlrev_b32 v18, 16, v18
v_mul_f32 v18, v18, v25
v_mul_f32 v19, v19, v25
v_cvt_pk_bf16_f32 v18, v18, v19
v_accvgpr_write_b32 a57, v18
v_accvgpr_read_b32 v18, a58
v_and_b32 v19, 0xffff0000, v18
v_lshlrev_b32 v18, 16, v18
v_mul_f32 v18, v18, v25
v_mul_f32 v19, v19, v25
v_cvt_pk_bf16_f32 v18, v18, v19
v_accvgpr_write_b32 a58, v18
v_accvgpr_read_b32 v18, a59
v_and_b32 v19, 0xffff0000, v18
v_lshlrev_b32 v18, 16, v18
v_mul_f32 v18, v18, v25
v_mul_f32 v19, v19, v25
v_cvt_pk_bf16_f32 v18, v18, v19
v_accvgpr_write_b32 a59, v18
v_accvgpr_read_b32 v18, a60
v_and_b32 v19, 0xffff0000, v18
v_lshlrev_b32 v18, 16, v18
v_mul_f32 v18, v18, v25
v_mul_f32 v19, v19, v25
v_cvt_pk_bf16_f32 v18, v18, v19
v_accvgpr_write_b32 a60, v18
v_accvgpr_read_b32 v18, a61
v_and_b32 v19, 0xffff0000, v18
v_lshlrev_b32 v18, 16, v18
v_mul_f32 v18, v18, v25
v_mul_f32 v19, v19, v25
v_cvt_pk_bf16_f32 v18, v18, v19
v_accvgpr_write_b32 a61, v18
v_accvgpr_read_b32 v18, a62
v_and_b32 v19, 0xffff0000, v18
v_lshlrev_b32 v18, 16, v18
v_mul_f32 v18, v18, v25
v_mul_f32 v19, v19, v25
v_cvt_pk_bf16_f32 v18, v18, v19
v_accvgpr_write_b32 a62, v18
v_accvgpr_read_b32 v18, a63
v_and_b32 v19, 0xffff0000, v18
v_lshlrev_b32 v18, 16, v18
v_mul_f32 v18, v18, v25
v_mul_f32 v19, v19, v25
v_cvt_pk_bf16_f32 v18, v18, v19
v_accvgpr_write_b32 a63, v18
v_accvgpr_read_b32 v18, a72
v_and_b32 v19, 0xffff0000, v18
v_lshlrev_b32 v18, 16, v18
v_mul_f32 v18, v18, v25
v_mul_f32 v19, v19, v25
v_cvt_pk_bf16_f32 v18, v18, v19
v_accvgpr_write_b32 a72, v18
v_accvgpr_read_b32 v18, a73
v_and_b32 v19, 0xffff0000, v18
v_lshlrev_b32 v18, 16, v18
v_mul_f32 v18, v18, v25
v_mul_f32 v19, v19, v25
v_cvt_pk_bf16_f32 v18, v18, v19
v_accvgpr_write_b32 a73, v18
v_accvgpr_read_b32 v18, a74
v_and_b32 v19, 0xffff0000, v18
v_lshlrev_b32 v18, 16, v18
v_mul_f32 v18, v18, v25
v_mul_f32 v19, v19, v25
v_cvt_pk_bf16_f32 v18, v18, v19
v_accvgpr_write_b32 a74, v18
v_accvgpr_read_b32 v18, a75
v_and_b32 v19, 0xffff0000, v18
v_lshlrev_b32 v18, 16, v18
v_mul_f32 v18, v18, v25
v_mul_f32 v19, v19, v25
v_cvt_pk_bf16_f32 v18, v18, v19
v_accvgpr_write_b32 a75, v18
v_accvgpr_read_b32 v18, a76
v_and_b32 v19, 0xffff0000, v18
v_lshlrev_b32 v18, 16, v18
v_mul_f32 v18, v18, v25
v_mul_f32 v19, v19, v25
v_cvt_pk_bf16_f32 v18, v18, v19
v_accvgpr_write_b32 a76, v18
v_accvgpr_read_b32 v18, a77
v_and_b32 v19, 0xffff0000, v18
v_lshlrev_b32 v18, 16, v18
v_mul_f32 v18, v18, v25
v_mul_f32 v19, v19, v25
v_cvt_pk_bf16_f32 v18, v18, v19
v_accvgpr_write_b32 a77, v18
v_accvgpr_read_b32 v18, a78
v_and_b32 v19, 0xffff0000, v18
v_lshlrev_b32 v18, 16, v18
v_mul_f32 v18, v18, v25
v_mul_f32 v19, v19, v25
v_cvt_pk_bf16_f32 v18, v18, v19
v_accvgpr_write_b32 a78, v18
v_accvgpr_read_b32 v18, a79
v_and_b32 v19, 0xffff0000, v18
v_lshlrev_b32 v18, 16, v18
v_mul_f32 v18, v18, v25
v_mul_f32 v19, v19, v25
v_cvt_pk_bf16_f32 v18, v18, v19
v_accvgpr_write_b32 a79, v18
v_accvgpr_read_b32 v18, a88
v_and_b32 v19, 0xffff0000, v18
v_lshlrev_b32 v18, 16, v18
v_mul_f32 v18, v18, v25
v_mul_f32 v19, v19, v25
v_cvt_pk_bf16_f32 v18, v18, v19
v_accvgpr_write_b32 a88, v18
v_accvgpr_read_b32 v18, a89
v_and_b32 v19, 0xffff0000, v18
v_lshlrev_b32 v18, 16, v18
v_mul_f32 v18, v18, v25
v_mul_f32 v19, v19, v25
v_cvt_pk_bf16_f32 v18, v18, v19
v_accvgpr_write_b32 a89, v18
v_accvgpr_read_b32 v18, a90
v_and_b32 v19, 0xffff0000, v18
v_lshlrev_b32 v18, 16, v18
v_mul_f32 v18, v18, v25
v_mul_f32 v19, v19, v25
v_cvt_pk_bf16_f32 v18, v18, v19
v_accvgpr_write_b32 a90, v18
v_accvgpr_read_b32 v18, a91
v_and_b32 v19, 0xffff0000, v18
v_lshlrev_b32 v18, 16, v18
v_mul_f32 v18, v18, v25
v_mul_f32 v19, v19, v25
v_cvt_pk_bf16_f32 v18, v18, v19
v_accvgpr_write_b32 a91, v18
v_accvgpr_read_b32 v18, a92
v_and_b32 v19, 0xffff0000, v18
v_lshlrev_b32 v18, 16, v18
v_mul_f32 v18, v18, v25
v_mul_f32 v19, v19, v25
v_cvt_pk_bf16_f32 v18, v18, v19
v_accvgpr_write_b32 a92, v18
v_accvgpr_read_b32 v18, a93
v_and_b32 v19, 0xffff0000, v18
v_lshlrev_b32 v18, 16, v18
v_mul_f32 v18, v18, v25
v_mul_f32 v19, v19, v25
v_cvt_pk_bf16_f32 v18, v18, v19
v_accvgpr_write_b32 a93, v18
v_accvgpr_read_b32 v18, a94
v_and_b32 v19, 0xffff0000, v18
v_lshlrev_b32 v18, 16, v18
v_mul_f32 v18, v18, v25
v_mul_f32 v19, v19, v25
v_cvt_pk_bf16_f32 v18, v18, v19
v_accvgpr_write_b32 a94, v18
v_accvgpr_read_b32 v18, a95
v_and_b32 v19, 0xffff0000, v18
v_lshlrev_b32 v18, 16, v18
v_mul_f32 v18, v18, v25
v_mul_f32 v19, v19, v25
v_cvt_pk_bf16_f32 v18, v18, v19
v_accvgpr_write_b32 a95, v18
v_accvgpr_read_b32 v18, a104
v_and_b32 v19, 0xffff0000, v18
v_lshlrev_b32 v18, 16, v18
v_mul_f32 v18, v18, v25
v_mul_f32 v19, v19, v25
v_cvt_pk_bf16_f32 v18, v18, v19
v_accvgpr_write_b32 a104, v18
v_accvgpr_read_b32 v18, a105
v_and_b32 v19, 0xffff0000, v18
v_lshlrev_b32 v18, 16, v18
v_mul_f32 v18, v18, v25
v_mul_f32 v19, v19, v25
v_cvt_pk_bf16_f32 v18, v18, v19
v_accvgpr_write_b32 a105, v18
v_accvgpr_read_b32 v18, a106
v_and_b32 v19, 0xffff0000, v18
v_lshlrev_b32 v18, 16, v18
v_mul_f32 v18, v18, v25
v_mul_f32 v19, v19, v25
v_cvt_pk_bf16_f32 v18, v18, v19
v_accvgpr_write_b32 a106, v18
v_accvgpr_read_b32 v18, a107
v_and_b32 v19, 0xffff0000, v18
v_lshlrev_b32 v18, 16, v18
v_mul_f32 v18, v18, v25
v_mul_f32 v19, v19, v25
v_cvt_pk_bf16_f32 v18, v18, v19
v_accvgpr_write_b32 a107, v18
v_accvgpr_read_b32 v18, a108
v_and_b32 v19, 0xffff0000, v18
v_lshlrev_b32 v18, 16, v18
v_mul_f32 v18, v18, v25
v_mul_f32 v19, v19, v25
v_cvt_pk_bf16_f32 v18, v18, v19
v_accvgpr_write_b32 a108, v18
v_accvgpr_read_b32 v18, a109
v_and_b32 v19, 0xffff0000, v18
v_lshlrev_b32 v18, 16, v18
v_mul_f32 v18, v18, v25
v_mul_f32 v19, v19, v25
v_cvt_pk_bf16_f32 v18, v18, v19
v_accvgpr_write_b32 a109, v18
v_accvgpr_read_b32 v18, a110
v_and_b32 v19, 0xffff0000, v18
v_lshlrev_b32 v18, 16, v18
v_mul_f32 v18, v18, v25
v_mul_f32 v19, v19, v25
v_cvt_pk_bf16_f32 v18, v18, v19
v_accvgpr_write_b32 a110, v18
v_accvgpr_read_b32 v18, a111
v_and_b32 v19, 0xffff0000, v18
v_lshlrev_b32 v18, 16, v18
v_mul_f32 v18, v18, v25
v_mul_f32 v19, v19, v25
v_cvt_pk_bf16_f32 v18, v18, v19
v_accvgpr_write_b32 a111, v18
v_accvgpr_read_b32 v18, a120
v_and_b32 v19, 0xffff0000, v18
v_lshlrev_b32 v18, 16, v18
v_mul_f32 v18, v18, v25
v_mul_f32 v19, v19, v25
v_cvt_pk_bf16_f32 v18, v18, v19
v_accvgpr_write_b32 a120, v18
v_accvgpr_read_b32 v18, a121
v_and_b32 v19, 0xffff0000, v18
v_lshlrev_b32 v18, 16, v18
v_mul_f32 v18, v18, v25
v_mul_f32 v19, v19, v25
v_cvt_pk_bf16_f32 v18, v18, v19
v_accvgpr_write_b32 a121, v18
v_accvgpr_read_b32 v18, a122
v_and_b32 v19, 0xffff0000, v18
v_lshlrev_b32 v18, 16, v18
v_mul_f32 v18, v18, v25
v_mul_f32 v19, v19, v25
v_cvt_pk_bf16_f32 v18, v18, v19
v_accvgpr_write_b32 a122, v18
v_accvgpr_read_b32 v18, a123
v_and_b32 v19, 0xffff0000, v18
v_lshlrev_b32 v18, 16, v18
v_mul_f32 v18, v18, v25
v_mul_f32 v19, v19, v25
v_cvt_pk_bf16_f32 v18, v18, v19
v_accvgpr_write_b32 a123, v18
v_accvgpr_read_b32 v18, a124
v_and_b32 v19, 0xffff0000, v18
v_lshlrev_b32 v18, 16, v18
v_mul_f32 v18, v18, v25
v_mul_f32 v19, v19, v25
v_cvt_pk_bf16_f32 v18, v18, v19
v_accvgpr_write_b32 a124, v18
v_accvgpr_read_b32 v18, a125
v_and_b32 v19, 0xffff0000, v18
v_lshlrev_b32 v18, 16, v18
v_mul_f32 v18, v18, v25
v_mul_f32 v19, v19, v25
v_cvt_pk_bf16_f32 v18, v18, v19
v_accvgpr_write_b32 a125, v18
v_accvgpr_read_b32 v18, a126
v_and_b32 v19, 0xffff0000, v18
v_lshlrev_b32 v18, 16, v18
v_mul_f32 v18, v18, v25
v_mul_f32 v19, v19, v25
v_cvt_pk_bf16_f32 v18, v18, v19
v_accvgpr_write_b32 a126, v18
v_accvgpr_read_b32 v18, a127
v_and_b32 v19, 0xffff0000, v18
v_lshlrev_b32 v18, 16, v18
v_mul_f32 v18, v18, v25
v_mul_f32 v19, v19, v25
v_cvt_pk_bf16_f32 v18, v18, v19
v_accvgpr_write_b32 a127, v18
v_accvgpr_read_b32 v18, a136
v_and_b32 v19, 0xffff0000, v18
v_lshlrev_b32 v18, 16, v18
v_mul_f32 v18, v18, v25
v_mul_f32 v19, v19, v25
v_cvt_pk_bf16_f32 v18, v18, v19
v_accvgpr_write_b32 a136, v18
v_accvgpr_read_b32 v18, a137
v_and_b32 v19, 0xffff0000, v18
v_lshlrev_b32 v18, 16, v18
v_mul_f32 v18, v18, v25
v_mul_f32 v19, v19, v25
v_cvt_pk_bf16_f32 v18, v18, v19
v_accvgpr_write_b32 a137, v18
v_accvgpr_read_b32 v18, a138
v_and_b32 v19, 0xffff0000, v18
v_lshlrev_b32 v18, 16, v18
v_mul_f32 v18, v18, v25
v_mul_f32 v19, v19, v25
v_cvt_pk_bf16_f32 v18, v18, v19
v_accvgpr_write_b32 a138, v18
v_accvgpr_read_b32 v18, a139
v_and_b32 v19, 0xffff0000, v18
v_lshlrev_b32 v18, 16, v18
v_mul_f32 v18, v18, v25
v_mul_f32 v19, v19, v25
v_cvt_pk_bf16_f32 v18, v18, v19
v_accvgpr_write_b32 a139, v18
v_accvgpr_read_b32 v18, a140
v_and_b32 v19, 0xffff0000, v18
v_lshlrev_b32 v18, 16, v18
v_mul_f32 v18, v18, v25
v_mul_f32 v19, v19, v25
v_cvt_pk_bf16_f32 v18, v18, v19
v_accvgpr_write_b32 a140, v18
v_accvgpr_read_b32 v18, a141
v_and_b32 v19, 0xffff0000, v18
v_lshlrev_b32 v18, 16, v18
v_mul_f32 v18, v18, v25
v_mul_f32 v19, v19, v25
v_cvt_pk_bf16_f32 v18, v18, v19
v_accvgpr_write_b32 a141, v18
v_accvgpr_read_b32 v18, a142
v_and_b32 v19, 0xffff0000, v18
v_lshlrev_b32 v18, 16, v18
v_mul_f32 v18, v18, v25
v_mul_f32 v19, v19, v25
v_cvt_pk_bf16_f32 v18, v18, v19
v_accvgpr_write_b32 a142, v18
v_accvgpr_read_b32 v18, a143
v_and_b32 v19, 0xffff0000, v18
v_lshlrev_b32 v18, 16, v18
v_mul_f32 v18, v18, v25
v_mul_f32 v19, v19, v25
v_cvt_pk_bf16_f32 v18, v18, v19
v_accvgpr_write_b32 a143, v18
v_accvgpr_read_b32 v18, a152
v_and_b32 v19, 0xffff0000, v18
v_lshlrev_b32 v18, 16, v18
v_mul_f32 v18, v18, v25
v_mul_f32 v19, v19, v25
v_cvt_pk_bf16_f32 v18, v18, v19
v_accvgpr_write_b32 a152, v18
v_accvgpr_read_b32 v18, a153
v_and_b32 v19, 0xffff0000, v18
v_lshlrev_b32 v18, 16, v18
v_mul_f32 v18, v18, v25
v_mul_f32 v19, v19, v25
v_cvt_pk_bf16_f32 v18, v18, v19
v_accvgpr_write_b32 a153, v18
v_accvgpr_read_b32 v18, a154
v_and_b32 v19, 0xffff0000, v18
v_lshlrev_b32 v18, 16, v18
v_mul_f32 v18, v18, v25
v_mul_f32 v19, v19, v25
v_cvt_pk_bf16_f32 v18, v18, v19
v_accvgpr_write_b32 a154, v18
v_accvgpr_read_b32 v18, a155
v_and_b32 v19, 0xffff0000, v18
v_lshlrev_b32 v18, 16, v18
v_mul_f32 v18, v18, v25
v_mul_f32 v19, v19, v25
v_cvt_pk_bf16_f32 v18, v18, v19
v_accvgpr_write_b32 a155, v18
v_accvgpr_read_b32 v18, a156
v_and_b32 v19, 0xffff0000, v18
v_lshlrev_b32 v18, 16, v18
v_mul_f32 v18, v18, v25
v_mul_f32 v19, v19, v25
v_cvt_pk_bf16_f32 v18, v18, v19
v_accvgpr_write_b32 a156, v18
v_accvgpr_read_b32 v18, a157
v_and_b32 v19, 0xffff0000, v18
v_lshlrev_b32 v18, 16, v18
v_mul_f32 v18, v18, v25
v_mul_f32 v19, v19, v25
v_cvt_pk_bf16_f32 v18, v18, v19
v_accvgpr_write_b32 a157, v18
v_accvgpr_read_b32 v18, a158
v_and_b32 v19, 0xffff0000, v18
v_lshlrev_b32 v18, 16, v18
v_mul_f32 v18, v18, v25
v_mul_f32 v19, v19, v25
v_cvt_pk_bf16_f32 v18, v18, v19
v_accvgpr_write_b32 a158, v18
v_accvgpr_read_b32 v18, a159
v_and_b32 v19, 0xffff0000, v18
v_lshlrev_b32 v18, 16, v18
v_mul_f32 v18, v18, v25
v_mul_f32 v19, v19, v25
v_cvt_pk_bf16_f32 v18, v18, v19
v_accvgpr_write_b32 a159, v18
v_accvgpr_read_b32 v18, a168
v_and_b32 v19, 0xffff0000, v18
v_lshlrev_b32 v18, 16, v18
v_mul_f32 v18, v18, v25
v_mul_f32 v19, v19, v25
v_cvt_pk_bf16_f32 v18, v18, v19
v_accvgpr_write_b32 a168, v18
v_accvgpr_read_b32 v18, a169
v_and_b32 v19, 0xffff0000, v18
v_lshlrev_b32 v18, 16, v18
v_mul_f32 v18, v18, v25
v_mul_f32 v19, v19, v25
v_cvt_pk_bf16_f32 v18, v18, v19
v_accvgpr_write_b32 a169, v18
v_accvgpr_read_b32 v18, a170
v_and_b32 v19, 0xffff0000, v18
v_lshlrev_b32 v18, 16, v18
v_mul_f32 v18, v18, v25
v_mul_f32 v19, v19, v25
v_cvt_pk_bf16_f32 v18, v18, v19
v_accvgpr_write_b32 a170, v18
v_accvgpr_read_b32 v18, a171
v_and_b32 v19, 0xffff0000, v18
v_lshlrev_b32 v18, 16, v18
v_mul_f32 v18, v18, v25
v_mul_f32 v19, v19, v25
v_cvt_pk_bf16_f32 v18, v18, v19
v_accvgpr_write_b32 a171, v18
v_accvgpr_read_b32 v18, a172
v_and_b32 v19, 0xffff0000, v18
v_lshlrev_b32 v18, 16, v18
v_mul_f32 v18, v18, v25
v_mul_f32 v19, v19, v25
v_cvt_pk_bf16_f32 v18, v18, v19
v_accvgpr_write_b32 a172, v18
v_accvgpr_read_b32 v18, a173
v_and_b32 v19, 0xffff0000, v18
v_lshlrev_b32 v18, 16, v18
v_mul_f32 v18, v18, v25
v_mul_f32 v19, v19, v25
v_cvt_pk_bf16_f32 v18, v18, v19
v_accvgpr_write_b32 a173, v18
v_accvgpr_read_b32 v18, a174
v_and_b32 v19, 0xffff0000, v18
v_lshlrev_b32 v18, 16, v18
v_mul_f32 v18, v18, v25
v_mul_f32 v19, v19, v25
v_cvt_pk_bf16_f32 v18, v18, v19
v_accvgpr_write_b32 a174, v18
v_accvgpr_read_b32 v18, a175
v_and_b32 v19, 0xffff0000, v18
v_lshlrev_b32 v18, 16, v18
v_mul_f32 v18, v18, v25
v_mul_f32 v19, v19, v25
v_cvt_pk_bf16_f32 v18, v18, v19
v_accvgpr_write_b32 a175, v18
v_accvgpr_read_b32 v18, a184
v_and_b32 v19, 0xffff0000, v18
v_lshlrev_b32 v18, 16, v18
v_mul_f32 v18, v18, v25
v_mul_f32 v19, v19, v25
v_cvt_pk_bf16_f32 v18, v18, v19
v_accvgpr_write_b32 a184, v18
v_accvgpr_read_b32 v18, a185
v_and_b32 v19, 0xffff0000, v18
v_lshlrev_b32 v18, 16, v18
v_mul_f32 v18, v18, v25
v_mul_f32 v19, v19, v25
v_cvt_pk_bf16_f32 v18, v18, v19
v_accvgpr_write_b32 a185, v18
v_accvgpr_read_b32 v18, a186
v_and_b32 v19, 0xffff0000, v18
v_lshlrev_b32 v18, 16, v18
v_mul_f32 v18, v18, v25
v_mul_f32 v19, v19, v25
v_cvt_pk_bf16_f32 v18, v18, v19
v_accvgpr_write_b32 a186, v18
v_accvgpr_read_b32 v18, a187
v_and_b32 v19, 0xffff0000, v18
v_lshlrev_b32 v18, 16, v18
v_mul_f32 v18, v18, v25
v_mul_f32 v19, v19, v25
v_cvt_pk_bf16_f32 v18, v18, v19
v_accvgpr_write_b32 a187, v18
v_accvgpr_read_b32 v18, a188
v_and_b32 v19, 0xffff0000, v18
v_lshlrev_b32 v18, 16, v18
v_mul_f32 v18, v18, v25
v_mul_f32 v19, v19, v25
v_cvt_pk_bf16_f32 v18, v18, v19
v_accvgpr_write_b32 a188, v18
v_accvgpr_read_b32 v18, a189
v_and_b32 v19, 0xffff0000, v18
v_lshlrev_b32 v18, 16, v18
v_mul_f32 v18, v18, v25
v_mul_f32 v19, v19, v25
v_cvt_pk_bf16_f32 v18, v18, v19
v_accvgpr_write_b32 a189, v18
v_accvgpr_read_b32 v18, a190
v_and_b32 v19, 0xffff0000, v18
v_lshlrev_b32 v18, 16, v18
v_mul_f32 v18, v18, v25
v_mul_f32 v19, v19, v25
v_cvt_pk_bf16_f32 v18, v18, v19
v_accvgpr_write_b32 a190, v18
v_accvgpr_read_b32 v18, a191
v_and_b32 v19, 0xffff0000, v18
v_lshlrev_b32 v18, 16, v18
v_mul_f32 v18, v18, v25
v_mul_f32 v19, v19, v25
v_cvt_pk_bf16_f32 v18, v18, v19
v_accvgpr_write_b32 a191, v18
v_accvgpr_read_b32 v18, a200
v_and_b32 v19, 0xffff0000, v18
v_lshlrev_b32 v18, 16, v18
v_mul_f32 v18, v18, v25
v_mul_f32 v19, v19, v25
v_cvt_pk_bf16_f32 v18, v18, v19
v_accvgpr_write_b32 a200, v18
v_accvgpr_read_b32 v18, a201
v_and_b32 v19, 0xffff0000, v18
v_lshlrev_b32 v18, 16, v18
v_mul_f32 v18, v18, v25
v_mul_f32 v19, v19, v25
v_cvt_pk_bf16_f32 v18, v18, v19
v_accvgpr_write_b32 a201, v18
v_accvgpr_read_b32 v18, a202
v_and_b32 v19, 0xffff0000, v18
v_lshlrev_b32 v18, 16, v18
v_mul_f32 v18, v18, v25
v_mul_f32 v19, v19, v25
v_cvt_pk_bf16_f32 v18, v18, v19
v_accvgpr_write_b32 a202, v18
v_accvgpr_read_b32 v18, a203
v_and_b32 v19, 0xffff0000, v18
v_lshlrev_b32 v18, 16, v18
v_mul_f32 v18, v18, v25
v_mul_f32 v19, v19, v25
v_cvt_pk_bf16_f32 v18, v18, v19
v_accvgpr_write_b32 a203, v18
v_accvgpr_read_b32 v18, a204
v_and_b32 v19, 0xffff0000, v18
v_lshlrev_b32 v18, 16, v18
v_mul_f32 v18, v18, v25
v_mul_f32 v19, v19, v25
v_cvt_pk_bf16_f32 v18, v18, v19
v_accvgpr_write_b32 a204, v18
v_accvgpr_read_b32 v18, a205
v_and_b32 v19, 0xffff0000, v18
v_lshlrev_b32 v18, 16, v18
v_mul_f32 v18, v18, v25
v_mul_f32 v19, v19, v25
v_cvt_pk_bf16_f32 v18, v18, v19
v_accvgpr_write_b32 a205, v18
v_accvgpr_read_b32 v18, a206
v_and_b32 v19, 0xffff0000, v18
v_lshlrev_b32 v18, 16, v18
v_mul_f32 v18, v18, v25
v_mul_f32 v19, v19, v25
v_cvt_pk_bf16_f32 v18, v18, v19
v_accvgpr_write_b32 a206, v18
v_accvgpr_read_b32 v18, a207
v_and_b32 v19, 0xffff0000, v18
v_lshlrev_b32 v18, 16, v18
v_mul_f32 v18, v18, v25
v_mul_f32 v19, v19, v25
v_cvt_pk_bf16_f32 v18, v18, v19
v_accvgpr_write_b32 a207, v18
v_accvgpr_read_b32 v18, a216
v_and_b32 v19, 0xffff0000, v18
v_lshlrev_b32 v18, 16, v18
v_mul_f32 v18, v18, v25
v_mul_f32 v19, v19, v25
v_cvt_pk_bf16_f32 v18, v18, v19
v_accvgpr_write_b32 a216, v18
v_accvgpr_read_b32 v18, a217
v_and_b32 v19, 0xffff0000, v18
v_lshlrev_b32 v18, 16, v18
v_mul_f32 v18, v18, v25
v_mul_f32 v19, v19, v25
v_cvt_pk_bf16_f32 v18, v18, v19
v_accvgpr_write_b32 a217, v18
v_accvgpr_read_b32 v18, a218
v_and_b32 v19, 0xffff0000, v18
v_lshlrev_b32 v18, 16, v18
v_mul_f32 v18, v18, v25
v_mul_f32 v19, v19, v25
v_cvt_pk_bf16_f32 v18, v18, v19
v_accvgpr_write_b32 a218, v18
v_accvgpr_read_b32 v18, a219
v_and_b32 v19, 0xffff0000, v18
v_lshlrev_b32 v18, 16, v18
v_mul_f32 v18, v18, v25
v_mul_f32 v19, v19, v25
v_cvt_pk_bf16_f32 v18, v18, v19
v_accvgpr_write_b32 a219, v18
v_accvgpr_read_b32 v18, a220
v_and_b32 v19, 0xffff0000, v18
v_lshlrev_b32 v18, 16, v18
v_mul_f32 v18, v18, v25
v_mul_f32 v19, v19, v25
v_cvt_pk_bf16_f32 v18, v18, v19
v_accvgpr_write_b32 a220, v18
v_accvgpr_read_b32 v18, a221
v_and_b32 v19, 0xffff0000, v18
v_lshlrev_b32 v18, 16, v18
v_mul_f32 v18, v18, v25
v_mul_f32 v19, v19, v25
v_cvt_pk_bf16_f32 v18, v18, v19
v_accvgpr_write_b32 a221, v18
v_accvgpr_read_b32 v18, a222
v_and_b32 v19, 0xffff0000, v18
v_lshlrev_b32 v18, 16, v18
v_mul_f32 v18, v18, v25
v_mul_f32 v19, v19, v25
v_cvt_pk_bf16_f32 v18, v18, v19
v_accvgpr_write_b32 a222, v18
v_accvgpr_read_b32 v18, a223
v_and_b32 v19, 0xffff0000, v18
v_lshlrev_b32 v18, 16, v18
v_mul_f32 v18, v18, v25
v_mul_f32 v19, v19, v25
v_cvt_pk_bf16_f32 v18, v18, v19
v_accvgpr_write_b32 a223, v18
v_accvgpr_read_b32 v18, a232
v_and_b32 v19, 0xffff0000, v18
v_lshlrev_b32 v18, 16, v18
v_mul_f32 v18, v18, v25
v_mul_f32 v19, v19, v25
v_cvt_pk_bf16_f32 v18, v18, v19
v_accvgpr_write_b32 a232, v18
v_accvgpr_read_b32 v18, a233
v_and_b32 v19, 0xffff0000, v18
v_lshlrev_b32 v18, 16, v18
v_mul_f32 v18, v18, v25
v_mul_f32 v19, v19, v25
v_cvt_pk_bf16_f32 v18, v18, v19
v_accvgpr_write_b32 a233, v18
v_accvgpr_read_b32 v18, a234
v_and_b32 v19, 0xffff0000, v18
v_lshlrev_b32 v18, 16, v18
v_mul_f32 v18, v18, v25
v_mul_f32 v19, v19, v25
v_cvt_pk_bf16_f32 v18, v18, v19
v_accvgpr_write_b32 a234, v18
v_accvgpr_read_b32 v18, a235
v_and_b32 v19, 0xffff0000, v18
v_lshlrev_b32 v18, 16, v18
v_mul_f32 v18, v18, v25
v_mul_f32 v19, v19, v25
v_cvt_pk_bf16_f32 v18, v18, v19
v_accvgpr_write_b32 a235, v18
v_accvgpr_read_b32 v18, a236
v_and_b32 v19, 0xffff0000, v18
v_lshlrev_b32 v18, 16, v18
v_mul_f32 v18, v18, v25
v_mul_f32 v19, v19, v25
v_cvt_pk_bf16_f32 v18, v18, v19
v_accvgpr_write_b32 a236, v18
v_accvgpr_read_b32 v18, a237
v_and_b32 v19, 0xffff0000, v18
v_lshlrev_b32 v18, 16, v18
v_mul_f32 v18, v18, v25
v_mul_f32 v19, v19, v25
v_cvt_pk_bf16_f32 v18, v18, v19
v_accvgpr_write_b32 a237, v18
v_accvgpr_read_b32 v18, a238
v_and_b32 v19, 0xffff0000, v18
v_lshlrev_b32 v18, 16, v18
v_mul_f32 v18, v18, v25
v_mul_f32 v19, v19, v25
v_cvt_pk_bf16_f32 v18, v18, v19
v_accvgpr_write_b32 a238, v18
v_accvgpr_read_b32 v18, a239
v_and_b32 v19, 0xffff0000, v18
v_lshlrev_b32 v18, 16, v18
v_mul_f32 v18, v18, v25
v_mul_f32 v19, v19, v25
v_cvt_pk_bf16_f32 v18, v18, v19
v_accvgpr_write_b32 a239, v18
v_exp_f32 v18, v208
v_exp_f32 v19, v209
s_nop 0
v_cvt_pk_bf16_f32 v208, v18, v19
v_add_f32 v17, v18, v19
v_exp_f32 v20, v210
v_exp_f32 v21, v211
v_add_f32 v17, v17, v20
v_cvt_pk_bf16_f32 v209, v20, v21
v_add_f32 v17, v17, v21
v_exp_f32 v18, v212
v_exp_f32 v19, v213
v_add_f32 v17, v17, v18
v_cvt_pk_bf16_f32 v210, v18, v19
v_add_f32 v17, v17, v19
v_exp_f32 v20, v214
v_exp_f32 v21, v215
v_add_f32 v17, v17, v20
v_cvt_pk_bf16_f32 v211, v20, v21
v_add_f32 v17, v17, v21
v_exp_f32 v18, v216
v_exp_f32 v19, v217
v_add_f32 v17, v17, v18
v_cvt_pk_bf16_f32 v212, v18, v19
v_add_f32 v17, v17, v19
v_exp_f32 v20, v218
v_exp_f32 v21, v219
v_add_f32 v17, v17, v20
v_cvt_pk_bf16_f32 v213, v20, v21
v_add_f32 v17, v17, v21
v_exp_f32 v18, v220
v_exp_f32 v19, v221
v_add_f32 v17, v17, v18
v_cvt_pk_bf16_f32 v214, v18, v19
v_add_f32 v17, v17, v19
v_exp_f32 v20, v222
v_exp_f32 v21, v223
v_add_f32 v17, v17, v20
v_cvt_pk_bf16_f32 v215, v20, v21
v_add_f32 v17, v17, v21
s_cmp_eq_u32 s55, 1
s_cbranch_scc0 RN1
v_accvgpr_write_b32 a16, v192
v_accvgpr_write_b32 a17, v193
v_accvgpr_write_b32 a18, v194
v_accvgpr_write_b32 a19, v195
v_accvgpr_write_b32 a20, v196
v_accvgpr_write_b32 a21, v197
v_accvgpr_write_b32 a22, v198
v_accvgpr_write_b32 a23, v199
v_accvgpr_write_b32 a24, v208
v_accvgpr_write_b32 a25, v209
v_accvgpr_write_b32 a26, v210
v_accvgpr_write_b32 a27, v211
v_accvgpr_write_b32 a28, v212
v_accvgpr_write_b32 a29, v213
v_accvgpr_write_b32 a30, v214
v_accvgpr_write_b32 a31, v215
s_nop 3
s_branch RET1
RN1:
s_cmp_eq_u32 s55, 3
s_cbranch_scc0 RN3
v_accvgpr_write_b32 a48, v192
v_accvgpr_write_b32 a49, v193
v_accvgpr_write_b32 a50, v194
v_accvgpr_write_b32 a51, v195
v_accvgpr_write_b32 a52, v196
v_accvgpr_write_b32 a53, v197
v_accvgpr_write_b32 a54, v198
v_accvgpr_write_b32 a55, v199
v_accvgpr_write_b32 a56, v208
v_accvgpr_write_b32 a57, v209
v_accvgpr_write_b32 a58, v210
v_accvgpr_write_b32 a59, v211
v_accvgpr_write_b32 a60, v212
v_accvgpr_write_b32 a61, v213
v_accvgpr_write_b32 a62, v214
v_accvgpr_write_b32 a63, v215
s_nop 3
s_branch RET3
RN3:
s_cmp_eq_u32 s55, 5
s_cbranch_scc0 RN5
v_accvgpr_write_b32 a80, v192
v_accvgpr_write_b32 a81, v193
v_accvgpr_write_b32 a82, v194
v_accvgpr_write_b32 a83, v195
v_accvgpr_write_b32 a84, v196
v_accvgpr_write_b32 a85, v197
v_accvgpr_write_b32 a86, v198
v_accvgpr_write_b32 a87, v199
v_accvgpr_write_b32 a88, v208
v_accvgpr_write_b32 a89, v209
v_accvgpr_write_b32 a90, v210
v_accvgpr_write_b32 a91, v211
v_accvgpr_write_b32 a92, v212
v_accvgpr_write_b32 a93, v213
v_accvgpr_write_b32 a94, v214
v_accvgpr_write_b32 a95, v215
s_nop 3
s_branch RET5
RN5:
s_cmp_eq_u32 s55, 7
s_cbranch_scc0 RN7
v_accvgpr_write_b32 a112, v192
v_accvgpr_write_b32 a113, v193
v_accvgpr_write_b32 a114, v194
v_accvgpr_write_b32 a115, v195
v_accvgpr_write_b32 a116, v196
v_accvgpr_write_b32 a117, v197
v_accvgpr_write_b32 a118, v198
v_accvgpr_write_b32 a119, v199
v_accvgpr_write_b32 a120, v208
v_accvgpr_write_b32 a121, v209
v_accvgpr_write_b32 a122, v210
v_accvgpr_write_b32 a123, v211
v_accvgpr_write_b32 a124, v212
v_accvgpr_write_b32 a125, v213
v_accvgpr_write_b32 a126, v214
v_accvgpr_write_b32 a127, v215
s_nop 3
s_branch RET7
RN7:
s_cmp_eq_u32 s55, 9
s_cbranch_scc0 RN9
v_accvgpr_write_b32 a144, v192
v_accvgpr_write_b32 a145, v193
v_accvgpr_write_b32 a146, v194
v_accvgpr_write_b32 a147, v195
v_accvgpr_write_b32 a148, v196
v_accvgpr_write_b32 a149, v197
v_accvgpr_write_b32 a150, v198
v_accvgpr_write_b32 a151, v199
v_accvgpr_write_b32 a152, v208
v_accvgpr_write_b32 a153, v209
v_accvgpr_write_b32 a154, v210
v_accvgpr_write_b32 a155, v211
v_accvgpr_write_b32 a156, v212
v_accvgpr_write_b32 a157, v213
v_accvgpr_write_b32 a158, v214
v_accvgpr_write_b32 a159, v215
s_nop 3
s_branch RET9
RN9:
s_cmp_eq_u32 s55, 11
s_cbranch_scc0 RN11
v_accvgpr_write_b32 a176, v192
v_accvgpr_write_b32 a177, v193
v_accvgpr_write_b32 a178, v194
v_accvgpr_write_b32 a179, v195
v_accvgpr_write_b32 a180, v196
v_accvgpr_write_b32 a181, v197
v_accvgpr_write_b32 a182, v198
v_accvgpr_write_b32 a183, v199
v_accvgpr_write_b32 a184, v208
v_accvgpr_write_b32 a185, v209
v_accvgpr_write_b32 a186, v210
v_accvgpr_write_b32 a187, v211
v_accvgpr_write_b32 a188, v212
v_accvgpr_write_b32 a189, v213
v_accvgpr_write_b32 a190, v214
v_accvgpr_write_b32 a191, v215
s_nop 3
s_branch RET11
RN11:
s_cmp_eq_u32 s55, 13
s_cbranch_scc0 RN13
v_accvgpr_write_b32 a208, v192
v_accvgpr_write_b32 a209, v193
v_accvgpr_write_b32 a210, v194
v_accvgpr_write_b32 a211, v195
v_accvgpr_write_b32 a212, v196
v_accvgpr_write_b32 a213, v197
v_accvgpr_write_b32 a214, v198
v_accvgpr_write_b32 a215, v199
v_accvgpr_write_b32 a216, v208
v_accvgpr_write_b32 a217, v209
v_accvgpr_write_b32 a218, v210
v_accvgpr_write_b32 a219, v211
v_accvgpr_write_b32 a220, v212
v_accvgpr_write_b32 a221, v213
v_accvgpr_write_b32 a222, v214
v_accvgpr_write_b32 a223, v215
s_nop 3
s_branch RET13
RN13:
v_accvgpr_write_b32 a240, v192
v_accvgpr_write_b32 a241, v193
v_accvgpr_write_b32 a242, v194
v_accvgpr_write_b32 a243, v195
v_accvgpr_write_b32 a244, v196
v_accvgpr_write_b32 a245, v197
v_accvgpr_write_b32 a246, v198
v_accvgpr_write_b32 a247, v199
v_accvgpr_write_b32 a248, v208
v_accvgpr_write_b32 a249, v209
v_accvgpr_write_b32 a250, v210
v_accvgpr_write_b32 a251, v211
v_accvgpr_write_b32 a252, v212
v_accvgpr_write_b32 a253, v213
v_accvgpr_write_b32 a254, v214
v_accvgpr_write_b32 a255, v215
v_mul_f32 v64, v64, v24
v_mul_f32 v65, v65, v24
v_mul_f32 v66, v66, v24
v_mul_f32 v67, v67, v24
v_mul_f32 v68, v68, v24
v_mul_f32 v69, v69, v24
v_mul_f32 v70, v70, v24
v_mul_f32 v71, v71, v24
v_mul_f32 v72, v72, v24
v_mul_f32 v73, v73, v24
v_mul_f32 v74, v74, v24
v_mul_f32 v75, v75, v24
v_mul_f32 v76, v76, v24
v_mul_f32 v77, v77, v24
v_mul_f32 v78, v78, v24
v_mul_f32 v79, v79, v24
v_mul_f32 v80, v80, v24
v_mul_f32 v81, v81, v24
v_mul_f32 v82, v82, v24
v_mul_f32 v83, v83, v24
v_mul_f32 v84, v84, v24
v_mul_f32 v85, v85, v24
v_mul_f32 v86, v86, v24
v_mul_f32 v87, v87, v24
v_mul_f32 v88, v88, v24
v_mul_f32 v89, v89, v24
v_mul_f32 v90, v90, v24
v_mul_f32 v91, v91, v24
v_mul_f32 v92, v92, v24
v_mul_f32 v93, v93, v24
v_mul_f32 v94, v94, v24
v_mul_f32 v95, v95, v24
v_mul_f32 v96, v96, v25
v_mul_f32 v97, v97, v25
v_mul_f32 v98, v98, v25
v_mul_f32 v99, v99, v25
v_mul_f32 v100, v100, v25
v_mul_f32 v101, v101, v25
v_mul_f32 v102, v102, v25
v_mul_f32 v103, v103, v25
v_mul_f32 v104, v104, v25
v_mul_f32 v105, v105, v25
v_mul_f32 v106, v106, v25
v_mul_f32 v107, v107, v25
v_mul_f32 v108, v108, v25
v_mul_f32 v109, v109, v25
v_mul_f32 v110, v110, v25
v_mul_f32 v111, v111, v25
v_mul_f32 v112, v112, v25
v_mul_f32 v113, v113, v25
v_mul_f32 v114, v114, v25
v_mul_f32 v115, v115, v25
v_mul_f32 v116, v116, v25
v_mul_f32 v117, v117, v25
v_mul_f32 v118, v118, v25
v_mul_f32 v119, v119, v25
v_mul_f32 v120, v120, v25
v_mul_f32 v121, v121, v25
v_mul_f32 v122, v122, v25
v_mul_f32 v123, v123, v25
v_mul_f32 v124, v124, v25
v_mul_f32 v125, v125, v25
v_mul_f32 v126, v126, v25
v_mul_f32 v127, v127, v25
s_nop 3
s_branch RET15
.section .rodata,"a"
.p2align 6
.amdhsa_kernel recurrent_scan__sliding_block_cached__dense_activation_squared_relu__prompt_kernel
  .amdhsa_next_free_vgpr 512
  .amdhsa_next_free_sgpr 102
  .amdhsa_accum_offset 256
  .amdhsa_group_segment_fixed_size 0
  .amdhsa_kernarg_size 104
  .amdhsa_user_sgpr_count 2
  .amdhsa_user_sgpr_kernarg_segment_ptr 1
  .amdhsa_system_sgpr_workgroup_id_x 1
.end_amdhsa_kernel
```
